```python
import torch

def _softmax(x, axis=-1):
    return torch.softmax(x, dim=axis)

def _gelu(x):
    return torch.nn.functional.gelu(x, approximate='tanh')

def _silu(x):
    return torch.nn.functional.silu(x)

def _sigmoid(x):
    return torch.sigmoid(x)

def _layernorm(x, axis=-1, eps=1e-05):
    m = x.mean(dim=axis, keepdim=True)
    v = x.var(dim=axis, keepdim=True, unbiased=False)
    return (x - m) / torch.sqrt(v + eps)

def _scatter_add(tgt, idx, src, axis=0):
    return tgt.clone().index_add_(axis, idx, src)

def _segment_sum(src, seg, n):
    out = torch.zeros((n,) + src.shape[1:], dtype=src.dtype)
    return out.index_add_(0, seg, src)

def _pad(x, pw):
    flat = tuple((v for pair in reversed(pw) for v in pair))
    return torch.nn.functional.pad(x, flat)
kernel_name = 'gated_mix__softmax_full_mha__memory_aug_recurrent_mem_tr__prompt'

def setup_inputs():

    _w = lambda a: (lambda t: t.to(torch.bfloat16) if t.is_floating_point() else t)(torch.as_tensor(a))

    def _A_setup():
        B, S, D = (1, 2048, 448)
        return {'x': _w((lambda *s: torch.randn(*s, dtype=torch.bfloat16) * 0.05)(B, S, D)), 'wqkv': _w((lambda *s: torch.randn(*s, dtype=torch.bfloat16) * 1.6)(D, 3 * D)), 'wo': _w((lambda *s: torch.randn(*s, dtype=torch.bfloat16) * 0.05)(D, D))}
    _A_in = _A_setup()

    def _B_setup():
        B, S, Dm = (1, 2048, 448)
        H, Dh = (16, 256)
        M, seg = (8, 32)
        seg = min(seg, S)
        S = S // seg * seg
        return {'x': _w((lambda *s: torch.randn(*s, dtype=torch.bfloat16) * 0.05)(B, S, Dm)), 'mem0': _w((lambda *s: torch.randn(*s, dtype=torch.bfloat16) * 1.6)(B, M, Dm)), 'Wq': _w((lambda *s: torch.randn(*s, dtype=torch.bfloat16) * 0.8)(Dm, H, Dh) * Dm ** (-0.5)), 'Wk': _w((lambda *s: torch.randn(*s, dtype=torch.bfloat16) * 0.8)(Dm, H, Dh) * Dm ** (-0.5)), 'Wv': _w((lambda *s: torch.randn(*s, dtype=torch.bfloat16) * 1.6)(Dm, H, Dh) * Dm ** (-0.5)), 'Wo': _w((lambda *s: torch.randn(*s, dtype=torch.bfloat16) * 1.6)(H, Dh, Dm) * (H * Dh) ** (-0.5)), 'seg_len': seg}
    _B_in = _B_setup()
    return {'A_x': _A_in['x'], 'A_wqkv': _A_in['wqkv'], 'A_wo': _A_in['wo'], 'B_x': _B_in['x'], 'B_mem0': _B_in['mem0'], 'B_Wq': _B_in['Wq'], 'B_Wk': _B_in['Wk'], 'B_Wv': _B_in['Wv'], 'B_Wo': _B_in['Wo'], 'B_seg_len': _B_in['seg_len'], 'gate_w': _w((lambda *s: torch.randn(*s, dtype=torch.bfloat16) * 0.05)(448) * 16.0)}

def reference(A_x, A_wqkv, A_wo, B_x, B_mem0, B_Wq, B_Wk, B_Wv, B_Wo, B_seg_len, gate_w):

    def _A_ref(x, wqkv, wo):
        B, S, D = x.shape
        H = 16
        Dh = D // H
        qkv = (lambda x, *d: x.permute(*d))((x @ wqkv).reshape(B, S, 3, H, Dh), 2, 0, 3, 1, 4)
        q, k, v = (qkv[0], qkv[1], qkv[2])
        scale = Dh ** (-0.5)
        scores = torch.einsum('bhqd,bhkd->bhqk', q, k) * scale
        p = _softmax(scores, axis=-1)
        o = torch.einsum('bhqk,bhkd->bhqd', p, v)
        return (lambda x, *d: x.permute(*d))(o, 0, 2, 1, 3).reshape(B, S, D) @ wo

    def _B_ref(x, mem0, Wq, Wk, Wv, Wo, seg_len):
        B, S, Dm = x.shape
        H, Dh = (Wq.shape[1], Wq.shape[2])
        M = mem0.shape[1]
        scale = Dh ** (-0.5)
        n_seg = S // seg_len
        L = M + seg_len
        idx = torch.arange(L)
        mask = (idx[:, None] < M) | (idx[:, None] >= idx[None, :])
        mem = mem0
        outs = []
        for s in range(n_seg):
            xs = x[:, s * seg_len:(s + 1) * seg_len, :].clone()
            h = torch.concatenate([mem, xs], axis=1)
            q = torch.einsum('btd,dhe->bhte', h, Wq)
            k = torch.einsum('btd,dhe->bhte', h, Wk)
            v = torch.einsum('btd,dhe->bhte', h, Wv)
            scores = torch.einsum('bhqe,bhke->bhqk', q, k) * scale
            scores = torch.where(mask[None, None], scores, -1000000000.0)
            p = _softmax(scores, axis=-1)
            o = torch.einsum('bhqk,bhke->bhqe', p, v)
            o = torch.einsum('bhte,hed->btd', o, Wo)
            mem = o[:, :M, :].clone()
            outs.append(o[:, M:, :])
        return torch.concatenate(outs, axis=1)
    x = A_x
    g = _sigmoid((x * gate_w).sum(-1, keepdims=True))
    a = _A_ref(x, A_wqkv, A_wo)
    b = _B_ref(x, B_mem0, B_Wq, B_Wk, B_Wv, B_Wo, B_seg_len)
    return g * a + (1 - g) * b
```

```asm
; @launch grid=(256,1,1) block=(256,1,1) lds=163840
.amdgcn_target "amdgcn-amd-amdhsa--gfx950"
.text
.globl gated_mix__softmax_full_mha__memory_aug_recurrent_mem_tr__prompt_kernel
.p2align 8
.type gated_mix__softmax_full_mha__memory_aug_recurrent_mem_tr__prompt_kernel,@function
gated_mix__softmax_full_mha__memory_aug_recurrent_mem_tr__prompt_kernel:
    s_cmp_ge_u32 s2, 256
    s_cbranch_scc1 main_end
    s_load_dwordx16 s[40:55], s[0:1], 40
    s_load_dwordx2 s[56:57], s[0:1], 104
    s_load_dwordx2 s[58:59], s[0:1], 0
    s_load_dwordx2 s[60:61], s[0:1], 32
    s_getpc_b64 s[6:7]
main_pc:
    s_mov_b64 s[98:99], s[6:7]
    s_bfe_u32 s3, s2, 0x30003
    s_lshl_b32 s3, s3, 14
    v_lshlrev_b32 v3, 7, v0
    v_add_u32 v4, s3, v3
    v_cmp_gt_u32 vcc, 128, v0
    s_getreg_b32 s5, hwreg(HW_REG_XCC_ID, 0, 4)
    v_min_u32 v4, job_table_end-main_pc-4, v4
    v_cndmask_b32 v3, v4, v3, vcc
    global_load_dword v1, v3, s[6:7]
    s_xor_b32 s5, s5, 3
    v_lshrrev_b32 v3, 6, v0
    v_and_b32 v2, 63, v0
    v_readfirstlane_b32 s21, v3
    v_lshlrev_b32 v2, 4, v2
    s_and_b32 s24, s2, 7
    s_lshr_b32 s25, s2, 3
    s_cmp_ge_u32 s25, 28
    s_cbranch_scc1 prep_misc
    s_cmp_ge_u32 s25, 14
    s_cselect_b32 s26, 1, 0
    s_lshl1_add_u32 s22, s24, s26
    s_mul_i32 s26, s26, 14
    s_sub_u32 s25, s25, s26
    s_lshr_b32 s20, s25, 1
    s_and_b32 s65, s25, 1
    s_lshl2_add_u32 s19, s65, s20
    s_sub_u32 s3, s19, 7
    s_cselect_b32 s19, s19, s3
    s_lshl_b32 s25, s22, 9
    s_lshl_b32 s28, s21, 13
    s_add_u32 s31, s28, 0x20000
    v_bfe_u32 v3, v0, 5, 1
    v_and_b32 v4, 31, v0
    v_xor_b32 v5, v4, v3
    v_lshlrev_b32 v5, 4, v5
    v_lshl_add_u32 v5, v3, 13, v5
    v_xor_b32 v8, 0, v5
    v_xor_b32 v9, 32, v5
    v_xor_b32 v10, 64, v5
    v_xor_b32 v11, 96, v5
    v_xor_b32 v12, 128, v5
    v_xor_b32 v13, 160, v5
    v_xor_b32 v14, 192, v5
    v_xor_b32 v15, 224, v5
    s_lshl_b32 s3, s2, 12
    v_lshl_add_u32 v121, v0, 4, s3
    v_mov_b32 v123, v121
    v_mov_b32 v122, 2147483632
    v_subrev_u32 v120, 0, v123
    v_cmp_gt_u32 vcc, 7168, v120
    s_nop 1
    v_cndmask_b32 v121, v121, v122, vcc
    v_subrev_u32 v120, 458752, v123
    v_cmp_gt_u32 vcc, 7168, v120
    s_nop 1
    v_cndmask_b32 v121, v121, v122, vcc
    s_cmp_lt_u32 s2, 201
    s_cselect_b32 s3, 0, 2147483632
    v_or_b32 v121, s3, v121
    s_cmp_lt_u32 s2, 192
    s_cselect_b32 s3, -1, 0
    v_mov_b32 v124, s3
    v_mov_b32 v125, s3
    v_mov_b32 v126, s3
    v_mov_b32 v127, s3
    s_mov_b32 s3, 17825792
    v_bfe_u32 v6, v0, 5, 1
    v_mul_u32_u24 v24, 7168, v6
    v_bfe_u32 v6, v0, 3, 2
    v_mul_u32_u24 v6, 896, v6
    v_add_u32 v24, v6, v24
    v_bfe_u32 v6, v0, 4, 2
    v_and_b32 v25, 7, v0
    v_xor_b32 v6, v6, v25
    v_xor_b32 v26, 4, v6
    v_lshl_add_u32 v25, v26, 4, v24
    v_lshl_add_u32 v24, v6, 4, v24
    s_lshl_b32 s26, s22, 2
    s_add_u32 s26, s26, s21
    s_mul_i32 s26, s26, 57344
    s_lshl_b32 s27, s20, 7
    s_add_u32 s26, s26, s27
    s_waitcnt lgkmcnt(0)
    s_mov_b32 s8, s56
    s_mov_b32 s9, s57
    s_mov_b32 s10, 268435456
    s_mov_b32 s11, 0x20000
    buffer_store_dwordx4 v[124:127], v121, s[8:11], s3 offen sc1
    s_mov_b32 s36, s46
    s_mov_b32 s37, s47
    s_mov_b32 s38, 3670016
    s_mov_b32 s39, 0x20000
    s_add_u32 m0, s31, 0
    s_add_u32 s27, s26, 0
    buffer_load_dwordx4 v24, s[36:39], s27 offen lds
    s_add_u32 m0, s31, 1024
    s_add_u32 s27, s26, 3584
    buffer_load_dwordx4 v25, s[36:39], s27 offen lds
    s_add_u32 m0, s31, 2048
    s_add_u32 s27, s26, 14336
    buffer_load_dwordx4 v24, s[36:39], s27 offen lds
    s_add_u32 m0, s31, 3072
    s_add_u32 s27, s26, 17920
    buffer_load_dwordx4 v25, s[36:39], s27 offen lds
    s_add_u32 m0, s31, 4096
    s_add_u32 s27, s26, 28672
    buffer_load_dwordx4 v24, s[36:39], s27 offen lds
    s_add_u32 m0, s31, 5120
    s_add_u32 s27, s26, 32256
    buffer_load_dwordx4 v25, s[36:39], s27 offen lds
    s_add_u32 m0, s31, 6144
    s_add_u32 s27, s26, 43008
    buffer_load_dwordx4 v24, s[36:39], s27 offen lds
    s_add_u32 m0, s31, 7168
    s_add_u32 s27, s26, 46592
    buffer_load_dwordx4 v25, s[36:39], s27 offen lds
    s_waitcnt vmcnt(8)
    s_barrier
    s_mov_b32 s92, s54
    s_mov_b32 s93, s55
    s_mov_b32 s94, 256
    s_mov_b32 s95, 0x20000
    s_and_b32 s3, s5, 7
    s_lshl_b32 s3, s3, 2
    s_lshr_b32 s4, s5, 3
    s_lshl1_add_u32 s3, s4, s3
    s_lshl_b32 s3, s3, 3
    s_cmp_eq_u32 s21, 0
    s_cselect_b32 s3, s3, 256
    v_mov_b32 v40, 1
    v_mov_b32 v41, s3
    s_mov_b64 exec, 1
    buffer_atomic_add v40, v41, s[92:95], 0 offen sc0 sc1
    s_mov_b64 exec, -1
    v_bfe_u32 v43, v0, 0, 3
    v_lshlrev_b32 v42, 5, v43
    v_bfe_u32 v43, v0, 3, 1
    v_lshl_add_u32 v42, v43, 4, v42
    s_mov_b32 s12, s44
    s_mov_b32 s13, s45
    s_mov_b32 s14, 3670016
    s_mov_b32 s15, 0x20000
    s_lshl_b32 s33, s21, 17
    s_add_u32 s33, s33, s25
    s_lshl_b32 s32, s19, 19
    s_add_u32 s32, s32, s33
    s_add_u32 m0, s28, 0
    s_add_u32 s27, s32, 0
    buffer_load_dwordx4 v8, s[12:15], s27 offen offset:0 lds
    s_add_u32 s27, s32, 64512
    buffer_load_dwordx4 v9, s[12:15], s27 offen offset:1024 lds
    s_add_u32 s27, s32, 30720
    buffer_load_dwordx4 v10, s[12:15], s27 offen offset:2048 lds
    s_add_u32 s27, s32, 95232
    buffer_load_dwordx4 v11, s[12:15], s27 offen offset:3072 lds
    s_add_u32 m0, s28, 4096
    s_add_u32 s27, s32, 16384
    buffer_load_dwordx4 v12, s[12:15], s27 offen offset:0 lds
    s_add_u32 s27, s32, 80896
    buffer_load_dwordx4 v13, s[12:15], s27 offen offset:1024 lds
    s_add_u32 s27, s32, 47104
    buffer_load_dwordx4 v14, s[12:15], s27 offen offset:2048 lds
    s_add_u32 s27, s32, 111616
    buffer_load_dwordx4 v15, s[12:15], s27 offen offset:3072 lds
    s_add_u32 s32, s32, 524288
    s_cmp_ge_u32 s32, 3670016
    s_cselect_b32 s32, s33, s32
    v_and_b32 v5, 15, v0
    v_xor_b32 v5, v5, v3
    v_lshlrev_b32 v5, 4, v5
    v_lshl_add_u32 v5, v4, 9, v5
    s_lshr_b32 s26, s21, 1
    s_lshl_b32 s29, s26, 14
    s_and_b32 s24, s21, 1
    s_lshl_b32 s30, s24, 11
    s_add_u32 s30, s30, 0x20000
    v_xor_b32 v6, 0, v5
    v_add_u32 v16, s29, v6
    v_add_u32 v32, 0x10000, v16
    v_xor_b32 v6, 32, v5
    v_add_u32 v17, s29, v6
    v_add_u32 v33, 0x10000, v17
    v_xor_b32 v6, 64, v5
    v_add_u32 v18, s29, v6
    v_add_u32 v34, 0x10000, v18
    v_xor_b32 v6, 96, v5
    v_add_u32 v19, s29, v6
    v_add_u32 v35, 0x10000, v19
    v_xor_b32 v6, 128, v5
    v_add_u32 v20, s29, v6
    v_add_u32 v36, 0x10000, v20
    v_xor_b32 v6, 160, v5
    v_add_u32 v21, s29, v6
    v_add_u32 v37, 0x10000, v21
    v_xor_b32 v6, 192, v5
    v_add_u32 v22, s29, v6
    v_add_u32 v38, 0x10000, v22
    v_xor_b32 v6, 224, v5
    v_add_u32 v23, s29, v6
    v_add_u32 v39, 0x10000, v23
    v_add_u32 v31, s30, v2
    s_mul_i32 s29, s22, 7
    s_add_u32 s29, s29, s20
    s_lshl1_add_u32 s29, s29, s24
    s_mul_i32 s29, s29, 28672
    s_add_u32 s29, s29, 6422528
    s_add_u32 s35, s29, 28672
    s_lshl_b32 s26, s26, 11
    s_add_u32 s29, s29, s26
    s_lshl_b32 s34, s19, 12
    s_add_u32 s34, s34, s29
    s_mov_b32 s30, 0x3db8aa3b
    v_bfe_u32 v6, v0, 1, 3
    v_xor_b32 v6, v6, v3
    v_lshlrev_b32 v6, 4, v6
    v_lshl_add_u32 v6, v4, 7, v6
    v_xor_b32 v24, 0, v6
    v_add_u32 v24, s31, v24
    v_xor_b32 v25, 32, v6
    v_add_u32 v25, s31, v25
    v_xor_b32 v26, 64, v6
    v_add_u32 v26, s31, v26
    v_xor_b32 v27, 96, v6
    v_add_u32 v27, s31, v27
    v_and_b32 v5, 16, v0
    v_mov_b32 v6, 0x3f80
    v_lshlrev_b32 v6, v5, v6
    v_and_b32 v5, 15, v0
    v_lshlrev_b32 v3, 2, v3
    v_sub_u32 v5, v5, v3
    v_cmp_eq_u32 vcc, 0, v5
    s_nop 1
    v_cndmask_b32 v128, 0, v6, vcc
    v_cmp_eq_u32 vcc, 1, v5
    s_nop 1
    v_cndmask_b32 v129, 0, v6, vcc
    v_cmp_eq_u32 vcc, 2, v5
    s_nop 1
    v_cndmask_b32 v130, 0, v6, vcc
    v_cmp_eq_u32 vcc, 3, v5
    s_nop 1
    v_cndmask_b32 v131, 0, v6, vcc
    v_cmp_eq_u32 vcc, 8, v5
    s_nop 1
    v_cndmask_b32 v132, 0, v6, vcc
    v_cmp_eq_u32 vcc, 9, v5
    s_nop 1
    v_cndmask_b32 v133, 0, v6, vcc
    v_cmp_eq_u32 vcc, 10, v5
    s_nop 1
    v_cndmask_b32 v134, 0, v6, vcc
    v_cmp_eq_u32 vcc, 11, v5
    s_nop 1
    v_cndmask_b32 v135, 0, v6, vcc
    v_add_u32 v6, s31, v2
    s_waitcnt vmcnt(9)
    ds_read_b128 v[136:139], v24 offset:0
    ds_read_b128 v[140:143], v25 offset:0
    ds_read_b128 v[144:147], v26 offset:0
    ds_read_b128 v[148:151], v27 offset:0
    ds_read_b128 v[152:155], v24 offset:4096
    ds_read_b128 v[156:159], v25 offset:4096
    ds_read_b128 v[160:163], v26 offset:4096
    ds_read_b128 v[164:167], v27 offset:4096
    s_waitcnt lgkmcnt(7)
    v_mfma_f32_32x32x16_bf16 v[48:63], v[136:139], v[128:131], 0
    s_waitcnt lgkmcnt(6)
    v_mfma_f32_32x32x16_bf16 v[48:63], v[140:143], v[132:135], v[48:63]
    s_waitcnt lgkmcnt(5)
    v_mfma_f32_32x32x16_bf16 v[64:79], v[144:147], v[128:131], 0
    s_waitcnt lgkmcnt(4)
    v_mfma_f32_32x32x16_bf16 v[64:79], v[148:151], v[132:135], v[64:79]
    s_waitcnt lgkmcnt(3)
    v_mfma_f32_32x32x16_bf16 v[80:95], v[152:155], v[128:131], 0
    s_waitcnt lgkmcnt(2)
    v_mfma_f32_32x32x16_bf16 v[80:95], v[156:159], v[132:135], v[80:95]
    s_waitcnt lgkmcnt(1)
    v_mfma_f32_32x32x16_bf16 v[96:111], v[160:163], v[128:131], 0
    s_waitcnt lgkmcnt(0)
    v_mfma_f32_32x32x16_bf16 v[96:111], v[164:167], v[132:135], v[96:111]
    v_cvt_pk_bf16_f32 v192, v48, v49
    v_cvt_pk_bf16_f32 v193, v50, v51
    v_cvt_pk_bf16_f32 v194, v52, v53
    v_cvt_pk_bf16_f32 v195, v54, v55
    v_cvt_pk_bf16_f32 v196, v56, v57
    v_cvt_pk_bf16_f32 v197, v58, v59
    v_cvt_pk_bf16_f32 v198, v60, v61
    v_cvt_pk_bf16_f32 v199, v62, v63
    ds_write_b128 v6, v[192:195] offset:0
    ds_write_b128 v6, v[196:199] offset:1024
    v_cvt_pk_bf16_f32 v200, v64, v65
    v_cvt_pk_bf16_f32 v201, v66, v67
    v_cvt_pk_bf16_f32 v202, v68, v69
    v_cvt_pk_bf16_f32 v203, v70, v71
    v_cvt_pk_bf16_f32 v204, v72, v73
    v_cvt_pk_bf16_f32 v205, v74, v75
    v_cvt_pk_bf16_f32 v206, v76, v77
    v_cvt_pk_bf16_f32 v207, v78, v79
    ds_write_b128 v6, v[200:203] offset:2048
    ds_write_b128 v6, v[204:207] offset:3072
    v_cvt_pk_bf16_f32 v208, v80, v81
    v_cvt_pk_bf16_f32 v209, v82, v83
    v_cvt_pk_bf16_f32 v210, v84, v85
    v_cvt_pk_bf16_f32 v211, v86, v87
    v_cvt_pk_bf16_f32 v212, v88, v89
    v_cvt_pk_bf16_f32 v213, v90, v91
    v_cvt_pk_bf16_f32 v214, v92, v93
    v_cvt_pk_bf16_f32 v215, v94, v95
    ds_write_b128 v6, v[208:211] offset:4096
    ds_write_b128 v6, v[212:215] offset:5120
    v_cvt_pk_bf16_f32 v216, v96, v97
    v_cvt_pk_bf16_f32 v217, v98, v99
    v_cvt_pk_bf16_f32 v218, v100, v101
    v_cvt_pk_bf16_f32 v219, v102, v103
    v_cvt_pk_bf16_f32 v220, v104, v105
    v_cvt_pk_bf16_f32 v221, v106, v107
    v_cvt_pk_bf16_f32 v222, v108, v109
    v_cvt_pk_bf16_f32 v223, v110, v111
    ds_write_b128 v6, v[216:219] offset:6144
    ds_write_b128 v6, v[220:223] offset:7168
    s_waitcnt lgkmcnt(0)
    s_barrier
    ds_read_b128 a[0:3], v31 offset:0
    ds_read_b128 a[4:7], v31 offset:1024
    ds_read_b128 a[8:11], v31 offset:4096
    ds_read_b128 a[12:15], v31 offset:5120
    ds_read_b128 a[16:19], v31 offset:8192
    ds_read_b128 a[20:23], v31 offset:9216
    ds_read_b128 a[24:27], v31 offset:12288
    ds_read_b128 a[28:31], v31 offset:13312
    s_waitcnt lgkmcnt(4)
    ds_read_b128 a[32:35], v31 offset:16384
    ds_read_b128 a[36:39], v31 offset:17408
    ds_read_b128 a[40:43], v31 offset:20480
    ds_read_b128 a[44:47], v31 offset:21504
    ds_read_b128 a[48:51], v31 offset:24576
    ds_read_b128 a[52:55], v31 offset:25600
    ds_read_b128 a[56:59], v31 offset:28672
    ds_read_b128 a[60:63], v31 offset:29696
    s_add_u32 m0, s28, 32768
    s_add_u32 s27, s32, 0
    buffer_load_dwordx4 v8, s[12:15], s27 offen offset:0 lds
    s_add_u32 s27, s32, 64512
    buffer_load_dwordx4 v9, s[12:15], s27 offen offset:1024 lds
    s_add_u32 s27, s32, 30720
    buffer_load_dwordx4 v10, s[12:15], s27 offen offset:2048 lds
    s_add_u32 s27, s32, 95232
    buffer_load_dwordx4 v11, s[12:15], s27 offen offset:3072 lds
    s_add_u32 m0, s28, 36864
    s_add_u32 s27, s32, 16384
    buffer_load_dwordx4 v12, s[12:15], s27 offen offset:0 lds
    s_add_u32 s27, s32, 80896
    buffer_load_dwordx4 v13, s[12:15], s27 offen offset:1024 lds
    s_add_u32 s27, s32, 47104
    buffer_load_dwordx4 v14, s[12:15], s27 offen offset:2048 lds
    s_add_u32 s27, s32, 111616
    buffer_load_dwordx4 v15, s[12:15], s27 offen offset:3072 lds
    s_add_u32 s32, s32, 524288
    s_cmp_ge_u32 s32, 3670016
    s_cselect_b32 s32, s33, s32
    s_waitcnt vmcnt(8)
    s_waitcnt lgkmcnt(0)
    s_barrier
    ds_read_b128 v[128:131], v16 offset:0
    ds_read_b128 v[132:135], v17 offset:0
    ds_read_b128 v[136:139], v18 offset:0
    ds_read_b128 v[140:143], v19 offset:0
    ds_read_b128 v[144:147], v20 offset:0
    s_waitcnt lgkmcnt(4)
    v_mfma_f32_32x32x16_bf16 v[48:63], v[128:131], a[0:3], 0
    ds_read_b128 v[148:151], v21 offset:0
    s_add_u32 m0, s28, 65536
    s_add_u32 s27, s32, 0
    buffer_load_dwordx4 v8, s[12:15], s27 offen offset:0 lds
    s_waitcnt lgkmcnt(4)
    v_mfma_f32_32x32x16_bf16 v[48:63], v[132:135], a[4:7], v[48:63]
    ds_read_b128 v[152:155], v22 offset:0
    s_add_u32 s27, s32, 64512
    buffer_load_dwordx4 v9, s[12:15], s27 offen offset:1024 lds
    s_waitcnt lgkmcnt(4)
    v_mfma_f32_32x32x16_bf16 v[48:63], v[136:139], a[8:11], v[48:63]
    ds_read_b128 v[156:159], v23 offset:0
    s_add_u32 s27, s32, 30720
    buffer_load_dwordx4 v10, s[12:15], s27 offen offset:2048 lds
    s_waitcnt lgkmcnt(4)
    v_mfma_f32_32x32x16_bf16 v[48:63], v[140:143], a[12:15], v[48:63]
    ds_read_b128 v[128:131], v16 offset:256
    s_add_u32 s27, s32, 95232
    buffer_load_dwordx4 v11, s[12:15], s27 offen offset:3072 lds
    s_waitcnt lgkmcnt(4)
    v_mfma_f32_32x32x16_bf16 v[48:63], v[144:147], a[16:19], v[48:63]
    ds_read_b128 v[132:135], v17 offset:256
    s_add_u32 m0, s28, 69632
    s_add_u32 s27, s32, 16384
    buffer_load_dwordx4 v12, s[12:15], s27 offen offset:0 lds
    s_waitcnt lgkmcnt(4)
    v_mfma_f32_32x32x16_bf16 v[48:63], v[148:151], a[20:23], v[48:63]
    ds_read_b128 v[136:139], v18 offset:256
    s_add_u32 s27, s32, 80896
    buffer_load_dwordx4 v13, s[12:15], s27 offen offset:1024 lds
    s_waitcnt lgkmcnt(4)
    v_mfma_f32_32x32x16_bf16 v[48:63], v[152:155], a[24:27], v[48:63]
    ds_read_b128 v[140:143], v19 offset:256
    s_add_u32 s27, s32, 47104
    buffer_load_dwordx4 v14, s[12:15], s27 offen offset:2048 lds
    s_waitcnt lgkmcnt(4)
    v_mfma_f32_32x32x16_bf16 v[48:63], v[156:159], a[28:31], v[48:63]
    ds_read_b128 v[144:147], v20 offset:256
    s_add_u32 s27, s32, 111616
    buffer_load_dwordx4 v15, s[12:15], s27 offen offset:3072 lds
    s_add_u32 s32, s32, 524288
    s_cmp_ge_u32 s32, 3670016
    s_cselect_b32 s32, s33, s32
    s_waitcnt lgkmcnt(4)
    v_mfma_f32_32x32x16_bf16 v[48:63], v[128:131], a[32:35], v[48:63]
    ds_read_b128 v[148:151], v21 offset:256
    s_add_u32 m0, s28, 98304
    s_add_u32 s27, s32, 0
    buffer_load_dwordx4 v8, s[12:15], s27 offen offset:0 lds
    s_waitcnt lgkmcnt(4)
    v_mfma_f32_32x32x16_bf16 v[48:63], v[132:135], a[36:39], v[48:63]
    ds_read_b128 v[152:155], v22 offset:256
    s_waitcnt vmcnt(9)
    s_barrier
    s_waitcnt lgkmcnt(4)
    v_mfma_f32_32x32x16_bf16 v[48:63], v[136:139], a[40:43], v[48:63]
    ds_read_b128 v[156:159], v23 offset:256
    s_add_u32 s27, s32, 64512
    buffer_load_dwordx4 v9, s[12:15], s27 offen offset:1024 lds
    s_waitcnt lgkmcnt(4)
    v_mfma_f32_32x32x16_bf16 v[48:63], v[140:143], a[44:47], v[48:63]
    ds_read_b128 v[128:131], v16 offset:32768
    s_add_u32 s27, s32, 30720
    buffer_load_dwordx4 v10, s[12:15], s27 offen offset:2048 lds
    s_waitcnt lgkmcnt(4)
    v_mfma_f32_32x32x16_bf16 v[48:63], v[144:147], a[48:51], v[48:63]
    ds_read_b128 v[132:135], v17 offset:32768
    s_add_u32 s27, s32, 95232
    buffer_load_dwordx4 v11, s[12:15], s27 offen offset:3072 lds
    s_waitcnt lgkmcnt(4)
    v_mfma_f32_32x32x16_bf16 v[48:63], v[148:151], a[52:55], v[48:63]
    ds_read_b128 v[136:139], v18 offset:32768
    s_add_u32 m0, s28, 102400
    s_add_u32 s27, s32, 16384
    buffer_load_dwordx4 v12, s[12:15], s27 offen offset:0 lds
    s_waitcnt lgkmcnt(4)
    v_mfma_f32_32x32x16_bf16 v[48:63], v[152:155], a[56:59], v[48:63]
    ds_read_b128 v[140:143], v19 offset:32768
    s_add_u32 s27, s32, 80896
    buffer_load_dwordx4 v13, s[12:15], s27 offen offset:1024 lds
    s_waitcnt lgkmcnt(4)
    v_mfma_f32_32x32x16_bf16 v[48:63], v[156:159], a[60:63], v[48:63]
    ds_read_b128 v[144:147], v20 offset:32768
    s_add_u32 s27, s32, 47104
    buffer_load_dwordx4 v14, s[12:15], s27 offen offset:2048 lds
    s_waitcnt lgkmcnt(4)
    v_mfma_f32_32x32x16_bf16 v[64:79], v[128:131], a[0:3], 0
    ds_read_b128 v[148:151], v21 offset:32768
    s_add_u32 s27, s32, 111616
    buffer_load_dwordx4 v15, s[12:15], s27 offen offset:3072 lds
    s_add_u32 s32, s32, 524288
    s_cmp_ge_u32 s32, 3670016
    s_cselect_b32 s32, s33, s32
    s_waitcnt lgkmcnt(4)
    v_mfma_f32_32x32x16_bf16 v[64:79], v[132:135], a[4:7], v[64:79]
    ds_read_b128 v[152:155], v22 offset:32768
    s_waitcnt lgkmcnt(4)
    v_mfma_f32_32x32x16_bf16 v[64:79], v[136:139], a[8:11], v[64:79]
    ds_read_b128 v[156:159], v23 offset:32768
    s_waitcnt lgkmcnt(4)
    v_mfma_f32_32x32x16_bf16 v[64:79], v[140:143], a[12:15], v[64:79]
    ds_read_b128 v[128:131], v16 offset:33024
    s_waitcnt lgkmcnt(4)
    v_mfma_f32_32x32x16_bf16 v[64:79], v[144:147], a[16:19], v[64:79]
    ds_read_b128 v[132:135], v17 offset:33024
    v_cvt_pk_bf16_f32 v192, v48, v49
    s_waitcnt lgkmcnt(4)
    v_mfma_f32_32x32x16_bf16 v[64:79], v[148:151], a[20:23], v[64:79]
    ds_read_b128 v[136:139], v18 offset:33024
    v_cvt_pk_bf16_f32 v193, v50, v51
    s_waitcnt lgkmcnt(4)
    v_mfma_f32_32x32x16_bf16 v[64:79], v[152:155], a[24:27], v[64:79]
    ds_read_b128 v[140:143], v19 offset:33024
    v_cvt_pk_bf16_f32 v194, v52, v53
    s_waitcnt lgkmcnt(4)
    v_mfma_f32_32x32x16_bf16 v[64:79], v[156:159], a[28:31], v[64:79]
    ds_read_b128 v[144:147], v20 offset:33024
    v_cvt_pk_bf16_f32 v195, v54, v55
    s_waitcnt lgkmcnt(4)
    v_mfma_f32_32x32x16_bf16 v[64:79], v[128:131], a[32:35], v[64:79]
    ds_read_b128 v[148:151], v21 offset:33024
    v_cvt_pk_bf16_f32 v196, v56, v57
    s_waitcnt lgkmcnt(4)
    v_mfma_f32_32x32x16_bf16 v[64:79], v[132:135], a[36:39], v[64:79]
    ds_read_b128 v[152:155], v22 offset:33024
    s_waitcnt vmcnt(8)
    s_barrier
    v_cvt_pk_bf16_f32 v197, v58, v59
    s_waitcnt lgkmcnt(4)
    v_mfma_f32_32x32x16_bf16 v[64:79], v[136:139], a[40:43], v[64:79]
    ds_read_b128 v[156:159], v23 offset:33024
    v_cvt_pk_bf16_f32 v198, v60, v61
    s_waitcnt lgkmcnt(4)
    v_mfma_f32_32x32x16_bf16 v[64:79], v[140:143], a[44:47], v[64:79]
    ds_read_b128 v[128:131], v32 offset:0
    v_cvt_pk_bf16_f32 v199, v62, v63
    s_waitcnt lgkmcnt(4)
    v_mfma_f32_32x32x16_bf16 v[64:79], v[144:147], a[48:51], v[64:79]
    ds_read_b128 v[132:135], v33 offset:0
    buffer_store_dwordx4 v[192:195], v2, s[8:11], s34 offen offset:0 sc1
    s_waitcnt lgkmcnt(4)
    v_mfma_f32_32x32x16_bf16 v[64:79], v[148:151], a[52:55], v[64:79]
    ds_read_b128 v[136:139], v34 offset:0
    s_waitcnt lgkmcnt(4)
    v_mfma_f32_32x32x16_bf16 v[64:79], v[152:155], a[56:59], v[64:79]
    ds_read_b128 v[140:143], v35 offset:0
    buffer_store_dwordx4 v[196:199], v2, s[8:11], s34 offen offset:1024 sc1
    s_add_u32 s34, s34, 4096
    s_cmp_ge_u32 s34, s35
    s_cselect_b32 s34, s29, s34
    s_waitcnt lgkmcnt(4)
    v_mfma_f32_32x32x16_bf16 v[64:79], v[156:159], a[60:63], v[64:79]
    ds_read_b128 v[144:147], v36 offset:0
    s_waitcnt lgkmcnt(4)
    v_mfma_f32_32x32x16_bf16 v[48:63], v[128:131], a[0:3], 0
    ds_read_b128 v[148:151], v37 offset:0
    s_waitcnt lgkmcnt(4)
    v_mfma_f32_32x32x16_bf16 v[48:63], v[132:135], a[4:7], v[48:63]
    ds_read_b128 v[152:155], v38 offset:0
    s_waitcnt lgkmcnt(4)
    v_mfma_f32_32x32x16_bf16 v[48:63], v[136:139], a[8:11], v[48:63]
    ds_read_b128 v[156:159], v39 offset:0
    s_waitcnt lgkmcnt(4)
    v_mfma_f32_32x32x16_bf16 v[48:63], v[140:143], a[12:15], v[48:63]
    ds_read_b128 v[128:131], v32 offset:256
    s_waitcnt lgkmcnt(4)
    v_mfma_f32_32x32x16_bf16 v[48:63], v[144:147], a[16:19], v[48:63]
    ds_read_b128 v[132:135], v33 offset:256
    v_cvt_pk_bf16_f32 v200, v64, v65
    s_waitcnt lgkmcnt(4)
    v_mfma_f32_32x32x16_bf16 v[48:63], v[148:151], a[20:23], v[48:63]
    ds_read_b128 v[136:139], v34 offset:256
    v_cvt_pk_bf16_f32 v201, v66, v67
    s_waitcnt lgkmcnt(4)
    v_mfma_f32_32x32x16_bf16 v[48:63], v[152:155], a[24:27], v[48:63]
    ds_read_b128 v[140:143], v35 offset:256
    v_cvt_pk_bf16_f32 v202, v68, v69
    s_waitcnt lgkmcnt(4)
    v_mfma_f32_32x32x16_bf16 v[48:63], v[156:159], a[28:31], v[48:63]
    ds_read_b128 v[144:147], v36 offset:256
    v_cvt_pk_bf16_f32 v203, v70, v71
    s_waitcnt lgkmcnt(4)
    v_mfma_f32_32x32x16_bf16 v[48:63], v[128:131], a[32:35], v[48:63]
    ds_read_b128 v[148:151], v37 offset:256
    v_cvt_pk_bf16_f32 v204, v72, v73
    s_waitcnt lgkmcnt(4)
    v_mfma_f32_32x32x16_bf16 v[48:63], v[132:135], a[36:39], v[48:63]
    ds_read_b128 v[152:155], v38 offset:256
    s_waitcnt vmcnt(2)
    s_barrier
    v_cvt_pk_bf16_f32 v205, v74, v75
    s_waitcnt lgkmcnt(4)
    v_mfma_f32_32x32x16_bf16 v[48:63], v[136:139], a[40:43], v[48:63]
    ds_read_b128 v[156:159], v39 offset:256
    v_cvt_pk_bf16_f32 v206, v76, v77
    s_waitcnt lgkmcnt(4)
    v_mfma_f32_32x32x16_bf16 v[48:63], v[140:143], a[44:47], v[48:63]
    ds_read_b128 v[128:131], v32 offset:32768
    v_cvt_pk_bf16_f32 v207, v78, v79
    buffer_load_dword v41, v42, s[92:95], 0 offen sc1
    s_waitcnt lgkmcnt(4)
    v_mfma_f32_32x32x16_bf16 v[48:63], v[144:147], a[48:51], v[48:63]
    ds_read_b128 v[132:135], v33 offset:32768
    buffer_store_dwordx4 v[200:203], v2, s[8:11], s34 offen offset:0 sc1
    s_waitcnt lgkmcnt(4)
    v_mfma_f32_32x32x16_bf16 v[48:63], v[148:151], a[52:55], v[48:63]
    ds_read_b128 v[136:139], v34 offset:32768
    s_waitcnt lgkmcnt(4)
    v_mfma_f32_32x32x16_bf16 v[48:63], v[152:155], a[56:59], v[48:63]
    ds_read_b128 v[140:143], v35 offset:32768
    buffer_store_dwordx4 v[204:207], v2, s[8:11], s34 offen offset:1024 sc1
    s_add_u32 s34, s34, 4096
    s_cmp_ge_u32 s34, s35
    s_cselect_b32 s34, s29, s34
    s_waitcnt lgkmcnt(4)
    v_mfma_f32_32x32x16_bf16 v[48:63], v[156:159], a[60:63], v[48:63]
    ds_read_b128 v[144:147], v36 offset:32768
    s_waitcnt lgkmcnt(4)
    v_mfma_f32_32x32x16_bf16 v[64:79], v[128:131], a[0:3], 0
    ds_read_b128 v[148:151], v37 offset:32768
    s_waitcnt lgkmcnt(4)
    v_mfma_f32_32x32x16_bf16 v[64:79], v[132:135], a[4:7], v[64:79]
    ds_read_b128 v[152:155], v38 offset:32768
    s_waitcnt lgkmcnt(4)
    v_mfma_f32_32x32x16_bf16 v[64:79], v[136:139], a[8:11], v[64:79]
    ds_read_b128 v[156:159], v39 offset:32768
    s_waitcnt lgkmcnt(4)
    v_mfma_f32_32x32x16_bf16 v[64:79], v[140:143], a[12:15], v[64:79]
    ds_read_b128 v[128:131], v32 offset:33024
    s_waitcnt lgkmcnt(4)
    v_mfma_f32_32x32x16_bf16 v[64:79], v[144:147], a[16:19], v[64:79]
    ds_read_b128 v[132:135], v33 offset:33024
    v_cvt_pk_bf16_f32 v208, v48, v49
    s_waitcnt lgkmcnt(4)
    v_mfma_f32_32x32x16_bf16 v[64:79], v[148:151], a[20:23], v[64:79]
    ds_read_b128 v[136:139], v34 offset:33024
    v_cvt_pk_bf16_f32 v209, v50, v51
    s_waitcnt lgkmcnt(4)
    v_mfma_f32_32x32x16_bf16 v[64:79], v[152:155], a[24:27], v[64:79]
    ds_read_b128 v[140:143], v35 offset:33024
    v_cvt_pk_bf16_f32 v210, v52, v53
    s_waitcnt lgkmcnt(4)
    v_mfma_f32_32x32x16_bf16 v[64:79], v[156:159], a[28:31], v[64:79]
    ds_read_b128 v[144:147], v36 offset:33024
    v_cvt_pk_bf16_f32 v211, v54, v55
    s_waitcnt lgkmcnt(4)
    v_mfma_f32_32x32x16_bf16 v[64:79], v[128:131], a[32:35], v[64:79]
    ds_read_b128 v[148:151], v37 offset:33024
    v_cvt_pk_bf16_f32 v212, v56, v57
    s_waitcnt lgkmcnt(4)
    v_mfma_f32_32x32x16_bf16 v[64:79], v[132:135], a[36:39], v[64:79]
    ds_read_b128 v[152:155], v38 offset:33024
    v_cvt_pk_bf16_f32 v213, v58, v59
    s_waitcnt lgkmcnt(4)
    v_mfma_f32_32x32x16_bf16 v[64:79], v[136:139], a[40:43], v[64:79]
    ds_read_b128 v[156:159], v39 offset:33024
    v_cvt_pk_bf16_f32 v214, v60, v61
    s_waitcnt lgkmcnt(4)
    v_mfma_f32_32x32x16_bf16 v[64:79], v[140:143], a[44:47], v[64:79]
    v_cvt_pk_bf16_f32 v215, v62, v63
    s_waitcnt lgkmcnt(3)
    v_mfma_f32_32x32x16_bf16 v[64:79], v[144:147], a[48:51], v[64:79]
    buffer_store_dwordx4 v[208:211], v2, s[8:11], s34 offen offset:0 sc1
    s_waitcnt lgkmcnt(2)
    v_mfma_f32_32x32x16_bf16 v[64:79], v[148:151], a[52:55], v[64:79]
    s_waitcnt lgkmcnt(1)
    v_mfma_f32_32x32x16_bf16 v[64:79], v[152:155], a[56:59], v[64:79]
    buffer_store_dwordx4 v[212:215], v2, s[8:11], s34 offen offset:1024 sc1
    s_add_u32 s34, s34, 4096
    s_cmp_ge_u32 s34, s35
    s_cselect_b32 s34, s29, s34
    s_waitcnt lgkmcnt(0)
    v_mfma_f32_32x32x16_bf16 v[64:79], v[156:159], a[60:63], v[64:79]
    s_nop 4
    s_lshl_b32 s19, s20, 1
    s_lshl_b32 s19, 1, s19
    s_lshl_b32 s18, s22, 7
    s_add_u32 s18, s18, 18636800
    s_cmp_eq_u32 s65, 0
    s_cselect_b32 s3, 0, 2147483632
    v_or_b32 v3, s3, v2
    v_or_b32 v5, s3, v4
    v_cvt_pk_bf16_f32 v216, v64, v65
    v_cvt_pk_bf16_f32 v217, v66, v67
    v_cvt_pk_bf16_f32 v218, v68, v69
    v_cvt_pk_bf16_f32 v219, v70, v71
    v_cvt_pk_bf16_f32 v220, v72, v73
    v_cvt_pk_bf16_f32 v221, v74, v75
    v_cvt_pk_bf16_f32 v222, v76, v77
    v_cvt_pk_bf16_f32 v223, v78, v79
    buffer_store_dwordx4 v[216:219], v3, s[8:11], s34 offen offset:0 sc1
    buffer_store_dwordx4 v[220:223], v3, s[8:11], s34 offen offset:1024 sc1
    s_add_u32 s34, s34, 4096
    s_cmp_ge_u32 s34, s35
    s_cselect_b32 s34, s29, s34
    s_waitcnt vmcnt(6)
    s_branch prep_done
prep_misc:
    s_xor_b32 s24, s24, 4
    s_lshl2_add_u32 s22, s24, s25
    s_sub_u32 s22, s22, 28
    s_lshl_b32 s24, s22, 2
    s_add_u32 s24, s24, s21
    s_mul_i32 s24, s24, 14336
    s_mul_i32 s28, s21, 14592
    v_bfe_u32 v3, v0, 0, 2
    v_mul_u32_u24 v4, 224, v3
    s_waitcnt lgkmcnt(0)
    s_mov_b32 s12, s58
    s_mov_b32 s13, s59
    s_mov_b32 s14, 1835008
    s_mov_b32 s15, 0x20000
    s_mov_b32 s36, s50
    s_mov_b32 s37, s51
    s_mov_b32 s38, 896
    s_mov_b32 s39, 0x20000
    s_mov_b32 s8, s56
    s_mov_b32 s9, s57
    s_mov_b32 s10, 268435456
    s_mov_b32 s11, 0x20000
    s_cmp_lg_u32 s22, 0
    s_cbranch_scc1 misc_m0
    s_mov_b32 s32, s60
    s_mov_b32 s33, s61
    s_mov_b32 s34, 7168
    s_mov_b32 s35, 0x20000
    v_bfe_u32 v3, v0, 3, 3
    v_mul_u32_u24 v6, 896, v3
    v_bfe_u32 v3, v0, 6, 2
    v_lshl_add_u32 v6, v3, 5, v6
    v_bfe_u32 v3, v0, 0, 3
    v_lshl_add_u32 v6, v3, 2, v6
    buffer_load_dword v44, v6, s[32:35], 0 offen offset:0
    buffer_load_dword v45, v6, s[32:35], 0 offen offset:128
    buffer_load_dword v46, v6, s[32:35], 0 offen offset:256
    buffer_load_dword v47, v6, s[32:35], 0 offen offset:384
    buffer_load_dword v48, v6, s[32:35], 0 offen offset:512
    buffer_load_dword v49, v6, s[32:35], 0 offen offset:640
    buffer_load_dword v50, v6, s[32:35], 0 offen offset:768
misc_m0:
    s_lshl_b32 s3, s2, 12
    v_lshl_add_u32 v121, v0, 4, s3
    v_mov_b32 v123, v121
    v_mov_b32 v122, 2147483632
    v_subrev_u32 v120, 0, v123
    v_cmp_gt_u32 vcc, 7168, v120
    s_nop 1
    v_cndmask_b32 v121, v121, v122, vcc
    v_subrev_u32 v120, 458752, v123
    v_cmp_gt_u32 vcc, 7168, v120
    s_nop 1
    v_cndmask_b32 v121, v121, v122, vcc
    s_cmp_lt_u32 s2, 201
    s_cselect_b32 s3, 0, 2147483632
    v_or_b32 v121, s3, v121
    s_cmp_lt_u32 s2, 192
    s_cselect_b32 s3, -1, 0
    v_mov_b32 v124, s3
    v_mov_b32 v125, s3
    v_mov_b32 v126, s3
    v_mov_b32 v127, s3
    s_mov_b32 s3, 17825792
    buffer_store_dwordx4 v[124:127], v121, s[8:11], s3 offen sc1
    s_mov_b32 exec_hi, 0x00ffffff
    s_add_u32 m0, s28, 0
    s_add_u32 s27, s24, 0
    buffer_load_dwordx4 v2, s[12:15], s27 offen lds
    s_add_u32 m0, s28, 912
    s_add_u32 s27, s24, 896
    buffer_load_dwordx4 v2, s[12:15], s27 offen lds
    s_add_u32 m0, s28, 1824
    s_add_u32 s27, s24, 1792
    buffer_load_dwordx4 v2, s[12:15], s27 offen lds
    s_add_u32 m0, s28, 2736
    s_add_u32 s27, s24, 2688
    buffer_load_dwordx4 v2, s[12:15], s27 offen lds
    s_add_u32 m0, s28, 3648
    s_add_u32 s27, s24, 3584
    buffer_load_dwordx4 v2, s[12:15], s27 offen lds
    s_add_u32 m0, s28, 4560
    s_add_u32 s27, s24, 4480
    buffer_load_dwordx4 v2, s[12:15], s27 offen lds
    s_add_u32 m0, s28, 5472
    s_add_u32 s27, s24, 5376
    buffer_load_dwordx4 v2, s[12:15], s27 offen lds
    s_add_u32 m0, s28, 6384
    s_add_u32 s27, s24, 6272
    buffer_load_dwordx4 v2, s[12:15], s27 offen lds
    s_add_u32 m0, s28, 7296
    s_add_u32 s27, s24, 7168
    buffer_load_dwordx4 v2, s[12:15], s27 offen lds
    s_add_u32 m0, s28, 8208
    s_add_u32 s27, s24, 8064
    buffer_load_dwordx4 v2, s[12:15], s27 offen lds
    s_add_u32 m0, s28, 9120
    s_add_u32 s27, s24, 8960
    buffer_load_dwordx4 v2, s[12:15], s27 offen lds
    s_add_u32 m0, s28, 10032
    s_add_u32 s27, s24, 9856
    buffer_load_dwordx4 v2, s[12:15], s27 offen lds
    s_add_u32 m0, s28, 10944
    s_add_u32 s27, s24, 10752
    buffer_load_dwordx4 v2, s[12:15], s27 offen lds
    s_add_u32 m0, s28, 11856
    s_add_u32 s27, s24, 11648
    buffer_load_dwordx4 v2, s[12:15], s27 offen lds
    s_add_u32 m0, s28, 12768
    s_add_u32 s27, s24, 12544
    buffer_load_dwordx4 v2, s[12:15], s27 offen lds
    s_add_u32 m0, s28, 13680
    s_add_u32 s27, s24, 13440
    buffer_load_dwordx4 v2, s[12:15], s27 offen lds
    s_mov_b64 exec, -1
    s_waitcnt vmcnt(16)
    s_barrier
    s_mov_b32 s92, s54
    s_mov_b32 s93, s55
    s_mov_b32 s94, 256
    s_mov_b32 s95, 0x20000
    s_and_b32 s3, s5, 7
    s_lshl_b32 s3, s3, 2
    s_lshr_b32 s4, s5, 3
    s_lshl1_add_u32 s3, s4, s3
    s_lshl_b32 s3, s3, 3
    s_cmp_eq_u32 s21, 0
    s_cselect_b32 s3, s3, 256
    v_mov_b32 v40, 1
    v_mov_b32 v41, s3
    s_mov_b64 exec, 1
    buffer_atomic_add v40, v41, s[92:95], 0 offen sc0 sc1
    s_mov_b64 exec, -1
    v_bfe_u32 v43, v0, 0, 3
    v_lshlrev_b32 v42, 5, v43
    v_bfe_u32 v43, v0, 3, 1
    v_lshl_add_u32 v42, v43, 4, v42
    buffer_load_dwordx4 v[64:67], v4, s[36:39], 0 offen offset:0
    buffer_load_dwordx4 v[68:71], v4, s[36:39], 0 offen offset:16
    buffer_load_dwordx4 v[72:75], v4, s[36:39], 0 offen offset:32
    buffer_load_dwordx4 v[76:79], v4, s[36:39], 0 offen offset:48
    buffer_load_dwordx4 v[80:83], v4, s[36:39], 0 offen offset:64
    buffer_load_dwordx4 v[84:87], v4, s[36:39], 0 offen offset:80
    buffer_load_dwordx4 v[88:91], v4, s[36:39], 0 offen offset:96
    buffer_load_dwordx4 v[92:95], v4, s[36:39], 0 offen offset:112
    buffer_load_dwordx4 v[96:99], v4, s[36:39], 0 offen offset:128
    buffer_load_dwordx4 v[100:103], v4, s[36:39], 0 offen offset:144
    buffer_load_dwordx4 v[104:107], v4, s[36:39], 0 offen offset:160
    buffer_load_dwordx4 v[108:111], v4, s[36:39], 0 offen offset:176
    buffer_load_dwordx4 v[112:115], v4, s[36:39], 0 offen offset:192
    buffer_load_dwordx4 v[116:119], v4, s[36:39], 0 offen offset:208
    v_bfe_u32 v3, v0, 0, 5
    v_mul_u32_u24 v8, 912, v3
    v_bfe_u32 v3, v0, 5, 1
    v_lshl_add_u32 v8, v3, 3, v8
    v_bfe_u32 v3, v0, 6, 1
    v_mul_u32_u24 v3, 448, v3
    v_add_u32 v8, v3, v8
    v_bfe_u32 v3, v0, 7, 1
    v_mul_u32_u24 v3, 29184, v3
    v_add_u32 v8, v3, v8
    v_bfe_u32 v3, v0, 2, 6
    v_mul_u32_u24 v11, 912, v3
    v_bfe_u32 v3, v0, 0, 2
    v_mul_u32_u24 v3, 224, v3
    v_add_u32 v11, v3, v11
    s_waitcnt vmcnt(15)
    s_barrier
    s_cmp_lg_u32 s22, 0
    s_cbranch_scc1 misc_m1
    v_lshlrev_b32 v6, 2, v0
    s_mov_b32 s26, 18284544
    buffer_store_dword v44, v6, s[8:11], s26 offen offset:0 sc1
    buffer_store_dword v45, v6, s[8:11], s26 offen offset:1024 sc1
    buffer_store_dword v46, v6, s[8:11], s26 offen offset:2048 sc1
    buffer_store_dword v47, v6, s[8:11], s26 offen offset:3072 sc1
    s_mov_b32 s26, 18288640
    buffer_store_dword v48, v6, s[8:11], s26 offen offset:0 sc1
    buffer_store_dword v49, v6, s[8:11], s26 offen offset:1024 sc1
    buffer_store_dword v50, v6, s[8:11], s26 offen offset:2048 sc1
    s_mov_b32 s26, 17825792
    buffer_store_dword v44, v6, s[8:11], s26 offen offset:0 sc1
    buffer_store_dword v45, v6, s[8:11], s26 offen offset:1024 sc1
    buffer_store_dword v46, v6, s[8:11], s26 offen offset:2048 sc1
    buffer_store_dword v47, v6, s[8:11], s26 offen offset:3072 sc1
    s_mov_b32 s26, 17829888
    buffer_store_dword v48, v6, s[8:11], s26 offen offset:0 sc1
    buffer_store_dword v49, v6, s[8:11], s26 offen offset:1024 sc1
    buffer_store_dword v50, v6, s[8:11], s26 offen offset:2048 sc1
    s_waitcnt vmcnt(24)
misc_m1:
    ds_read2_b64 v[128:131], v8 offset0:0 offset1:2
    ds_read2_b64 v[132:135], v8 offset0:4 offset1:6
    ds_read2_b64 v[136:139], v8 offset0:8 offset1:10
    ds_read2_b64 v[140:143], v8 offset0:12 offset1:14
    ds_read2_b64 v[144:147], v8 offset0:16 offset1:18
    ds_read2_b64 v[148:151], v8 offset0:20 offset1:22
    ds_read2_b64 v[152:155], v8 offset0:24 offset1:26
    ds_read2_b64 v[156:159], v8 offset0:28 offset1:30
    ds_read2_b64 v[160:163], v8 offset0:32 offset1:34
    ds_read2_b64 v[164:167], v8 offset0:36 offset1:38
    ds_read2_b64 v[168:171], v8 offset0:40 offset1:42
    ds_read2_b64 v[172:175], v8 offset0:44 offset1:46
    ds_read2_b64 v[176:179], v8 offset0:48 offset1:50
    ds_read2_b64 v[180:183], v8 offset0:52 offset1:54
    s_lshl_b32 s26, s22, 2
    s_add_u32 s26, s26, s21
    s_mul_i32 s26, s26, 14336
    s_add_u32 s26, s26, 15728640
    s_waitcnt lgkmcnt(13)
    v_swap_b32 v129, v130
    buffer_store_dwordx4 v[128:131], v2, s[8:11], s26 offen offset:0 sc1
    s_waitcnt lgkmcnt(12)
    v_swap_b32 v133, v134
    buffer_store_dwordx4 v[132:135], v2, s[8:11], s26 offen offset:1024 sc1
    s_waitcnt lgkmcnt(11)
    v_swap_b32 v137, v138
    buffer_store_dwordx4 v[136:139], v2, s[8:11], s26 offen offset:2048 sc1
    s_waitcnt lgkmcnt(10)
    v_swap_b32 v141, v142
    buffer_store_dwordx4 v[140:143], v2, s[8:11], s26 offen offset:3072 sc1
    s_add_u32 s26, s26, 4096
    s_waitcnt lgkmcnt(9)
    v_swap_b32 v145, v146
    buffer_store_dwordx4 v[144:147], v2, s[8:11], s26 offen offset:0 sc1
    s_waitcnt lgkmcnt(8)
    v_swap_b32 v149, v150
    buffer_store_dwordx4 v[148:151], v2, s[8:11], s26 offen offset:1024 sc1
    s_waitcnt lgkmcnt(7)
    v_swap_b32 v153, v154
    buffer_store_dwordx4 v[152:155], v2, s[8:11], s26 offen offset:2048 sc1
    s_waitcnt lgkmcnt(6)
    v_swap_b32 v157, v158
    buffer_store_dwordx4 v[156:159], v2, s[8:11], s26 offen offset:3072 sc1
    s_add_u32 s26, s26, 4096
    s_waitcnt lgkmcnt(5)
    v_swap_b32 v161, v162
    buffer_store_dwordx4 v[160:163], v2, s[8:11], s26 offen offset:0 sc1
    s_waitcnt lgkmcnt(4)
    v_swap_b32 v165, v166
    buffer_store_dwordx4 v[164:167], v2, s[8:11], s26 offen offset:1024 sc1
    s_waitcnt lgkmcnt(3)
    v_swap_b32 v169, v170
    buffer_store_dwordx4 v[168:171], v2, s[8:11], s26 offen offset:2048 sc1
    s_waitcnt lgkmcnt(2)
    v_swap_b32 v173, v174
    buffer_store_dwordx4 v[172:175], v2, s[8:11], s26 offen offset:3072 sc1
    s_add_u32 s26, s26, 4096
    s_waitcnt lgkmcnt(1)
    v_swap_b32 v177, v178
    buffer_store_dwordx4 v[176:179], v2, s[8:11], s26 offen offset:0 sc1
    s_waitcnt lgkmcnt(0)
    v_swap_b32 v181, v182
    buffer_store_dwordx4 v[180:183], v2, s[8:11], s26 offen offset:1024 sc1
    v_mov_b32 v6, v11
    ds_read_b128 v[184:187], v6 offset:0
    ds_read_b128 v[188:191], v6 offset:16
    ds_read_b128 v[192:195], v6 offset:32
    ds_read_b128 v[196:199], v6 offset:48
    ds_read_b128 v[200:203], v6 offset:64
    ds_read_b128 v[204:207], v6 offset:80
    ds_read_b128 v[208:211], v6 offset:96
    ds_read_b128 v[212:215], v6 offset:112
    ds_read_b128 v[216:219], v6 offset:128
    ds_read_b128 v[220:223], v6 offset:144
    ds_read_b128 v[224:227], v6 offset:160
    ds_read_b128 v[228:231], v6 offset:176
    ds_read_b128 v[232:235], v6 offset:192
    ds_read_b128 v[236:239], v6 offset:208
    v_mov_b32 v5, 0
    s_waitcnt vmcnt(14) lgkmcnt(0)
    v_dot2_f32_bf16 v5, v184, v64, v5
    v_dot2_f32_bf16 v5, v185, v65, v5
    v_dot2_f32_bf16 v5, v186, v66, v5
    v_dot2_f32_bf16 v5, v187, v67, v5
    v_dot2_f32_bf16 v5, v188, v68, v5
    v_dot2_f32_bf16 v5, v189, v69, v5
    v_dot2_f32_bf16 v5, v190, v70, v5
    v_dot2_f32_bf16 v5, v191, v71, v5
    v_dot2_f32_bf16 v5, v192, v72, v5
    v_dot2_f32_bf16 v5, v193, v73, v5
    v_dot2_f32_bf16 v5, v194, v74, v5
    v_dot2_f32_bf16 v5, v195, v75, v5
    v_dot2_f32_bf16 v5, v196, v76, v5
    v_dot2_f32_bf16 v5, v197, v77, v5
    v_dot2_f32_bf16 v5, v198, v78, v5
    v_dot2_f32_bf16 v5, v199, v79, v5
    v_dot2_f32_bf16 v5, v200, v80, v5
    v_dot2_f32_bf16 v5, v201, v81, v5
    v_dot2_f32_bf16 v5, v202, v82, v5
    v_dot2_f32_bf16 v5, v203, v83, v5
    v_dot2_f32_bf16 v5, v204, v84, v5
    v_dot2_f32_bf16 v5, v205, v85, v5
    v_dot2_f32_bf16 v5, v206, v86, v5
    v_dot2_f32_bf16 v5, v207, v87, v5
    v_dot2_f32_bf16 v5, v208, v88, v5
    v_dot2_f32_bf16 v5, v209, v89, v5
    v_dot2_f32_bf16 v5, v210, v90, v5
    v_dot2_f32_bf16 v5, v211, v91, v5
    v_dot2_f32_bf16 v5, v212, v92, v5
    v_dot2_f32_bf16 v5, v213, v93, v5
    v_dot2_f32_bf16 v5, v214, v94, v5
    v_dot2_f32_bf16 v5, v215, v95, v5
    v_dot2_f32_bf16 v5, v216, v96, v5
    v_dot2_f32_bf16 v5, v217, v97, v5
    v_dot2_f32_bf16 v5, v218, v98, v5
    v_dot2_f32_bf16 v5, v219, v99, v5
    v_dot2_f32_bf16 v5, v220, v100, v5
    v_dot2_f32_bf16 v5, v221, v101, v5
    v_dot2_f32_bf16 v5, v222, v102, v5
    v_dot2_f32_bf16 v5, v223, v103, v5
    v_dot2_f32_bf16 v5, v224, v104, v5
    v_dot2_f32_bf16 v5, v225, v105, v5
    v_dot2_f32_bf16 v5, v226, v106, v5
    v_dot2_f32_bf16 v5, v227, v107, v5
    v_dot2_f32_bf16 v5, v228, v108, v5
    v_dot2_f32_bf16 v5, v229, v109, v5
    v_dot2_f32_bf16 v5, v230, v110, v5
    v_dot2_f32_bf16 v5, v231, v111, v5
    v_dot2_f32_bf16 v5, v232, v112, v5
    v_dot2_f32_bf16 v5, v233, v113, v5
    v_dot2_f32_bf16 v5, v234, v114, v5
    v_dot2_f32_bf16 v5, v235, v115, v5
    v_dot2_f32_bf16 v5, v236, v116, v5
    v_dot2_f32_bf16 v5, v237, v117, v5
    v_dot2_f32_bf16 v5, v238, v118, v5
    v_dot2_f32_bf16 v5, v239, v119, v5
    s_nop 2
    v_add_f32_dpp v5, v5, v5 quad_perm:[1,0,3,2] row_mask:0xf bank_mask:0xf
    s_nop 1
    v_add_f32_dpp v5, v5, v5 quad_perm:[2,3,0,1] row_mask:0xf bank_mask:0xf
    v_mul_f32 v5, 0xbfb8aa3b, v5
    v_exp_f32 v5, v5
    v_and_b32 v3, 0xfc, v0
    v_add_f32 v5, 1.0, v5
    v_rcp_f32 v5, v5
    s_lshl_b32 s26, s22, 8
    s_add_u32 s26, s26, 17629184
    buffer_store_dword v5, v3, s[8:11], s26 offen sc1
misc_end:
    buffer_load_dword v41, v42, s[92:95], 0 offen sc1
    s_mov_b32 s19, 1
    s_lshr_b32 s18, s22, 1
    s_lshl_b32 s18, s18, 7
    s_add_u32 s18, s18, 18614272
    s_waitcnt vmcnt(0)
prep_done:
    s_mov_b32 s23, 400000
    v_mov_b32 v3, 0x20000
    s_cmp_lg_u32 s21, 0
    s_cbranch_scc1 main_c
    s_mov_b64 exec, 1
    ds_write_b32 v3, v40
    s_mov_b64 exec, -1
main_c:
    s_mov_b32 s60, 0
    s_mov_b32 s63, 0
    s_mov_b32 s90, 0
    v_readlane_b32 s61, v41, 0
    v_readlane_b32 s64, v41, 0
    s_add_u32 s63, s63, s64
    s_or_b32 s90, s90, s64
    s_cmp_gt_u32 s5, 0
    s_cselect_b32 s64, s64, 0
    s_add_u32 s60, s60, s64
    v_readlane_b32 s64, v41, 1
    s_add_u32 s63, s63, s64
    s_or_b32 s90, s90, s64
    s_cmp_gt_u32 s5, 1
    s_cselect_b32 s64, s64, 0
    s_add_u32 s60, s60, s64
    v_readlane_b32 s64, v41, 2
    s_add_u32 s63, s63, s64
    s_or_b32 s90, s90, s64
    s_cmp_gt_u32 s5, 2
    s_cselect_b32 s64, s64, 0
    s_add_u32 s60, s60, s64
    v_readlane_b32 s64, v41, 3
    s_add_u32 s63, s63, s64
    s_or_b32 s90, s90, s64
    s_cmp_gt_u32 s5, 3
    s_cselect_b32 s64, s64, 0
    s_add_u32 s60, s60, s64
    v_readlane_b32 s64, v41, 4
    s_add_u32 s63, s63, s64
    s_or_b32 s90, s90, s64
    s_cmp_gt_u32 s5, 4
    s_cselect_b32 s64, s64, 0
    s_add_u32 s60, s60, s64
    v_readlane_b32 s64, v41, 5
    s_add_u32 s63, s63, s64
    s_or_b32 s90, s90, s64
    s_cmp_gt_u32 s5, 5
    s_cselect_b32 s64, s64, 0
    s_add_u32 s60, s60, s64
    v_readlane_b32 s64, v41, 6
    s_add_u32 s63, s63, s64
    s_or_b32 s90, s90, s64
    s_cmp_gt_u32 s5, 6
    s_cselect_b32 s64, s64, 0
    s_add_u32 s60, s60, s64
    v_readlane_b32 s64, v41, 7
    s_add_u32 s63, s63, s64
    s_or_b32 s90, s90, s64
    s_cmp_gt_u32 s5, 7
    s_cselect_b32 s64, s64, 0
    s_add_u32 s60, s60, s64
    v_readlane_b32 s64, v41, 8
    s_add_u32 s63, s63, s64
    s_or_b32 s90, s90, s64
    s_cmp_gt_u32 s5, 8
    s_cselect_b32 s64, s64, 0
    s_add_u32 s60, s60, s64
    v_readlane_b32 s64, v41, 9
    s_add_u32 s63, s63, s64
    s_or_b32 s90, s90, s64
    s_cmp_gt_u32 s5, 9
    s_cselect_b32 s64, s64, 0
    s_add_u32 s60, s60, s64
    v_readlane_b32 s64, v41, 10
    s_add_u32 s63, s63, s64
    s_or_b32 s90, s90, s64
    s_cmp_gt_u32 s5, 10
    s_cselect_b32 s64, s64, 0
    s_add_u32 s60, s60, s64
    v_readlane_b32 s64, v41, 11
    s_add_u32 s63, s63, s64
    s_or_b32 s90, s90, s64
    s_cmp_gt_u32 s5, 11
    s_cselect_b32 s64, s64, 0
    s_add_u32 s60, s60, s64
    v_readlane_b32 s64, v41, 12
    s_add_u32 s63, s63, s64
    s_or_b32 s90, s90, s64
    s_cmp_gt_u32 s5, 12
    s_cselect_b32 s64, s64, 0
    s_add_u32 s60, s60, s64
    v_readlane_b32 s64, v41, 13
    s_add_u32 s63, s63, s64
    s_or_b32 s90, s90, s64
    s_cmp_gt_u32 s5, 13
    s_cselect_b32 s64, s64, 0
    s_add_u32 s60, s60, s64
    v_readlane_b32 s64, v41, 14
    s_add_u32 s63, s63, s64
    s_or_b32 s90, s90, s64
    s_cmp_gt_u32 s5, 14
    s_cselect_b32 s64, s64, 0
    s_add_u32 s60, s60, s64
    v_readlane_b32 s64, v41, 15
    s_add_u32 s63, s63, s64
    s_or_b32 s90, s90, s64
    s_cmp_gt_u32 s5, 15
    s_cselect_b32 s64, s64, 0
    s_add_u32 s60, s60, s64
    s_cmp_ge_u32 s63, 256
    s_cbranch_scc1 main_ck
    buffer_load_dword v41, v42, s[92:95], 0 offen sc1
    s_waitcnt vmcnt(0)
    s_sub_u32 s23, s23, 1
    s_cbranch_scc0 main_c
    s_branch main_end
main_ck:
    s_cmp_eq_u32 s90, 32
    s_cselect_b32 s90, 1, 0
    s_waitcnt lgkmcnt(0)
    s_waitcnt vmcnt(0)
    s_barrier
    s_cmp_lg_u32 s21, 0
    s_cbranch_scc1 sig_1
    v_mov_b32 v3, s19
    s_mov_b64 exec, 1
    buffer_atomic_add v3, off, s[8:11], s18 sc1
    s_mov_b64 exec, -1
sig_1:
    v_mov_b32 v3, 0x20000
    ds_read_b32 v4, v3
    s_cmp_ge_u32 s61, 32
    s_cselect_b32 s17, 0, 1
    s_waitcnt lgkmcnt(0)
    v_readfirstlane_b32 s20, v4
    s_barrier
    s_add_u32 s20, s20, s60
    s_mov_b32 s16, s20
    s_mov_b32 s14, 0
    s_cmp_ge_u32 s20, 32
    s_cbranch_scc1 main_w
    s_cmp_ge_u32 s20, 30
    s_cbranch_scc1 main_P
    s_cmp_ge_u32 s20, 16
    s_cbranch_scc1 main_B
    v_and_b32 v2, 63, v0
    v_and_b32 v3, 1, v0
    v_cmp_eq_u32 vcc, 0, v3
    v_mov_b32 v3, 0xeeeeeeee
    v_mov_b32 v1, 0x44444444
    v_cndmask_b32 v3, v3, v1, vcc
    s_mov_b32 s22, 0
    s_mov_b32 s23, 400000
    v_and_b32 v62, 15, v2
    v_lshrrev_b32 v63, 4, v2
    s_lshl_b32 s26, s21, 2
    s_lshr_b32 s26, 12816, s26
    s_and_b32 s26, s26, 7
    s_lshl_b32 s40, s26, 10
    s_lshl_b32 s26, s21, 2
    s_lshr_b32 s26, 5716, s26
    s_and_b32 s26, s26, 7
    s_lshl_b32 s41, s26, 10
    s_lshl_b32 s26, s21, 2
    s_lshr_b32 s26, 17185, s26
    s_and_b32 s26, s26, 7
    s_lshl_b32 s42, s26, 10
    s_lshl_b32 s26, s21, 2
    s_lshr_b32 s26, 21554, s26
    s_and_b32 s26, s26, 7
    s_lshl_b32 s43, s26, 10
    s_lshl_b32 s26, s21, 2
    s_lshr_b32 s26, 25923, s26
    s_and_b32 s26, s26, 7
    s_lshl_b32 s44, s26, 10
    s_lshl_b32 s26, s21, 2
    s_lshr_b32 s26, 101, s26
    s_and_b32 s26, s26, 7
    s_lshl_b32 s45, s26, 10
    s_lshl_b32 s26, s21, 2
    s_lshr_b32 s26, 8454, s26
    s_and_b32 s26, s26, 7
    s_lshl_b32 s46, s26, 10
    v_bfe_u32 v64, v2, 4, 2
    v_lshlrev_b32 v21, 9, v64
    v_bfe_u32 v64, v2, 3, 1
    v_lshl_add_u32 v21, v64, 8, v21
    v_bfe_u32 v64, v2, 0, 3
    v_lshl_add_u32 v21, v64, 4, v21
    s_lshr_b32 s26, s21, 1
    s_mul_i32 s26, s26, 7
    s_and_b32 s27, s21, 1
    s_add_u32 s29, s26, 3
    s_lshl_b32 s28, s27, 2
    s_add_u32 s28, s28, s26
    s_mul_i32 s26, s20, 14
    s_add_u32 s30, s26, s28
    s_mul_i32 s30, s30, 28672
    s_add_u32 s31, s26, s29
    s_mul_i32 s31, s31, 28672
    s_lshl_b32 s27, s27, 7
    s_add_u32 s31, s31, s27
    v_lshlrev_b32 v4, 4, v2
    s_mul_i32 s26, s21, 18432
    s_add_u32 s26, s26, 0
    v_add_u32 v7, s26, v4
    s_lshl_b32 s26, s21, 13
    v_add_u32 v16, s26, v4
    v_add_u32 v9, 73728, v4
    v_and_b32 v64, 7, v62
    v_lshlrev_b32 v64, 5, v64
    v_lshrrev_b32 v65, 1, v63
    v_lshl_add_u32 v64, v65, 4, v64
    v_add_u32 v64, 73728, v64
    v_and_b32 v65, 1, v63
    v_add_u32 v5, s28, v65
    v_lshl_add_u32 v5, v5, 9, v64
    s_add_u32 s26, s28, 2
    s_sub_u32 s27, s29, s26
    v_mul_i32_i24 v6, s27, v65
    v_add_u32 v6, s26, v6
    v_lshl_add_u32 v6, v6, 9, v64
    s_lshl_b32 s26, s21, 10
    s_add_u32 s26, s26, 81920
    v_add_u32 v10, s26, v4
    v_lshrrev_b32 v64, 1, v62
    v_lshlrev_b32 v64, 4, v64
    v_and_b32 v65, 1, v62
    v_lshl_add_u32 v64, v65, 2, v64
    v_lshl_add_u32 v64, v63, 7, v64
    s_add_u32 s26, s26, 4096
    v_add_u32 v11, s26, v64
    v_and_b32 v65, 1, v63
    v_lshlrev_b32 v64, 4, v62
    v_lshl_add_u32 v64, v65, 3, v64
    s_lshl_b32 s26, s21, 8
    s_add_u32 s26, s26, 81920
    s_lshl_b32 s27, s21, 7
    s_add_u32 s27, s27, 86016
    v_add_u32 v12, s26, v64
    v_add_u32 v64, s27, v64
    v_cmp_gt_u32 vcc, 32, v2
    s_nop 1
    v_cndmask_b32 v12, v64, v12, vcc
    v_lshrrev_b32 v64, 3, v62
    v_lshlrev_b32 v66, 6, v64
    v_lshl_add_u32 v66, v65, 5, v66
    v_and_b32 v64, 7, v62
    v_lshl_add_u32 v66, v64, 2, v66
    s_lshl_b32 s26, s20, 9
    s_lshl_b32 s27, s21, 7
    s_add_u32 s26, s26, s27
    v_add_u32 v66, s26, v66
    v_bfe_u32 v64, v2, 1, 1
    v_lshlrev_b32 v67, 6, v64
    v_bfe_u32 v64, v2, 4, 1
    v_lshl_add_u32 v67, v64, 5, v67
    v_bfe_u32 v64, v2, 0, 1
    v_lshl_add_u32 v67, v64, 3, v67
    s_lshr_b32 s26, s20, 2
    s_lshl_b32 s26, s26, 9
    s_add_u32 s27, s27, s26
    s_and_b32 s26, s20, 1
    s_lshl_b32 s26, s26, 4
    s_add_u32 s27, s27, s26
    s_and_b32 s26, s20, 2
    s_lshl_b32 s26, s26, 1
    s_add_u32 s27, s27, s26
    s_add_u32 s27, s27, 8192
    v_add_u32 v67, s27, v67
    v_cndmask_b32 v13, v67, v66, vcc
    s_mov_b32 s36, -1
    s_mov_b32 s37, 0x000f000f
    v_mov_b32 v67, 2147483632
    v_cndmask_b32 v13, v67, v13, s[36:37]
    v_mov_b32 v66, 86528
    v_cndmask_b32 v12, v66, v12, s[36:37]
    v_mov_b32 v27, 0xff800000
    v_cndmask_b32 v27, v27, -1, s[36:37]
    v_mov_b32 v118, v27
    v_mov_b32 v119, v27
    ds_write_b64 v12, v[118:119] offset:0
    ds_write_b64 v12, v[118:119] offset:1024
    ds_write_b64 v12, v[118:119] offset:2048
    ds_write_b64 v12, v[118:119] offset:3072
    v_mov_b32 v66, 0x7f800000
    v_mov_b32 v26, 0x42c80000
    v_cndmask_b32 v26, v66, v26, s[36:37]
    s_and_b32 s26, s20, 0
    s_lshl_b32 s26, s26, 7
    s_add_u32 s26, s26, 18622464
    v_min_u32 v14, 13, v2
    v_lshl_add_u32 v14, v14, 2, s26
    s_lshl_b32 s26, s20, 2
    s_add_u32 s26, s26, 18623488
    v_lshl_add_u32 v15, v2, 7, s26
    v_cmp_gt_u32 vcc, 1, v2
    s_nop 1
    v_cndmask_b32 v15, v67, v15, vcc
    v_bfe_u32 v64, v2, 0, 1
    v_lshlrev_b32 v19, 2, v64
    v_add_u32 v19, 18612736, v19
    v_mov_b32 v20, -1
    v_lshlrev_b32 v64, 2, v63
    v_add_u32 v64, 0, v64
    v_cmp_eq_u32 vcc, v64, v62
    v_mov_b32 v65, 0x3f803f80
    s_nop 0
    v_cndmask_b32 v28, 0, v65, vcc
    v_lshlrev_b32 v64, 2, v63
    v_add_u32 v64, 2, v64
    v_cmp_eq_u32 vcc, v64, v62
    v_mov_b32 v65, 0x3f803f80
    s_nop 0
    v_cndmask_b32 v29, 0, v65, vcc
    v_lshlrev_b32 v64, 2, v63
    v_add_u32 v64, 1, v64
    v_cmp_eq_u32 vcc, v64, v62
    v_mov_b32 v65, 0x3f803f80
    s_nop 0
    v_cndmask_b32 v30, 0, v65, vcc
    v_lshlrev_b32 v64, 2, v63
    v_add_u32 v64, 3, v64
    v_cmp_eq_u32 vcc, v64, v62
    v_mov_b32 v65, 0x3f803f80
    s_nop 0
    v_cndmask_b32 v31, 0, v65, vcc
    v_mov_b32 v32, v28
    v_mov_b32 v33, v29
    s_bitcmp1_b32 s21, 0
    s_cbranch_scc0 selodd_2
    v_mov_b32 v32, v30
    v_mov_b32 v33, v31
selodd_2:
    v_mov_b64 v[62:63], 0
    v_mov_b64 v[64:65], 0
    v_mov_b64 v[66:67], 0
    v_mov_b64 v[68:69], 0
    v_mov_b64 v[70:71], 0
    v_mov_b64 v[72:73], 0
    v_mov_b64 v[74:75], 0
    v_mov_b64 v[76:77], 0
    v_mov_b64 v[78:79], 0
    v_mov_b64 v[80:81], 0
    v_mov_b64 v[82:83], 0
    v_mov_b64 v[84:85], 0
    v_mov_b64 v[86:87], 0
    v_mov_b64 v[88:89], 0
    v_mov_b64 v[90:91], 0
    v_mov_b64 v[92:93], 0
    v_mov_b64 v[94:95], 0
    v_mov_b64 v[96:97], 0
    v_mov_b64 v[98:99], 0
    v_mov_b64 v[100:101], 0
    v_mov_b64 v[102:103], 0
    v_mov_b64 v[104:105], 0
    v_mov_b64 v[106:107], 0
    v_mov_b64 v[108:109], 0
    v_mov_b64 v[110:111], 0
    v_mov_b64 v[112:113], 0
    v_mov_b64 v[114:115], 0
    v_mov_b64 v[116:117], 0
    s_lshl_b32 s26, s20, 7
    s_add_u32 s26, s26, 18634752
    v_mov_b32 v22, s26
    s_lshl_b32 s26, s21, 3
    s_lshr_b32 s26, 0xa02a0200, s26
    s_and_b32 s26, s26, 0xff
    s_lshl_b32 s26, s26, 6
    s_cmp_eq_u32 s21, 0
    s_cselect_b32 s26, 0xa, s26
    s_cmp_eq_u32 s21, 1
    s_cselect_b32 s26, 0xa8, s26
ww_3:
    buffer_load_dword v23, v22, s[8:11], 0 offen sc1
    s_waitcnt vmcnt(0)
    v_and_b32 v23, s26, v23
    v_cmp_gt_u32 vcc, s26, v23
    s_cbranch_vccz ww_3k
    s_sleep 3
    s_sub_u32 s23, s23, 1
    s_cbranch_scc0 ww_3
    s_mov_b32 s23, 0
ww_3k:
    s_lshl_b32 s32, s40, 2
    s_add_u32 s32, s32, s30
    buffer_load_dwordx4 v[120:123], v21, s[8:11], s32 offen offset:0 sc1
    buffer_load_dwordx4 v[124:127], v21, s[8:11], s32 offen offset:2048 sc1
    buffer_load_dwordx4 v[128:131], v21, s[8:11], s32 offen offset:128 sc1
    buffer_load_dwordx4 v[132:135], v21, s[8:11], s32 offen offset:2176 sc1
    s_lshl_b32 s32, s40, 2
    s_add_u32 s32, s32, s30
    s_add_u32 s32, s32, 28672
    buffer_load_dwordx4 v[136:139], v21, s[8:11], s32 offen offset:0 sc1
    buffer_load_dwordx4 v[140:143], v21, s[8:11], s32 offen offset:2048 sc1
    buffer_load_dwordx4 v[144:147], v21, s[8:11], s32 offen offset:128 sc1
    buffer_load_dwordx4 v[148:151], v21, s[8:11], s32 offen offset:2176 sc1
    s_lshl_b32 s32, s40, 2
    s_add_u32 s32, s32, s30
    s_add_u32 s32, s32, 57344
    buffer_load_dwordx4 v[152:155], v21, s[8:11], s32 offen offset:0 sc1
    buffer_load_dwordx4 v[156:159], v21, s[8:11], s32 offen offset:2048 sc1
    buffer_load_dwordx4 v[160:163], v21, s[8:11], s32 offen offset:128 sc1
    buffer_load_dwordx4 v[164:167], v21, s[8:11], s32 offen offset:2176 sc1
    s_lshl_b32 s32, s40, 2
    s_add_u32 s32, s32, s31
    buffer_load_dwordx4 v[168:171], v21, s[8:11], s32 offen offset:0 sc1
    buffer_load_dwordx4 v[172:175], v21, s[8:11], s32 offen offset:2048 sc1
    s_lshl_b32 s32, s41, 2
    s_add_u32 s32, s32, s30
    buffer_load_dwordx4 v[46:49], v21, s[8:11], s32 offen offset:0 sc1
    buffer_load_dwordx4 v[50:53], v21, s[8:11], s32 offen offset:2048 sc1
    buffer_load_dwordx4 v[54:57], v21, s[8:11], s32 offen offset:128 sc1
    buffer_load_dwordx4 v[58:61], v21, s[8:11], s32 offen offset:2176 sc1
    s_lshl_b32 s32, s41, 2
    s_add_u32 s32, s32, s30
    s_add_u32 s32, s32, 28672
    buffer_load_dwordx4 a[0:3], v21, s[8:11], s32 offen offset:0 sc1
    buffer_load_dwordx4 a[4:7], v21, s[8:11], s32 offen offset:2048 sc1
    buffer_load_dwordx4 a[8:11], v21, s[8:11], s32 offen offset:128 sc1
    buffer_load_dwordx4 a[12:15], v21, s[8:11], s32 offen offset:2176 sc1
    s_lshl_b32 s32, s41, 2
    s_add_u32 s32, s32, s30
    s_add_u32 s32, s32, 57344
    buffer_load_dwordx4 a[16:19], v21, s[8:11], s32 offen offset:0 sc1
    buffer_load_dwordx4 a[20:23], v21, s[8:11], s32 offen offset:2048 sc1
    buffer_load_dwordx4 a[24:27], v21, s[8:11], s32 offen offset:128 sc1
    buffer_load_dwordx4 a[28:31], v21, s[8:11], s32 offen offset:2176 sc1
    s_lshl_b32 s32, s41, 2
    s_add_u32 s32, s32, s31
    buffer_load_dwordx4 a[32:35], v21, s[8:11], s32 offen offset:0 sc1
    buffer_load_dwordx4 a[36:39], v21, s[8:11], s32 offen offset:2048 sc1
    s_lshl_b32 s32, s42, 2
    s_add_u32 s32, s32, s30
    buffer_load_dwordx4 a[40:43], v21, s[8:11], s32 offen offset:0 sc1
    buffer_load_dwordx4 a[44:47], v21, s[8:11], s32 offen offset:2048 sc1
    buffer_load_dwordx4 a[48:51], v21, s[8:11], s32 offen offset:128 sc1
    buffer_load_dwordx4 a[52:55], v21, s[8:11], s32 offen offset:2176 sc1
    s_lshl_b32 s32, s42, 2
    s_add_u32 s32, s32, s30
    s_add_u32 s32, s32, 28672
    buffer_load_dwordx4 a[56:59], v21, s[8:11], s32 offen offset:0 sc1
    buffer_load_dwordx4 a[60:63], v21, s[8:11], s32 offen offset:2048 sc1
    buffer_load_dwordx4 a[64:67], v21, s[8:11], s32 offen offset:128 sc1
    buffer_load_dwordx4 a[68:71], v21, s[8:11], s32 offen offset:2176 sc1
    s_lshl_b32 s32, s42, 2
    s_add_u32 s32, s32, s30
    s_add_u32 s32, s32, 57344
    buffer_load_dwordx4 a[72:75], v21, s[8:11], s32 offen offset:0 sc1
    buffer_load_dwordx4 a[76:79], v21, s[8:11], s32 offen offset:2048 sc1
    buffer_load_dwordx4 a[80:83], v21, s[8:11], s32 offen offset:128 sc1
    buffer_load_dwordx4 a[84:87], v21, s[8:11], s32 offen offset:2176 sc1
    s_lshl_b32 s32, s42, 2
    s_add_u32 s32, s32, s31
    buffer_load_dwordx4 a[88:91], v21, s[8:11], s32 offen offset:0 sc1
    buffer_load_dwordx4 a[92:95], v21, s[8:11], s32 offen offset:2048 sc1
    s_lshl_b32 s32, s43, 2
    s_add_u32 s32, s32, s30
    buffer_load_dwordx4 a[96:99], v21, s[8:11], s32 offen offset:0 sc1
    buffer_load_dwordx4 a[100:103], v21, s[8:11], s32 offen offset:2048 sc1
    buffer_load_dwordx4 a[104:107], v21, s[8:11], s32 offen offset:128 sc1
    buffer_load_dwordx4 a[108:111], v21, s[8:11], s32 offen offset:2176 sc1
    s_lshl_b32 s32, s43, 2
    s_add_u32 s32, s32, s30
    s_add_u32 s32, s32, 28672
    buffer_load_dwordx4 a[112:115], v21, s[8:11], s32 offen offset:0 sc1
    buffer_load_dwordx4 a[116:119], v21, s[8:11], s32 offen offset:2048 sc1
    s_waitcnt vmcnt(46)
    ds_write_b128 v7, v[120:123] offset:0
    buffer_load_dwordx4 a[120:123], v21, s[8:11], s32 offen offset:128 sc1
    buffer_load_dwordx4 a[124:127], v21, s[8:11], s32 offen offset:2176 sc1
    s_waitcnt vmcnt(46)
    ds_write_b128 v7, v[124:127] offset:1024
    s_lshl_b32 s32, s43, 2
    s_add_u32 s32, s32, s30
    s_add_u32 s32, s32, 57344
    buffer_load_dwordx4 a[128:131], v21, s[8:11], s32 offen offset:0 sc1
    buffer_load_dwordx4 a[132:135], v21, s[8:11], s32 offen offset:2048 sc1
    s_waitcnt vmcnt(46)
    ds_write_b128 v7, v[128:131] offset:2048
    buffer_load_dwordx4 a[136:139], v21, s[8:11], s32 offen offset:128 sc1
    buffer_load_dwordx4 a[140:143], v21, s[8:11], s32 offen offset:2176 sc1
    s_waitcnt vmcnt(46)
    ds_write_b128 v7, v[132:135] offset:3072
    s_lshl_b32 s32, s43, 2
    s_add_u32 s32, s32, s31
    buffer_load_dwordx4 a[144:147], v21, s[8:11], s32 offen offset:0 sc1
    buffer_load_dwordx4 a[148:151], v21, s[8:11], s32 offen offset:2048 sc1
    s_waitcnt vmcnt(46)
    ds_write_b128 v7, v[136:139] offset:4096
    s_lshl_b32 s32, s44, 2
    s_add_u32 s32, s32, s30
    buffer_load_dwordx4 a[152:155], v21, s[8:11], s32 offen offset:0 sc1
    buffer_load_dwordx4 a[156:159], v21, s[8:11], s32 offen offset:2048 sc1
    s_waitcnt vmcnt(46)
    ds_write_b128 v7, v[140:143] offset:5120
    buffer_load_dwordx4 a[160:163], v21, s[8:11], s32 offen offset:128 sc1
    buffer_load_dwordx4 a[164:167], v21, s[8:11], s32 offen offset:2176 sc1
    s_waitcnt vmcnt(46)
    ds_write_b128 v7, v[144:147] offset:6144
    s_lshl_b32 s32, s44, 2
    s_add_u32 s32, s32, s30
    s_add_u32 s32, s32, 28672
    buffer_load_dwordx4 a[168:171], v21, s[8:11], s32 offen offset:0 sc1
    buffer_load_dwordx4 a[172:175], v21, s[8:11], s32 offen offset:2048 sc1
    s_waitcnt vmcnt(46)
    ds_write_b128 v7, v[148:151] offset:7168
    buffer_load_dwordx4 a[176:179], v21, s[8:11], s32 offen offset:128 sc1
    buffer_load_dwordx4 a[180:183], v21, s[8:11], s32 offen offset:2176 sc1
    s_waitcnt vmcnt(46)
    ds_write_b128 v7, v[152:155] offset:8192
    s_lshl_b32 s32, s44, 2
    s_add_u32 s32, s32, s30
    s_add_u32 s32, s32, 57344
    buffer_load_dwordx4 a[184:187], v21, s[8:11], s32 offen offset:0 sc1
    buffer_load_dwordx4 a[188:191], v21, s[8:11], s32 offen offset:2048 sc1
    s_waitcnt vmcnt(46)
    ds_write_b128 v7, v[156:159] offset:9216
    buffer_load_dwordx4 a[192:195], v21, s[8:11], s32 offen offset:128 sc1
    buffer_load_dwordx4 a[196:199], v21, s[8:11], s32 offen offset:2176 sc1
    s_waitcnt vmcnt(46)
    ds_write_b128 v7, v[160:163] offset:10240
    s_lshl_b32 s32, s44, 2
    s_add_u32 s32, s32, s31
    buffer_load_dwordx4 a[200:203], v21, s[8:11], s32 offen offset:0 sc1
    buffer_load_dwordx4 a[204:207], v21, s[8:11], s32 offen offset:2048 sc1
    s_waitcnt vmcnt(46)
    ds_write_b128 v7, v[164:167] offset:11264
    s_lshl_b32 s32, s45, 2
    s_add_u32 s32, s32, s30
    buffer_load_dwordx4 a[208:211], v21, s[8:11], s32 offen offset:0 sc1
    buffer_load_dwordx4 a[212:215], v21, s[8:11], s32 offen offset:2048 sc1
    s_waitcnt vmcnt(46)
    ds_write_b128 v7, v[168:171] offset:12288
    buffer_load_dwordx4 a[216:219], v21, s[8:11], s32 offen offset:128 sc1
    buffer_load_dwordx4 a[220:223], v21, s[8:11], s32 offen offset:2176 sc1
    s_waitcnt vmcnt(46)
    ds_write_b128 v7, v[172:175] offset:13312
    s_lshl_b32 s32, s45, 2
    s_add_u32 s32, s32, s30
    s_add_u32 s32, s32, 28672
    buffer_load_dwordx4 a[224:227], v21, s[8:11], s32 offen offset:0 sc1
    buffer_load_dwordx4 a[228:231], v21, s[8:11], s32 offen offset:2048 sc1
    s_waitcnt vmcnt(46)
    ds_write_b128 v7, v[46:49] offset:14336
    buffer_load_dwordx4 a[232:235], v21, s[8:11], s32 offen offset:128 sc1
    buffer_load_dwordx4 a[236:239], v21, s[8:11], s32 offen offset:2176 sc1
    s_waitcnt vmcnt(46)
    ds_write_b128 v7, v[50:53] offset:15360
    s_lshl_b32 s32, s45, 2
    s_add_u32 s32, s32, s30
    s_add_u32 s32, s32, 57344
    buffer_load_dwordx4 a[240:243], v21, s[8:11], s32 offen offset:0 sc1
    buffer_load_dwordx4 a[244:247], v21, s[8:11], s32 offen offset:2048 sc1
    s_waitcnt vmcnt(46)
    ds_write_b128 v7, v[54:57] offset:16384
    buffer_load_dwordx4 a[248:251], v21, s[8:11], s32 offen offset:128 sc1
    buffer_load_dwordx4 a[252:255], v21, s[8:11], s32 offen offset:2176 sc1
    s_waitcnt vmcnt(46)
    ds_write_b128 v7, v[58:61] offset:17408
    s_lshl_b32 s32, s45, 2
    s_add_u32 s32, s32, s31
    buffer_load_dwordx4 v[192:195], v21, s[8:11], s32 offen offset:0 sc1
    buffer_load_dwordx4 v[196:199], v21, s[8:11], s32 offen offset:2048 sc1
    s_waitcnt vmcnt(46)
    s_lshl_b32 s32, s46, 2
    s_add_u32 s32, s32, s30
    buffer_load_dwordx4 v[200:203], v21, s[8:11], s32 offen offset:0 sc1
    buffer_load_dwordx4 v[204:207], v21, s[8:11], s32 offen offset:2048 sc1
    s_waitcnt vmcnt(46)
    buffer_load_dwordx4 v[208:211], v21, s[8:11], s32 offen offset:128 sc1
    buffer_load_dwordx4 v[212:215], v21, s[8:11], s32 offen offset:2176 sc1
    s_waitcnt vmcnt(46)
    s_lshl_b32 s32, s46, 2
    s_add_u32 s32, s32, s30
    s_add_u32 s32, s32, 28672
    buffer_load_dwordx4 v[216:219], v21, s[8:11], s32 offen offset:0 sc1
    buffer_load_dwordx4 v[220:223], v21, s[8:11], s32 offen offset:2048 sc1
    s_waitcnt vmcnt(46)
    buffer_load_dwordx4 v[224:227], v21, s[8:11], s32 offen offset:128 sc1
    buffer_load_dwordx4 v[228:231], v21, s[8:11], s32 offen offset:2176 sc1
    s_waitcnt vmcnt(46)
    s_lshl_b32 s32, s46, 2
    s_add_u32 s32, s32, s30
    s_add_u32 s32, s32, 57344
    buffer_load_dwordx4 v[232:235], v21, s[8:11], s32 offen offset:0 sc1
    buffer_load_dwordx4 v[236:239], v21, s[8:11], s32 offen offset:2048 sc1
    s_waitcnt vmcnt(46)
    buffer_load_dwordx4 v[240:243], v21, s[8:11], s32 offen offset:128 sc1
    buffer_load_dwordx4 v[244:247], v21, s[8:11], s32 offen offset:2176 sc1
    s_waitcnt vmcnt(46)
    s_lshl_b32 s32, s46, 2
    s_add_u32 s32, s32, s31
    buffer_load_dwordx4 v[248:251], v21, s[8:11], s32 offen offset:0 sc1
    buffer_load_dwordx4 v[252:255], v21, s[8:11], s32 offen offset:2048 sc1
    s_cmp_lg_u32 s17, 0
    s_cbranch_scc1 own_4
    v_mov_b32 v24, 0
    buffer_store_dword v24, v15, s[8:11], 0 offen
    s_mov_b32 s27, 18341888
    buffer_store_dword v20, v13, s[8:11], s27 offen
    s_mov_b32 s27, 18352128
    buffer_store_dword v20, v13, s[8:11], s27 offen
    s_mov_b32 s27, 18362368
    buffer_store_dword v20, v13, s[8:11], s27 offen
    s_mov_b32 s27, 18372608
    buffer_store_dword v20, v13, s[8:11], s27 offen
own_4:
    s_waitcnt vmcnt(46)
    s_mov_b32 s30, 13598720
    v_bfe_u32 v22, v0, 0, 4
    v_lshlrev_b32 v21, 3, v22
    v_bfe_u32 v22, v0, 4, 2
    v_mul_u32_u24 v22, 192, v22
    v_add_u32 v21, v22, v21
    v_bfe_u32 v22, v0, 6, 2
    v_mul_u32_u24 v22, 768, v22
    v_add_u32 v21, v22, v21
    v_add_u32 v21, 90112, v21
    v_bfe_u32 v22, v0, 0, 2
    v_mul_u32_u24 v2, 192, v22
    v_bfe_u32 v22, v0, 2, 4
    v_lshl_add_u32 v2, v22, 3, v2
    v_bfe_u32 v22, v0, 6, 2
    v_mul_u32_u24 v22, 768, v22
    v_add_u32 v2, v22, v2
    v_add_u32 v2, 90112, v2
    s_mov_b32 s25, 18372608
    s_mov_b32 s32, 18362368
    s_waitcnt vmcnt(0) lgkmcnt(0)
    v_mov_b32 v23, 0
    s_lshl_b32 s26, s17, 2
    s_add_u32 s26, s26, s21
    s_cmp_eq_u32 s26, 0
    s_cbranch_scc1 A0_top
    s_cmp_eq_u32 s26, 1
    s_cbranch_scc1 A1_top
    s_cmp_eq_u32 s26, 2
    s_cbranch_scc1 A2_top
    s_cmp_eq_u32 s26, 3
    s_cbranch_scc1 A3_top
    s_cmp_eq_u32 s26, 4
    s_cbranch_scc1 Asc10_top
    s_cmp_eq_u32 s26, 5
    s_cbranch_scc1 Asc11_top
    s_cmp_eq_u32 s26, 6
    s_cbranch_scc1 Asc12_top
    s_branch Asc13_top
.p2align 6
A0_top:
    s_add_u32 s30, s30, 32768
    s_add_u32 s31, s30, 4096
    v_mov_b32 v118, v27
    v_mov_b32 v119, v27
    ds_write_b64 v12, v[118:119] offset:0
    ds_write_b64 v12, v[118:119] offset:1024
    ds_write_b64 v12, v[118:119] offset:2048
    ds_write_b64 v12, v[118:119] offset:3072
    buffer_store_dword v20, v13, s[8:11], s32 offen
    s_mov_b32 s32, s25
    ds_read_b128 v[120:123], v7 offset:0
    ds_read_b128 v[124:127], v7 offset:1024
    ds_read_b128 v[128:131], v7 offset:2048
    ds_read_b128 v[132:135], v7 offset:3072
    ds_read_b128 v[136:139], v7 offset:4096
    ds_read_b128 v[140:143], v7 offset:5120
    ds_read_b128 v[144:147], v7 offset:6144
    ds_read_b128 v[148:151], v7 offset:7168
    ds_read_b128 v[152:155], v7 offset:8192
    ds_read_b128 v[156:159], v7 offset:9216
    ds_read_b128 v[160:163], v7 offset:10240
    ds_read_b128 v[164:167], v7 offset:11264
    ds_read_b128 v[168:171], v7 offset:12288
    ds_read_b128 v[172:175], v7 offset:13312
    ds_read_b128 v[46:49], v7 offset:14336
    ds_read_b128 v[50:53], v7 offset:15360
    ds_read_b128 v[54:57], v7 offset:16384
    ds_read_b128 v[58:61], v7 offset:17408
    buffer_load_dword v90, v14, s[8:11], 0 offen sc1
    s_and_b32 s26, s22, 7
    s_mul_i32 s24, s26, 7168
    s_and_b32 s26, s22, 3
    s_nop 2
    buffer_load_dword v91, v14, s[8:11], 0 offen sc1
    s_nop 5
    buffer_load_dword v92, v14, s[8:11], 0 offen sc1
    s_nop 5
    buffer_load_dword v93, v14, s[8:11], 0 offen sc1
    s_nop 5
    buffer_load_dword v106, v14, s[8:11], 0 offen sc1
    s_nop 5
A0_pg:
    s_waitcnt vmcnt(4)
    v_cmp_gt_u32 vcc, s22, v90
    buffer_load_dword v107, v14, s[8:11], 0 offen sc1
    s_cbranch_vccz A0_pg_ok
    s_waitcnt vmcnt(4)
    v_cmp_gt_u32 vcc, s22, v91
    buffer_load_dword v90, v14, s[8:11], 0 offen sc1
    s_cbranch_vccz A0_pg_ok
    s_waitcnt vmcnt(4)
    v_cmp_gt_u32 vcc, s22, v92
    buffer_load_dword v91, v14, s[8:11], 0 offen sc1
    s_cbranch_vccz A0_pg_ok
    s_waitcnt vmcnt(4)
    v_cmp_gt_u32 vcc, s22, v93
    buffer_load_dword v92, v14, s[8:11], 0 offen sc1
    s_cbranch_vccz A0_pg_ok
    s_waitcnt vmcnt(4)
    v_cmp_gt_u32 vcc, s22, v106
    buffer_load_dword v93, v14, s[8:11], 0 offen sc1
    s_cbranch_vccz A0_pg_ok
    s_waitcnt vmcnt(4)
    v_cmp_gt_u32 vcc, s22, v107
    buffer_load_dword v106, v14, s[8:11], 0 offen sc1
    s_cbranch_vccz A0_pg_ok
    s_waitcnt vmcnt(4)
    v_cmp_gt_u32 vcc, s22, v90
    buffer_load_dword v107, v14, s[8:11], 0 offen sc1
    s_cbranch_vccz A0_pg_ok
    s_waitcnt vmcnt(4)
    v_cmp_gt_u32 vcc, s22, v91
    buffer_load_dword v90, v14, s[8:11], 0 offen sc1
    s_cbranch_vccz A0_pg_ok
    s_waitcnt vmcnt(4)
    v_cmp_gt_u32 vcc, s22, v92
    buffer_load_dword v91, v14, s[8:11], 0 offen sc1
    s_cbranch_vccz A0_pg_ok
    s_waitcnt vmcnt(4)
    v_cmp_gt_u32 vcc, s22, v93
    buffer_load_dword v92, v14, s[8:11], 0 offen sc1
    s_cbranch_vccz A0_pg_ok
    s_waitcnt vmcnt(4)
    v_cmp_gt_u32 vcc, s22, v106
    buffer_load_dword v93, v14, s[8:11], 0 offen sc1
    s_cbranch_vccz A0_pg_ok
    s_waitcnt vmcnt(4)
    v_cmp_gt_u32 vcc, s22, v107
    buffer_load_dword v106, v14, s[8:11], 0 offen sc1
    s_cbranch_vccz A0_pg_ok
    s_sub_u32 s23, s23, 1
    s_cbranch_scc0 A0_pg
    s_mov_b32 s23, 0
A0_pg_ok:
    s_barrier
    s_mul_i32 s27, s26, 10240
    s_add_u32 s25, s27, 18341888
    s_add_u32 s27, s24, 18284544
    s_add_u32 s28, s24, 18288640
    buffer_load_dwordx4 v[34:37], v4, s[8:11], s27 offen sc1
    s_barrier
    buffer_load_dwordx4 v[38:41], v4, s[8:11], s28 offen sc1
    s_barrier
    buffer_load_dwordx4 v[176:179], v16, s[8:11], s30 offen offset:0 sc1
    s_waitcnt lgkmcnt(0)
    s_waitcnt vmcnt(2)
A0_retry:
    v_smfmac_f32_16x16x64_bf16 v[62:65], v[34:37], v[120:127], v3
    ds_write_b128 v9, v[34:37] offset:0
    v_smfmac_f32_16x16x64_bf16 v[66:69], v[34:37], v[128:135], v3
    buffer_load_dwordx4 v[180:183], v16, s[8:11], s30 offen offset:1024 sc1
    v_smfmac_f32_16x16x64_bf16 v[70:73], v[34:37], v[136:143], v3
    buffer_load_dwordx4 v[184:187], v16, s[8:11], s31 offen offset:0 sc1
    v_smfmac_f32_16x16x64_bf16 v[74:77], v[34:37], v[144:151], v3
    v_max_u32 v22, v34, v35
    v_smfmac_f32_16x16x64_bf16 v[78:81], v[34:37], v[152:159], v3
    s_waitcnt vmcnt(3)
    ds_write_b128 v9, v[38:41] offset:4096
    v_max3_u32 v22, v36, v37, v22
    v_smfmac_f32_16x16x64_bf16 v[82:85], v[34:37], v[160:167], v3
    v_max3_u32 v22, v38, v39, v22
    v_smfmac_f32_16x16x64_bf16 v[86:89], v[34:37], v[168:175], v3
    v_max3_u32 v22, v40, v41, v22
    v_smfmac_f32_16x16x64_bf16 v[62:65], v[38:41], v[46:53], v3
    v_cmp_eq_u32 vcc, -1, v22
    v_smfmac_f32_16x16x64_bf16 v[66:69], v[38:41], v[54:61], v3
    buffer_load_dwordx4 v[188:191], v16, s[8:11], s31 offen offset:1024 sc1
    v_smfmac_f32_16x16x64_bf16 v[70:73], v[38:41], a[0:7], v3
    s_waitcnt lgkmcnt(0)
    s_cbranch_vccnz A0_fix
    v_smfmac_f32_16x16x64_bf16 v[74:77], v[38:41], a[8:15], v3
    s_barrier
    ds_read_b128 v[42:45], v9 offset:1024
    v_smfmac_f32_16x16x64_bf16 v[78:81], v[38:41], a[16:23], v3
    ds_read_b128 v[46:49], v9 offset:2048
    v_smfmac_f32_16x16x64_bf16 v[82:85], v[38:41], a[24:31], v3
    ds_read_b128 v[50:53], v9 offset:3072
    v_smfmac_f32_16x16x64_bf16 v[86:89], v[38:41], a[32:39], v3
    ds_read_b128 v[54:57], v9 offset:5120
    s_waitcnt lgkmcnt(3)
    v_smfmac_f32_16x16x64_bf16 v[62:65], v[42:45], a[40:47], v3
    ds_read_b128 v[58:61], v9 offset:6144
    v_smfmac_f32_16x16x64_bf16 v[66:69], v[42:45], a[48:55], v3
    buffer_load_dwordx4 v[120:123], v16, s[8:11], s30 offen offset:2048 sc1
    v_smfmac_f32_16x16x64_bf16 v[70:73], v[42:45], a[56:63], v3
    v_smfmac_f32_16x16x64_bf16 v[74:77], v[42:45], a[64:71], v3
    v_smfmac_f32_16x16x64_bf16 v[78:81], v[42:45], a[72:79], v3
    v_smfmac_f32_16x16x64_bf16 v[82:85], v[42:45], a[80:87], v3
    buffer_load_dwordx4 v[124:127], v16, s[8:11], s30 offen offset:3072 sc1
    v_smfmac_f32_16x16x64_bf16 v[86:89], v[42:45], a[88:95], v3
    s_waitcnt lgkmcnt(0)
    v_smfmac_f32_16x16x64_bf16 v[62:65], v[46:49], a[96:103], v3
    s_nop 2
    v_smfmac_f32_16x16x64_bf16 v[62:65], v[50:53], a[152:159], v3
    s_nop 2
    v_smfmac_f32_16x16x64_bf16 v[62:65], v[54:57], a[208:215], v3
    s_nop 0
    buffer_load_dwordx4 v[128:131], v16, s[8:11], s31 offen offset:2048 sc1
    v_smfmac_f32_16x16x64_bf16 v[62:65], v[58:61], v[200:207], v3
    s_nop 2
    v_smfmac_f32_16x16x64_bf16 v[66:69], v[46:49], a[104:111], v3
    s_nop 2
    v_smfmac_f32_16x16x64_bf16 v[66:69], v[50:53], a[160:167], v3
    s_nop 2
    v_smfmac_f32_16x16x64_bf16 v[66:69], v[54:57], a[216:223], v3
    s_nop 0
    buffer_load_dwordx4 v[132:135], v16, s[8:11], s31 offen offset:3072 sc1
    v_smfmac_f32_16x16x64_bf16 v[66:69], v[58:61], v[208:215], v3
    s_nop 0
    ds_read_b128 v[152:155], v5 offset:0
    v_add_f32 v62, v62, v63
    v_smfmac_f32_16x16x64_bf16 v[70:73], v[46:49], a[112:119], v3
    s_nop 0
    ds_read_b128 v[156:159], v5 offset:256
    v_add_f32 v64, v64, v65
    v_smfmac_f32_16x16x64_bf16 v[70:73], v[50:53], a[168:175], v3
    s_nop 0
    ds_read_b128 v[160:163], v6 offset:0
    v_add_f32 v66, v66, v67
    v_smfmac_f32_16x16x64_bf16 v[70:73], v[54:57], a[224:231], v3
    s_nop 0
    ds_read_b128 v[164:167], v6 offset:256
    v_cvt_pk_bf16_f32 v90, v62, v66
    v_smfmac_f32_16x16x64_bf16 v[70:73], v[58:61], v[216:223], v3
    s_nop 1
    v_add_f32 v68, v68, v69
    v_smfmac_f32_16x16x64_bf16 v[74:77], v[46:49], a[120:127], v3
    s_nop 1
    v_cvt_pk_bf16_f32 v91, v64, v68
    v_smfmac_f32_16x16x64_bf16 v[74:77], v[50:53], a[176:183], v3
    s_nop 0
    ds_write_b64 v21, v[90:91]
    v_smfmac_f32_16x16x64_bf16 v[74:77], v[54:57], a[232:239], v3
    s_nop 1
    ds_read_b64_tr_b16 v[168:169], v2
    v_smfmac_f32_16x16x64_bf16 v[74:77], v[58:61], v[224:231], v3
    s_nop 1
    v_add_f32 v70, v70, v71
    v_smfmac_f32_16x16x64_bf16 v[78:81], v[46:49], a[128:135], v3
    s_nop 1
    v_add_f32 v72, v72, v73
    v_smfmac_f32_16x16x64_bf16 v[78:81], v[50:53], a[184:191], v3
    s_nop 1
    v_add_f32 v74, v74, v75
    v_smfmac_f32_16x16x64_bf16 v[78:81], v[54:57], a[240:247], v3
    s_nop 1
    v_cvt_pk_bf16_f32 v90, v70, v74
    v_smfmac_f32_16x16x64_bf16 v[78:81], v[58:61], v[232:239], v3
    s_nop 1
    v_add_f32 v76, v76, v77
    v_smfmac_f32_16x16x64_bf16 v[82:85], v[46:49], a[136:143], v3
    s_nop 1
    v_cvt_pk_bf16_f32 v91, v72, v76
    v_smfmac_f32_16x16x64_bf16 v[82:85], v[50:53], a[192:199], v3
    s_nop 0
    ds_write_b64 v21, v[90:91]
    v_smfmac_f32_16x16x64_bf16 v[82:85], v[54:57], a[248:255], v3
    s_nop 1
    ds_read_b64_tr_b16 v[170:171], v2
    v_smfmac_f32_16x16x64_bf16 v[82:85], v[58:61], v[240:247], v3
    s_nop 1
    v_cvt_pk_bf16_f32 v90, v78, v79
    v_smfmac_f32_16x16x64_bf16 v[86:89], v[46:49], a[144:151], v3
    s_nop 1
    v_cvt_pk_bf16_f32 v91, v80, v81
    v_smfmac_f32_16x16x64_bf16 v[86:89], v[50:53], a[200:207], v3
    s_nop 1
    v_cvt_pk_bf16_f32 v92, v82, v83
    v_smfmac_f32_16x16x64_bf16 v[86:89], v[54:57], v[192:199], v3
    s_nop 1
    v_cvt_pk_bf16_f32 v93, v84, v85
    v_smfmac_f32_16x16x64_bf16 v[86:89], v[58:61], v[248:255], v3
    s_nop 0
    s_waitcnt vmcnt(4)
    s_waitcnt lgkmcnt(0)
    v_mfma_f32_16x16x32_bf16 v[106:109], v[90:93], v[28:31], 0
    s_nop 2
    v_smfmac_f32_16x16x64_bf16 v[98:101], v[168:171], v[176:183], v3
    v_cvt_pk_bf16_f32 v38, v86, v87
    v_cvt_pk_bf16_f32 v39, v88, v89
    s_nop 1
    v_mfma_f32_16x16x16_bf16 v[34:37], v[38:39], v[32:33], 0
    v_cvt_pk_bf16_f32 v172, v106, v107
    v_cvt_pk_bf16_f32 v173, v108, v109
    v_smfmac_f32_16x16x64_bf16 v[102:105], v[168:171], v[184:191], v3
    s_nop 2
    v_smfmac_f32_16x16x64_bf16 v[94:97], v[168:171], v[152:159], v3
    s_nop 0
    v_cvt_pk_bf16_f32 v174, v34, v35
    v_cvt_pk_bf16_f32 v175, v36, v37
    s_add_u32 s22, s22, 1
    s_waitcnt vmcnt(0)
    v_smfmac_f32_16x16x64_bf16 v[98:101], v[172:175], v[120:127], v3
    s_nop 1
    v_mov_b32 v25, s22
    v_smfmac_f32_16x16x64_bf16 v[102:105], v[172:175], v[128:135], v3
    s_nop 2
    v_smfmac_f32_16x16x64_bf16 v[94:97], v[172:175], v[160:167], v3
    s_nop 1
    v_add_f32 v42, v98, v99
    v_add_f32 v44, v100, v101
    v_add_f32 v43, v102, v103
    v_add_f32 v45, v104, v105
    v_mfma_f32_32x32x16_bf16 v[62:77], v[110:113], v[110:113], 0
    ds_write_b128 v10, v[42:45]
    v_add_f32 v46, v94, v95
    v_add_f32 v47, v96, v97
    ds_write2_b32 v11, v46, v47 offset0:0 offset1:2
    v_mfma_f32_32x32x16_bf16 v[78:93], v[110:113], v[110:113], 0
    s_barrier
    ds_read_b64 v[50:51], v12 offset:0
    ds_read_b64 v[52:53], v12 offset:1024
    ds_read_b64 v[54:55], v12 offset:2048
    ds_read_b64 v[56:57], v12 offset:3072
    v_mfma_f32_32x32x16_bf16 v[94:109], v[110:113], v[110:113], 0
    s_waitcnt lgkmcnt(2)
    v_add_f32 v50, v50, v52
    v_add_f32 v51, v51, v53
    s_waitcnt lgkmcnt(1)
    v_add_f32 v50, v50, v54
    v_add_f32 v51, v51, v55
    s_waitcnt lgkmcnt(0)
    v_add_f32 v50, v50, v56
    v_add_f32 v51, v51, v57
    v_exp_f32 v118, v50
    v_exp_f32 v119, v51
    v_add_f32 v58, abs(v50), abs(v51)
A0_back:
    v_add_f32 v59, v118, v119
    v_add_f32 v60, v118, v119
    v_cmp_nge_f32 vcc, v26, v58
    s_nop 0
    v_permlane32_swap_b32 v59, v60
    v_add_f32 v59, v59, v60
    s_nop 1
    v_add_f32_dpp v59, v59, v59 row_ror:1 row_mask:0xf bank_mask:0xf
    s_nop 1
    v_add_f32_dpp v59, v59, v59 row_ror:2 row_mask:0xf bank_mask:0xf
    s_cbranch_vccnz A0_slow
    s_nop 0
    v_add_f32_dpp v59, v59, v59 row_ror:4 row_mask:0xf bank_mask:0xf
    s_nop 1
    v_add_f32_dpp v59, v59, v59 row_ror:8 row_mask:0xf bank_mask:0xf
    v_rcp_f32 v59, v59
    s_nop 0
    v_pk_mul_f32 v[60:61], v[118:119], v[58:59] op_sel:[0,1] op_sel_hi:[1,1]
    v_cvt_pk_bf16_f32 v60, v60, v61
    buffer_store_dword v60, v13, s[8:11], s25 offen
    s_cmp_lt_u32 s22, 63
    s_cbranch_scc1 A0_top
    s_branch A_done
A0_fix:
    buffer_load_dwordx4 v[34:37], v4, s[8:11], s27 offen sc1
    buffer_load_dwordx4 v[38:41], v4, s[8:11], s28 offen sc1
    s_nop 4
    s_nop 0
    v_mov_b64 v[62:63], 0
    v_mov_b64 v[64:65], 0
    v_mov_b64 v[66:67], 0
    v_mov_b64 v[68:69], 0
    v_mov_b64 v[70:71], 0
    v_mov_b64 v[72:73], 0
    v_mov_b64 v[74:75], 0
    v_mov_b64 v[76:77], 0
    v_mov_b64 v[78:79], 0
    v_mov_b64 v[80:81], 0
    v_mov_b64 v[82:83], 0
    v_mov_b64 v[84:85], 0
    v_mov_b64 v[86:87], 0
    v_mov_b64 v[88:89], 0
    s_waitcnt vmcnt(2)
    ds_read_b128 v[120:123], v7 offset:0
    ds_read_b128 v[124:127], v7 offset:1024
    ds_read_b128 v[128:131], v7 offset:2048
    ds_read_b128 v[132:135], v7 offset:3072
    s_waitcnt vmcnt(0) lgkmcnt(0)
    s_sub_u32 s23, s23, 1
    s_cbranch_scc0 A0_retry
    s_branch A_done
A0_slow:
    ds_read_b64 v[50:51], v12 offset:0
    ds_read_b64 v[52:53], v12 offset:1024
    ds_read_b64 v[54:55], v12 offset:2048
    ds_read_b64 v[56:57], v12 offset:3072
    s_sub_u32 s23, s23, 1
    s_cbranch_scc1 A_done
    s_waitcnt lgkmcnt(0)
    v_max_u32 v59, v50, v51
    v_max3_u32 v59, v52, v53, v59
    v_max3_u32 v59, v54, v55, v59
    v_max3_u32 v59, v56, v57, v59
    v_cmp_eq_u32 vcc, -1, v59
    s_cbranch_vccnz A0_slow
    v_add_f32 v50, v50, v52
    v_add_f32 v51, v51, v53
    v_add_f32 v50, v50, v54
    v_add_f32 v51, v51, v55
    v_add_f32 v50, v50, v56
    v_add_f32 v51, v51, v57
    v_max_f32 v59, v50, v51
    v_mov_b32 v60, v59
    s_nop 1
    v_permlane32_swap_b32 v59, v60
    v_max_f32 v59, v59, v60
    s_nop 1
    v_max_f32_dpp v59, v59, v59 row_ror:1 row_mask:0xf bank_mask:0xf
    s_nop 1
    v_max_f32_dpp v59, v59, v59 row_ror:2 row_mask:0xf bank_mask:0xf
    s_nop 1
    v_max_f32_dpp v59, v59, v59 row_ror:4 row_mask:0xf bank_mask:0xf
    s_nop 1
    v_max_f32_dpp v59, v59, v59 row_ror:8 row_mask:0xf bank_mask:0xf
    v_sub_f32 v50, v50, v59
    v_sub_f32 v51, v51, v59
    v_exp_f32 v118, v50
    v_exp_f32 v119, v51
    v_mov_b32 v58, 0
    s_branch A0_back
.p2align 6
A1_top:
    s_add_u32 s30, s30, 32768
    s_add_u32 s31, s30, 4096
    v_mov_b32 v118, v27
    v_mov_b32 v119, v27
    ds_write_b64 v12, v[118:119] offset:0
    ds_write_b64 v12, v[118:119] offset:1024
    ds_write_b64 v12, v[118:119] offset:2048
    ds_write_b64 v12, v[118:119] offset:3072
    buffer_store_dword v20, v13, s[8:11], s32 offen
    s_mov_b32 s32, s25
    ds_read_b128 v[120:123], v7 offset:0
    ds_read_b128 v[124:127], v7 offset:1024
    ds_read_b128 v[128:131], v7 offset:2048
    ds_read_b128 v[132:135], v7 offset:3072
    ds_read_b128 v[136:139], v7 offset:4096
    ds_read_b128 v[140:143], v7 offset:5120
    ds_read_b128 v[144:147], v7 offset:6144
    ds_read_b128 v[148:151], v7 offset:7168
    ds_read_b128 v[152:155], v7 offset:8192
    ds_read_b128 v[156:159], v7 offset:9216
    ds_read_b128 v[160:163], v7 offset:10240
    ds_read_b128 v[164:167], v7 offset:11264
    ds_read_b128 v[168:171], v7 offset:12288
    ds_read_b128 v[172:175], v7 offset:13312
    ds_read_b128 v[46:49], v7 offset:14336
    ds_read_b128 v[50:53], v7 offset:15360
    ds_read_b128 v[54:57], v7 offset:16384
    ds_read_b128 v[58:61], v7 offset:17408
    s_and_b32 s26, s22, 7
    s_mul_i32 s24, s26, 7168
    s_and_b32 s26, s22, 3
    s_barrier
    s_mul_i32 s27, s26, 10240
    s_add_u32 s25, s27, 18341888
    s_add_u32 s27, s24, 18285568
    s_add_u32 s28, s24, 18289664
    buffer_load_dwordx4 v[34:37], v4, s[8:11], s27 offen sc1
    s_barrier
    buffer_load_dwordx4 v[38:41], v4, s[8:11], s28 offen sc1
    s_barrier
    buffer_load_dwordx4 v[176:179], v16, s[8:11], s30 offen offset:0 sc1
    s_waitcnt lgkmcnt(0)
    s_waitcnt vmcnt(2)
A1_retry:
    v_smfmac_f32_16x16x64_bf16 v[62:65], v[34:37], v[120:127], v3
    ds_write_b128 v9, v[34:37] offset:1024
    v_smfmac_f32_16x16x64_bf16 v[66:69], v[34:37], v[128:135], v3
    buffer_load_dwordx4 v[180:183], v16, s[8:11], s30 offen offset:1024 sc1
    v_smfmac_f32_16x16x64_bf16 v[70:73], v[34:37], v[136:143], v3
    buffer_load_dwordx4 v[184:187], v16, s[8:11], s31 offen offset:0 sc1
    v_smfmac_f32_16x16x64_bf16 v[74:77], v[34:37], v[144:151], v3
    v_max_u32 v22, v34, v35
    v_smfmac_f32_16x16x64_bf16 v[78:81], v[34:37], v[152:159], v3
    s_waitcnt vmcnt(3)
    ds_write_b128 v9, v[38:41] offset:5120
    v_max3_u32 v22, v36, v37, v22
    v_smfmac_f32_16x16x64_bf16 v[82:85], v[34:37], v[160:167], v3
    v_max3_u32 v22, v38, v39, v22
    v_smfmac_f32_16x16x64_bf16 v[86:89], v[34:37], v[168:175], v3
    v_max3_u32 v22, v40, v41, v22
    v_smfmac_f32_16x16x64_bf16 v[62:65], v[38:41], v[46:53], v3
    v_cmp_eq_u32 vcc, -1, v22
    v_smfmac_f32_16x16x64_bf16 v[66:69], v[38:41], v[54:61], v3
    buffer_load_dwordx4 v[188:191], v16, s[8:11], s31 offen offset:1024 sc1
    v_smfmac_f32_16x16x64_bf16 v[70:73], v[38:41], a[0:7], v3
    s_waitcnt lgkmcnt(0)
    s_cbranch_vccnz A1_fix
    v_smfmac_f32_16x16x64_bf16 v[74:77], v[38:41], a[8:15], v3
    s_barrier
    ds_read_b128 v[42:45], v9 offset:2048
    v_smfmac_f32_16x16x64_bf16 v[78:81], v[38:41], a[16:23], v3
    ds_read_b128 v[46:49], v9 offset:3072
    v_smfmac_f32_16x16x64_bf16 v[82:85], v[38:41], a[24:31], v3
    ds_read_b128 v[50:53], v9 offset:4096
    v_smfmac_f32_16x16x64_bf16 v[86:89], v[38:41], a[32:39], v3
    ds_read_b128 v[54:57], v9 offset:6144
    s_waitcnt lgkmcnt(3)
    v_smfmac_f32_16x16x64_bf16 v[62:65], v[42:45], a[40:47], v3
    ds_read_b128 v[58:61], v9 offset:0
    v_smfmac_f32_16x16x64_bf16 v[66:69], v[42:45], a[48:55], v3
    buffer_load_dwordx4 v[120:123], v16, s[8:11], s30 offen offset:2048 sc1
    v_smfmac_f32_16x16x64_bf16 v[70:73], v[42:45], a[56:63], v3
    v_smfmac_f32_16x16x64_bf16 v[74:77], v[42:45], a[64:71], v3
    v_smfmac_f32_16x16x64_bf16 v[78:81], v[42:45], a[72:79], v3
    v_smfmac_f32_16x16x64_bf16 v[82:85], v[42:45], a[80:87], v3
    buffer_load_dwordx4 v[124:127], v16, s[8:11], s30 offen offset:3072 sc1
    v_smfmac_f32_16x16x64_bf16 v[86:89], v[42:45], a[88:95], v3
    s_waitcnt lgkmcnt(0)
    v_smfmac_f32_16x16x64_bf16 v[62:65], v[46:49], a[96:103], v3
    s_nop 2
    v_smfmac_f32_16x16x64_bf16 v[62:65], v[50:53], a[152:159], v3
    s_nop 2
    v_smfmac_f32_16x16x64_bf16 v[62:65], v[54:57], a[208:215], v3
    s_nop 0
    buffer_load_dwordx4 v[128:131], v16, s[8:11], s31 offen offset:2048 sc1
    v_smfmac_f32_16x16x64_bf16 v[62:65], v[58:61], v[200:207], v3
    s_nop 2
    v_smfmac_f32_16x16x64_bf16 v[66:69], v[46:49], a[104:111], v3
    s_nop 2
    v_smfmac_f32_16x16x64_bf16 v[66:69], v[50:53], a[160:167], v3
    s_nop 2
    v_smfmac_f32_16x16x64_bf16 v[66:69], v[54:57], a[216:223], v3
    s_nop 0
    buffer_load_dwordx4 v[132:135], v16, s[8:11], s31 offen offset:3072 sc1
    v_smfmac_f32_16x16x64_bf16 v[66:69], v[58:61], v[208:215], v3
    s_nop 0
    ds_read_b128 v[152:155], v5 offset:0
    v_add_f32 v62, v62, v63
    v_smfmac_f32_16x16x64_bf16 v[70:73], v[46:49], a[112:119], v3
    s_nop 0
    ds_read_b128 v[156:159], v5 offset:256
    v_add_f32 v64, v64, v65
    v_smfmac_f32_16x16x64_bf16 v[70:73], v[50:53], a[168:175], v3
    s_nop 0
    ds_read_b128 v[160:163], v6 offset:0
    v_add_f32 v66, v66, v67
    v_smfmac_f32_16x16x64_bf16 v[70:73], v[54:57], a[224:231], v3
    s_nop 0
    ds_read_b128 v[164:167], v6 offset:256
    v_cvt_pk_bf16_f32 v90, v62, v66
    v_smfmac_f32_16x16x64_bf16 v[70:73], v[58:61], v[216:223], v3
    s_nop 1
    v_add_f32 v68, v68, v69
    v_smfmac_f32_16x16x64_bf16 v[74:77], v[46:49], a[120:127], v3
    s_nop 1
    v_cvt_pk_bf16_f32 v91, v64, v68
    v_smfmac_f32_16x16x64_bf16 v[74:77], v[50:53], a[176:183], v3
    s_nop 0
    ds_write_b64 v21, v[90:91]
    v_smfmac_f32_16x16x64_bf16 v[74:77], v[54:57], a[232:239], v3
    s_nop 1
    ds_read_b64_tr_b16 v[168:169], v2
    v_smfmac_f32_16x16x64_bf16 v[74:77], v[58:61], v[224:231], v3
    s_nop 1
    v_add_f32 v70, v70, v71
    v_smfmac_f32_16x16x64_bf16 v[78:81], v[46:49], a[128:135], v3
    s_nop 1
    v_add_f32 v72, v72, v73
    v_smfmac_f32_16x16x64_bf16 v[78:81], v[50:53], a[184:191], v3
    s_nop 1
    v_add_f32 v74, v74, v75
    v_smfmac_f32_16x16x64_bf16 v[78:81], v[54:57], a[240:247], v3
    s_nop 1
    v_cvt_pk_bf16_f32 v90, v70, v74
    v_smfmac_f32_16x16x64_bf16 v[78:81], v[58:61], v[232:239], v3
    s_nop 1
    v_add_f32 v76, v76, v77
    v_smfmac_f32_16x16x64_bf16 v[82:85], v[46:49], a[136:143], v3
    s_nop 1
    v_cvt_pk_bf16_f32 v91, v72, v76
    v_smfmac_f32_16x16x64_bf16 v[82:85], v[50:53], a[192:199], v3
    s_nop 0
    ds_write_b64 v21, v[90:91]
    v_smfmac_f32_16x16x64_bf16 v[82:85], v[54:57], a[248:255], v3
    s_nop 1
    ds_read_b64_tr_b16 v[170:171], v2
    v_smfmac_f32_16x16x64_bf16 v[82:85], v[58:61], v[240:247], v3
    s_nop 1
    v_cvt_pk_bf16_f32 v90, v78, v79
    v_smfmac_f32_16x16x64_bf16 v[86:89], v[46:49], a[144:151], v3
    s_nop 1
    v_cvt_pk_bf16_f32 v91, v80, v81
    v_smfmac_f32_16x16x64_bf16 v[86:89], v[50:53], a[200:207], v3
    s_nop 1
    v_cvt_pk_bf16_f32 v92, v82, v83
    v_smfmac_f32_16x16x64_bf16 v[86:89], v[54:57], v[192:199], v3
    s_nop 1
    v_cvt_pk_bf16_f32 v93, v84, v85
    v_smfmac_f32_16x16x64_bf16 v[86:89], v[58:61], v[248:255], v3
    s_nop 0
    s_waitcnt vmcnt(4)
    s_waitcnt lgkmcnt(0)
    v_mfma_f32_16x16x32_bf16 v[106:109], v[90:93], v[28:31], 0
    s_nop 2
    v_smfmac_f32_16x16x64_bf16 v[98:101], v[168:171], v[176:183], v3
    v_cvt_pk_bf16_f32 v38, v86, v87
    v_cvt_pk_bf16_f32 v39, v88, v89
    s_nop 1
    v_mfma_f32_16x16x16_bf16 v[34:37], v[38:39], v[32:33], 0
    v_cvt_pk_bf16_f32 v172, v106, v107
    v_cvt_pk_bf16_f32 v173, v108, v109
    v_smfmac_f32_16x16x64_bf16 v[102:105], v[168:171], v[184:191], v3
    s_nop 2
    v_smfmac_f32_16x16x64_bf16 v[94:97], v[168:171], v[152:159], v3
    s_nop 0
    v_cvt_pk_bf16_f32 v174, v34, v35
    v_cvt_pk_bf16_f32 v175, v36, v37
    s_add_u32 s22, s22, 1
    s_waitcnt vmcnt(0)
    v_smfmac_f32_16x16x64_bf16 v[98:101], v[172:175], v[120:127], v3
    s_nop 1
    v_mov_b32 v25, s22
    v_smfmac_f32_16x16x64_bf16 v[102:105], v[172:175], v[128:135], v3
    s_nop 2
    v_smfmac_f32_16x16x64_bf16 v[94:97], v[172:175], v[160:167], v3
    s_nop 1
    v_add_f32 v42, v98, v99
    v_add_f32 v44, v100, v101
    v_add_f32 v43, v102, v103
    v_add_f32 v45, v104, v105
    v_mfma_f32_32x32x16_bf16 v[62:77], v[110:113], v[110:113], 0
    ds_write_b128 v10, v[42:45]
    v_add_f32 v46, v94, v95
    v_add_f32 v47, v96, v97
    ds_write2_b32 v11, v46, v47 offset0:0 offset1:2
    v_mfma_f32_32x32x16_bf16 v[78:93], v[110:113], v[110:113], 0
    s_barrier
    ds_read_b64 v[50:51], v12 offset:0
    ds_read_b64 v[52:53], v12 offset:1024
    ds_read_b64 v[54:55], v12 offset:2048
    ds_read_b64 v[56:57], v12 offset:3072
    buffer_store_dword v25, v15, s[8:11], 0 offen
    v_mfma_f32_32x32x16_bf16 v[94:109], v[110:113], v[110:113], 0
    s_waitcnt lgkmcnt(2)
    v_add_f32 v50, v50, v52
    v_add_f32 v51, v51, v53
    s_waitcnt lgkmcnt(1)
    v_add_f32 v50, v50, v54
    v_add_f32 v51, v51, v55
    s_waitcnt lgkmcnt(0)
    v_add_f32 v50, v50, v56
    v_add_f32 v51, v51, v57
    v_exp_f32 v118, v50
    v_exp_f32 v119, v51
    v_add_f32 v58, abs(v50), abs(v51)
A1_back:
    v_add_f32 v59, v118, v119
    v_add_f32 v60, v118, v119
    v_cmp_nge_f32 vcc, v26, v58
    s_nop 0
    v_permlane32_swap_b32 v59, v60
    v_add_f32 v59, v59, v60
    s_nop 1
    v_add_f32_dpp v59, v59, v59 row_ror:1 row_mask:0xf bank_mask:0xf
    s_nop 1
    v_add_f32_dpp v59, v59, v59 row_ror:2 row_mask:0xf bank_mask:0xf
    s_cbranch_vccnz A1_slow
    s_nop 0
    v_add_f32_dpp v59, v59, v59 row_ror:4 row_mask:0xf bank_mask:0xf
    s_nop 1
    v_add_f32_dpp v59, v59, v59 row_ror:8 row_mask:0xf bank_mask:0xf
    v_rcp_f32 v59, v59
    s_nop 0
    v_pk_mul_f32 v[60:61], v[118:119], v[58:59] op_sel:[0,1] op_sel_hi:[1,1]
    v_cvt_pk_bf16_f32 v60, v60, v61
    buffer_store_dword v60, v13, s[8:11], s25 offen
    s_cmp_lt_u32 s22, 63
    s_cbranch_scc1 A1_top
    s_branch A_done
A1_fix:
    buffer_load_dwordx4 v[34:37], v4, s[8:11], s27 offen sc1
    buffer_load_dwordx4 v[38:41], v4, s[8:11], s28 offen sc1
    s_nop 4
    s_nop 0
    v_mov_b64 v[62:63], 0
    v_mov_b64 v[64:65], 0
    v_mov_b64 v[66:67], 0
    v_mov_b64 v[68:69], 0
    v_mov_b64 v[70:71], 0
    v_mov_b64 v[72:73], 0
    v_mov_b64 v[74:75], 0
    v_mov_b64 v[76:77], 0
    v_mov_b64 v[78:79], 0
    v_mov_b64 v[80:81], 0
    v_mov_b64 v[82:83], 0
    v_mov_b64 v[84:85], 0
    v_mov_b64 v[86:87], 0
    v_mov_b64 v[88:89], 0
    s_waitcnt vmcnt(2)
    ds_read_b128 v[120:123], v7 offset:0
    ds_read_b128 v[124:127], v7 offset:1024
    ds_read_b128 v[128:131], v7 offset:2048
    ds_read_b128 v[132:135], v7 offset:3072
    s_waitcnt vmcnt(0) lgkmcnt(0)
    s_sub_u32 s23, s23, 1
    s_cbranch_scc0 A1_retry
    s_branch A_done
A1_slow:
    ds_read_b64 v[50:51], v12 offset:0
    ds_read_b64 v[52:53], v12 offset:1024
    ds_read_b64 v[54:55], v12 offset:2048
    ds_read_b64 v[56:57], v12 offset:3072
    s_sub_u32 s23, s23, 1
    s_cbranch_scc1 A_done
    s_waitcnt lgkmcnt(0)
    v_max_u32 v59, v50, v51
    v_max3_u32 v59, v52, v53, v59
    v_max3_u32 v59, v54, v55, v59
    v_max3_u32 v59, v56, v57, v59
    v_cmp_eq_u32 vcc, -1, v59
    s_cbranch_vccnz A1_slow
    v_add_f32 v50, v50, v52
    v_add_f32 v51, v51, v53
    v_add_f32 v50, v50, v54
    v_add_f32 v51, v51, v55
    v_add_f32 v50, v50, v56
    v_add_f32 v51, v51, v57
    v_max_f32 v59, v50, v51
    v_mov_b32 v60, v59
    s_nop 1
    v_permlane32_swap_b32 v59, v60
    v_max_f32 v59, v59, v60
    s_nop 1
    v_max_f32_dpp v59, v59, v59 row_ror:1 row_mask:0xf bank_mask:0xf
    s_nop 1
    v_max_f32_dpp v59, v59, v59 row_ror:2 row_mask:0xf bank_mask:0xf
    s_nop 1
    v_max_f32_dpp v59, v59, v59 row_ror:4 row_mask:0xf bank_mask:0xf
    s_nop 1
    v_max_f32_dpp v59, v59, v59 row_ror:8 row_mask:0xf bank_mask:0xf
    v_sub_f32 v50, v50, v59
    v_sub_f32 v51, v51, v59
    v_exp_f32 v118, v50
    v_exp_f32 v119, v51
    v_mov_b32 v58, 0
    s_branch A1_back
.p2align 6
A2_top:
    s_add_u32 s30, s30, 32768
    s_add_u32 s31, s30, 4096
    v_mov_b32 v118, v27
    v_mov_b32 v119, v27
    ds_write_b64 v12, v[118:119] offset:0
    ds_write_b64 v12, v[118:119] offset:1024
    ds_write_b64 v12, v[118:119] offset:2048
    ds_write_b64 v12, v[118:119] offset:3072
    buffer_store_dword v20, v13, s[8:11], s32 offen
    s_mov_b32 s32, s25
    ds_read_b128 v[120:123], v7 offset:0
    ds_read_b128 v[124:127], v7 offset:1024
    ds_read_b128 v[128:131], v7 offset:2048
    ds_read_b128 v[132:135], v7 offset:3072
    ds_read_b128 v[136:139], v7 offset:4096
    ds_read_b128 v[140:143], v7 offset:5120
    ds_read_b128 v[144:147], v7 offset:6144
    ds_read_b128 v[148:151], v7 offset:7168
    ds_read_b128 v[152:155], v7 offset:8192
    ds_read_b128 v[156:159], v7 offset:9216
    ds_read_b128 v[160:163], v7 offset:10240
    ds_read_b128 v[164:167], v7 offset:11264
    ds_read_b128 v[168:171], v7 offset:12288
    ds_read_b128 v[172:175], v7 offset:13312
    ds_read_b128 v[46:49], v7 offset:14336
    ds_read_b128 v[50:53], v7 offset:15360
    ds_read_b128 v[54:57], v7 offset:16384
    ds_read_b128 v[58:61], v7 offset:17408
    s_and_b32 s26, s22, 7
    s_mul_i32 s24, s26, 7168
    s_and_b32 s26, s22, 3
    s_barrier
    s_mul_i32 s27, s26, 10240
    s_add_u32 s25, s27, 18341888
    s_add_u32 s27, s24, 18286592
    s_add_u32 s28, s24, 18290688
    buffer_load_dwordx4 v[34:37], v4, s[8:11], s27 offen sc1
    s_barrier
    buffer_load_dwordx4 v[38:41], v4, s[8:11], s28 offen sc1
    s_barrier
    buffer_load_dwordx4 v[176:179], v16, s[8:11], s30 offen offset:0 sc1
    s_waitcnt lgkmcnt(0)
    s_waitcnt vmcnt(2)
A2_retry:
    v_smfmac_f32_16x16x64_bf16 v[62:65], v[34:37], v[120:127], v3
    ds_write_b128 v9, v[34:37] offset:2048
    v_smfmac_f32_16x16x64_bf16 v[66:69], v[34:37], v[128:135], v3
    buffer_load_dwordx4 v[180:183], v16, s[8:11], s30 offen offset:1024 sc1
    v_smfmac_f32_16x16x64_bf16 v[70:73], v[34:37], v[136:143], v3
    buffer_load_dwordx4 v[184:187], v16, s[8:11], s31 offen offset:0 sc1
    v_smfmac_f32_16x16x64_bf16 v[74:77], v[34:37], v[144:151], v3
    v_max_u32 v22, v34, v35
    v_smfmac_f32_16x16x64_bf16 v[78:81], v[34:37], v[152:159], v3
    s_waitcnt vmcnt(3)
    ds_write_b128 v9, v[38:41] offset:6144
    v_max3_u32 v22, v36, v37, v22
    v_smfmac_f32_16x16x64_bf16 v[82:85], v[34:37], v[160:167], v3
    v_max3_u32 v22, v38, v39, v22
    v_smfmac_f32_16x16x64_bf16 v[86:89], v[34:37], v[168:175], v3
    v_max3_u32 v22, v40, v41, v22
    v_smfmac_f32_16x16x64_bf16 v[62:65], v[38:41], v[46:53], v3
    v_cmp_eq_u32 vcc, -1, v22
    v_smfmac_f32_16x16x64_bf16 v[66:69], v[38:41], v[54:61], v3
    buffer_load_dwordx4 v[188:191], v16, s[8:11], s31 offen offset:1024 sc1
    v_smfmac_f32_16x16x64_bf16 v[70:73], v[38:41], a[0:7], v3
    s_waitcnt lgkmcnt(0)
    s_cbranch_vccnz A2_fix
    v_smfmac_f32_16x16x64_bf16 v[74:77], v[38:41], a[8:15], v3
    s_barrier
    ds_read_b128 v[42:45], v9 offset:3072
    v_smfmac_f32_16x16x64_bf16 v[78:81], v[38:41], a[16:23], v3
    ds_read_b128 v[46:49], v9 offset:4096
    v_smfmac_f32_16x16x64_bf16 v[82:85], v[38:41], a[24:31], v3
    ds_read_b128 v[50:53], v9 offset:5120
    v_smfmac_f32_16x16x64_bf16 v[86:89], v[38:41], a[32:39], v3
    ds_read_b128 v[54:57], v9 offset:0
    s_waitcnt lgkmcnt(3)
    v_smfmac_f32_16x16x64_bf16 v[62:65], v[42:45], a[40:47], v3
    ds_read_b128 v[58:61], v9 offset:1024
    v_smfmac_f32_16x16x64_bf16 v[66:69], v[42:45], a[48:55], v3
    buffer_load_dwordx4 v[120:123], v16, s[8:11], s30 offen offset:2048 sc1
    v_smfmac_f32_16x16x64_bf16 v[70:73], v[42:45], a[56:63], v3
    v_smfmac_f32_16x16x64_bf16 v[74:77], v[42:45], a[64:71], v3
    v_smfmac_f32_16x16x64_bf16 v[78:81], v[42:45], a[72:79], v3
    v_smfmac_f32_16x16x64_bf16 v[82:85], v[42:45], a[80:87], v3
    buffer_load_dwordx4 v[124:127], v16, s[8:11], s30 offen offset:3072 sc1
    v_smfmac_f32_16x16x64_bf16 v[86:89], v[42:45], a[88:95], v3
    s_waitcnt lgkmcnt(0)
    v_smfmac_f32_16x16x64_bf16 v[62:65], v[46:49], a[96:103], v3
    s_nop 2
    v_smfmac_f32_16x16x64_bf16 v[62:65], v[50:53], a[152:159], v3
    s_nop 2
    v_smfmac_f32_16x16x64_bf16 v[62:65], v[54:57], a[208:215], v3
    s_nop 0
    buffer_load_dwordx4 v[128:131], v16, s[8:11], s31 offen offset:2048 sc1
    v_smfmac_f32_16x16x64_bf16 v[62:65], v[58:61], v[200:207], v3
    s_nop 2
    v_smfmac_f32_16x16x64_bf16 v[66:69], v[46:49], a[104:111], v3
    s_nop 2
    v_smfmac_f32_16x16x64_bf16 v[66:69], v[50:53], a[160:167], v3
    s_nop 2
    v_smfmac_f32_16x16x64_bf16 v[66:69], v[54:57], a[216:223], v3
    s_nop 0
    buffer_load_dwordx4 v[132:135], v16, s[8:11], s31 offen offset:3072 sc1
    v_smfmac_f32_16x16x64_bf16 v[66:69], v[58:61], v[208:215], v3
    s_nop 0
    ds_read_b128 v[152:155], v5 offset:0
    v_add_f32 v62, v62, v63
    v_smfmac_f32_16x16x64_bf16 v[70:73], v[46:49], a[112:119], v3
    s_nop 0
    ds_read_b128 v[156:159], v5 offset:256
    v_add_f32 v64, v64, v65
    v_smfmac_f32_16x16x64_bf16 v[70:73], v[50:53], a[168:175], v3
    s_nop 0
    ds_read_b128 v[160:163], v6 offset:0
    v_add_f32 v66, v66, v67
    v_smfmac_f32_16x16x64_bf16 v[70:73], v[54:57], a[224:231], v3
    s_nop 0
    ds_read_b128 v[164:167], v6 offset:256
    v_cvt_pk_bf16_f32 v90, v62, v66
    v_smfmac_f32_16x16x64_bf16 v[70:73], v[58:61], v[216:223], v3
    s_nop 1
    v_add_f32 v68, v68, v69
    v_smfmac_f32_16x16x64_bf16 v[74:77], v[46:49], a[120:127], v3
    s_nop 1
    v_cvt_pk_bf16_f32 v91, v64, v68
    v_smfmac_f32_16x16x64_bf16 v[74:77], v[50:53], a[176:183], v3
    s_nop 0
    ds_write_b64 v21, v[90:91]
    v_smfmac_f32_16x16x64_bf16 v[74:77], v[54:57], a[232:239], v3
    s_nop 1
    ds_read_b64_tr_b16 v[168:169], v2
    v_smfmac_f32_16x16x64_bf16 v[74:77], v[58:61], v[224:231], v3
    s_nop 1
    v_add_f32 v70, v70, v71
    v_smfmac_f32_16x16x64_bf16 v[78:81], v[46:49], a[128:135], v3
    s_nop 1
    v_add_f32 v72, v72, v73
    v_smfmac_f32_16x16x64_bf16 v[78:81], v[50:53], a[184:191], v3
    s_nop 1
    v_add_f32 v74, v74, v75
    v_smfmac_f32_16x16x64_bf16 v[78:81], v[54:57], a[240:247], v3
    s_nop 1
    v_cvt_pk_bf16_f32 v90, v70, v74
    v_smfmac_f32_16x16x64_bf16 v[78:81], v[58:61], v[232:239], v3
    s_nop 1
    v_add_f32 v76, v76, v77
    v_smfmac_f32_16x16x64_bf16 v[82:85], v[46:49], a[136:143], v3
    s_nop 1
    v_cvt_pk_bf16_f32 v91, v72, v76
    v_smfmac_f32_16x16x64_bf16 v[82:85], v[50:53], a[192:199], v3
    s_nop 0
    ds_write_b64 v21, v[90:91]
    v_smfmac_f32_16x16x64_bf16 v[82:85], v[54:57], a[248:255], v3
    s_nop 1
    ds_read_b64_tr_b16 v[170:171], v2
    v_smfmac_f32_16x16x64_bf16 v[82:85], v[58:61], v[240:247], v3
    s_nop 1
    v_cvt_pk_bf16_f32 v90, v78, v79
    v_smfmac_f32_16x16x64_bf16 v[86:89], v[46:49], a[144:151], v3
    s_nop 1
    v_cvt_pk_bf16_f32 v91, v80, v81
    v_smfmac_f32_16x16x64_bf16 v[86:89], v[50:53], a[200:207], v3
    s_nop 1
    v_cvt_pk_bf16_f32 v92, v82, v83
    v_smfmac_f32_16x16x64_bf16 v[86:89], v[54:57], v[192:199], v3
    s_nop 1
    v_cvt_pk_bf16_f32 v93, v84, v85
    v_smfmac_f32_16x16x64_bf16 v[86:89], v[58:61], v[248:255], v3
    s_nop 0
    s_waitcnt vmcnt(4)
    s_waitcnt lgkmcnt(0)
    v_mfma_f32_16x16x32_bf16 v[106:109], v[90:93], v[28:31], 0
    s_nop 2
    v_smfmac_f32_16x16x64_bf16 v[98:101], v[168:171], v[176:183], v3
    v_cvt_pk_bf16_f32 v38, v86, v87
    v_cvt_pk_bf16_f32 v39, v88, v89
    s_nop 1
    v_mfma_f32_16x16x16_bf16 v[34:37], v[38:39], v[32:33], 0
    v_cvt_pk_bf16_f32 v172, v106, v107
    v_cvt_pk_bf16_f32 v173, v108, v109
    v_smfmac_f32_16x16x64_bf16 v[102:105], v[168:171], v[184:191], v3
    s_nop 2
    v_smfmac_f32_16x16x64_bf16 v[94:97], v[168:171], v[152:159], v3
    s_nop 0
    v_cvt_pk_bf16_f32 v174, v34, v35
    v_cvt_pk_bf16_f32 v175, v36, v37
    s_add_u32 s22, s22, 1
    s_waitcnt vmcnt(0)
    v_smfmac_f32_16x16x64_bf16 v[98:101], v[172:175], v[120:127], v3
    s_nop 1
    v_mov_b32 v25, s22
    v_smfmac_f32_16x16x64_bf16 v[102:105], v[172:175], v[128:135], v3
    s_nop 2
    v_smfmac_f32_16x16x64_bf16 v[94:97], v[172:175], v[160:167], v3
    s_nop 1
    v_add_f32 v42, v98, v99
    v_add_f32 v44, v100, v101
    v_add_f32 v43, v102, v103
    v_add_f32 v45, v104, v105
    v_mfma_f32_32x32x16_bf16 v[62:77], v[110:113], v[110:113], 0
    ds_write_b128 v10, v[42:45]
    v_add_f32 v46, v94, v95
    v_add_f32 v47, v96, v97
    ds_write2_b32 v11, v46, v47 offset0:0 offset1:2
    v_mfma_f32_32x32x16_bf16 v[78:93], v[110:113], v[110:113], 0
    s_barrier
    ds_read_b64 v[50:51], v12 offset:0
    ds_read_b64 v[52:53], v12 offset:1024
    ds_read_b64 v[54:55], v12 offset:2048
    ds_read_b64 v[56:57], v12 offset:3072
    v_mfma_f32_32x32x16_bf16 v[94:109], v[110:113], v[110:113], 0
    s_waitcnt lgkmcnt(2)
    v_add_f32 v50, v50, v52
    v_add_f32 v51, v51, v53
    s_waitcnt lgkmcnt(1)
    v_add_f32 v50, v50, v54
    v_add_f32 v51, v51, v55
    s_waitcnt lgkmcnt(0)
    v_add_f32 v50, v50, v56
    v_add_f32 v51, v51, v57
    v_exp_f32 v118, v50
    v_exp_f32 v119, v51
    v_add_f32 v58, abs(v50), abs(v51)
A2_back:
    v_add_f32 v59, v118, v119
    v_add_f32 v60, v118, v119
    v_cmp_nge_f32 vcc, v26, v58
    s_nop 0
    v_permlane32_swap_b32 v59, v60
    v_add_f32 v59, v59, v60
    s_nop 1
    v_add_f32_dpp v59, v59, v59 row_ror:1 row_mask:0xf bank_mask:0xf
    s_nop 1
    v_add_f32_dpp v59, v59, v59 row_ror:2 row_mask:0xf bank_mask:0xf
    s_cbranch_vccnz A2_slow
    s_nop 0
    v_add_f32_dpp v59, v59, v59 row_ror:4 row_mask:0xf bank_mask:0xf
    s_nop 1
    v_add_f32_dpp v59, v59, v59 row_ror:8 row_mask:0xf bank_mask:0xf
    v_rcp_f32 v59, v59
    s_nop 0
    v_pk_mul_f32 v[60:61], v[118:119], v[58:59] op_sel:[0,1] op_sel_hi:[1,1]
    v_cvt_pk_bf16_f32 v60, v60, v61
    buffer_store_dword v60, v13, s[8:11], s25 offen
    s_cmp_lt_u32 s22, 63
    s_cbranch_scc1 A2_top
    s_branch A_done
A2_fix:
    buffer_load_dwordx4 v[34:37], v4, s[8:11], s27 offen sc1
    buffer_load_dwordx4 v[38:41], v4, s[8:11], s28 offen sc1
    s_nop 4
    s_nop 0
    v_mov_b64 v[62:63], 0
    v_mov_b64 v[64:65], 0
    v_mov_b64 v[66:67], 0
    v_mov_b64 v[68:69], 0
    v_mov_b64 v[70:71], 0
    v_mov_b64 v[72:73], 0
    v_mov_b64 v[74:75], 0
    v_mov_b64 v[76:77], 0
    v_mov_b64 v[78:79], 0
    v_mov_b64 v[80:81], 0
    v_mov_b64 v[82:83], 0
    v_mov_b64 v[84:85], 0
    v_mov_b64 v[86:87], 0
    v_mov_b64 v[88:89], 0
    s_waitcnt vmcnt(2)
    ds_read_b128 v[120:123], v7 offset:0
    ds_read_b128 v[124:127], v7 offset:1024
    ds_read_b128 v[128:131], v7 offset:2048
    ds_read_b128 v[132:135], v7 offset:3072
    s_waitcnt vmcnt(0) lgkmcnt(0)
    s_sub_u32 s23, s23, 1
    s_cbranch_scc0 A2_retry
    s_branch A_done
A2_slow:
    ds_read_b64 v[50:51], v12 offset:0
    ds_read_b64 v[52:53], v12 offset:1024
    ds_read_b64 v[54:55], v12 offset:2048
    ds_read_b64 v[56:57], v12 offset:3072
    s_sub_u32 s23, s23, 1
    s_cbranch_scc1 A_done
    s_waitcnt lgkmcnt(0)
    v_max_u32 v59, v50, v51
    v_max3_u32 v59, v52, v53, v59
    v_max3_u32 v59, v54, v55, v59
    v_max3_u32 v59, v56, v57, v59
    v_cmp_eq_u32 vcc, -1, v59
    s_cbranch_vccnz A2_slow
    v_add_f32 v50, v50, v52
    v_add_f32 v51, v51, v53
    v_add_f32 v50, v50, v54
    v_add_f32 v51, v51, v55
    v_add_f32 v50, v50, v56
    v_add_f32 v51, v51, v57
    v_max_f32 v59, v50, v51
    v_mov_b32 v60, v59
    s_nop 1
    v_permlane32_swap_b32 v59, v60
    v_max_f32 v59, v59, v60
    s_nop 1
    v_max_f32_dpp v59, v59, v59 row_ror:1 row_mask:0xf bank_mask:0xf
    s_nop 1
    v_max_f32_dpp v59, v59, v59 row_ror:2 row_mask:0xf bank_mask:0xf
    s_nop 1
    v_max_f32_dpp v59, v59, v59 row_ror:4 row_mask:0xf bank_mask:0xf
    s_nop 1
    v_max_f32_dpp v59, v59, v59 row_ror:8 row_mask:0xf bank_mask:0xf
    v_sub_f32 v50, v50, v59
    v_sub_f32 v51, v51, v59
    v_exp_f32 v118, v50
    v_exp_f32 v119, v51
    v_mov_b32 v58, 0
    s_branch A2_back
.p2align 6
A3_top:
    s_add_u32 s30, s30, 32768
    s_add_u32 s31, s30, 4096
    v_mov_b32 v118, v27
    v_mov_b32 v119, v27
    ds_write_b64 v12, v[118:119] offset:0
    ds_write_b64 v12, v[118:119] offset:1024
    ds_write_b64 v12, v[118:119] offset:2048
    ds_write_b64 v12, v[118:119] offset:3072
    buffer_store_dword v20, v13, s[8:11], s32 offen
    s_mov_b32 s32, s25
    ds_read_b128 v[120:123], v7 offset:0
    ds_read_b128 v[124:127], v7 offset:1024
    ds_read_b128 v[128:131], v7 offset:2048
    ds_read_b128 v[132:135], v7 offset:3072
    ds_read_b128 v[136:139], v7 offset:4096
    ds_read_b128 v[140:143], v7 offset:5120
    ds_read_b128 v[144:147], v7 offset:6144
    ds_read_b128 v[148:151], v7 offset:7168
    ds_read_b128 v[152:155], v7 offset:8192
    ds_read_b128 v[156:159], v7 offset:9216
    ds_read_b128 v[160:163], v7 offset:10240
    ds_read_b128 v[164:167], v7 offset:11264
    ds_read_b128 v[168:171], v7 offset:12288
    ds_read_b128 v[172:175], v7 offset:13312
    ds_read_b128 v[46:49], v7 offset:14336
    ds_read_b128 v[50:53], v7 offset:15360
    ds_read_b128 v[54:57], v7 offset:16384
    ds_read_b128 v[58:61], v7 offset:17408
    s_add_u32 s34, s22, 1
    s_lshr_b32 s34, s34, 2
    s_lshl_b32 s34, s34, 7
    s_add_u32 s34, s34, 18616320
    v_writelane_b32 v19, s34, 0
    s_sub_u32 s34, s22, 2
    s_cselect_b32 s34, 0, s34
    buffer_load_dword v18, v19, s[8:11], 0 offen sc1
    v_mov_b32 v17, s34
    s_movk_i32 s34, 66
    v_writelane_b32 v17, s34, 0
    s_and_b32 s26, s22, 7
    s_mul_i32 s24, s26, 7168
    s_and_b32 s26, s22, 3
    s_waitcnt vmcnt(0)
    v_cmp_gt_u32 vcc, v17, v18
    s_cbranch_vccnz A3_rdyw
A3_rdyb:
    s_barrier
    s_mul_i32 s27, s26, 10240
    s_add_u32 s25, s27, 18341888
    s_add_u32 s27, s24, 18287616
    s_add_u32 s28, s24, 18285568
    buffer_load_dwordx4 v[34:37], v4, s[8:11], s27 offen sc1
    s_barrier
    buffer_load_dwordx4 v[38:41], v4, s[8:11], s28 offen sc1
    s_barrier
    buffer_load_dwordx4 v[176:179], v16, s[8:11], s30 offen offset:0 sc1
    s_waitcnt lgkmcnt(0)
    s_waitcnt vmcnt(2)
A3_retry:
    v_smfmac_f32_16x16x64_bf16 v[62:65], v[34:37], v[120:127], v3
    ds_write_b128 v9, v[34:37] offset:3072
    v_smfmac_f32_16x16x64_bf16 v[66:69], v[34:37], v[128:135], v3
    buffer_load_dwordx4 v[180:183], v16, s[8:11], s30 offen offset:1024 sc1
    v_smfmac_f32_16x16x64_bf16 v[70:73], v[34:37], v[136:143], v3
    buffer_load_dwordx4 v[184:187], v16, s[8:11], s31 offen offset:0 sc1
    v_smfmac_f32_16x16x64_bf16 v[74:77], v[34:37], v[144:151], v3
    v_max_u32 v22, v34, v35
    v_smfmac_f32_16x16x64_bf16 v[78:81], v[34:37], v[152:159], v3
    s_waitcnt vmcnt(3)
    v_max3_u32 v22, v36, v37, v22
    v_smfmac_f32_16x16x64_bf16 v[82:85], v[34:37], v[160:167], v3
    v_max3_u32 v22, v38, v39, v22
    v_smfmac_f32_16x16x64_bf16 v[86:89], v[34:37], v[168:175], v3
    v_max3_u32 v22, v40, v41, v22
    v_smfmac_f32_16x16x64_bf16 v[62:65], v[38:41], v[46:53], v3
    v_cmp_eq_u32 vcc, -1, v22
    v_smfmac_f32_16x16x64_bf16 v[66:69], v[38:41], v[54:61], v3
    buffer_load_dwordx4 v[188:191], v16, s[8:11], s31 offen offset:1024 sc1
    v_smfmac_f32_16x16x64_bf16 v[70:73], v[38:41], a[0:7], v3
    s_waitcnt lgkmcnt(0)
    s_cbranch_vccnz A3_fix
    v_smfmac_f32_16x16x64_bf16 v[74:77], v[38:41], a[8:15], v3
    s_barrier
    ds_read_b128 v[42:45], v9 offset:4096
    v_smfmac_f32_16x16x64_bf16 v[78:81], v[38:41], a[16:23], v3
    ds_read_b128 v[46:49], v9 offset:5120
    v_smfmac_f32_16x16x64_bf16 v[82:85], v[38:41], a[24:31], v3
    ds_read_b128 v[50:53], v9 offset:6144
    v_smfmac_f32_16x16x64_bf16 v[86:89], v[38:41], a[32:39], v3
    ds_read_b128 v[54:57], v9 offset:0
    s_waitcnt lgkmcnt(3)
    v_smfmac_f32_16x16x64_bf16 v[62:65], v[42:45], a[40:47], v3
    ds_read_b128 v[58:61], v9 offset:2048
    v_smfmac_f32_16x16x64_bf16 v[66:69], v[42:45], a[48:55], v3
    buffer_load_dwordx4 v[120:123], v16, s[8:11], s30 offen offset:2048 sc1
    v_smfmac_f32_16x16x64_bf16 v[70:73], v[42:45], a[56:63], v3
    v_smfmac_f32_16x16x64_bf16 v[74:77], v[42:45], a[64:71], v3
    v_smfmac_f32_16x16x64_bf16 v[78:81], v[42:45], a[72:79], v3
    v_smfmac_f32_16x16x64_bf16 v[82:85], v[42:45], a[80:87], v3
    buffer_load_dwordx4 v[124:127], v16, s[8:11], s30 offen offset:3072 sc1
    v_smfmac_f32_16x16x64_bf16 v[86:89], v[42:45], a[88:95], v3
    s_waitcnt lgkmcnt(0)
    v_smfmac_f32_16x16x64_bf16 v[62:65], v[46:49], a[96:103], v3
    s_nop 2
    v_smfmac_f32_16x16x64_bf16 v[62:65], v[50:53], a[152:159], v3
    s_nop 2
    v_smfmac_f32_16x16x64_bf16 v[62:65], v[54:57], a[208:215], v3
    s_nop 0
    buffer_load_dwordx4 v[128:131], v16, s[8:11], s31 offen offset:2048 sc1
    v_smfmac_f32_16x16x64_bf16 v[62:65], v[58:61], v[200:207], v3
    s_nop 2
    v_smfmac_f32_16x16x64_bf16 v[66:69], v[46:49], a[104:111], v3
    s_nop 2
    v_smfmac_f32_16x16x64_bf16 v[66:69], v[50:53], a[160:167], v3
    s_nop 2
    v_smfmac_f32_16x16x64_bf16 v[66:69], v[54:57], a[216:223], v3
    s_nop 0
    buffer_load_dwordx4 v[132:135], v16, s[8:11], s31 offen offset:3072 sc1
    v_smfmac_f32_16x16x64_bf16 v[66:69], v[58:61], v[208:215], v3
    s_nop 0
    ds_read_b128 v[152:155], v5 offset:0
    v_add_f32 v62, v62, v63
    v_smfmac_f32_16x16x64_bf16 v[70:73], v[46:49], a[112:119], v3
    s_nop 0
    ds_read_b128 v[156:159], v5 offset:256
    v_add_f32 v64, v64, v65
    v_smfmac_f32_16x16x64_bf16 v[70:73], v[50:53], a[168:175], v3
    s_nop 0
    ds_read_b128 v[160:163], v6 offset:0
    v_add_f32 v66, v66, v67
    v_smfmac_f32_16x16x64_bf16 v[70:73], v[54:57], a[224:231], v3
    s_nop 0
    ds_read_b128 v[164:167], v6 offset:256
    v_cvt_pk_bf16_f32 v90, v62, v66
    v_smfmac_f32_16x16x64_bf16 v[70:73], v[58:61], v[216:223], v3
    s_nop 1
    v_add_f32 v68, v68, v69
    v_smfmac_f32_16x16x64_bf16 v[74:77], v[46:49], a[120:127], v3
    s_nop 1
    v_cvt_pk_bf16_f32 v91, v64, v68
    v_smfmac_f32_16x16x64_bf16 v[74:77], v[50:53], a[176:183], v3
    s_nop 0
    ds_write_b64 v21, v[90:91]
    v_smfmac_f32_16x16x64_bf16 v[74:77], v[54:57], a[232:239], v3
    s_nop 1
    ds_read_b64_tr_b16 v[168:169], v2
    v_smfmac_f32_16x16x64_bf16 v[74:77], v[58:61], v[224:231], v3
    s_nop 1
    v_add_f32 v70, v70, v71
    v_smfmac_f32_16x16x64_bf16 v[78:81], v[46:49], a[128:135], v3
    s_nop 1
    v_add_f32 v72, v72, v73
    v_smfmac_f32_16x16x64_bf16 v[78:81], v[50:53], a[184:191], v3
    s_nop 1
    v_add_f32 v74, v74, v75
    v_smfmac_f32_16x16x64_bf16 v[78:81], v[54:57], a[240:247], v3
    s_nop 1
    v_cvt_pk_bf16_f32 v90, v70, v74
    v_smfmac_f32_16x16x64_bf16 v[78:81], v[58:61], v[232:239], v3
    s_nop 1
    v_add_f32 v76, v76, v77
    v_smfmac_f32_16x16x64_bf16 v[82:85], v[46:49], a[136:143], v3
    s_nop 1
    v_cvt_pk_bf16_f32 v91, v72, v76
    v_smfmac_f32_16x16x64_bf16 v[82:85], v[50:53], a[192:199], v3
    s_nop 0
    ds_write_b64 v21, v[90:91]
    v_smfmac_f32_16x16x64_bf16 v[82:85], v[54:57], a[248:255], v3
    s_nop 1
    ds_read_b64_tr_b16 v[170:171], v2
    v_smfmac_f32_16x16x64_bf16 v[82:85], v[58:61], v[240:247], v3
    s_nop 1
    v_cvt_pk_bf16_f32 v90, v78, v79
    v_smfmac_f32_16x16x64_bf16 v[86:89], v[46:49], a[144:151], v3
    s_nop 1
    v_cvt_pk_bf16_f32 v91, v80, v81
    v_smfmac_f32_16x16x64_bf16 v[86:89], v[50:53], a[200:207], v3
    s_nop 1
    v_cvt_pk_bf16_f32 v92, v82, v83
    v_smfmac_f32_16x16x64_bf16 v[86:89], v[54:57], v[192:199], v3
    s_nop 1
    v_cvt_pk_bf16_f32 v93, v84, v85
    v_smfmac_f32_16x16x64_bf16 v[86:89], v[58:61], v[248:255], v3
    s_nop 0
    s_waitcnt vmcnt(4)
    s_waitcnt lgkmcnt(0)
    v_mfma_f32_16x16x32_bf16 v[106:109], v[90:93], v[28:31], 0
    s_nop 2
    v_smfmac_f32_16x16x64_bf16 v[98:101], v[168:171], v[176:183], v3
    v_cvt_pk_bf16_f32 v38, v86, v87
    v_cvt_pk_bf16_f32 v39, v88, v89
    s_nop 1
    v_mfma_f32_16x16x16_bf16 v[34:37], v[38:39], v[32:33], 0
    v_cvt_pk_bf16_f32 v172, v106, v107
    v_cvt_pk_bf16_f32 v173, v108, v109
    v_smfmac_f32_16x16x64_bf16 v[102:105], v[168:171], v[184:191], v3
    s_nop 2
    v_smfmac_f32_16x16x64_bf16 v[94:97], v[168:171], v[152:159], v3
    s_nop 0
    v_cvt_pk_bf16_f32 v174, v34, v35
    v_cvt_pk_bf16_f32 v175, v36, v37
    s_add_u32 s22, s22, 1
    s_waitcnt vmcnt(0)
    v_smfmac_f32_16x16x64_bf16 v[98:101], v[172:175], v[120:127], v3
    s_nop 1
    v_mov_b32 v25, s22
    v_smfmac_f32_16x16x64_bf16 v[102:105], v[172:175], v[128:135], v3
    s_nop 2
    v_smfmac_f32_16x16x64_bf16 v[94:97], v[172:175], v[160:167], v3
    s_nop 1
    v_add_f32 v42, v98, v99
    v_add_f32 v44, v100, v101
    v_add_f32 v43, v102, v103
    v_add_f32 v45, v104, v105
    v_mfma_f32_32x32x16_bf16 v[62:77], v[110:113], v[110:113], 0
    ds_write_b128 v10, v[42:45]
    v_add_f32 v46, v94, v95
    v_add_f32 v47, v96, v97
    ds_write2_b32 v11, v46, v47 offset0:0 offset1:2
    v_mfma_f32_32x32x16_bf16 v[78:93], v[110:113], v[110:113], 0
    s_barrier
    ds_read_b64 v[50:51], v12 offset:0
    ds_read_b64 v[52:53], v12 offset:1024
    ds_read_b64 v[54:55], v12 offset:2048
    ds_read_b64 v[56:57], v12 offset:3072
    v_mfma_f32_32x32x16_bf16 v[94:109], v[110:113], v[110:113], 0
    s_waitcnt lgkmcnt(2)
    v_add_f32 v50, v50, v52
    v_add_f32 v51, v51, v53
    s_waitcnt lgkmcnt(1)
    v_add_f32 v50, v50, v54
    v_add_f32 v51, v51, v55
    s_waitcnt lgkmcnt(0)
    v_add_f32 v50, v50, v56
    v_add_f32 v51, v51, v57
    v_exp_f32 v118, v50
    v_exp_f32 v119, v51
    v_add_f32 v58, abs(v50), abs(v51)
A3_back:
    v_add_f32 v59, v118, v119
    v_add_f32 v60, v118, v119
    v_cmp_nge_f32 vcc, v26, v58
    s_nop 0
    v_permlane32_swap_b32 v59, v60
    v_add_f32 v59, v59, v60
    s_nop 1
    v_add_f32_dpp v59, v59, v59 row_ror:1 row_mask:0xf bank_mask:0xf
    s_nop 1
    v_add_f32_dpp v59, v59, v59 row_ror:2 row_mask:0xf bank_mask:0xf
    s_cbranch_vccnz A3_slow
    s_nop 0
    v_add_f32_dpp v59, v59, v59 row_ror:4 row_mask:0xf bank_mask:0xf
    s_nop 1
    v_add_f32_dpp v59, v59, v59 row_ror:8 row_mask:0xf bank_mask:0xf
    v_rcp_f32 v59, v59
    s_nop 0
    v_pk_mul_f32 v[60:61], v[118:119], v[58:59] op_sel:[0,1] op_sel_hi:[1,1]
    v_cvt_pk_bf16_f32 v60, v60, v61
    buffer_store_dword v60, v13, s[8:11], s25 offen
    s_cmp_lt_u32 s22, 63
    s_cbranch_scc1 A3_top
    s_branch A_done
A3_fix:
    buffer_load_dwordx4 v[34:37], v4, s[8:11], s27 offen sc1
    buffer_load_dwordx4 v[38:41], v4, s[8:11], s28 offen sc1
    s_nop 4
    s_nop 0
    v_mov_b64 v[62:63], 0
    v_mov_b64 v[64:65], 0
    v_mov_b64 v[66:67], 0
    v_mov_b64 v[68:69], 0
    v_mov_b64 v[70:71], 0
    v_mov_b64 v[72:73], 0
    v_mov_b64 v[74:75], 0
    v_mov_b64 v[76:77], 0
    v_mov_b64 v[78:79], 0
    v_mov_b64 v[80:81], 0
    v_mov_b64 v[82:83], 0
    v_mov_b64 v[84:85], 0
    v_mov_b64 v[86:87], 0
    v_mov_b64 v[88:89], 0
    s_waitcnt vmcnt(2)
    ds_read_b128 v[120:123], v7 offset:0
    ds_read_b128 v[124:127], v7 offset:1024
    ds_read_b128 v[128:131], v7 offset:2048
    ds_read_b128 v[132:135], v7 offset:3072
    s_waitcnt vmcnt(0) lgkmcnt(0)
    s_sub_u32 s23, s23, 1
    s_cbranch_scc0 A3_retry
    s_branch A_done
A3_slow:
    ds_read_b64 v[50:51], v12 offset:0
    ds_read_b64 v[52:53], v12 offset:1024
    ds_read_b64 v[54:55], v12 offset:2048
    ds_read_b64 v[56:57], v12 offset:3072
    s_sub_u32 s23, s23, 1
    s_cbranch_scc1 A_done
    s_waitcnt lgkmcnt(0)
    v_max_u32 v59, v50, v51
    v_max3_u32 v59, v52, v53, v59
    v_max3_u32 v59, v54, v55, v59
    v_max3_u32 v59, v56, v57, v59
    v_cmp_eq_u32 vcc, -1, v59
    s_cbranch_vccnz A3_slow
    v_add_f32 v50, v50, v52
    v_add_f32 v51, v51, v53
    v_add_f32 v50, v50, v54
    v_add_f32 v51, v51, v55
    v_add_f32 v50, v50, v56
    v_add_f32 v51, v51, v57
    v_max_f32 v59, v50, v51
    v_mov_b32 v60, v59
    s_nop 1
    v_permlane32_swap_b32 v59, v60
    v_max_f32 v59, v59, v60
    s_nop 1
    v_max_f32_dpp v59, v59, v59 row_ror:1 row_mask:0xf bank_mask:0xf
    s_nop 1
    v_max_f32_dpp v59, v59, v59 row_ror:2 row_mask:0xf bank_mask:0xf
    s_nop 1
    v_max_f32_dpp v59, v59, v59 row_ror:4 row_mask:0xf bank_mask:0xf
    s_nop 1
    v_max_f32_dpp v59, v59, v59 row_ror:8 row_mask:0xf bank_mask:0xf
    v_sub_f32 v50, v50, v59
    v_sub_f32 v51, v51, v59
    v_exp_f32 v118, v50
    v_exp_f32 v119, v51
    v_mov_b32 v58, 0
    s_branch A3_back
A3_rdyw:
    buffer_load_dword v18, v19, s[8:11], 0 offen sc1
    s_waitcnt vmcnt(0)
    v_cmp_gt_u32 vcc, v17, v18
    s_cbranch_vccz A3_rdyb
    s_sleep 2
    s_sub_u32 s23, s23, 1
    s_cbranch_scc0 A3_rdyw
    s_branch A_done
.p2align 6
Asc10_top:
    s_add_u32 s30, s30, 32768
    s_add_u32 s31, s30, 4096
    v_mov_b32 v118, v27
    v_mov_b32 v119, v27
    ds_write_b64 v12, v[118:119] offset:0
    ds_write_b64 v12, v[118:119] offset:1024
    ds_write_b64 v12, v[118:119] offset:2048
    ds_write_b64 v12, v[118:119] offset:3072
    buffer_store_dword v20, v13, s[8:11], s32 offen sc1
    s_mov_b32 s32, s25
    ds_read_b128 v[120:123], v7 offset:0
    ds_read_b128 v[124:127], v7 offset:1024
    ds_read_b128 v[128:131], v7 offset:2048
    ds_read_b128 v[132:135], v7 offset:3072
    ds_read_b128 v[136:139], v7 offset:4096
    ds_read_b128 v[140:143], v7 offset:5120
    ds_read_b128 v[144:147], v7 offset:6144
    ds_read_b128 v[148:151], v7 offset:7168
    ds_read_b128 v[152:155], v7 offset:8192
    ds_read_b128 v[156:159], v7 offset:9216
    ds_read_b128 v[160:163], v7 offset:10240
    ds_read_b128 v[164:167], v7 offset:11264
    ds_read_b128 v[168:171], v7 offset:12288
    ds_read_b128 v[172:175], v7 offset:13312
    ds_read_b128 v[46:49], v7 offset:14336
    ds_read_b128 v[50:53], v7 offset:15360
    ds_read_b128 v[54:57], v7 offset:16384
    ds_read_b128 v[58:61], v7 offset:17408
    buffer_load_dword v90, v14, s[8:11], 0 offen sc1
    s_and_b32 s26, s22, 7
    s_mul_i32 s24, s26, 7168
    s_and_b32 s26, s22, 3
    s_nop 2
    buffer_load_dword v91, v14, s[8:11], 0 offen sc1
    s_nop 5
    buffer_load_dword v92, v14, s[8:11], 0 offen sc1
    s_nop 5
    buffer_load_dword v93, v14, s[8:11], 0 offen sc1
    s_nop 5
    buffer_load_dword v106, v14, s[8:11], 0 offen sc1
    s_nop 5
Asc10_pg:
    s_waitcnt vmcnt(4)
    v_cmp_gt_u32 vcc, s22, v90
    buffer_load_dword v107, v14, s[8:11], 0 offen sc1
    s_cbranch_vccz Asc10_pg_ok
    s_waitcnt vmcnt(4)
    v_cmp_gt_u32 vcc, s22, v91
    buffer_load_dword v90, v14, s[8:11], 0 offen sc1
    s_cbranch_vccz Asc10_pg_ok
    s_waitcnt vmcnt(4)
    v_cmp_gt_u32 vcc, s22, v92
    buffer_load_dword v91, v14, s[8:11], 0 offen sc1
    s_cbranch_vccz Asc10_pg_ok
    s_waitcnt vmcnt(4)
    v_cmp_gt_u32 vcc, s22, v93
    buffer_load_dword v92, v14, s[8:11], 0 offen sc1
    s_cbranch_vccz Asc10_pg_ok
    s_waitcnt vmcnt(4)
    v_cmp_gt_u32 vcc, s22, v106
    buffer_load_dword v93, v14, s[8:11], 0 offen sc1
    s_cbranch_vccz Asc10_pg_ok
    s_waitcnt vmcnt(4)
    v_cmp_gt_u32 vcc, s22, v107
    buffer_load_dword v106, v14, s[8:11], 0 offen sc1
    s_cbranch_vccz Asc10_pg_ok
    s_waitcnt vmcnt(4)
    v_cmp_gt_u32 vcc, s22, v90
    buffer_load_dword v107, v14, s[8:11], 0 offen sc1
    s_cbranch_vccz Asc10_pg_ok
    s_waitcnt vmcnt(4)
    v_cmp_gt_u32 vcc, s22, v91
    buffer_load_dword v90, v14, s[8:11], 0 offen sc1
    s_cbranch_vccz Asc10_pg_ok
    s_waitcnt vmcnt(4)
    v_cmp_gt_u32 vcc, s22, v92
    buffer_load_dword v91, v14, s[8:11], 0 offen sc1
    s_cbranch_vccz Asc10_pg_ok
    s_waitcnt vmcnt(4)
    v_cmp_gt_u32 vcc, s22, v93
    buffer_load_dword v92, v14, s[8:11], 0 offen sc1
    s_cbranch_vccz Asc10_pg_ok
    s_waitcnt vmcnt(4)
    v_cmp_gt_u32 vcc, s22, v106
    buffer_load_dword v93, v14, s[8:11], 0 offen sc1
    s_cbranch_vccz Asc10_pg_ok
    s_waitcnt vmcnt(4)
    v_cmp_gt_u32 vcc, s22, v107
    buffer_load_dword v106, v14, s[8:11], 0 offen sc1
    s_cbranch_vccz Asc10_pg_ok
    s_sub_u32 s23, s23, 1
    s_cbranch_scc0 Asc10_pg
    s_mov_b32 s23, 0
Asc10_pg_ok:
    s_barrier
    s_mul_i32 s27, s26, 10240
    s_add_u32 s25, s27, 18341888
    s_add_u32 s27, s24, 18284544
    s_add_u32 s28, s24, 18288640
    buffer_load_dwordx4 v[34:37], v4, s[8:11], s27 offen sc1
    s_barrier
    buffer_load_dwordx4 v[38:41], v4, s[8:11], s28 offen sc1
    s_barrier
    buffer_load_dwordx4 v[176:179], v16, s[8:11], s30 offen offset:0 sc1
    s_waitcnt lgkmcnt(0)
    s_waitcnt vmcnt(2)
Asc10_retry:
    v_smfmac_f32_16x16x64_bf16 v[62:65], v[34:37], v[120:127], v3
    ds_write_b128 v9, v[34:37] offset:0
    v_smfmac_f32_16x16x64_bf16 v[66:69], v[34:37], v[128:135], v3
    buffer_load_dwordx4 v[180:183], v16, s[8:11], s30 offen offset:1024 sc1
    v_smfmac_f32_16x16x64_bf16 v[70:73], v[34:37], v[136:143], v3
    buffer_load_dwordx4 v[184:187], v16, s[8:11], s31 offen offset:0 sc1
    v_smfmac_f32_16x16x64_bf16 v[74:77], v[34:37], v[144:151], v3
    v_max_u32 v22, v34, v35
    v_smfmac_f32_16x16x64_bf16 v[78:81], v[34:37], v[152:159], v3
    s_waitcnt vmcnt(3)
    ds_write_b128 v9, v[38:41] offset:4096
    v_max3_u32 v22, v36, v37, v22
    v_smfmac_f32_16x16x64_bf16 v[82:85], v[34:37], v[160:167], v3
    v_max3_u32 v22, v38, v39, v22
    v_smfmac_f32_16x16x64_bf16 v[86:89], v[34:37], v[168:175], v3
    v_max3_u32 v22, v40, v41, v22
    v_smfmac_f32_16x16x64_bf16 v[62:65], v[38:41], v[46:53], v3
    v_cmp_eq_u32 vcc, -1, v22
    v_smfmac_f32_16x16x64_bf16 v[66:69], v[38:41], v[54:61], v3
    buffer_load_dwordx4 v[188:191], v16, s[8:11], s31 offen offset:1024 sc1
    v_smfmac_f32_16x16x64_bf16 v[70:73], v[38:41], a[0:7], v3
    s_waitcnt lgkmcnt(0)
    s_cbranch_vccnz Asc10_fix
    v_smfmac_f32_16x16x64_bf16 v[74:77], v[38:41], a[8:15], v3
    s_barrier
    ds_read_b128 v[42:45], v9 offset:1024
    v_smfmac_f32_16x16x64_bf16 v[78:81], v[38:41], a[16:23], v3
    ds_read_b128 v[46:49], v9 offset:2048
    v_smfmac_f32_16x16x64_bf16 v[82:85], v[38:41], a[24:31], v3
    ds_read_b128 v[50:53], v9 offset:3072
    v_smfmac_f32_16x16x64_bf16 v[86:89], v[38:41], a[32:39], v3
    ds_read_b128 v[54:57], v9 offset:5120
    s_waitcnt lgkmcnt(3)
    v_smfmac_f32_16x16x64_bf16 v[62:65], v[42:45], a[40:47], v3
    ds_read_b128 v[58:61], v9 offset:6144
    v_smfmac_f32_16x16x64_bf16 v[66:69], v[42:45], a[48:55], v3
    buffer_load_dwordx4 v[120:123], v16, s[8:11], s30 offen offset:2048 sc1
    v_smfmac_f32_16x16x64_bf16 v[70:73], v[42:45], a[56:63], v3
    v_smfmac_f32_16x16x64_bf16 v[74:77], v[42:45], a[64:71], v3
    v_smfmac_f32_16x16x64_bf16 v[78:81], v[42:45], a[72:79], v3
    v_smfmac_f32_16x16x64_bf16 v[82:85], v[42:45], a[80:87], v3
    buffer_load_dwordx4 v[124:127], v16, s[8:11], s30 offen offset:3072 sc1
    v_smfmac_f32_16x16x64_bf16 v[86:89], v[42:45], a[88:95], v3
    s_waitcnt lgkmcnt(0)
    v_smfmac_f32_16x16x64_bf16 v[62:65], v[46:49], a[96:103], v3
    s_nop 2
    v_smfmac_f32_16x16x64_bf16 v[62:65], v[50:53], a[152:159], v3
    s_nop 2
    v_smfmac_f32_16x16x64_bf16 v[62:65], v[54:57], a[208:215], v3
    s_nop 0
    buffer_load_dwordx4 v[128:131], v16, s[8:11], s31 offen offset:2048 sc1
    v_smfmac_f32_16x16x64_bf16 v[62:65], v[58:61], v[200:207], v3
    s_nop 2
    v_smfmac_f32_16x16x64_bf16 v[66:69], v[46:49], a[104:111], v3
    s_nop 2
    v_smfmac_f32_16x16x64_bf16 v[66:69], v[50:53], a[160:167], v3
    s_nop 2
    v_smfmac_f32_16x16x64_bf16 v[66:69], v[54:57], a[216:223], v3
    s_nop 0
    buffer_load_dwordx4 v[132:135], v16, s[8:11], s31 offen offset:3072 sc1
    v_smfmac_f32_16x16x64_bf16 v[66:69], v[58:61], v[208:215], v3
    s_nop 0
    ds_read_b128 v[152:155], v5 offset:0
    v_add_f32 v62, v62, v63
    v_smfmac_f32_16x16x64_bf16 v[70:73], v[46:49], a[112:119], v3
    s_nop 0
    ds_read_b128 v[156:159], v5 offset:256
    v_add_f32 v64, v64, v65
    v_smfmac_f32_16x16x64_bf16 v[70:73], v[50:53], a[168:175], v3
    s_nop 0
    ds_read_b128 v[160:163], v6 offset:0
    v_add_f32 v66, v66, v67
    v_smfmac_f32_16x16x64_bf16 v[70:73], v[54:57], a[224:231], v3
    s_nop 0
    ds_read_b128 v[164:167], v6 offset:256
    v_cvt_pk_bf16_f32 v90, v62, v66
    v_smfmac_f32_16x16x64_bf16 v[70:73], v[58:61], v[216:223], v3
    s_nop 1
    v_add_f32 v68, v68, v69
    v_smfmac_f32_16x16x64_bf16 v[74:77], v[46:49], a[120:127], v3
    s_nop 1
    v_cvt_pk_bf16_f32 v91, v64, v68
    v_smfmac_f32_16x16x64_bf16 v[74:77], v[50:53], a[176:183], v3
    s_nop 0
    ds_write_b64 v21, v[90:91]
    v_smfmac_f32_16x16x64_bf16 v[74:77], v[54:57], a[232:239], v3
    s_nop 1
    ds_read_b64_tr_b16 v[168:169], v2
    v_smfmac_f32_16x16x64_bf16 v[74:77], v[58:61], v[224:231], v3
    s_nop 1
    v_add_f32 v70, v70, v71
    v_smfmac_f32_16x16x64_bf16 v[78:81], v[46:49], a[128:135], v3
    s_nop 1
    v_add_f32 v72, v72, v73
    v_smfmac_f32_16x16x64_bf16 v[78:81], v[50:53], a[184:191], v3
    s_nop 1
    v_add_f32 v74, v74, v75
    v_smfmac_f32_16x16x64_bf16 v[78:81], v[54:57], a[240:247], v3
    s_nop 1
    v_cvt_pk_bf16_f32 v90, v70, v74
    v_smfmac_f32_16x16x64_bf16 v[78:81], v[58:61], v[232:239], v3
    s_nop 1
    v_add_f32 v76, v76, v77
    v_smfmac_f32_16x16x64_bf16 v[82:85], v[46:49], a[136:143], v3
    s_nop 1
    v_cvt_pk_bf16_f32 v91, v72, v76
    v_smfmac_f32_16x16x64_bf16 v[82:85], v[50:53], a[192:199], v3
    s_nop 0
    ds_write_b64 v21, v[90:91]
    v_smfmac_f32_16x16x64_bf16 v[82:85], v[54:57], a[248:255], v3
    s_nop 1
    ds_read_b64_tr_b16 v[170:171], v2
    v_smfmac_f32_16x16x64_bf16 v[82:85], v[58:61], v[240:247], v3
    s_nop 1
    v_cvt_pk_bf16_f32 v90, v78, v79
    v_smfmac_f32_16x16x64_bf16 v[86:89], v[46:49], a[144:151], v3
    s_nop 1
    v_cvt_pk_bf16_f32 v91, v80, v81
    v_smfmac_f32_16x16x64_bf16 v[86:89], v[50:53], a[200:207], v3
    s_nop 1
    v_cvt_pk_bf16_f32 v92, v82, v83
    v_smfmac_f32_16x16x64_bf16 v[86:89], v[54:57], v[192:199], v3
    s_nop 1
    v_cvt_pk_bf16_f32 v93, v84, v85
    v_smfmac_f32_16x16x64_bf16 v[86:89], v[58:61], v[248:255], v3
    s_nop 0
    s_waitcnt vmcnt(4)
    s_waitcnt lgkmcnt(0)
    v_mfma_f32_16x16x32_bf16 v[106:109], v[90:93], v[28:31], 0
    s_nop 2
    v_smfmac_f32_16x16x64_bf16 v[98:101], v[168:171], v[176:183], v3
    v_cvt_pk_bf16_f32 v38, v86, v87
    v_cvt_pk_bf16_f32 v39, v88, v89
    s_nop 1
    v_mfma_f32_16x16x16_bf16 v[34:37], v[38:39], v[32:33], 0
    v_cvt_pk_bf16_f32 v172, v106, v107
    v_cvt_pk_bf16_f32 v173, v108, v109
    v_smfmac_f32_16x16x64_bf16 v[102:105], v[168:171], v[184:191], v3
    s_nop 2
    v_smfmac_f32_16x16x64_bf16 v[94:97], v[168:171], v[152:159], v3
    s_nop 0
    v_cvt_pk_bf16_f32 v174, v34, v35
    v_cvt_pk_bf16_f32 v175, v36, v37
    s_add_u32 s22, s22, 1
    s_waitcnt vmcnt(0)
    v_smfmac_f32_16x16x64_bf16 v[98:101], v[172:175], v[120:127], v3
    s_nop 1
    v_mov_b32 v25, s22
    v_smfmac_f32_16x16x64_bf16 v[102:105], v[172:175], v[128:135], v3
    s_nop 2
    v_smfmac_f32_16x16x64_bf16 v[94:97], v[172:175], v[160:167], v3
    s_nop 1
    v_add_f32 v42, v98, v99
    v_add_f32 v44, v100, v101
    v_add_f32 v43, v102, v103
    v_add_f32 v45, v104, v105
    v_mfma_f32_32x32x16_bf16 v[62:77], v[110:113], v[110:113], 0
    ds_write_b128 v10, v[42:45]
    v_add_f32 v46, v94, v95
    v_add_f32 v47, v96, v97
    ds_write2_b32 v11, v46, v47 offset0:0 offset1:2
    v_mfma_f32_32x32x16_bf16 v[78:93], v[110:113], v[110:113], 0
    s_barrier
    ds_read_b64 v[50:51], v12 offset:0
    ds_read_b64 v[52:53], v12 offset:1024
    ds_read_b64 v[54:55], v12 offset:2048
    ds_read_b64 v[56:57], v12 offset:3072
    v_mfma_f32_32x32x16_bf16 v[94:109], v[110:113], v[110:113], 0
    s_waitcnt lgkmcnt(2)
    v_add_f32 v50, v50, v52
    v_add_f32 v51, v51, v53
    s_waitcnt lgkmcnt(1)
    v_add_f32 v50, v50, v54
    v_add_f32 v51, v51, v55
    s_waitcnt lgkmcnt(0)
    v_add_f32 v50, v50, v56
    v_add_f32 v51, v51, v57
    v_exp_f32 v118, v50
    v_exp_f32 v119, v51
    v_add_f32 v58, abs(v50), abs(v51)
Asc10_back:
    v_add_f32 v59, v118, v119
    v_add_f32 v60, v118, v119
    v_cmp_nge_f32 vcc, v26, v58
    s_nop 0
    v_permlane32_swap_b32 v59, v60
    v_add_f32 v59, v59, v60
    s_nop 1
    v_add_f32_dpp v59, v59, v59 row_ror:1 row_mask:0xf bank_mask:0xf
    s_nop 1
    v_add_f32_dpp v59, v59, v59 row_ror:2 row_mask:0xf bank_mask:0xf
    s_cbranch_vccnz Asc10_slow
    s_nop 0
    v_add_f32_dpp v59, v59, v59 row_ror:4 row_mask:0xf bank_mask:0xf
    s_nop 1
    v_add_f32_dpp v59, v59, v59 row_ror:8 row_mask:0xf bank_mask:0xf
    v_rcp_f32 v59, v59
    s_nop 0
    v_pk_mul_f32 v[60:61], v[118:119], v[58:59] op_sel:[0,1] op_sel_hi:[1,1]
    v_cvt_pk_bf16_f32 v60, v60, v61
    buffer_store_dword v60, v13, s[8:11], s25 offen sc1
    s_cmp_lt_u32 s22, 63
    s_cbranch_scc1 Asc10_top
    s_branch A_done
Asc10_fix:
    buffer_load_dwordx4 v[34:37], v4, s[8:11], s27 offen sc1
    buffer_load_dwordx4 v[38:41], v4, s[8:11], s28 offen sc1
    s_nop 4
    s_nop 0
    v_mov_b64 v[62:63], 0
    v_mov_b64 v[64:65], 0
    v_mov_b64 v[66:67], 0
    v_mov_b64 v[68:69], 0
    v_mov_b64 v[70:71], 0
    v_mov_b64 v[72:73], 0
    v_mov_b64 v[74:75], 0
    v_mov_b64 v[76:77], 0
    v_mov_b64 v[78:79], 0
    v_mov_b64 v[80:81], 0
    v_mov_b64 v[82:83], 0
    v_mov_b64 v[84:85], 0
    v_mov_b64 v[86:87], 0
    v_mov_b64 v[88:89], 0
    s_waitcnt vmcnt(2)
    ds_read_b128 v[120:123], v7 offset:0
    ds_read_b128 v[124:127], v7 offset:1024
    ds_read_b128 v[128:131], v7 offset:2048
    ds_read_b128 v[132:135], v7 offset:3072
    s_waitcnt vmcnt(0) lgkmcnt(0)
    s_sub_u32 s23, s23, 1
    s_cbranch_scc0 Asc10_retry
    s_branch A_done
Asc10_slow:
    ds_read_b64 v[50:51], v12 offset:0
    ds_read_b64 v[52:53], v12 offset:1024
    ds_read_b64 v[54:55], v12 offset:2048
    ds_read_b64 v[56:57], v12 offset:3072
    s_sub_u32 s23, s23, 1
    s_cbranch_scc1 A_done
    s_waitcnt lgkmcnt(0)
    v_max_u32 v59, v50, v51
    v_max3_u32 v59, v52, v53, v59
    v_max3_u32 v59, v54, v55, v59
    v_max3_u32 v59, v56, v57, v59
    v_cmp_eq_u32 vcc, -1, v59
    s_cbranch_vccnz Asc10_slow
    v_add_f32 v50, v50, v52
    v_add_f32 v51, v51, v53
    v_add_f32 v50, v50, v54
    v_add_f32 v51, v51, v55
    v_add_f32 v50, v50, v56
    v_add_f32 v51, v51, v57
    v_max_f32 v59, v50, v51
    v_mov_b32 v60, v59
    s_nop 1
    v_permlane32_swap_b32 v59, v60
    v_max_f32 v59, v59, v60
    s_nop 1
    v_max_f32_dpp v59, v59, v59 row_ror:1 row_mask:0xf bank_mask:0xf
    s_nop 1
    v_max_f32_dpp v59, v59, v59 row_ror:2 row_mask:0xf bank_mask:0xf
    s_nop 1
    v_max_f32_dpp v59, v59, v59 row_ror:4 row_mask:0xf bank_mask:0xf
    s_nop 1
    v_max_f32_dpp v59, v59, v59 row_ror:8 row_mask:0xf bank_mask:0xf
    v_sub_f32 v50, v50, v59
    v_sub_f32 v51, v51, v59
    v_exp_f32 v118, v50
    v_exp_f32 v119, v51
    v_mov_b32 v58, 0
    s_branch Asc10_back
.p2align 6
Asc11_top:
    s_add_u32 s30, s30, 32768
    s_add_u32 s31, s30, 4096
    v_mov_b32 v118, v27
    v_mov_b32 v119, v27
    ds_write_b64 v12, v[118:119] offset:0
    ds_write_b64 v12, v[118:119] offset:1024
    ds_write_b64 v12, v[118:119] offset:2048
    ds_write_b64 v12, v[118:119] offset:3072
    buffer_store_dword v20, v13, s[8:11], s32 offen sc1
    s_mov_b32 s32, s25
    ds_read_b128 v[120:123], v7 offset:0
    ds_read_b128 v[124:127], v7 offset:1024
    ds_read_b128 v[128:131], v7 offset:2048
    ds_read_b128 v[132:135], v7 offset:3072
    ds_read_b128 v[136:139], v7 offset:4096
    ds_read_b128 v[140:143], v7 offset:5120
    ds_read_b128 v[144:147], v7 offset:6144
    ds_read_b128 v[148:151], v7 offset:7168
    ds_read_b128 v[152:155], v7 offset:8192
    ds_read_b128 v[156:159], v7 offset:9216
    ds_read_b128 v[160:163], v7 offset:10240
    ds_read_b128 v[164:167], v7 offset:11264
    ds_read_b128 v[168:171], v7 offset:12288
    ds_read_b128 v[172:175], v7 offset:13312
    ds_read_b128 v[46:49], v7 offset:14336
    ds_read_b128 v[50:53], v7 offset:15360
    ds_read_b128 v[54:57], v7 offset:16384
    ds_read_b128 v[58:61], v7 offset:17408
    s_and_b32 s26, s22, 7
    s_mul_i32 s24, s26, 7168
    s_and_b32 s26, s22, 3
    s_barrier
    s_mul_i32 s27, s26, 10240
    s_add_u32 s25, s27, 18341888
    s_add_u32 s27, s24, 18285568
    s_add_u32 s28, s24, 18289664
    buffer_load_dwordx4 v[34:37], v4, s[8:11], s27 offen sc1
    s_barrier
    buffer_load_dwordx4 v[38:41], v4, s[8:11], s28 offen sc1
    s_barrier
    buffer_load_dwordx4 v[176:179], v16, s[8:11], s30 offen offset:0 sc1
    s_waitcnt lgkmcnt(0)
    s_waitcnt vmcnt(2)
Asc11_retry:
    v_smfmac_f32_16x16x64_bf16 v[62:65], v[34:37], v[120:127], v3
    ds_write_b128 v9, v[34:37] offset:1024
    v_smfmac_f32_16x16x64_bf16 v[66:69], v[34:37], v[128:135], v3
    buffer_load_dwordx4 v[180:183], v16, s[8:11], s30 offen offset:1024 sc1
    v_smfmac_f32_16x16x64_bf16 v[70:73], v[34:37], v[136:143], v3
    buffer_load_dwordx4 v[184:187], v16, s[8:11], s31 offen offset:0 sc1
    v_smfmac_f32_16x16x64_bf16 v[74:77], v[34:37], v[144:151], v3
    v_max_u32 v22, v34, v35
    v_smfmac_f32_16x16x64_bf16 v[78:81], v[34:37], v[152:159], v3
    s_waitcnt vmcnt(3)
    ds_write_b128 v9, v[38:41] offset:5120
    v_max3_u32 v22, v36, v37, v22
    v_smfmac_f32_16x16x64_bf16 v[82:85], v[34:37], v[160:167], v3
    v_max3_u32 v22, v38, v39, v22
    v_smfmac_f32_16x16x64_bf16 v[86:89], v[34:37], v[168:175], v3
    v_max3_u32 v22, v40, v41, v22
    v_smfmac_f32_16x16x64_bf16 v[62:65], v[38:41], v[46:53], v3
    v_cmp_eq_u32 vcc, -1, v22
    v_smfmac_f32_16x16x64_bf16 v[66:69], v[38:41], v[54:61], v3
    buffer_load_dwordx4 v[188:191], v16, s[8:11], s31 offen offset:1024 sc1
    v_smfmac_f32_16x16x64_bf16 v[70:73], v[38:41], a[0:7], v3
    s_waitcnt lgkmcnt(0)
    s_cbranch_vccnz Asc11_fix
    v_smfmac_f32_16x16x64_bf16 v[74:77], v[38:41], a[8:15], v3
    s_barrier
    ds_read_b128 v[42:45], v9 offset:2048
    v_smfmac_f32_16x16x64_bf16 v[78:81], v[38:41], a[16:23], v3
    ds_read_b128 v[46:49], v9 offset:3072
    v_smfmac_f32_16x16x64_bf16 v[82:85], v[38:41], a[24:31], v3
    ds_read_b128 v[50:53], v9 offset:4096
    v_smfmac_f32_16x16x64_bf16 v[86:89], v[38:41], a[32:39], v3
    ds_read_b128 v[54:57], v9 offset:6144
    s_waitcnt lgkmcnt(3)
    v_smfmac_f32_16x16x64_bf16 v[62:65], v[42:45], a[40:47], v3
    ds_read_b128 v[58:61], v9 offset:0
    v_smfmac_f32_16x16x64_bf16 v[66:69], v[42:45], a[48:55], v3
    buffer_load_dwordx4 v[120:123], v16, s[8:11], s30 offen offset:2048 sc1
    v_smfmac_f32_16x16x64_bf16 v[70:73], v[42:45], a[56:63], v3
    v_smfmac_f32_16x16x64_bf16 v[74:77], v[42:45], a[64:71], v3
    v_smfmac_f32_16x16x64_bf16 v[78:81], v[42:45], a[72:79], v3
    v_smfmac_f32_16x16x64_bf16 v[82:85], v[42:45], a[80:87], v3
    buffer_load_dwordx4 v[124:127], v16, s[8:11], s30 offen offset:3072 sc1
    v_smfmac_f32_16x16x64_bf16 v[86:89], v[42:45], a[88:95], v3
    s_waitcnt lgkmcnt(0)
    v_smfmac_f32_16x16x64_bf16 v[62:65], v[46:49], a[96:103], v3
    s_nop 2
    v_smfmac_f32_16x16x64_bf16 v[62:65], v[50:53], a[152:159], v3
    s_nop 2
    v_smfmac_f32_16x16x64_bf16 v[62:65], v[54:57], a[208:215], v3
    s_nop 0
    buffer_load_dwordx4 v[128:131], v16, s[8:11], s31 offen offset:2048 sc1
    v_smfmac_f32_16x16x64_bf16 v[62:65], v[58:61], v[200:207], v3
    s_nop 2
    v_smfmac_f32_16x16x64_bf16 v[66:69], v[46:49], a[104:111], v3
    s_nop 2
    v_smfmac_f32_16x16x64_bf16 v[66:69], v[50:53], a[160:167], v3
    s_nop 2
    v_smfmac_f32_16x16x64_bf16 v[66:69], v[54:57], a[216:223], v3
    s_nop 0
    buffer_load_dwordx4 v[132:135], v16, s[8:11], s31 offen offset:3072 sc1
    v_smfmac_f32_16x16x64_bf16 v[66:69], v[58:61], v[208:215], v3
    s_nop 0
    ds_read_b128 v[152:155], v5 offset:0
    v_add_f32 v62, v62, v63
    v_smfmac_f32_16x16x64_bf16 v[70:73], v[46:49], a[112:119], v3
    s_nop 0
    ds_read_b128 v[156:159], v5 offset:256
    v_add_f32 v64, v64, v65
    v_smfmac_f32_16x16x64_bf16 v[70:73], v[50:53], a[168:175], v3
    s_nop 0
    ds_read_b128 v[160:163], v6 offset:0
    v_add_f32 v66, v66, v67
    v_smfmac_f32_16x16x64_bf16 v[70:73], v[54:57], a[224:231], v3
    s_nop 0
    ds_read_b128 v[164:167], v6 offset:256
    v_cvt_pk_bf16_f32 v90, v62, v66
    v_smfmac_f32_16x16x64_bf16 v[70:73], v[58:61], v[216:223], v3
    s_nop 1
    v_add_f32 v68, v68, v69
    v_smfmac_f32_16x16x64_bf16 v[74:77], v[46:49], a[120:127], v3
    s_nop 1
    v_cvt_pk_bf16_f32 v91, v64, v68
    v_smfmac_f32_16x16x64_bf16 v[74:77], v[50:53], a[176:183], v3
    s_nop 0
    ds_write_b64 v21, v[90:91]
    v_smfmac_f32_16x16x64_bf16 v[74:77], v[54:57], a[232:239], v3
    s_nop 1
    ds_read_b64_tr_b16 v[168:169], v2
    v_smfmac_f32_16x16x64_bf16 v[74:77], v[58:61], v[224:231], v3
    s_nop 1
    v_add_f32 v70, v70, v71
    v_smfmac_f32_16x16x64_bf16 v[78:81], v[46:49], a[128:135], v3
    s_nop 1
    v_add_f32 v72, v72, v73
    v_smfmac_f32_16x16x64_bf16 v[78:81], v[50:53], a[184:191], v3
    s_nop 1
    v_add_f32 v74, v74, v75
    v_smfmac_f32_16x16x64_bf16 v[78:81], v[54:57], a[240:247], v3
    s_nop 1
    v_cvt_pk_bf16_f32 v90, v70, v74
    v_smfmac_f32_16x16x64_bf16 v[78:81], v[58:61], v[232:239], v3
    s_nop 1
    v_add_f32 v76, v76, v77
    v_smfmac_f32_16x16x64_bf16 v[82:85], v[46:49], a[136:143], v3
    s_nop 1
    v_cvt_pk_bf16_f32 v91, v72, v76
    v_smfmac_f32_16x16x64_bf16 v[82:85], v[50:53], a[192:199], v3
    s_nop 0
    ds_write_b64 v21, v[90:91]
    v_smfmac_f32_16x16x64_bf16 v[82:85], v[54:57], a[248:255], v3
    s_nop 1
    ds_read_b64_tr_b16 v[170:171], v2
    v_smfmac_f32_16x16x64_bf16 v[82:85], v[58:61], v[240:247], v3
    s_nop 1
    v_cvt_pk_bf16_f32 v90, v78, v79
    v_smfmac_f32_16x16x64_bf16 v[86:89], v[46:49], a[144:151], v3
    s_nop 1
    v_cvt_pk_bf16_f32 v91, v80, v81
    v_smfmac_f32_16x16x64_bf16 v[86:89], v[50:53], a[200:207], v3
    s_nop 1
    v_cvt_pk_bf16_f32 v92, v82, v83
    v_smfmac_f32_16x16x64_bf16 v[86:89], v[54:57], v[192:199], v3
    s_nop 1
    v_cvt_pk_bf16_f32 v93, v84, v85
    v_smfmac_f32_16x16x64_bf16 v[86:89], v[58:61], v[248:255], v3
    s_nop 0
    s_waitcnt vmcnt(4)
    s_waitcnt lgkmcnt(0)
    v_mfma_f32_16x16x32_bf16 v[106:109], v[90:93], v[28:31], 0
    s_nop 2
    v_smfmac_f32_16x16x64_bf16 v[98:101], v[168:171], v[176:183], v3
    v_cvt_pk_bf16_f32 v38, v86, v87
    v_cvt_pk_bf16_f32 v39, v88, v89
    s_nop 1
    v_mfma_f32_16x16x16_bf16 v[34:37], v[38:39], v[32:33], 0
    v_cvt_pk_bf16_f32 v172, v106, v107
    v_cvt_pk_bf16_f32 v173, v108, v109
    v_smfmac_f32_16x16x64_bf16 v[102:105], v[168:171], v[184:191], v3
    s_nop 2
    v_smfmac_f32_16x16x64_bf16 v[94:97], v[168:171], v[152:159], v3
    s_nop 0
    v_cvt_pk_bf16_f32 v174, v34, v35
    v_cvt_pk_bf16_f32 v175, v36, v37
    s_add_u32 s22, s22, 1
    s_waitcnt vmcnt(0)
    v_smfmac_f32_16x16x64_bf16 v[98:101], v[172:175], v[120:127], v3
    s_nop 1
    v_mov_b32 v25, s22
    v_smfmac_f32_16x16x64_bf16 v[102:105], v[172:175], v[128:135], v3
    s_nop 2
    v_smfmac_f32_16x16x64_bf16 v[94:97], v[172:175], v[160:167], v3
    s_nop 1
    v_add_f32 v42, v98, v99
    v_add_f32 v44, v100, v101
    v_add_f32 v43, v102, v103
    v_add_f32 v45, v104, v105
    v_mfma_f32_32x32x16_bf16 v[62:77], v[110:113], v[110:113], 0
    ds_write_b128 v10, v[42:45]
    v_add_f32 v46, v94, v95
    v_add_f32 v47, v96, v97
    ds_write2_b32 v11, v46, v47 offset0:0 offset1:2
    v_mfma_f32_32x32x16_bf16 v[78:93], v[110:113], v[110:113], 0
    s_barrier
    ds_read_b64 v[50:51], v12 offset:0
    ds_read_b64 v[52:53], v12 offset:1024
    ds_read_b64 v[54:55], v12 offset:2048
    ds_read_b64 v[56:57], v12 offset:3072
    buffer_store_dword v25, v15, s[8:11], 0 offen sc1
    v_mfma_f32_32x32x16_bf16 v[94:109], v[110:113], v[110:113], 0
    s_waitcnt lgkmcnt(2)
    v_add_f32 v50, v50, v52
    v_add_f32 v51, v51, v53
    s_waitcnt lgkmcnt(1)
    v_add_f32 v50, v50, v54
    v_add_f32 v51, v51, v55
    s_waitcnt lgkmcnt(0)
    v_add_f32 v50, v50, v56
    v_add_f32 v51, v51, v57
    v_exp_f32 v118, v50
    v_exp_f32 v119, v51
    v_add_f32 v58, abs(v50), abs(v51)
Asc11_back:
    v_add_f32 v59, v118, v119
    v_add_f32 v60, v118, v119
    v_cmp_nge_f32 vcc, v26, v58
    s_nop 0
    v_permlane32_swap_b32 v59, v60
    v_add_f32 v59, v59, v60
    s_nop 1
    v_add_f32_dpp v59, v59, v59 row_ror:1 row_mask:0xf bank_mask:0xf
    s_nop 1
    v_add_f32_dpp v59, v59, v59 row_ror:2 row_mask:0xf bank_mask:0xf
    s_cbranch_vccnz Asc11_slow
    s_nop 0
    v_add_f32_dpp v59, v59, v59 row_ror:4 row_mask:0xf bank_mask:0xf
    s_nop 1
    v_add_f32_dpp v59, v59, v59 row_ror:8 row_mask:0xf bank_mask:0xf
    v_rcp_f32 v59, v59
    s_nop 0
    v_pk_mul_f32 v[60:61], v[118:119], v[58:59] op_sel:[0,1] op_sel_hi:[1,1]
    v_cvt_pk_bf16_f32 v60, v60, v61
    buffer_store_dword v60, v13, s[8:11], s25 offen sc1
    s_cmp_lt_u32 s22, 63
    s_cbranch_scc1 Asc11_top
    s_branch A_done
Asc11_fix:
    buffer_load_dwordx4 v[34:37], v4, s[8:11], s27 offen sc1
    buffer_load_dwordx4 v[38:41], v4, s[8:11], s28 offen sc1
    s_nop 4
    s_nop 0
    v_mov_b64 v[62:63], 0
    v_mov_b64 v[64:65], 0
    v_mov_b64 v[66:67], 0
    v_mov_b64 v[68:69], 0
    v_mov_b64 v[70:71], 0
    v_mov_b64 v[72:73], 0
    v_mov_b64 v[74:75], 0
    v_mov_b64 v[76:77], 0
    v_mov_b64 v[78:79], 0
    v_mov_b64 v[80:81], 0
    v_mov_b64 v[82:83], 0
    v_mov_b64 v[84:85], 0
    v_mov_b64 v[86:87], 0
    v_mov_b64 v[88:89], 0
    s_waitcnt vmcnt(2)
    ds_read_b128 v[120:123], v7 offset:0
    ds_read_b128 v[124:127], v7 offset:1024
    ds_read_b128 v[128:131], v7 offset:2048
    ds_read_b128 v[132:135], v7 offset:3072
    s_waitcnt vmcnt(0) lgkmcnt(0)
    s_sub_u32 s23, s23, 1
    s_cbranch_scc0 Asc11_retry
    s_branch A_done
Asc11_slow:
    ds_read_b64 v[50:51], v12 offset:0
    ds_read_b64 v[52:53], v12 offset:1024
    ds_read_b64 v[54:55], v12 offset:2048
    ds_read_b64 v[56:57], v12 offset:3072
    s_sub_u32 s23, s23, 1
    s_cbranch_scc1 A_done
    s_waitcnt lgkmcnt(0)
    v_max_u32 v59, v50, v51
    v_max3_u32 v59, v52, v53, v59
    v_max3_u32 v59, v54, v55, v59
    v_max3_u32 v59, v56, v57, v59
    v_cmp_eq_u32 vcc, -1, v59
    s_cbranch_vccnz Asc11_slow
    v_add_f32 v50, v50, v52
    v_add_f32 v51, v51, v53
    v_add_f32 v50, v50, v54
    v_add_f32 v51, v51, v55
    v_add_f32 v50, v50, v56
    v_add_f32 v51, v51, v57
    v_max_f32 v59, v50, v51
    v_mov_b32 v60, v59
    s_nop 1
    v_permlane32_swap_b32 v59, v60
    v_max_f32 v59, v59, v60
    s_nop 1
    v_max_f32_dpp v59, v59, v59 row_ror:1 row_mask:0xf bank_mask:0xf
    s_nop 1
    v_max_f32_dpp v59, v59, v59 row_ror:2 row_mask:0xf bank_mask:0xf
    s_nop 1
    v_max_f32_dpp v59, v59, v59 row_ror:4 row_mask:0xf bank_mask:0xf
    s_nop 1
    v_max_f32_dpp v59, v59, v59 row_ror:8 row_mask:0xf bank_mask:0xf
    v_sub_f32 v50, v50, v59
    v_sub_f32 v51, v51, v59
    v_exp_f32 v118, v50
    v_exp_f32 v119, v51
    v_mov_b32 v58, 0
    s_branch Asc11_back
.p2align 6
Asc12_top:
    s_add_u32 s30, s30, 32768
    s_add_u32 s31, s30, 4096
    v_mov_b32 v118, v27
    v_mov_b32 v119, v27
    ds_write_b64 v12, v[118:119] offset:0
    ds_write_b64 v12, v[118:119] offset:1024
    ds_write_b64 v12, v[118:119] offset:2048
    ds_write_b64 v12, v[118:119] offset:3072
    buffer_store_dword v20, v13, s[8:11], s32 offen sc1
    s_mov_b32 s32, s25
    ds_read_b128 v[120:123], v7 offset:0
    ds_read_b128 v[124:127], v7 offset:1024
    ds_read_b128 v[128:131], v7 offset:2048
    ds_read_b128 v[132:135], v7 offset:3072
    ds_read_b128 v[136:139], v7 offset:4096
    ds_read_b128 v[140:143], v7 offset:5120
    ds_read_b128 v[144:147], v7 offset:6144
    ds_read_b128 v[148:151], v7 offset:7168
    ds_read_b128 v[152:155], v7 offset:8192
    ds_read_b128 v[156:159], v7 offset:9216
    ds_read_b128 v[160:163], v7 offset:10240
    ds_read_b128 v[164:167], v7 offset:11264
    ds_read_b128 v[168:171], v7 offset:12288
    ds_read_b128 v[172:175], v7 offset:13312
    ds_read_b128 v[46:49], v7 offset:14336
    ds_read_b128 v[50:53], v7 offset:15360
    ds_read_b128 v[54:57], v7 offset:16384
    ds_read_b128 v[58:61], v7 offset:17408
    s_and_b32 s26, s22, 7
    s_mul_i32 s24, s26, 7168
    s_and_b32 s26, s22, 3
    s_barrier
    s_mul_i32 s27, s26, 10240
    s_add_u32 s25, s27, 18341888
    s_add_u32 s27, s24, 18286592
    s_add_u32 s28, s24, 18290688
    buffer_load_dwordx4 v[34:37], v4, s[8:11], s27 offen sc1
    s_barrier
    buffer_load_dwordx4 v[38:41], v4, s[8:11], s28 offen sc1
    s_barrier
    buffer_load_dwordx4 v[176:179], v16, s[8:11], s30 offen offset:0 sc1
    s_waitcnt lgkmcnt(0)
    s_waitcnt vmcnt(2)
Asc12_retry:
    v_smfmac_f32_16x16x64_bf16 v[62:65], v[34:37], v[120:127], v3
    ds_write_b128 v9, v[34:37] offset:2048
    v_smfmac_f32_16x16x64_bf16 v[66:69], v[34:37], v[128:135], v3
    buffer_load_dwordx4 v[180:183], v16, s[8:11], s30 offen offset:1024 sc1
    v_smfmac_f32_16x16x64_bf16 v[70:73], v[34:37], v[136:143], v3
    buffer_load_dwordx4 v[184:187], v16, s[8:11], s31 offen offset:0 sc1
    v_smfmac_f32_16x16x64_bf16 v[74:77], v[34:37], v[144:151], v3
    v_max_u32 v22, v34, v35
    v_smfmac_f32_16x16x64_bf16 v[78:81], v[34:37], v[152:159], v3
    s_waitcnt vmcnt(3)
    ds_write_b128 v9, v[38:41] offset:6144
    v_max3_u32 v22, v36, v37, v22
    v_smfmac_f32_16x16x64_bf16 v[82:85], v[34:37], v[160:167], v3
    v_max3_u32 v22, v38, v39, v22
    v_smfmac_f32_16x16x64_bf16 v[86:89], v[34:37], v[168:175], v3
    v_max3_u32 v22, v40, v41, v22
    v_smfmac_f32_16x16x64_bf16 v[62:65], v[38:41], v[46:53], v3
    v_cmp_eq_u32 vcc, -1, v22
    v_smfmac_f32_16x16x64_bf16 v[66:69], v[38:41], v[54:61], v3
    buffer_load_dwordx4 v[188:191], v16, s[8:11], s31 offen offset:1024 sc1
    v_smfmac_f32_16x16x64_bf16 v[70:73], v[38:41], a[0:7], v3
    s_waitcnt lgkmcnt(0)
    s_cbranch_vccnz Asc12_fix
    v_smfmac_f32_16x16x64_bf16 v[74:77], v[38:41], a[8:15], v3
    s_barrier
    ds_read_b128 v[42:45], v9 offset:3072
    v_smfmac_f32_16x16x64_bf16 v[78:81], v[38:41], a[16:23], v3
    ds_read_b128 v[46:49], v9 offset:4096
    v_smfmac_f32_16x16x64_bf16 v[82:85], v[38:41], a[24:31], v3
    ds_read_b128 v[50:53], v9 offset:5120
    v_smfmac_f32_16x16x64_bf16 v[86:89], v[38:41], a[32:39], v3
    ds_read_b128 v[54:57], v9 offset:0
    s_waitcnt lgkmcnt(3)
    v_smfmac_f32_16x16x64_bf16 v[62:65], v[42:45], a[40:47], v3
    ds_read_b128 v[58:61], v9 offset:1024
    v_smfmac_f32_16x16x64_bf16 v[66:69], v[42:45], a[48:55], v3
    buffer_load_dwordx4 v[120:123], v16, s[8:11], s30 offen offset:2048 sc1
    v_smfmac_f32_16x16x64_bf16 v[70:73], v[42:45], a[56:63], v3
    v_smfmac_f32_16x16x64_bf16 v[74:77], v[42:45], a[64:71], v3
    v_smfmac_f32_16x16x64_bf16 v[78:81], v[42:45], a[72:79], v3
    v_smfmac_f32_16x16x64_bf16 v[82:85], v[42:45], a[80:87], v3
    buffer_load_dwordx4 v[124:127], v16, s[8:11], s30 offen offset:3072 sc1
    v_smfmac_f32_16x16x64_bf16 v[86:89], v[42:45], a[88:95], v3
    s_waitcnt lgkmcnt(0)
    v_smfmac_f32_16x16x64_bf16 v[62:65], v[46:49], a[96:103], v3
    s_nop 2
    v_smfmac_f32_16x16x64_bf16 v[62:65], v[50:53], a[152:159], v3
    s_nop 2
    v_smfmac_f32_16x16x64_bf16 v[62:65], v[54:57], a[208:215], v3
    s_nop 0
    buffer_load_dwordx4 v[128:131], v16, s[8:11], s31 offen offset:2048 sc1
    v_smfmac_f32_16x16x64_bf16 v[62:65], v[58:61], v[200:207], v3
    s_nop 2
    v_smfmac_f32_16x16x64_bf16 v[66:69], v[46:49], a[104:111], v3
    s_nop 2
    v_smfmac_f32_16x16x64_bf16 v[66:69], v[50:53], a[160:167], v3
    s_nop 2
    v_smfmac_f32_16x16x64_bf16 v[66:69], v[54:57], a[216:223], v3
    s_nop 0
    buffer_load_dwordx4 v[132:135], v16, s[8:11], s31 offen offset:3072 sc1
    v_smfmac_f32_16x16x64_bf16 v[66:69], v[58:61], v[208:215], v3
    s_nop 0
    ds_read_b128 v[152:155], v5 offset:0
    v_add_f32 v62, v62, v63
    v_smfmac_f32_16x16x64_bf16 v[70:73], v[46:49], a[112:119], v3
    s_nop 0
    ds_read_b128 v[156:159], v5 offset:256
    v_add_f32 v64, v64, v65
    v_smfmac_f32_16x16x64_bf16 v[70:73], v[50:53], a[168:175], v3
    s_nop 0
    ds_read_b128 v[160:163], v6 offset:0
    v_add_f32 v66, v66, v67
    v_smfmac_f32_16x16x64_bf16 v[70:73], v[54:57], a[224:231], v3
    s_nop 0
    ds_read_b128 v[164:167], v6 offset:256
    v_cvt_pk_bf16_f32 v90, v62, v66
    v_smfmac_f32_16x16x64_bf16 v[70:73], v[58:61], v[216:223], v3
    s_nop 1
    v_add_f32 v68, v68, v69
    v_smfmac_f32_16x16x64_bf16 v[74:77], v[46:49], a[120:127], v3
    s_nop 1
    v_cvt_pk_bf16_f32 v91, v64, v68
    v_smfmac_f32_16x16x64_bf16 v[74:77], v[50:53], a[176:183], v3
    s_nop 0
    ds_write_b64 v21, v[90:91]
    v_smfmac_f32_16x16x64_bf16 v[74:77], v[54:57], a[232:239], v3
    s_nop 1
    ds_read_b64_tr_b16 v[168:169], v2
    v_smfmac_f32_16x16x64_bf16 v[74:77], v[58:61], v[224:231], v3
    s_nop 1
    v_add_f32 v70, v70, v71
    v_smfmac_f32_16x16x64_bf16 v[78:81], v[46:49], a[128:135], v3
    s_nop 1
    v_add_f32 v72, v72, v73
    v_smfmac_f32_16x16x64_bf16 v[78:81], v[50:53], a[184:191], v3
    s_nop 1
    v_add_f32 v74, v74, v75
    v_smfmac_f32_16x16x64_bf16 v[78:81], v[54:57], a[240:247], v3
    s_nop 1
    v_cvt_pk_bf16_f32 v90, v70, v74
    v_smfmac_f32_16x16x64_bf16 v[78:81], v[58:61], v[232:239], v3
    s_nop 1
    v_add_f32 v76, v76, v77
    v_smfmac_f32_16x16x64_bf16 v[82:85], v[46:49], a[136:143], v3
    s_nop 1
    v_cvt_pk_bf16_f32 v91, v72, v76
    v_smfmac_f32_16x16x64_bf16 v[82:85], v[50:53], a[192:199], v3
    s_nop 0
    ds_write_b64 v21, v[90:91]
    v_smfmac_f32_16x16x64_bf16 v[82:85], v[54:57], a[248:255], v3
    s_nop 1
    ds_read_b64_tr_b16 v[170:171], v2
    v_smfmac_f32_16x16x64_bf16 v[82:85], v[58:61], v[240:247], v3
    s_nop 1
    v_cvt_pk_bf16_f32 v90, v78, v79
    v_smfmac_f32_16x16x64_bf16 v[86:89], v[46:49], a[144:151], v3
    s_nop 1
    v_cvt_pk_bf16_f32 v91, v80, v81
    v_smfmac_f32_16x16x64_bf16 v[86:89], v[50:53], a[200:207], v3
    s_nop 1
    v_cvt_pk_bf16_f32 v92, v82, v83
    v_smfmac_f32_16x16x64_bf16 v[86:89], v[54:57], v[192:199], v3
    s_nop 1
    v_cvt_pk_bf16_f32 v93, v84, v85
    v_smfmac_f32_16x16x64_bf16 v[86:89], v[58:61], v[248:255], v3
    s_nop 0
    s_waitcnt vmcnt(4)
    s_waitcnt lgkmcnt(0)
    v_mfma_f32_16x16x32_bf16 v[106:109], v[90:93], v[28:31], 0
    s_nop 2
    v_smfmac_f32_16x16x64_bf16 v[98:101], v[168:171], v[176:183], v3
    v_cvt_pk_bf16_f32 v38, v86, v87
    v_cvt_pk_bf16_f32 v39, v88, v89
    s_nop 1
    v_mfma_f32_16x16x16_bf16 v[34:37], v[38:39], v[32:33], 0
    v_cvt_pk_bf16_f32 v172, v106, v107
    v_cvt_pk_bf16_f32 v173, v108, v109
    v_smfmac_f32_16x16x64_bf16 v[102:105], v[168:171], v[184:191], v3
    s_nop 2
    v_smfmac_f32_16x16x64_bf16 v[94:97], v[168:171], v[152:159], v3
    s_nop 0
    v_cvt_pk_bf16_f32 v174, v34, v35
    v_cvt_pk_bf16_f32 v175, v36, v37
    s_add_u32 s22, s22, 1
    s_waitcnt vmcnt(0)
    v_smfmac_f32_16x16x64_bf16 v[98:101], v[172:175], v[120:127], v3
    s_nop 1
    v_mov_b32 v25, s22
    v_smfmac_f32_16x16x64_bf16 v[102:105], v[172:175], v[128:135], v3
    s_nop 2
    v_smfmac_f32_16x16x64_bf16 v[94:97], v[172:175], v[160:167], v3
    s_nop 1
    v_add_f32 v42, v98, v99
    v_add_f32 v44, v100, v101
    v_add_f32 v43, v102, v103
    v_add_f32 v45, v104, v105
    v_mfma_f32_32x32x16_bf16 v[62:77], v[110:113], v[110:113], 0
    ds_write_b128 v10, v[42:45]
    v_add_f32 v46, v94, v95
    v_add_f32 v47, v96, v97
    ds_write2_b32 v11, v46, v47 offset0:0 offset1:2
    v_mfma_f32_32x32x16_bf16 v[78:93], v[110:113], v[110:113], 0
    s_barrier
    ds_read_b64 v[50:51], v12 offset:0
    ds_read_b64 v[52:53], v12 offset:1024
    ds_read_b64 v[54:55], v12 offset:2048
    ds_read_b64 v[56:57], v12 offset:3072
    v_mfma_f32_32x32x16_bf16 v[94:109], v[110:113], v[110:113], 0
    s_waitcnt lgkmcnt(2)
    v_add_f32 v50, v50, v52
    v_add_f32 v51, v51, v53
    s_waitcnt lgkmcnt(1)
    v_add_f32 v50, v50, v54
    v_add_f32 v51, v51, v55
    s_waitcnt lgkmcnt(0)
    v_add_f32 v50, v50, v56
    v_add_f32 v51, v51, v57
    v_exp_f32 v118, v50
    v_exp_f32 v119, v51
    v_add_f32 v58, abs(v50), abs(v51)
Asc12_back:
    v_add_f32 v59, v118, v119
    v_add_f32 v60, v118, v119
    v_cmp_nge_f32 vcc, v26, v58
    s_nop 0
    v_permlane32_swap_b32 v59, v60
    v_add_f32 v59, v59, v60
    s_nop 1
    v_add_f32_dpp v59, v59, v59 row_ror:1 row_mask:0xf bank_mask:0xf
    s_nop 1
    v_add_f32_dpp v59, v59, v59 row_ror:2 row_mask:0xf bank_mask:0xf
    s_cbranch_vccnz Asc12_slow
    s_nop 0
    v_add_f32_dpp v59, v59, v59 row_ror:4 row_mask:0xf bank_mask:0xf
    s_nop 1
    v_add_f32_dpp v59, v59, v59 row_ror:8 row_mask:0xf bank_mask:0xf
    v_rcp_f32 v59, v59
    s_nop 0
    v_pk_mul_f32 v[60:61], v[118:119], v[58:59] op_sel:[0,1] op_sel_hi:[1,1]
    v_cvt_pk_bf16_f32 v60, v60, v61
    buffer_store_dword v60, v13, s[8:11], s25 offen sc1
    s_cmp_lt_u32 s22, 63
    s_cbranch_scc1 Asc12_top
    s_branch A_done
Asc12_fix:
    buffer_load_dwordx4 v[34:37], v4, s[8:11], s27 offen sc1
    buffer_load_dwordx4 v[38:41], v4, s[8:11], s28 offen sc1
    s_nop 4
    s_nop 0
    v_mov_b64 v[62:63], 0
    v_mov_b64 v[64:65], 0
    v_mov_b64 v[66:67], 0
    v_mov_b64 v[68:69], 0
    v_mov_b64 v[70:71], 0
    v_mov_b64 v[72:73], 0
    v_mov_b64 v[74:75], 0
    v_mov_b64 v[76:77], 0
    v_mov_b64 v[78:79], 0
    v_mov_b64 v[80:81], 0
    v_mov_b64 v[82:83], 0
    v_mov_b64 v[84:85], 0
    v_mov_b64 v[86:87], 0
    v_mov_b64 v[88:89], 0
    s_waitcnt vmcnt(2)
    ds_read_b128 v[120:123], v7 offset:0
    ds_read_b128 v[124:127], v7 offset:1024
    ds_read_b128 v[128:131], v7 offset:2048
    ds_read_b128 v[132:135], v7 offset:3072
    s_waitcnt vmcnt(0) lgkmcnt(0)
    s_sub_u32 s23, s23, 1
    s_cbranch_scc0 Asc12_retry
    s_branch A_done
Asc12_slow:
    ds_read_b64 v[50:51], v12 offset:0
    ds_read_b64 v[52:53], v12 offset:1024
    ds_read_b64 v[54:55], v12 offset:2048
    ds_read_b64 v[56:57], v12 offset:3072
    s_sub_u32 s23, s23, 1
    s_cbranch_scc1 A_done
    s_waitcnt lgkmcnt(0)
    v_max_u32 v59, v50, v51
    v_max3_u32 v59, v52, v53, v59
    v_max3_u32 v59, v54, v55, v59
    v_max3_u32 v59, v56, v57, v59
    v_cmp_eq_u32 vcc, -1, v59
    s_cbranch_vccnz Asc12_slow
    v_add_f32 v50, v50, v52
    v_add_f32 v51, v51, v53
    v_add_f32 v50, v50, v54
    v_add_f32 v51, v51, v55
    v_add_f32 v50, v50, v56
    v_add_f32 v51, v51, v57
    v_max_f32 v59, v50, v51
    v_mov_b32 v60, v59
    s_nop 1
    v_permlane32_swap_b32 v59, v60
    v_max_f32 v59, v59, v60
    s_nop 1
    v_max_f32_dpp v59, v59, v59 row_ror:1 row_mask:0xf bank_mask:0xf
    s_nop 1
    v_max_f32_dpp v59, v59, v59 row_ror:2 row_mask:0xf bank_mask:0xf
    s_nop 1
    v_max_f32_dpp v59, v59, v59 row_ror:4 row_mask:0xf bank_mask:0xf
    s_nop 1
    v_max_f32_dpp v59, v59, v59 row_ror:8 row_mask:0xf bank_mask:0xf
    v_sub_f32 v50, v50, v59
    v_sub_f32 v51, v51, v59
    v_exp_f32 v118, v50
    v_exp_f32 v119, v51
    v_mov_b32 v58, 0
    s_branch Asc12_back
.p2align 6
Asc13_top:
    s_add_u32 s30, s30, 32768
    s_add_u32 s31, s30, 4096
    v_mov_b32 v118, v27
    v_mov_b32 v119, v27
    ds_write_b64 v12, v[118:119] offset:0
    ds_write_b64 v12, v[118:119] offset:1024
    ds_write_b64 v12, v[118:119] offset:2048
    ds_write_b64 v12, v[118:119] offset:3072
    buffer_store_dword v20, v13, s[8:11], s32 offen sc1
    s_mov_b32 s32, s25
    ds_read_b128 v[120:123], v7 offset:0
    ds_read_b128 v[124:127], v7 offset:1024
    ds_read_b128 v[128:131], v7 offset:2048
    ds_read_b128 v[132:135], v7 offset:3072
    ds_read_b128 v[136:139], v7 offset:4096
    ds_read_b128 v[140:143], v7 offset:5120
    ds_read_b128 v[144:147], v7 offset:6144
    ds_read_b128 v[148:151], v7 offset:7168
    ds_read_b128 v[152:155], v7 offset:8192
    ds_read_b128 v[156:159], v7 offset:9216
    ds_read_b128 v[160:163], v7 offset:10240
    ds_read_b128 v[164:167], v7 offset:11264
    ds_read_b128 v[168:171], v7 offset:12288
    ds_read_b128 v[172:175], v7 offset:13312
    ds_read_b128 v[46:49], v7 offset:14336
    ds_read_b128 v[50:53], v7 offset:15360
    ds_read_b128 v[54:57], v7 offset:16384
    ds_read_b128 v[58:61], v7 offset:17408
    s_add_u32 s34, s22, 1
    s_lshr_b32 s34, s34, 2
    s_lshl_b32 s34, s34, 7
    s_add_u32 s34, s34, 18616320
    v_writelane_b32 v19, s34, 0
    s_sub_u32 s34, s22, 2
    s_cselect_b32 s34, 0, s34
    buffer_load_dword v18, v19, s[8:11], 0 offen sc1
    v_mov_b32 v17, s34
    s_movk_i32 s34, 66
    v_writelane_b32 v17, s34, 0
    s_and_b32 s26, s22, 7
    s_mul_i32 s24, s26, 7168
    s_and_b32 s26, s22, 3
    s_waitcnt vmcnt(0)
    v_cmp_gt_u32 vcc, v17, v18
    s_cbranch_vccnz Asc13_rdyw
Asc13_rdyb:
    s_barrier
    s_mul_i32 s27, s26, 10240
    s_add_u32 s25, s27, 18341888
    s_add_u32 s27, s24, 18287616
    s_add_u32 s28, s24, 18285568
    buffer_load_dwordx4 v[34:37], v4, s[8:11], s27 offen sc1
    s_barrier
    buffer_load_dwordx4 v[38:41], v4, s[8:11], s28 offen sc1
    s_barrier
    buffer_load_dwordx4 v[176:179], v16, s[8:11], s30 offen offset:0 sc1
    s_waitcnt lgkmcnt(0)
    s_waitcnt vmcnt(2)
Asc13_retry:
    v_smfmac_f32_16x16x64_bf16 v[62:65], v[34:37], v[120:127], v3
    ds_write_b128 v9, v[34:37] offset:3072
    v_smfmac_f32_16x16x64_bf16 v[66:69], v[34:37], v[128:135], v3
    buffer_load_dwordx4 v[180:183], v16, s[8:11], s30 offen offset:1024 sc1
    v_smfmac_f32_16x16x64_bf16 v[70:73], v[34:37], v[136:143], v3
    buffer_load_dwordx4 v[184:187], v16, s[8:11], s31 offen offset:0 sc1
    v_smfmac_f32_16x16x64_bf16 v[74:77], v[34:37], v[144:151], v3
    v_max_u32 v22, v34, v35
    v_smfmac_f32_16x16x64_bf16 v[78:81], v[34:37], v[152:159], v3
    s_waitcnt vmcnt(3)
    v_max3_u32 v22, v36, v37, v22
    v_smfmac_f32_16x16x64_bf16 v[82:85], v[34:37], v[160:167], v3
    v_max3_u32 v22, v38, v39, v22
    v_smfmac_f32_16x16x64_bf16 v[86:89], v[34:37], v[168:175], v3
    v_max3_u32 v22, v40, v41, v22
    v_smfmac_f32_16x16x64_bf16 v[62:65], v[38:41], v[46:53], v3
    v_cmp_eq_u32 vcc, -1, v22
    v_smfmac_f32_16x16x64_bf16 v[66:69], v[38:41], v[54:61], v3
    buffer_load_dwordx4 v[188:191], v16, s[8:11], s31 offen offset:1024 sc1
    v_smfmac_f32_16x16x64_bf16 v[70:73], v[38:41], a[0:7], v3
    s_waitcnt lgkmcnt(0)
    s_cbranch_vccnz Asc13_fix
    v_smfmac_f32_16x16x64_bf16 v[74:77], v[38:41], a[8:15], v3
    s_barrier
    ds_read_b128 v[42:45], v9 offset:4096
    v_smfmac_f32_16x16x64_bf16 v[78:81], v[38:41], a[16:23], v3
    ds_read_b128 v[46:49], v9 offset:5120
    v_smfmac_f32_16x16x64_bf16 v[82:85], v[38:41], a[24:31], v3
    ds_read_b128 v[50:53], v9 offset:6144
    v_smfmac_f32_16x16x64_bf16 v[86:89], v[38:41], a[32:39], v3
    ds_read_b128 v[54:57], v9 offset:0
    s_waitcnt lgkmcnt(3)
    v_smfmac_f32_16x16x64_bf16 v[62:65], v[42:45], a[40:47], v3
    ds_read_b128 v[58:61], v9 offset:2048
    v_smfmac_f32_16x16x64_bf16 v[66:69], v[42:45], a[48:55], v3
    buffer_load_dwordx4 v[120:123], v16, s[8:11], s30 offen offset:2048 sc1
    v_smfmac_f32_16x16x64_bf16 v[70:73], v[42:45], a[56:63], v3
    v_smfmac_f32_16x16x64_bf16 v[74:77], v[42:45], a[64:71], v3
    v_smfmac_f32_16x16x64_bf16 v[78:81], v[42:45], a[72:79], v3
    v_smfmac_f32_16x16x64_bf16 v[82:85], v[42:45], a[80:87], v3
    buffer_load_dwordx4 v[124:127], v16, s[8:11], s30 offen offset:3072 sc1
    v_smfmac_f32_16x16x64_bf16 v[86:89], v[42:45], a[88:95], v3
    s_waitcnt lgkmcnt(0)
    v_smfmac_f32_16x16x64_bf16 v[62:65], v[46:49], a[96:103], v3
    s_nop 2
    v_smfmac_f32_16x16x64_bf16 v[62:65], v[50:53], a[152:159], v3
    s_nop 2
    v_smfmac_f32_16x16x64_bf16 v[62:65], v[54:57], a[208:215], v3
    s_nop 0
    buffer_load_dwordx4 v[128:131], v16, s[8:11], s31 offen offset:2048 sc1
    v_smfmac_f32_16x16x64_bf16 v[62:65], v[58:61], v[200:207], v3
    s_nop 2
    v_smfmac_f32_16x16x64_bf16 v[66:69], v[46:49], a[104:111], v3
    s_nop 2
    v_smfmac_f32_16x16x64_bf16 v[66:69], v[50:53], a[160:167], v3
    s_nop 2
    v_smfmac_f32_16x16x64_bf16 v[66:69], v[54:57], a[216:223], v3
    s_nop 0
    buffer_load_dwordx4 v[132:135], v16, s[8:11], s31 offen offset:3072 sc1
    v_smfmac_f32_16x16x64_bf16 v[66:69], v[58:61], v[208:215], v3
    s_nop 0
    ds_read_b128 v[152:155], v5 offset:0
    v_add_f32 v62, v62, v63
    v_smfmac_f32_16x16x64_bf16 v[70:73], v[46:49], a[112:119], v3
    s_nop 0
    ds_read_b128 v[156:159], v5 offset:256
    v_add_f32 v64, v64, v65
    v_smfmac_f32_16x16x64_bf16 v[70:73], v[50:53], a[168:175], v3
    s_nop 0
    ds_read_b128 v[160:163], v6 offset:0
    v_add_f32 v66, v66, v67
    v_smfmac_f32_16x16x64_bf16 v[70:73], v[54:57], a[224:231], v3
    s_nop 0
    ds_read_b128 v[164:167], v6 offset:256
    v_cvt_pk_bf16_f32 v90, v62, v66
    v_smfmac_f32_16x16x64_bf16 v[70:73], v[58:61], v[216:223], v3
    s_nop 1
    v_add_f32 v68, v68, v69
    v_smfmac_f32_16x16x64_bf16 v[74:77], v[46:49], a[120:127], v3
    s_nop 1
    v_cvt_pk_bf16_f32 v91, v64, v68
    v_smfmac_f32_16x16x64_bf16 v[74:77], v[50:53], a[176:183], v3
    s_nop 0
    ds_write_b64 v21, v[90:91]
    v_smfmac_f32_16x16x64_bf16 v[74:77], v[54:57], a[232:239], v3
    s_nop 1
    ds_read_b64_tr_b16 v[168:169], v2
    v_smfmac_f32_16x16x64_bf16 v[74:77], v[58:61], v[224:231], v3
    s_nop 1
    v_add_f32 v70, v70, v71
    v_smfmac_f32_16x16x64_bf16 v[78:81], v[46:49], a[128:135], v3
    s_nop 1
    v_add_f32 v72, v72, v73
    v_smfmac_f32_16x16x64_bf16 v[78:81], v[50:53], a[184:191], v3
    s_nop 1
    v_add_f32 v74, v74, v75
    v_smfmac_f32_16x16x64_bf16 v[78:81], v[54:57], a[240:247], v3
    s_nop 1
    v_cvt_pk_bf16_f32 v90, v70, v74
    v_smfmac_f32_16x16x64_bf16 v[78:81], v[58:61], v[232:239], v3
    s_nop 1
    v_add_f32 v76, v76, v77
    v_smfmac_f32_16x16x64_bf16 v[82:85], v[46:49], a[136:143], v3
    s_nop 1
    v_cvt_pk_bf16_f32 v91, v72, v76
    v_smfmac_f32_16x16x64_bf16 v[82:85], v[50:53], a[192:199], v3
    s_nop 0
    ds_write_b64 v21, v[90:91]
    v_smfmac_f32_16x16x64_bf16 v[82:85], v[54:57], a[248:255], v3
    s_nop 1
    ds_read_b64_tr_b16 v[170:171], v2
    v_smfmac_f32_16x16x64_bf16 v[82:85], v[58:61], v[240:247], v3
    s_nop 1
    v_cvt_pk_bf16_f32 v90, v78, v79
    v_smfmac_f32_16x16x64_bf16 v[86:89], v[46:49], a[144:151], v3
    s_nop 1
    v_cvt_pk_bf16_f32 v91, v80, v81
    v_smfmac_f32_16x16x64_bf16 v[86:89], v[50:53], a[200:207], v3
    s_nop 1
    v_cvt_pk_bf16_f32 v92, v82, v83
    v_smfmac_f32_16x16x64_bf16 v[86:89], v[54:57], v[192:199], v3
    s_nop 1
    v_cvt_pk_bf16_f32 v93, v84, v85
    v_smfmac_f32_16x16x64_bf16 v[86:89], v[58:61], v[248:255], v3
    s_nop 0
    s_waitcnt vmcnt(4)
    s_waitcnt lgkmcnt(0)
    v_mfma_f32_16x16x32_bf16 v[106:109], v[90:93], v[28:31], 0
    s_nop 2
    v_smfmac_f32_16x16x64_bf16 v[98:101], v[168:171], v[176:183], v3
    v_cvt_pk_bf16_f32 v38, v86, v87
    v_cvt_pk_bf16_f32 v39, v88, v89
    s_nop 1
    v_mfma_f32_16x16x16_bf16 v[34:37], v[38:39], v[32:33], 0
    v_cvt_pk_bf16_f32 v172, v106, v107
    v_cvt_pk_bf16_f32 v173, v108, v109
    v_smfmac_f32_16x16x64_bf16 v[102:105], v[168:171], v[184:191], v3
    s_nop 2
    v_smfmac_f32_16x16x64_bf16 v[94:97], v[168:171], v[152:159], v3
    s_nop 0
    v_cvt_pk_bf16_f32 v174, v34, v35
    v_cvt_pk_bf16_f32 v175, v36, v37
    s_add_u32 s22, s22, 1
    s_waitcnt vmcnt(0)
    v_smfmac_f32_16x16x64_bf16 v[98:101], v[172:175], v[120:127], v3
    s_nop 1
    v_mov_b32 v25, s22
    v_smfmac_f32_16x16x64_bf16 v[102:105], v[172:175], v[128:135], v3
    s_nop 2
    v_smfmac_f32_16x16x64_bf16 v[94:97], v[172:175], v[160:167], v3
    s_nop 1
    v_add_f32 v42, v98, v99
    v_add_f32 v44, v100, v101
    v_add_f32 v43, v102, v103
    v_add_f32 v45, v104, v105
    v_mfma_f32_32x32x16_bf16 v[62:77], v[110:113], v[110:113], 0
    ds_write_b128 v10, v[42:45]
    v_add_f32 v46, v94, v95
    v_add_f32 v47, v96, v97
    ds_write2_b32 v11, v46, v47 offset0:0 offset1:2
    v_mfma_f32_32x32x16_bf16 v[78:93], v[110:113], v[110:113], 0
    s_barrier
    ds_read_b64 v[50:51], v12 offset:0
    ds_read_b64 v[52:53], v12 offset:1024
    ds_read_b64 v[54:55], v12 offset:2048
    ds_read_b64 v[56:57], v12 offset:3072
    v_mfma_f32_32x32x16_bf16 v[94:109], v[110:113], v[110:113], 0
    s_waitcnt lgkmcnt(2)
    v_add_f32 v50, v50, v52
    v_add_f32 v51, v51, v53
    s_waitcnt lgkmcnt(1)
    v_add_f32 v50, v50, v54
    v_add_f32 v51, v51, v55
    s_waitcnt lgkmcnt(0)
    v_add_f32 v50, v50, v56
    v_add_f32 v51, v51, v57
    v_exp_f32 v118, v50
    v_exp_f32 v119, v51
    v_add_f32 v58, abs(v50), abs(v51)
Asc13_back:
    v_add_f32 v59, v118, v119
    v_add_f32 v60, v118, v119
    v_cmp_nge_f32 vcc, v26, v58
    s_nop 0
    v_permlane32_swap_b32 v59, v60
    v_add_f32 v59, v59, v60
    s_nop 1
    v_add_f32_dpp v59, v59, v59 row_ror:1 row_mask:0xf bank_mask:0xf
    s_nop 1
    v_add_f32_dpp v59, v59, v59 row_ror:2 row_mask:0xf bank_mask:0xf
    s_cbranch_vccnz Asc13_slow
    s_nop 0
    v_add_f32_dpp v59, v59, v59 row_ror:4 row_mask:0xf bank_mask:0xf
    s_nop 1
    v_add_f32_dpp v59, v59, v59 row_ror:8 row_mask:0xf bank_mask:0xf
    v_rcp_f32 v59, v59
    s_nop 0
    v_pk_mul_f32 v[60:61], v[118:119], v[58:59] op_sel:[0,1] op_sel_hi:[1,1]
    v_cvt_pk_bf16_f32 v60, v60, v61
    buffer_store_dword v60, v13, s[8:11], s25 offen sc1
    s_cmp_lt_u32 s22, 63
    s_cbranch_scc1 Asc13_top
    s_branch A_done
Asc13_fix:
    buffer_load_dwordx4 v[34:37], v4, s[8:11], s27 offen sc1
    buffer_load_dwordx4 v[38:41], v4, s[8:11], s28 offen sc1
    s_nop 4
    s_nop 0
    v_mov_b64 v[62:63], 0
    v_mov_b64 v[64:65], 0
    v_mov_b64 v[66:67], 0
    v_mov_b64 v[68:69], 0
    v_mov_b64 v[70:71], 0
    v_mov_b64 v[72:73], 0
    v_mov_b64 v[74:75], 0
    v_mov_b64 v[76:77], 0
    v_mov_b64 v[78:79], 0
    v_mov_b64 v[80:81], 0
    v_mov_b64 v[82:83], 0
    v_mov_b64 v[84:85], 0
    v_mov_b64 v[86:87], 0
    v_mov_b64 v[88:89], 0
    s_waitcnt vmcnt(2)
    ds_read_b128 v[120:123], v7 offset:0
    ds_read_b128 v[124:127], v7 offset:1024
    ds_read_b128 v[128:131], v7 offset:2048
    ds_read_b128 v[132:135], v7 offset:3072
    s_waitcnt vmcnt(0) lgkmcnt(0)
    s_sub_u32 s23, s23, 1
    s_cbranch_scc0 Asc13_retry
    s_branch A_done
Asc13_slow:
    ds_read_b64 v[50:51], v12 offset:0
    ds_read_b64 v[52:53], v12 offset:1024
    ds_read_b64 v[54:55], v12 offset:2048
    ds_read_b64 v[56:57], v12 offset:3072
    s_sub_u32 s23, s23, 1
    s_cbranch_scc1 A_done
    s_waitcnt lgkmcnt(0)
    v_max_u32 v59, v50, v51
    v_max3_u32 v59, v52, v53, v59
    v_max3_u32 v59, v54, v55, v59
    v_max3_u32 v59, v56, v57, v59
    v_cmp_eq_u32 vcc, -1, v59
    s_cbranch_vccnz Asc13_slow
    v_add_f32 v50, v50, v52
    v_add_f32 v51, v51, v53
    v_add_f32 v50, v50, v54
    v_add_f32 v51, v51, v55
    v_add_f32 v50, v50, v56
    v_add_f32 v51, v51, v57
    v_max_f32 v59, v50, v51
    v_mov_b32 v60, v59
    s_nop 1
    v_permlane32_swap_b32 v59, v60
    v_max_f32 v59, v59, v60
    s_nop 1
    v_max_f32_dpp v59, v59, v59 row_ror:1 row_mask:0xf bank_mask:0xf
    s_nop 1
    v_max_f32_dpp v59, v59, v59 row_ror:2 row_mask:0xf bank_mask:0xf
    s_nop 1
    v_max_f32_dpp v59, v59, v59 row_ror:4 row_mask:0xf bank_mask:0xf
    s_nop 1
    v_max_f32_dpp v59, v59, v59 row_ror:8 row_mask:0xf bank_mask:0xf
    v_sub_f32 v50, v50, v59
    v_sub_f32 v51, v51, v59
    v_exp_f32 v118, v50
    v_exp_f32 v119, v51
    v_mov_b32 v58, 0
    s_branch Asc13_back
Asc13_rdyw:
    buffer_load_dword v18, v19, s[8:11], 0 offen sc1
    s_waitcnt vmcnt(0)
    v_cmp_gt_u32 vcc, v17, v18
    s_cbranch_vccz Asc13_rdyb
    s_sleep 2
    s_sub_u32 s23, s23, 1
    s_cbranch_scc0 Asc13_rdyw
    s_branch A_done
A_done:
    s_branch main_fin
main_B:
    s_sub_u32 s20, s20, 16
main_Bf:
    v_and_b32 v2, 63, v0
    v_and_b32 v3, 1, v0
    v_cmp_eq_u32 vcc, 0, v3
    v_mov_b32 v3, 0xeeeeeeee
    v_mov_b32 v1, 0x44444444
    v_cndmask_b32 v3, v3, v1, vcc
    s_mov_b32 s22, 0
    s_mov_b32 s23, 400000
    v_and_b32 v28, 15, v2
    v_lshrrev_b32 v29, 4, v2
    v_mov_b32 v32, 2147483632
    v_lshlrev_b32 v4, 4, v2
    v_lshlrev_b32 v30, 4, v28
    v_lshl_add_u32 v5, v29, 9, v30
    s_mul_i32 s30, s21, 56
    s_add_u32 s30, s30, s20
    s_mul_i32 s30, s30, 28672
    s_add_u32 s30, s30, 6422528
    s_lshl_b32 s26, s21, 2
    s_lshr_b32 s26, 12816, s26
    s_and_b32 s26, s26, 7
    s_lshl_b32 s40, s26, 12
    s_add_u32 s40, s40, s30
    s_lshl_b32 s26, s21, 2
    s_lshr_b32 s26, 5716, s26
    s_and_b32 s26, s26, 7
    s_lshl_b32 s41, s26, 12
    s_add_u32 s41, s41, s30
    s_lshl_b32 s26, s21, 2
    s_lshr_b32 s26, 17185, s26
    s_and_b32 s26, s26, 7
    s_lshl_b32 s42, s26, 12
    s_add_u32 s42, s42, s30
    s_lshl_b32 s26, s21, 2
    s_lshr_b32 s26, 21554, s26
    s_and_b32 s26, s26, 7
    s_lshl_b32 s43, s26, 12
    s_add_u32 s43, s43, s30
    s_lshl_b32 s26, s21, 2
    s_lshr_b32 s26, 25923, s26
    s_and_b32 s26, s26, 7
    s_lshl_b32 s44, s26, 12
    s_add_u32 s44, s44, s30
    s_lshl_b32 s26, s21, 2
    s_lshr_b32 s26, 101, s26
    s_and_b32 s26, s26, 7
    s_lshl_b32 s45, s26, 12
    s_add_u32 s45, s45, s30
    s_lshl_b32 s26, s21, 2
    s_lshr_b32 s26, 8454, s26
    s_and_b32 s26, s26, 7
    s_lshl_b32 s46, s26, 12
    s_add_u32 s46, s46, s30
    s_lshl_b32 s28, s21, 15
    v_add_u32 v6, s28, v4
    v_add_u32 v7, 131072, v4
    s_lshl_b32 s26, s21, 10
    v_add_u32 v9, 139264, v4
    v_add_u32 v8, s26, v9
    s_lshl_b32 s26, s20, 9
    v_bfe_u32 v30, v0, 0, 7
    v_lshlrev_b32 v10, 2, v30
    v_add_u32 v10, s26, v10
    s_cmp_lg_u32 s21, 3
    s_cbranch_scc1 vo_5
    v_bfe_u32 v30, v2, 3, 1
    v_lshlrev_b32 v10, 8, v30
    v_bfe_u32 v30, v2, 4, 2
    v_lshl_add_u32 v10, v30, 6, v10
    v_bfe_u32 v30, v2, 0, 3
    v_lshl_add_u32 v10, v30, 2, v10
    v_add_u32 v10, s26, v10
vo_5:
    s_and_b32 s26, s20, 0
    s_lshl_b32 s26, s26, 7
    s_add_u32 s26, s26, 18623488
    v_lshl_add_u32 v13, v28, 2, s26
    s_and_b32 s26, s20, 0
    s_lshl_b32 s26, s26, 7
    s_add_u32 s26, s26, 18622464
    v_min_u32 v22, 13, v2
    v_lshl_add_u32 v22, v22, 2, s26
    s_lshl_b32 s26, s20, 2
    s_add_u32 s27, s26, 18622464
    v_lshl_add_u32 v12, v2, 7, s27
    v_cmp_gt_u32 vcc, 1, v2
    s_lshl2_add_u32 s27, s20, s21
    s_lshl_b32 s27, s27, 7
    v_cndmask_b32 v12, v32, v12, vcc
    s_add_u32 s27, s27, 18638848
    v_mov_b32 v21, s27
    v_cmp_eq_u32 vcc, 0, v2
    s_nop 1
    v_cndmask_b32 v21, v32, v21, vcc
    s_lshl_b32 s26, s20, 15
    s_lshl_b32 s27, s21, 13
    s_add_u32 s26, s26, s27
    v_add_u32 v14, s26, v5
    v_bfe_u32 v30, v2, 2, 2
    v_lshlrev_b32 v15, 7, v30
    v_bfe_u32 v30, v2, 4, 1
    v_lshl_add_u32 v15, v30, 6, v15
    v_bfe_u32 v30, v2, 0, 2
    v_lshl_add_u32 v15, v30, 4, v15
    v_bfe_u32 v30, v2, 5, 1
    v_lshl_add_u32 v15, v30, 9, v15
    s_lshl_b32 s26, s21, 11
    v_add_u32 v16, 8192, v15
    v_add_u32 v15, s26, v15
    s_lshl_b32 s27, s20, 13
    s_add_u32 s27, s27, s26
    v_add_u32 v17, s27, v5
    v_add_u32 v19, 143360, v4
    v_mov_b64 v[152:153], -1
    v_mov_b64 v[154:155], -1
    v_mov_b32 v18, -1
    v_mov_b32 v20, 0
    v_mov_b64 v[162:163], 0
    v_mov_b64 v[164:165], 0
    v_mov_b64 v[170:171], 0
    v_mov_b64 v[172:173], 0
    v_mov_b64 v[56:57], 0
    v_mov_b64 v[58:59], 0
    v_mov_b64 v[60:61], 0
    v_mov_b64 v[62:63], 0
    v_mov_b64 v[64:65], 0
    v_mov_b64 v[66:67], 0
    v_mov_b64 v[68:69], 0
    v_mov_b64 v[70:71], 0
    v_mov_b64 v[72:73], 0
    v_mov_b64 v[74:75], 0
    v_mov_b64 v[76:77], 0
    v_mov_b64 v[78:79], 0
    v_mov_b64 v[80:81], 0
    v_mov_b64 v[82:83], 0
    v_mov_b64 v[84:85], 0
    v_mov_b64 v[86:87], 0
    v_mov_b64 v[182:183], 0
    v_mov_b64 v[184:185], 0
    v_mov_b64 v[186:187], 0
    v_mov_b64 v[188:189], 0
    v_bfe_u32 v24, v0, 6, 2
    v_lshlrev_b32 v23, 9, v24
    v_bfe_u32 v24, v0, 0, 2
    v_lshl_add_u32 v23, v24, 7, v23
    v_add_u32 v23, 18636800, v23
    s_and_b32 s26, s20, 14
    s_lshl_b32 s26, 2, s26
ww_6:
    buffer_load_dword v24, v23, s[8:11], 0 offen sc1
    s_waitcnt vmcnt(0)
    v_and_b32 v24, s26, v24
    v_cmp_gt_u32 vcc, s26, v24
    s_cbranch_vccz ww_6k
    s_sleep 3
    s_sub_u32 s23, s23, 1
    s_cbranch_scc0 ww_6
    s_mov_b32 s23, 0
ww_6k:
    s_cmp_eq_u32 s17, 0
    s_cselect_b64 vcc, -1, 0
    s_add_u32 s32, s45, 0
    s_add_u32 m0, s28, 0
    s_nop 0
    buffer_load_dwordx4 v5, s[8:11], s32 offen sc1 lds
    s_add_u32 s32, s45, 2048
    s_add_u32 m0, s28, 1024
    s_nop 0
    buffer_load_dwordx4 v5, s[8:11], s32 offen sc1 lds
    s_add_u32 s32, s45, 256
    s_add_u32 m0, s28, 4096
    s_nop 0
    buffer_load_dwordx4 v5, s[8:11], s32 offen sc1 lds
    s_add_u32 s32, s45, 2304
    s_add_u32 m0, s28, 5120
    s_nop 0
    buffer_load_dwordx4 v5, s[8:11], s32 offen sc1 lds
    s_add_u32 s32, s45, 401408
    s_add_u32 m0, s28, 8192
    s_nop 0
    buffer_load_dwordx4 v5, s[8:11], s32 offen sc1 lds
    s_add_u32 s32, s45, 403456
    s_add_u32 m0, s28, 9216
    s_nop 0
    buffer_load_dwordx4 v5, s[8:11], s32 offen sc1 lds
    s_add_u32 s32, s45, 401664
    s_add_u32 m0, s28, 12288
    s_nop 0
    buffer_load_dwordx4 v5, s[8:11], s32 offen sc1 lds
    s_add_u32 s32, s45, 403712
    s_add_u32 m0, s28, 13312
    s_nop 0
    buffer_load_dwordx4 v5, s[8:11], s32 offen sc1 lds
    s_add_u32 s32, s45, 802816
    s_add_u32 m0, s28, 16384
    s_nop 0
    buffer_load_dwordx4 v5, s[8:11], s32 offen sc1 lds
    s_add_u32 s32, s45, 804864
    s_add_u32 m0, s28, 17408
    s_nop 0
    buffer_load_dwordx4 v5, s[8:11], s32 offen sc1 lds
    s_add_u32 s32, s45, 803072
    s_add_u32 m0, s28, 20480
    s_nop 0
    buffer_load_dwordx4 v5, s[8:11], s32 offen sc1 lds
    s_add_u32 s32, s45, 805120
    s_add_u32 m0, s28, 21504
    s_nop 0
    buffer_load_dwordx4 v5, s[8:11], s32 offen sc1 lds
    s_add_u32 s32, s45, 1204224
    s_add_u32 m0, s28, 24576
    s_nop 0
    buffer_load_dwordx4 v5, s[8:11], s32 offen sc1 lds
    s_add_u32 s32, s45, 1206272
    s_add_u32 m0, s28, 25600
    s_nop 0
    buffer_load_dwordx4 v5, s[8:11], s32 offen sc1 lds
    s_add_u32 s32, s45, 1204480
    s_add_u32 m0, s28, 28672
    s_nop 0
    buffer_load_dwordx4 v5, s[8:11], s32 offen sc1 lds
    s_add_u32 s32, s45, 1206528
    s_add_u32 m0, s28, 29696
    s_nop 0
    buffer_load_dwordx4 v5, s[8:11], s32 offen sc1 lds
    s_add_u32 s32, s46, 0
    s_add_u32 m0, s28, 2048
    s_nop 0
    buffer_load_dwordx4 v5, s[8:11], s32 offen sc1 lds
    s_add_u32 s32, s46, 2048
    s_add_u32 m0, s28, 3072
    s_nop 0
    buffer_load_dwordx4 v5, s[8:11], s32 offen sc1 lds
    s_add_u32 s32, s46, 256
    s_add_u32 m0, s28, 6144
    s_nop 0
    buffer_load_dwordx4 v5, s[8:11], s32 offen sc1 lds
    s_add_u32 s32, s46, 2304
    s_add_u32 m0, s28, 7168
    s_nop 0
    buffer_load_dwordx4 v5, s[8:11], s32 offen sc1 lds
    s_add_u32 s32, s46, 401408
    s_add_u32 m0, s28, 10240
    s_nop 0
    buffer_load_dwordx4 v5, s[8:11], s32 offen sc1 lds
    s_add_u32 s32, s46, 403456
    s_add_u32 m0, s28, 11264
    s_nop 0
    buffer_load_dwordx4 v5, s[8:11], s32 offen sc1 lds
    s_add_u32 s32, s46, 401664
    s_add_u32 m0, s28, 14336
    s_nop 0
    buffer_load_dwordx4 v5, s[8:11], s32 offen sc1 lds
    s_add_u32 s32, s46, 403712
    s_add_u32 m0, s28, 15360
    s_nop 0
    buffer_load_dwordx4 v5, s[8:11], s32 offen sc1 lds
    s_add_u32 s32, s46, 802816
    s_add_u32 m0, s28, 18432
    s_nop 0
    buffer_load_dwordx4 v5, s[8:11], s32 offen sc1 lds
    s_add_u32 s32, s46, 804864
    s_add_u32 m0, s28, 19456
    s_nop 0
    buffer_load_dwordx4 v5, s[8:11], s32 offen sc1 lds
    s_add_u32 s32, s46, 803072
    s_add_u32 m0, s28, 22528
    s_nop 0
    buffer_load_dwordx4 v5, s[8:11], s32 offen sc1 lds
    s_add_u32 s32, s46, 805120
    s_add_u32 m0, s28, 23552
    s_nop 0
    buffer_load_dwordx4 v5, s[8:11], s32 offen sc1 lds
    s_add_u32 s32, s46, 1204224
    s_add_u32 m0, s28, 26624
    s_nop 0
    buffer_load_dwordx4 v5, s[8:11], s32 offen sc1 lds
    s_add_u32 s32, s46, 1206272
    s_add_u32 m0, s28, 27648
    s_nop 0
    buffer_load_dwordx4 v5, s[8:11], s32 offen sc1 lds
    s_add_u32 s32, s46, 1204480
    s_add_u32 m0, s28, 30720
    s_nop 0
    buffer_load_dwordx4 v5, s[8:11], s32 offen sc1 lds
    s_add_u32 s32, s46, 1206528
    s_add_u32 m0, s28, 31744
    s_nop 0
    buffer_load_dwordx4 v5, s[8:11], s32 offen sc1 lds
    s_add_u32 s32, s40, 0
    buffer_load_dwordx4 a[0:3], v5, s[8:11], s32 offen offset:0 sc1
    buffer_load_dwordx4 a[4:7], v5, s[8:11], s32 offen offset:2048 sc1
    buffer_load_dwordx4 a[8:11], v5, s[8:11], s32 offen offset:256 sc1
    buffer_load_dwordx4 a[12:15], v5, s[8:11], s32 offen offset:2304 sc1
    s_add_u32 s32, s40, 401408
    buffer_load_dwordx4 a[16:19], v5, s[8:11], s32 offen offset:0 sc1
    buffer_load_dwordx4 a[20:23], v5, s[8:11], s32 offen offset:2048 sc1
    buffer_load_dwordx4 a[24:27], v5, s[8:11], s32 offen offset:256 sc1
    buffer_load_dwordx4 a[28:31], v5, s[8:11], s32 offen offset:2304 sc1
    s_add_u32 s32, s40, 802816
    buffer_load_dwordx4 a[32:35], v5, s[8:11], s32 offen offset:0 sc1
    buffer_load_dwordx4 a[36:39], v5, s[8:11], s32 offen offset:2048 sc1
    buffer_load_dwordx4 a[40:43], v5, s[8:11], s32 offen offset:256 sc1
    buffer_load_dwordx4 a[44:47], v5, s[8:11], s32 offen offset:2304 sc1
    s_add_u32 s32, s40, 1204224
    buffer_load_dwordx4 a[48:51], v5, s[8:11], s32 offen offset:0 sc1
    buffer_load_dwordx4 a[52:55], v5, s[8:11], s32 offen offset:2048 sc1
    buffer_load_dwordx4 a[56:59], v5, s[8:11], s32 offen offset:256 sc1
    buffer_load_dwordx4 a[60:63], v5, s[8:11], s32 offen offset:2304 sc1
    s_waitcnt vmcnt(40)
    s_add_u32 s32, s41, 0
    buffer_load_dwordx4 a[64:67], v5, s[8:11], s32 offen offset:0 sc1
    buffer_load_dwordx4 a[68:71], v5, s[8:11], s32 offen offset:2048 sc1
    buffer_load_dwordx4 a[72:75], v5, s[8:11], s32 offen offset:256 sc1
    buffer_load_dwordx4 a[76:79], v5, s[8:11], s32 offen offset:2304 sc1
    s_add_u32 s32, s41, 401408
    buffer_load_dwordx4 a[80:83], v5, s[8:11], s32 offen offset:0 sc1
    buffer_load_dwordx4 a[84:87], v5, s[8:11], s32 offen offset:2048 sc1
    buffer_load_dwordx4 a[88:91], v5, s[8:11], s32 offen offset:256 sc1
    buffer_load_dwordx4 a[92:95], v5, s[8:11], s32 offen offset:2304 sc1
    s_waitcnt vmcnt(40)
    s_add_u32 s32, s41, 802816
    buffer_load_dwordx4 a[96:99], v5, s[8:11], s32 offen offset:0 sc1
    buffer_load_dwordx4 a[100:103], v5, s[8:11], s32 offen offset:2048 sc1
    buffer_load_dwordx4 a[104:107], v5, s[8:11], s32 offen offset:256 sc1
    buffer_load_dwordx4 a[108:111], v5, s[8:11], s32 offen offset:2304 sc1
    s_add_u32 s32, s41, 1204224
    buffer_load_dwordx4 a[112:115], v5, s[8:11], s32 offen offset:0 sc1
    buffer_load_dwordx4 a[116:119], v5, s[8:11], s32 offen offset:2048 sc1
    buffer_load_dwordx4 a[120:123], v5, s[8:11], s32 offen offset:256 sc1
    buffer_load_dwordx4 a[124:127], v5, s[8:11], s32 offen offset:2304 sc1
    s_waitcnt vmcnt(40)
    s_add_u32 s32, s42, 0
    buffer_load_dwordx4 a[128:131], v5, s[8:11], s32 offen offset:0 sc1
    buffer_load_dwordx4 a[132:135], v5, s[8:11], s32 offen offset:2048 sc1
    buffer_load_dwordx4 a[136:139], v5, s[8:11], s32 offen offset:256 sc1
    buffer_load_dwordx4 a[140:143], v5, s[8:11], s32 offen offset:2304 sc1
    s_add_u32 s32, s42, 401408
    buffer_load_dwordx4 a[144:147], v5, s[8:11], s32 offen offset:0 sc1
    buffer_load_dwordx4 a[148:151], v5, s[8:11], s32 offen offset:2048 sc1
    buffer_load_dwordx4 a[152:155], v5, s[8:11], s32 offen offset:256 sc1
    buffer_load_dwordx4 a[156:159], v5, s[8:11], s32 offen offset:2304 sc1
    s_waitcnt vmcnt(40)
    s_cbranch_vccz bw_7
    s_waitcnt vmcnt(2)
bw_7:
    s_add_u32 s32, s42, 802816
    buffer_load_dwordx4 a[160:163], v5, s[8:11], s32 offen offset:0 sc1
    s_cbranch_vccz bw_8
    s_waitcnt vmcnt(2)
bw_8:
    buffer_load_dwordx4 a[164:167], v5, s[8:11], s32 offen offset:2048 sc1
    s_cbranch_vccz bw_9
    s_waitcnt vmcnt(2)
bw_9:
    buffer_load_dwordx4 a[168:171], v5, s[8:11], s32 offen offset:256 sc1
    s_cbranch_vccz bw_10
    s_waitcnt vmcnt(2)
bw_10:
    buffer_load_dwordx4 a[172:175], v5, s[8:11], s32 offen offset:2304 sc1
    s_cbranch_vccz bw_11
    s_waitcnt vmcnt(2)
bw_11:
    s_add_u32 s32, s42, 1204224
    buffer_load_dwordx4 a[176:179], v5, s[8:11], s32 offen offset:0 sc1
    s_cbranch_vccz bw_12
    s_waitcnt vmcnt(2)
bw_12:
    buffer_load_dwordx4 a[180:183], v5, s[8:11], s32 offen offset:2048 sc1
    s_cbranch_vccz bw_13
    s_waitcnt vmcnt(2)
bw_13:
    buffer_load_dwordx4 a[184:187], v5, s[8:11], s32 offen offset:256 sc1
    s_cbranch_vccz bw_14
    s_waitcnt vmcnt(2)
bw_14:
    buffer_load_dwordx4 a[188:191], v5, s[8:11], s32 offen offset:2304 sc1
    s_waitcnt vmcnt(40)
    s_cbranch_vccz bw_15
    s_waitcnt vmcnt(2)
bw_15:
    s_add_u32 s32, s43, 0
    buffer_load_dwordx4 a[192:195], v5, s[8:11], s32 offen offset:0 sc1
    s_cbranch_vccz bw_16
    s_waitcnt vmcnt(2)
bw_16:
    buffer_load_dwordx4 a[196:199], v5, s[8:11], s32 offen offset:2048 sc1
    s_cbranch_vccz bw_17
    s_waitcnt vmcnt(2)
bw_17:
    buffer_load_dwordx4 a[200:203], v5, s[8:11], s32 offen offset:256 sc1
    s_cbranch_vccz bw_18
    s_waitcnt vmcnt(2)
bw_18:
    buffer_load_dwordx4 a[204:207], v5, s[8:11], s32 offen offset:2304 sc1
    s_cbranch_vccz bw_19
    s_waitcnt vmcnt(2)
bw_19:
    s_add_u32 s32, s43, 401408
    buffer_load_dwordx4 a[208:211], v5, s[8:11], s32 offen offset:0 sc1
    s_cbranch_vccz bw_20
    s_waitcnt vmcnt(2)
bw_20:
    buffer_load_dwordx4 a[212:215], v5, s[8:11], s32 offen offset:2048 sc1
    s_cbranch_vccz bw_21
    s_waitcnt vmcnt(2)
bw_21:
    buffer_load_dwordx4 a[216:219], v5, s[8:11], s32 offen offset:256 sc1
    s_cbranch_vccz bw_22
    s_waitcnt vmcnt(2)
bw_22:
    buffer_load_dwordx4 a[220:223], v5, s[8:11], s32 offen offset:2304 sc1
    s_waitcnt vmcnt(40)
    s_cbranch_vccz bw_23
    s_waitcnt vmcnt(2)
bw_23:
    s_add_u32 s32, s43, 802816
    buffer_load_dwordx4 a[224:227], v5, s[8:11], s32 offen offset:0 sc1
    s_cbranch_vccz bw_24
    s_waitcnt vmcnt(2)
bw_24:
    buffer_load_dwordx4 a[228:231], v5, s[8:11], s32 offen offset:2048 sc1
    s_cbranch_vccz bw_25
    s_waitcnt vmcnt(2)
bw_25:
    buffer_load_dwordx4 a[232:235], v5, s[8:11], s32 offen offset:256 sc1
    s_cbranch_vccz bw_26
    s_waitcnt vmcnt(2)
bw_26:
    buffer_load_dwordx4 a[236:239], v5, s[8:11], s32 offen offset:2304 sc1
    s_cbranch_vccz bw_27
    s_waitcnt vmcnt(2)
bw_27:
    s_add_u32 s32, s43, 1204224
    buffer_load_dwordx4 a[240:243], v5, s[8:11], s32 offen offset:0 sc1
    s_cbranch_vccz bw_28
    s_waitcnt vmcnt(2)
bw_28:
    buffer_load_dwordx4 a[244:247], v5, s[8:11], s32 offen offset:2048 sc1
    s_cbranch_vccz bw_29
    s_waitcnt vmcnt(2)
bw_29:
    buffer_load_dwordx4 a[248:251], v5, s[8:11], s32 offen offset:256 sc1
    s_cbranch_vccz bw_30
    s_waitcnt vmcnt(2)
bw_30:
    buffer_load_dwordx4 a[252:255], v5, s[8:11], s32 offen offset:2304 sc1
    s_waitcnt vmcnt(40)
    s_cbranch_vccz bw_31
    s_waitcnt vmcnt(2)
bw_31:
    s_add_u32 s32, s44, 0
    buffer_load_dwordx4 v[190:193], v5, s[8:11], s32 offen offset:0 sc1
    s_cbranch_vccz bw_32
    s_waitcnt vmcnt(2)
bw_32:
    buffer_load_dwordx4 v[194:197], v5, s[8:11], s32 offen offset:2048 sc1
    s_cbranch_vccz bw_33
    s_waitcnt vmcnt(2)
bw_33:
    buffer_load_dwordx4 v[198:201], v5, s[8:11], s32 offen offset:256 sc1
    s_cbranch_vccz bw_34
    s_waitcnt vmcnt(2)
bw_34:
    buffer_load_dwordx4 v[202:205], v5, s[8:11], s32 offen offset:2304 sc1
    s_cbranch_vccz bw_35
    s_waitcnt vmcnt(2)
bw_35:
    s_add_u32 s32, s44, 401408
    buffer_load_dwordx4 v[206:209], v5, s[8:11], s32 offen offset:0 sc1
    s_cbranch_vccz bw_36
    s_waitcnt vmcnt(2)
bw_36:
    buffer_load_dwordx4 v[210:213], v5, s[8:11], s32 offen offset:2048 sc1
    s_cbranch_vccz bw_37
    s_waitcnt vmcnt(2)
bw_37:
    buffer_load_dwordx4 v[214:217], v5, s[8:11], s32 offen offset:256 sc1
    s_cbranch_vccz bw_38
    s_waitcnt vmcnt(2)
bw_38:
    buffer_load_dwordx4 v[218:221], v5, s[8:11], s32 offen offset:2304 sc1
    s_waitcnt vmcnt(40)
    s_cbranch_vccz bw_39
    s_waitcnt vmcnt(2)
bw_39:
    s_add_u32 s32, s44, 802816
    buffer_load_dwordx4 v[222:225], v5, s[8:11], s32 offen offset:0 sc1
    s_cbranch_vccz bw_40
    s_waitcnt vmcnt(2)
bw_40:
    buffer_load_dwordx4 v[226:229], v5, s[8:11], s32 offen offset:2048 sc1
    s_cbranch_vccz bw_41
    s_waitcnt vmcnt(2)
bw_41:
    buffer_load_dwordx4 v[230:233], v5, s[8:11], s32 offen offset:256 sc1
    s_cbranch_vccz bw_42
    s_waitcnt vmcnt(2)
bw_42:
    buffer_load_dwordx4 v[234:237], v5, s[8:11], s32 offen offset:2304 sc1
    s_cbranch_vccz bw_43
    s_waitcnt vmcnt(2)
bw_43:
    s_add_u32 s32, s44, 1204224
    buffer_load_dwordx4 v[238:241], v5, s[8:11], s32 offen offset:0 sc1
    s_cbranch_vccz bw_44
    s_waitcnt vmcnt(2)
bw_44:
    buffer_load_dwordx4 v[242:245], v5, s[8:11], s32 offen offset:2048 sc1
    s_cbranch_vccz bw_45
    s_waitcnt vmcnt(2)
bw_45:
    buffer_load_dwordx4 v[246:249], v5, s[8:11], s32 offen offset:256 sc1
    s_cbranch_vccz bw_46
    s_waitcnt vmcnt(2)
bw_46:
    buffer_load_dwordx4 v[250:253], v5, s[8:11], s32 offen offset:2304 sc1
    s_cmp_lg_u32 s17, 0
    s_cbranch_scc1 own_47
    v_mov_b32 v25, 0
    buffer_store_dword v25, v12, s[8:11], 0 offen
    s_mov_b32 s27, 18291712
    buffer_store_dword v18, v10, s[8:11], s27 offen
    s_mov_b32 s27, 18298880
    buffer_store_dword v18, v10, s[8:11], s27 offen
    s_mov_b32 s27, 18306048
    buffer_store_dword v18, v10, s[8:11], s27 offen
    s_mov_b32 s27, 18313216
    buffer_store_dword v18, v10, s[8:11], s27 offen
    s_mov_b32 s27, 18320384
    buffer_store_dword v18, v10, s[8:11], s27 offen
    s_mov_b32 s27, 18327552
    buffer_store_dword v18, v10, s[8:11], s27 offen
    s_mov_b32 s27, 18334720
    buffer_store_dword v18, v10, s[8:11], s27 offen
own_47:
    s_waitcnt vmcnt(40)
    s_cbranch_vccz bw_48
    s_waitcnt vmcnt(2)
bw_48:
    s_mov_b32 s24, 18284544
    s_mov_b32 s25, 18341888
    s_mov_b32 s32, 18320384
    s_mov_b32 s34, 18874368
    s_mov_b32 s31, 27262976
    s_waitcnt vmcnt(0)
    ds_read_b128 v[120:123], v6 offset:0
    ds_read_b128 v[124:127], v6 offset:1024
    ds_read_b128 v[128:131], v6 offset:2048
    ds_read_b128 v[132:135], v6 offset:3072
    ds_read_b128 v[136:139], v6 offset:4096
    ds_read_b128 v[140:143], v6 offset:5120
    ds_read_b128 v[144:147], v6 offset:6144
    ds_read_b128 v[148:151], v6 offset:7168
    s_cmp_eq_u32 s17, 2
    s_cselect_b32 s24, 17825792, s24
    s_cbranch_scc1 B_r0f
B_r0f:
    v_mov_b32 v24, 18616320
B_r0:
    buffer_load_dword v23, v24, s[8:11], 0 offen sc1
    s_waitcnt vmcnt(0)
    v_cmp_gt_u32 vcc, 66, v23
    s_cbranch_vccz B_r0ok
    s_sleep 2
    s_sub_u32 s23, s23, 1
    s_cbranch_scc0 B_r0
    s_branch B_done
B_r0ok:
    v_mov_b32 v24, 0
    s_lshl_b32 s26, s17, 2
    s_add_u32 s26, s26, s21
    s_cmp_eq_u32 s26, 0
    s_cbranch_scc1 B0_top
    s_cmp_eq_u32 s26, 1
    s_cbranch_scc1 B1_top
    s_cmp_eq_u32 s26, 2
    s_cbranch_scc1 B2_top
    s_cmp_eq_u32 s26, 3
    s_cbranch_scc1 B3_top
    s_cmp_eq_u32 s26, 4
    s_cbranch_scc1 Bsc10_top
    s_cmp_eq_u32 s26, 5
    s_cbranch_scc1 Bsc11_top
    s_cmp_eq_u32 s26, 6
    s_cbranch_scc1 Bsc12_top
    s_cmp_eq_u32 s26, 7
    s_cbranch_scc1 Bsc13_top
    s_cmp_eq_u32 s26, 8
    s_cbranch_scc1 Bfol0_top
    s_cmp_eq_u32 s26, 9
    s_cbranch_scc1 Bfol1_top
    s_cmp_eq_u32 s26, 10
    s_cbranch_scc1 Bfol2_top
    s_branch Bfol3_top
.p2align 6
B0_top:
    s_add_u32 s27, s24, 0
    s_add_u32 s28, s24, 4096
    s_add_u32 s29, s24, 1024
    s_add_u32 s26, s31, 4096
    s_barrier
    buffer_load_dwordx4 v[28:31], v4, s[8:11], s27 offen sc1
    ds_write_b128 v8, v[152:155]
    s_barrier
    buffer_load_dwordx4 v[32:35], v4, s[8:11], s28 offen sc1
    s_barrier
    buffer_load_dwordx4 v[88:91], v14, s[8:11], s31 offen offset:0 sc1
    buffer_load_dwordx4 v[96:99], v14, s[8:11], s31 offen offset:256 sc1
    buffer_load_dwordx4 v[92:95], v14, s[8:11], s31 offen offset:2048 sc1
    s_waitcnt vmcnt(4)
B0_retry:
    v_smfmac_f32_16x16x64_bf16 v[56:59], v[28:31], a[0:7], v3
    ds_write_b128 v7, v[28:31] offset:0
    v_smfmac_f32_16x16x64_bf16 v[60:63], v[28:31], a[8:15], v3
    buffer_load_dwordx4 v[100:103], v14, s[8:11], s31 offen offset:2304 sc1
    v_smfmac_f32_16x16x64_bf16 v[64:67], v[28:31], a[16:23], v3
    buffer_load_dwordx4 v[104:107], v14, s[8:11], s26 offen offset:0 sc1
    v_smfmac_f32_16x16x64_bf16 v[68:71], v[28:31], a[24:31], v3
    buffer_load_dwordx4 v[112:115], v14, s[8:11], s26 offen offset:256 sc1
    v_smfmac_f32_16x16x64_bf16 v[72:75], v[28:31], a[32:39], v3
    s_waitcnt vmcnt(6)
    ds_write_b128 v7, v[32:35] offset:4096
    v_smfmac_f32_16x16x64_bf16 v[76:79], v[28:31], a[40:47], v3
    buffer_load_dwordx4 v[108:111], v14, s[8:11], s26 offen offset:2048 sc1
    v_smfmac_f32_16x16x64_bf16 v[80:83], v[28:31], a[48:55], v3
    buffer_load_dwordx4 v[116:119], v14, s[8:11], s26 offen offset:2304 sc1
    v_smfmac_f32_16x16x64_bf16 v[84:87], v[28:31], a[56:63], v3
    v_max_u32 v23, v28, v29
    v_smfmac_f32_16x16x64_bf16 v[56:59], v[32:35], a[64:71], v3
    v_max3_u32 v23, v30, v31, v23
    v_smfmac_f32_16x16x64_bf16 v[60:63], v[32:35], a[72:79], v3
    v_max3_u32 v23, v32, v33, v23
    v_smfmac_f32_16x16x64_bf16 v[64:67], v[32:35], a[80:87], v3
    v_max3_u32 v23, v34, v35, v23
    v_smfmac_f32_16x16x64_bf16 v[68:71], v[32:35], a[88:95], v3
    v_cmp_eq_u32 vcc, -1, v23
    v_smfmac_f32_16x16x64_bf16 v[72:75], v[32:35], a[96:103], v3
    v_smfmac_f32_16x16x64_bf16 v[76:79], v[32:35], a[104:111], v3
    s_cbranch_vccnz B0_fix
    s_waitcnt lgkmcnt(0)
    s_barrier
    ds_read_b128 v[36:39], v7 offset:1024
    v_smfmac_f32_16x16x64_bf16 v[80:83], v[32:35], a[112:119], v3
    ds_read_b128 v[40:43], v7 offset:2048
    v_smfmac_f32_16x16x64_bf16 v[84:87], v[32:35], a[120:127], v3
    ds_read_b128 v[48:51], v7 offset:5120
    s_waitcnt lgkmcnt(2)
    v_smfmac_f32_16x16x64_bf16 v[56:59], v[36:39], a[128:135], v3
    ds_read_b128 v[44:47], v7 offset:3072
    v_smfmac_f32_16x16x64_bf16 v[60:63], v[36:39], a[136:143], v3
    ds_read_b128 v[52:55], v7 offset:6144
    v_smfmac_f32_16x16x64_bf16 v[64:67], v[36:39], a[144:151], v3
    v_smfmac_f32_16x16x64_bf16 v[68:71], v[36:39], a[152:159], v3
    v_smfmac_f32_16x16x64_bf16 v[72:75], v[36:39], a[160:167], v3
    v_smfmac_f32_16x16x64_bf16 v[76:79], v[36:39], a[168:175], v3
    buffer_store_dword v18, v10, s[8:11], s32 offen
    v_smfmac_f32_16x16x64_bf16 v[80:83], v[36:39], a[176:183], v3
    v_smfmac_f32_16x16x64_bf16 v[84:87], v[36:39], a[184:191], v3
    s_waitcnt lgkmcnt(0)
    v_smfmac_f32_16x16x64_bf16 v[56:59], v[40:43], a[192:199], v3
    s_nop 2
    v_smfmac_f32_16x16x64_bf16 v[56:59], v[48:51], v[120:127], v3
    s_nop 1
    ds_read_b128 v[120:123], v6 offset:8192
    v_smfmac_f32_16x16x64_bf16 v[56:59], v[44:47], v[190:197], v3
    s_nop 1
    ds_read_b128 v[124:127], v6 offset:9216
    v_smfmac_f32_16x16x64_bf16 v[56:59], v[52:55], v[128:135], v3
    s_nop 1
    ds_read_b128 v[128:131], v6 offset:10240
    v_smfmac_f32_16x16x64_bf16 v[60:63], v[40:43], a[200:207], v3
    s_nop 1
    ds_read_b128 v[132:135], v6 offset:11264
    v_smfmac_f32_16x16x64_bf16 v[60:63], v[48:51], v[136:143], v3
    s_nop 0
    ds_read_b128 v[136:139], v6 offset:12288
    v_add_f32 v56, v56, v57
    v_smfmac_f32_16x16x64_bf16 v[60:63], v[44:47], v[198:205], v3
    s_nop 0
    ds_read_b128 v[140:143], v6 offset:13312
    v_add_f32 v58, v58, v59
    v_smfmac_f32_16x16x64_bf16 v[60:63], v[52:55], v[144:151], v3
    s_nop 0
    ds_read_b128 v[144:147], v6 offset:14336
    v_cvt_pk_bf16_f32 v162, v56, v58
    v_smfmac_f32_16x16x64_bf16 v[64:67], v[40:43], a[208:215], v3
    s_nop 0
    s_waitcnt lgkmcnt(5)
    ds_read_b128 v[148:151], v6 offset:15360
    v_smfmac_f32_16x16x64_bf16 v[64:67], v[48:51], v[120:127], v3
    s_nop 0
    ds_read_b128 v[120:123], v6 offset:16384
    v_add_f32 v60, v60, v61
    v_smfmac_f32_16x16x64_bf16 v[64:67], v[44:47], v[206:213], v3
    s_waitcnt lgkmcnt(5)
    ds_read_b128 v[124:127], v6 offset:17408
    v_add_f32 v62, v62, v63
    v_smfmac_f32_16x16x64_bf16 v[64:67], v[52:55], v[128:135], v3
    s_nop 0
    ds_read_b128 v[128:131], v6 offset:18432
    v_cvt_pk_bf16_f32 v170, v60, v62
    v_smfmac_f32_16x16x64_bf16 v[68:71], v[40:43], a[216:223], v3
    s_nop 0
    s_waitcnt lgkmcnt(5)
    ds_read_b128 v[132:135], v6 offset:19456
    v_smfmac_f32_16x16x64_bf16 v[68:71], v[48:51], v[136:143], v3
    s_nop 0
    ds_read_b128 v[136:139], v6 offset:20480
    v_add_f32 v64, v64, v65
    v_smfmac_f32_16x16x64_bf16 v[68:71], v[44:47], v[214:221], v3
    s_waitcnt lgkmcnt(5)
    ds_read_b128 v[140:143], v6 offset:21504
    v_add_f32 v66, v66, v67
    v_smfmac_f32_16x16x64_bf16 v[68:71], v[52:55], v[144:151], v3
    s_nop 0
    ds_read_b128 v[144:147], v6 offset:22528
    v_cvt_pk_bf16_f32 v163, v64, v66
    v_smfmac_f32_16x16x64_bf16 v[72:75], v[40:43], a[224:231], v3
    s_nop 0
    s_waitcnt lgkmcnt(5)
    ds_read_b128 v[148:151], v6 offset:23552
    v_smfmac_f32_16x16x64_bf16 v[72:75], v[48:51], v[120:127], v3
    s_nop 0
    ds_read_b128 v[120:123], v6 offset:24576
    v_add_f32 v68, v68, v69
    v_smfmac_f32_16x16x64_bf16 v[72:75], v[44:47], v[222:229], v3
    s_waitcnt lgkmcnt(5)
    ds_read_b128 v[124:127], v6 offset:25600
    v_add_f32 v70, v70, v71
    v_smfmac_f32_16x16x64_bf16 v[72:75], v[52:55], v[128:135], v3
    s_nop 0
    ds_read_b128 v[128:131], v6 offset:26624
    v_cvt_pk_bf16_f32 v171, v68, v70
    v_smfmac_f32_16x16x64_bf16 v[76:79], v[40:43], a[232:239], v3
    s_nop 0
    s_waitcnt lgkmcnt(5)
    ds_read_b128 v[132:135], v6 offset:27648
    v_smfmac_f32_16x16x64_bf16 v[76:79], v[48:51], v[136:143], v3
    s_nop 0
    ds_read_b128 v[136:139], v6 offset:28672
    v_add_f32 v72, v72, v73
    v_smfmac_f32_16x16x64_bf16 v[76:79], v[44:47], v[230:237], v3
    s_waitcnt lgkmcnt(5)
    ds_read_b128 v[140:143], v6 offset:29696
    v_add_f32 v74, v74, v75
    v_smfmac_f32_16x16x64_bf16 v[76:79], v[52:55], v[144:151], v3
    s_nop 0
    ds_read_b128 v[144:147], v6 offset:30720
    v_cvt_pk_bf16_f32 v164, v72, v74
    v_smfmac_f32_16x16x64_bf16 v[80:83], v[40:43], a[240:247], v3
    s_nop 0
    s_waitcnt lgkmcnt(5)
    ds_read_b128 v[148:151], v6 offset:31744
    v_smfmac_f32_16x16x64_bf16 v[80:83], v[48:51], v[120:127], v3
    s_nop 1
    v_add_f32 v76, v76, v77
    v_smfmac_f32_16x16x64_bf16 v[80:83], v[44:47], v[238:245], v3
    s_nop 0
    s_waitcnt lgkmcnt(4)
    v_add_f32 v78, v78, v79
    v_smfmac_f32_16x16x64_bf16 v[80:83], v[52:55], v[128:135], v3
    s_nop 1
    v_cvt_pk_bf16_f32 v172, v76, v78
    v_smfmac_f32_16x16x64_bf16 v[84:87], v[40:43], a[248:255], v3
    s_nop 1
    s_waitcnt lgkmcnt(2)
    v_smfmac_f32_16x16x64_bf16 v[84:87], v[48:51], v[136:143], v3
    s_nop 1
    v_add_f32 v80, v80, v81
    v_smfmac_f32_16x16x64_bf16 v[84:87], v[44:47], v[246:253], v3
    s_nop 0
    s_waitcnt lgkmcnt(0)
    v_add_f32 v82, v82, v83
    v_smfmac_f32_16x16x64_bf16 v[84:87], v[52:55], v[144:151], v3
    s_nop 1
    v_cvt_pk_bf16_f32 v165, v80, v82
    v_mov_b64 v[174:175], 0
    v_mov_b64 v[176:177], 0
    v_mov_b64 v[178:179], 0
    v_mov_b64 v[180:181], 0
    s_add_u32 s22, s22, 1
    s_nop 0
    v_add_f32 v84, v84, v85
    v_add_f32 v86, v86, v87
    v_cvt_pk_bf16_f32 v173, v84, v86
    v_mov_b32 v20, s22
    v_mfma_f32_32x32x16_bf16 v[56:71], v[182:185], v[182:185], 0
    v_mfma_f32_32x32x16_bf16 v[72:87], v[182:185], v[182:185], 0
    ds_write_b128 v19, v[162:165] offset:0
    ds_write_b128 v19, v[170:173] offset:1024
    s_waitcnt lgkmcnt(0)
    s_nop 3
    buffer_load_dword v28, v13, s[8:11], 0 offen sc1
    s_nop 5
    buffer_load_dword v29, v13, s[8:11], 0 offen sc1
    s_nop 5
    buffer_load_dword v30, v13, s[8:11], 0 offen sc1
    s_nop 5
    buffer_load_dword v31, v13, s[8:11], 0 offen sc1
    s_nop 5
    buffer_load_dword v32, v13, s[8:11], 0 offen sc1
    s_nop 5
B0_pf:
    s_waitcnt vmcnt(4)
    v_cmp_gt_u32 vcc, s22, v28
    buffer_load_dword v33, v13, s[8:11], 0 offen sc1
    s_cbranch_vccz B0_pf_ok
    s_waitcnt vmcnt(4)
    v_cmp_gt_u32 vcc, s22, v29
    buffer_load_dword v28, v13, s[8:11], 0 offen sc1
    s_cbranch_vccz B0_pf_ok
    s_waitcnt vmcnt(4)
    v_cmp_gt_u32 vcc, s22, v30
    buffer_load_dword v29, v13, s[8:11], 0 offen sc1
    s_cbranch_vccz B0_pf_ok
    s_waitcnt vmcnt(4)
    v_cmp_gt_u32 vcc, s22, v31
    buffer_load_dword v30, v13, s[8:11], 0 offen sc1
    s_cbranch_vccz B0_pf_ok
    s_waitcnt vmcnt(4)
    v_cmp_gt_u32 vcc, s22, v32
    buffer_load_dword v31, v13, s[8:11], 0 offen sc1
    s_cbranch_vccz B0_pf_ok
    s_waitcnt vmcnt(4)
    v_cmp_gt_u32 vcc, s22, v33
    buffer_load_dword v32, v13, s[8:11], 0 offen sc1
    s_cbranch_vccz B0_pf_ok
    s_waitcnt vmcnt(4)
    v_cmp_gt_u32 vcc, s22, v28
    buffer_load_dword v33, v13, s[8:11], 0 offen sc1
    s_cbranch_vccz B0_pf_ok
    s_waitcnt vmcnt(4)
    v_cmp_gt_u32 vcc, s22, v29
    buffer_load_dword v28, v13, s[8:11], 0 offen sc1
    s_cbranch_vccz B0_pf_ok
    s_waitcnt vmcnt(4)
    v_cmp_gt_u32 vcc, s22, v30
    buffer_load_dword v29, v13, s[8:11], 0 offen sc1
    s_cbranch_vccz B0_pf_ok
    s_waitcnt vmcnt(4)
    v_cmp_gt_u32 vcc, s22, v31
    buffer_load_dword v30, v13, s[8:11], 0 offen sc1
    s_cbranch_vccz B0_pf_ok
    s_waitcnt vmcnt(4)
    v_cmp_gt_u32 vcc, s22, v32
    buffer_load_dword v31, v13, s[8:11], 0 offen sc1
    s_cbranch_vccz B0_pf_ok
    s_waitcnt vmcnt(4)
    v_cmp_gt_u32 vcc, s22, v33
    buffer_load_dword v32, v13, s[8:11], 0 offen sc1
    s_cbranch_vccz B0_pf_ok
    s_sub_u32 s23, s23, 1
    s_cbranch_scc0 B0_pf
    s_mov_b32 s23, 0
B0_pf_ok:
    s_barrier
    s_and_b32 s26, s22, 7
    s_mul_i32 s26, s26, 7168
    s_add_u32 s24, s26, 18284544
    buffer_load_dwordx4 v[28:31], v15, s[8:11], s25 offen offset:0 sc1
    s_barrier
    buffer_load_dwordx4 v[32:35], v15, s[8:11], s25 offen offset:1024 sc1
    s_barrier
    ds_read_b128 v[120:123], v6 offset:0
    ds_read_b128 v[124:127], v6 offset:1024
    ds_read_b128 v[128:131], v6 offset:2048
    ds_read_b128 v[132:135], v6 offset:3072
    ds_read_b128 v[136:139], v6 offset:4096
    ds_read_b128 v[140:143], v6 offset:5120
    ds_read_b128 v[144:147], v6 offset:6144
    ds_read_b128 v[148:151], v6 offset:7168
    s_add_u32 s26, s22, 5
    s_and_b32 s26, s26, 7
    s_mul_i32 s26, s26, 7168
    s_add_u32 s32, s26, 18284544
    s_add_u32 s31, s31, 458752
B0_backP:
    s_waitcnt vmcnt(1)
    v_smfmac_f32_16x16x64_bf16 v[174:177], v[28:31], v[88:95], v3
    v_max3_u32 v23, v28, v29, v30
    v_smfmac_f32_16x16x64_bf16 v[178:181], v[28:31], v[96:103], v3
    v_max3_u32 v23, v30, v31, v23
    s_waitcnt vmcnt(0)
    v_smfmac_f32_16x16x64_bf16 v[174:177], v[32:35], v[104:111], v3
    s_nop 1
    v_max3_u32 v23, v32, v33, v23
    v_smfmac_f32_16x16x64_bf16 v[178:181], v[32:35], v[112:119], v3
    s_nop 1
    v_max3_u32 v23, v34, v35, v23
    v_cmp_eq_u32 vcc, -1, v23
    v_add_f32 v40, v174, v175
    v_add_f32 v42, v176, v177
    s_nop 0
    s_cbranch_vccnz B0_fixP
    v_add_f32 v41, v178, v179
    v_add_f32 v43, v180, v181
    ds_write_b128 v8, v[40:43]
    s_barrier
    s_and_b32 s26, s22, 3
    s_mul_i32 s26, s26, 10240
    s_add_u32 s25, s26, 18341888
    s_cmp_lt_u32 s22, 63
    s_cbranch_scc1 B0_top
    s_add_u32 s27, s24, 0
    s_add_u32 s28, s24, 4096
    s_add_u32 s29, s24, 1024
    s_mov_b32 s34, 18382848
    v_mov_b32 v21, 2147483632
    s_barrier
    buffer_load_dwordx4 v[28:31], v4, s[8:11], s27 offen sc1
    buffer_load_dwordx4 v[32:35], v4, s[8:11], s28 offen sc1
    buffer_load_dwordx4 v[36:39], v4, s[8:11], s29 offen sc1
    s_barrier
    buffer_store_dwordx4 v[162:165], v17, s[8:11], s34 offen offset:0 sc1
    buffer_store_dwordx4 v[170:173], v17, s[8:11], s34 offen offset:256 sc1
    s_mov_b32 s34, 18497536
    s_waitcnt vmcnt(2)
    s_branch Bfol0_chk
B0_fix:
    buffer_load_dwordx4 v[28:31], v4, s[8:11], s27 offen sc1
    buffer_load_dwordx4 v[32:35], v4, s[8:11], s28 offen sc1
    buffer_load_dwordx4 v[36:39], v4, s[8:11], s29 offen sc1
    s_nop 3
    v_mov_b64 v[56:57], 0
    v_mov_b64 v[58:59], 0
    v_mov_b64 v[60:61], 0
    v_mov_b64 v[62:63], 0
    v_mov_b64 v[64:65], 0
    v_mov_b64 v[66:67], 0
    v_mov_b64 v[68:69], 0
    v_mov_b64 v[70:71], 0
    v_mov_b64 v[72:73], 0
    v_mov_b64 v[74:75], 0
    v_mov_b64 v[76:77], 0
    v_mov_b64 v[78:79], 0
    v_mov_b64 v[80:81], 0
    v_mov_b64 v[82:83], 0
    v_mov_b64 v[84:85], 0
    v_mov_b64 v[86:87], 0
    s_waitcnt vmcnt(0)
    s_sub_u32 s23, s23, 1
    s_cbranch_scc0 B0_retry
    s_branch B_done
B0_fixP:
    buffer_load_dwordx4 v[28:31], v15, s[8:11], s25 offen offset:0 sc1
    buffer_load_dwordx4 v[32:35], v15, s[8:11], s25 offen offset:1024 sc1
    v_mov_b64 v[174:175], 0
    v_mov_b64 v[176:177], 0
    v_mov_b64 v[178:179], 0
    v_mov_b64 v[180:181], 0
    s_sub_u32 s23, s23, 1
    s_cbranch_scc0 B0_backP
    s_branch B_done
.p2align 6
B1_top:
    s_add_u32 s27, s24, 1024
    s_add_u32 s28, s24, 5120
    s_add_u32 s29, s24, 2048
    s_add_u32 s26, s31, 4096
    s_barrier
    buffer_load_dwordx4 v[28:31], v4, s[8:11], s27 offen sc1
    ds_write_b128 v8, v[152:155]
    s_barrier
    buffer_load_dwordx4 v[32:35], v4, s[8:11], s28 offen sc1
    s_barrier
    buffer_load_dwordx4 v[88:91], v14, s[8:11], s31 offen offset:0 sc1
    buffer_load_dwordx4 v[96:99], v14, s[8:11], s31 offen offset:256 sc1
    buffer_load_dwordx4 v[92:95], v14, s[8:11], s31 offen offset:2048 sc1
    s_waitcnt vmcnt(4)
B1_retry:
    v_smfmac_f32_16x16x64_bf16 v[56:59], v[28:31], a[0:7], v3
    ds_write_b128 v7, v[28:31] offset:1024
    v_smfmac_f32_16x16x64_bf16 v[60:63], v[28:31], a[8:15], v3
    buffer_load_dwordx4 v[100:103], v14, s[8:11], s31 offen offset:2304 sc1
    v_smfmac_f32_16x16x64_bf16 v[64:67], v[28:31], a[16:23], v3
    buffer_load_dwordx4 v[104:107], v14, s[8:11], s26 offen offset:0 sc1
    v_smfmac_f32_16x16x64_bf16 v[68:71], v[28:31], a[24:31], v3
    buffer_load_dwordx4 v[112:115], v14, s[8:11], s26 offen offset:256 sc1
    v_smfmac_f32_16x16x64_bf16 v[72:75], v[28:31], a[32:39], v3
    s_waitcnt vmcnt(6)
    ds_write_b128 v7, v[32:35] offset:5120
    v_smfmac_f32_16x16x64_bf16 v[76:79], v[28:31], a[40:47], v3
    buffer_load_dwordx4 v[108:111], v14, s[8:11], s26 offen offset:2048 sc1
    v_smfmac_f32_16x16x64_bf16 v[80:83], v[28:31], a[48:55], v3
    buffer_load_dwordx4 v[116:119], v14, s[8:11], s26 offen offset:2304 sc1
    v_smfmac_f32_16x16x64_bf16 v[84:87], v[28:31], a[56:63], v3
    v_max_u32 v23, v28, v29
    v_smfmac_f32_16x16x64_bf16 v[56:59], v[32:35], a[64:71], v3
    v_max3_u32 v23, v30, v31, v23
    v_smfmac_f32_16x16x64_bf16 v[60:63], v[32:35], a[72:79], v3
    v_max3_u32 v23, v32, v33, v23
    v_smfmac_f32_16x16x64_bf16 v[64:67], v[32:35], a[80:87], v3
    v_max3_u32 v23, v34, v35, v23
    v_smfmac_f32_16x16x64_bf16 v[68:71], v[32:35], a[88:95], v3
    v_cmp_eq_u32 vcc, -1, v23
    v_smfmac_f32_16x16x64_bf16 v[72:75], v[32:35], a[96:103], v3
    v_smfmac_f32_16x16x64_bf16 v[76:79], v[32:35], a[104:111], v3
    s_cbranch_vccnz B1_fix
    s_waitcnt lgkmcnt(0)
    s_barrier
    ds_read_b128 v[36:39], v7 offset:2048
    v_smfmac_f32_16x16x64_bf16 v[80:83], v[32:35], a[112:119], v3
    ds_read_b128 v[40:43], v7 offset:3072
    v_smfmac_f32_16x16x64_bf16 v[84:87], v[32:35], a[120:127], v3
    ds_read_b128 v[48:51], v7 offset:6144
    s_waitcnt lgkmcnt(2)
    v_smfmac_f32_16x16x64_bf16 v[56:59], v[36:39], a[128:135], v3
    ds_read_b128 v[44:47], v7 offset:4096
    v_smfmac_f32_16x16x64_bf16 v[60:63], v[36:39], a[136:143], v3
    ds_read_b128 v[52:55], v7 offset:0
    v_smfmac_f32_16x16x64_bf16 v[64:67], v[36:39], a[144:151], v3
    v_smfmac_f32_16x16x64_bf16 v[68:71], v[36:39], a[152:159], v3
    v_smfmac_f32_16x16x64_bf16 v[72:75], v[36:39], a[160:167], v3
    v_smfmac_f32_16x16x64_bf16 v[76:79], v[36:39], a[168:175], v3
    buffer_store_dword v18, v10, s[8:11], s32 offen
    v_smfmac_f32_16x16x64_bf16 v[80:83], v[36:39], a[176:183], v3
    v_smfmac_f32_16x16x64_bf16 v[84:87], v[36:39], a[184:191], v3
    s_waitcnt lgkmcnt(0)
    v_smfmac_f32_16x16x64_bf16 v[56:59], v[40:43], a[192:199], v3
    s_nop 2
    v_smfmac_f32_16x16x64_bf16 v[56:59], v[48:51], v[120:127], v3
    s_nop 1
    ds_read_b128 v[120:123], v6 offset:8192
    v_smfmac_f32_16x16x64_bf16 v[56:59], v[44:47], v[190:197], v3
    s_nop 1
    ds_read_b128 v[124:127], v6 offset:9216
    v_smfmac_f32_16x16x64_bf16 v[56:59], v[52:55], v[128:135], v3
    s_nop 1
    ds_read_b128 v[128:131], v6 offset:10240
    v_smfmac_f32_16x16x64_bf16 v[60:63], v[40:43], a[200:207], v3
    s_nop 1
    ds_read_b128 v[132:135], v6 offset:11264
    v_smfmac_f32_16x16x64_bf16 v[60:63], v[48:51], v[136:143], v3
    s_nop 0
    ds_read_b128 v[136:139], v6 offset:12288
    v_add_f32 v56, v56, v57
    v_smfmac_f32_16x16x64_bf16 v[60:63], v[44:47], v[198:205], v3
    s_nop 0
    ds_read_b128 v[140:143], v6 offset:13312
    v_add_f32 v58, v58, v59
    v_smfmac_f32_16x16x64_bf16 v[60:63], v[52:55], v[144:151], v3
    s_nop 0
    ds_read_b128 v[144:147], v6 offset:14336
    v_cvt_pk_bf16_f32 v162, v56, v58
    v_smfmac_f32_16x16x64_bf16 v[64:67], v[40:43], a[208:215], v3
    s_nop 0
    s_waitcnt lgkmcnt(5)
    ds_read_b128 v[148:151], v6 offset:15360
    v_smfmac_f32_16x16x64_bf16 v[64:67], v[48:51], v[120:127], v3
    s_nop 0
    ds_read_b128 v[120:123], v6 offset:16384
    v_add_f32 v60, v60, v61
    v_smfmac_f32_16x16x64_bf16 v[64:67], v[44:47], v[206:213], v3
    s_waitcnt lgkmcnt(5)
    ds_read_b128 v[124:127], v6 offset:17408
    v_add_f32 v62, v62, v63
    v_smfmac_f32_16x16x64_bf16 v[64:67], v[52:55], v[128:135], v3
    s_nop 0
    ds_read_b128 v[128:131], v6 offset:18432
    v_cvt_pk_bf16_f32 v170, v60, v62
    v_smfmac_f32_16x16x64_bf16 v[68:71], v[40:43], a[216:223], v3
    s_nop 0
    s_waitcnt lgkmcnt(5)
    ds_read_b128 v[132:135], v6 offset:19456
    v_smfmac_f32_16x16x64_bf16 v[68:71], v[48:51], v[136:143], v3
    s_nop 0
    ds_read_b128 v[136:139], v6 offset:20480
    v_add_f32 v64, v64, v65
    v_smfmac_f32_16x16x64_bf16 v[68:71], v[44:47], v[214:221], v3
    s_waitcnt lgkmcnt(5)
    ds_read_b128 v[140:143], v6 offset:21504
    v_add_f32 v66, v66, v67
    v_smfmac_f32_16x16x64_bf16 v[68:71], v[52:55], v[144:151], v3
    s_nop 0
    ds_read_b128 v[144:147], v6 offset:22528
    v_cvt_pk_bf16_f32 v163, v64, v66
    v_smfmac_f32_16x16x64_bf16 v[72:75], v[40:43], a[224:231], v3
    s_nop 0
    s_waitcnt lgkmcnt(5)
    ds_read_b128 v[148:151], v6 offset:23552
    v_smfmac_f32_16x16x64_bf16 v[72:75], v[48:51], v[120:127], v3
    s_nop 0
    ds_read_b128 v[120:123], v6 offset:24576
    v_add_f32 v68, v68, v69
    v_smfmac_f32_16x16x64_bf16 v[72:75], v[44:47], v[222:229], v3
    s_waitcnt lgkmcnt(5)
    ds_read_b128 v[124:127], v6 offset:25600
    v_add_f32 v70, v70, v71
    v_smfmac_f32_16x16x64_bf16 v[72:75], v[52:55], v[128:135], v3
    s_nop 0
    ds_read_b128 v[128:131], v6 offset:26624
    v_cvt_pk_bf16_f32 v171, v68, v70
    v_smfmac_f32_16x16x64_bf16 v[76:79], v[40:43], a[232:239], v3
    s_nop 0
    s_waitcnt lgkmcnt(5)
    ds_read_b128 v[132:135], v6 offset:27648
    v_smfmac_f32_16x16x64_bf16 v[76:79], v[48:51], v[136:143], v3
    s_nop 0
    ds_read_b128 v[136:139], v6 offset:28672
    v_add_f32 v72, v72, v73
    v_smfmac_f32_16x16x64_bf16 v[76:79], v[44:47], v[230:237], v3
    s_waitcnt lgkmcnt(5)
    ds_read_b128 v[140:143], v6 offset:29696
    v_add_f32 v74, v74, v75
    v_smfmac_f32_16x16x64_bf16 v[76:79], v[52:55], v[144:151], v3
    s_nop 0
    ds_read_b128 v[144:147], v6 offset:30720
    v_cvt_pk_bf16_f32 v164, v72, v74
    v_smfmac_f32_16x16x64_bf16 v[80:83], v[40:43], a[240:247], v3
    s_nop 0
    s_waitcnt lgkmcnt(5)
    ds_read_b128 v[148:151], v6 offset:31744
    v_smfmac_f32_16x16x64_bf16 v[80:83], v[48:51], v[120:127], v3
    s_nop 1
    v_add_f32 v76, v76, v77
    v_smfmac_f32_16x16x64_bf16 v[80:83], v[44:47], v[238:245], v3
    s_nop 0
    s_waitcnt lgkmcnt(4)
    v_add_f32 v78, v78, v79
    v_smfmac_f32_16x16x64_bf16 v[80:83], v[52:55], v[128:135], v3
    s_nop 1
    v_cvt_pk_bf16_f32 v172, v76, v78
    v_smfmac_f32_16x16x64_bf16 v[84:87], v[40:43], a[248:255], v3
    s_nop 1
    s_waitcnt lgkmcnt(2)
    v_smfmac_f32_16x16x64_bf16 v[84:87], v[48:51], v[136:143], v3
    s_nop 1
    v_add_f32 v80, v80, v81
    v_smfmac_f32_16x16x64_bf16 v[84:87], v[44:47], v[246:253], v3
    s_nop 0
    s_waitcnt lgkmcnt(0)
    v_add_f32 v82, v82, v83
    v_smfmac_f32_16x16x64_bf16 v[84:87], v[52:55], v[144:151], v3
    s_nop 1
    v_cvt_pk_bf16_f32 v165, v80, v82
    v_mov_b64 v[174:175], 0
    v_mov_b64 v[176:177], 0
    v_mov_b64 v[178:179], 0
    v_mov_b64 v[180:181], 0
    s_add_u32 s22, s22, 1
    s_nop 0
    v_add_f32 v84, v84, v85
    v_add_f32 v86, v86, v87
    v_cvt_pk_bf16_f32 v173, v84, v86
    v_mov_b32 v20, s22
    v_mfma_f32_32x32x16_bf16 v[56:71], v[182:185], v[182:185], 0
    v_mfma_f32_32x32x16_bf16 v[72:87], v[182:185], v[182:185], 0
    ds_write_b128 v19, v[162:165] offset:2048
    ds_write_b128 v19, v[170:173] offset:3072
    s_waitcnt lgkmcnt(0)
    s_barrier
    s_and_b32 s26, s22, 7
    s_mul_i32 s26, s26, 7168
    s_add_u32 s24, s26, 18284544
    buffer_load_dwordx4 v[28:31], v15, s[8:11], s25 offen offset:1024 sc1
    s_barrier
    buffer_load_dwordx4 v[32:35], v15, s[8:11], s25 offen offset:0 sc1
    s_barrier
    ds_read_b128 v[120:123], v6 offset:0
    ds_read_b128 v[124:127], v6 offset:1024
    ds_read_b128 v[128:131], v6 offset:2048
    ds_read_b128 v[132:135], v6 offset:3072
    ds_read_b128 v[136:139], v6 offset:4096
    ds_read_b128 v[140:143], v6 offset:5120
    ds_read_b128 v[144:147], v6 offset:6144
    ds_read_b128 v[148:151], v6 offset:7168
    s_add_u32 s26, s22, 5
    s_and_b32 s26, s26, 7
    s_mul_i32 s26, s26, 7168
    s_add_u32 s32, s26, 18284544
    s_add_u32 s31, s31, 458752
B1_backP:
    s_waitcnt vmcnt(1)
    v_smfmac_f32_16x16x64_bf16 v[174:177], v[28:31], v[104:111], v3
    v_max3_u32 v23, v28, v29, v30
    v_smfmac_f32_16x16x64_bf16 v[178:181], v[28:31], v[112:119], v3
    v_max3_u32 v23, v30, v31, v23
    s_waitcnt vmcnt(0)
    v_smfmac_f32_16x16x64_bf16 v[174:177], v[32:35], v[88:95], v3
    s_nop 1
    v_max3_u32 v23, v32, v33, v23
    v_smfmac_f32_16x16x64_bf16 v[178:181], v[32:35], v[96:103], v3
    s_nop 1
    v_max3_u32 v23, v34, v35, v23
    v_cmp_eq_u32 vcc, -1, v23
    v_add_f32 v40, v174, v175
    v_add_f32 v42, v176, v177
    s_nop 0
    s_cbranch_vccnz B1_fixP
    v_add_f32 v41, v178, v179
    v_add_f32 v43, v180, v181
    ds_write_b128 v8, v[40:43]
    s_barrier
    s_and_b32 s26, s22, 3
    s_mul_i32 s26, s26, 10240
    s_add_u32 s25, s26, 18341888
    s_cmp_lt_u32 s22, 63
    s_cbranch_scc1 B1_top
    s_add_u32 s27, s24, 1024
    s_add_u32 s28, s24, 5120
    s_add_u32 s29, s24, 2048
    s_mov_b32 s34, 18382848
    v_mov_b32 v21, 2147483632
    s_barrier
    buffer_load_dwordx4 v[28:31], v4, s[8:11], s27 offen sc1
    buffer_load_dwordx4 v[32:35], v4, s[8:11], s28 offen sc1
    buffer_load_dwordx4 v[36:39], v4, s[8:11], s29 offen sc1
    s_barrier
    buffer_store_dwordx4 v[162:165], v17, s[8:11], s34 offen offset:0 sc1
    buffer_store_dwordx4 v[170:173], v17, s[8:11], s34 offen offset:256 sc1
    s_mov_b32 s34, 18497536
    s_waitcnt vmcnt(2)
    s_branch Bfol1_chk
B1_fix:
    buffer_load_dwordx4 v[28:31], v4, s[8:11], s27 offen sc1
    buffer_load_dwordx4 v[32:35], v4, s[8:11], s28 offen sc1
    buffer_load_dwordx4 v[36:39], v4, s[8:11], s29 offen sc1
    s_nop 3
    v_mov_b64 v[56:57], 0
    v_mov_b64 v[58:59], 0
    v_mov_b64 v[60:61], 0
    v_mov_b64 v[62:63], 0
    v_mov_b64 v[64:65], 0
    v_mov_b64 v[66:67], 0
    v_mov_b64 v[68:69], 0
    v_mov_b64 v[70:71], 0
    v_mov_b64 v[72:73], 0
    v_mov_b64 v[74:75], 0
    v_mov_b64 v[76:77], 0
    v_mov_b64 v[78:79], 0
    v_mov_b64 v[80:81], 0
    v_mov_b64 v[82:83], 0
    v_mov_b64 v[84:85], 0
    v_mov_b64 v[86:87], 0
    s_waitcnt vmcnt(0)
    s_sub_u32 s23, s23, 1
    s_cbranch_scc0 B1_retry
    s_branch B_done
B1_fixP:
    buffer_load_dwordx4 v[28:31], v15, s[8:11], s25 offen offset:1024 sc1
    buffer_load_dwordx4 v[32:35], v15, s[8:11], s25 offen offset:0 sc1
    v_mov_b64 v[174:175], 0
    v_mov_b64 v[176:177], 0
    v_mov_b64 v[178:179], 0
    v_mov_b64 v[180:181], 0
    s_sub_u32 s23, s23, 1
    s_cbranch_scc0 B1_backP
    s_branch B_done
.p2align 6
B2_top:
    s_add_u32 s27, s24, 2048
    s_add_u32 s28, s24, 6144
    s_add_u32 s29, s24, 3072
    s_add_u32 s26, s31, 4096
    s_barrier
    buffer_load_dwordx4 v[28:31], v4, s[8:11], s27 offen sc1
    ds_write_b128 v8, v[152:155]
    s_barrier
    buffer_load_dwordx4 v[32:35], v4, s[8:11], s28 offen sc1
    s_barrier
    buffer_load_dwordx4 v[88:91], v14, s[8:11], s31 offen offset:0 sc1
    buffer_load_dwordx4 v[96:99], v14, s[8:11], s31 offen offset:256 sc1
    buffer_load_dwordx4 v[92:95], v14, s[8:11], s31 offen offset:2048 sc1
    s_waitcnt vmcnt(4)
B2_retry:
    v_smfmac_f32_16x16x64_bf16 v[56:59], v[28:31], a[0:7], v3
    ds_write_b128 v7, v[28:31] offset:2048
    v_smfmac_f32_16x16x64_bf16 v[60:63], v[28:31], a[8:15], v3
    buffer_load_dwordx4 v[100:103], v14, s[8:11], s31 offen offset:2304 sc1
    v_smfmac_f32_16x16x64_bf16 v[64:67], v[28:31], a[16:23], v3
    buffer_load_dwordx4 v[104:107], v14, s[8:11], s26 offen offset:0 sc1
    v_smfmac_f32_16x16x64_bf16 v[68:71], v[28:31], a[24:31], v3
    buffer_load_dwordx4 v[112:115], v14, s[8:11], s26 offen offset:256 sc1
    v_smfmac_f32_16x16x64_bf16 v[72:75], v[28:31], a[32:39], v3
    s_waitcnt vmcnt(6)
    ds_write_b128 v7, v[32:35] offset:6144
    v_smfmac_f32_16x16x64_bf16 v[76:79], v[28:31], a[40:47], v3
    buffer_load_dwordx4 v[108:111], v14, s[8:11], s26 offen offset:2048 sc1
    v_smfmac_f32_16x16x64_bf16 v[80:83], v[28:31], a[48:55], v3
    buffer_load_dwordx4 v[116:119], v14, s[8:11], s26 offen offset:2304 sc1
    v_smfmac_f32_16x16x64_bf16 v[84:87], v[28:31], a[56:63], v3
    v_max_u32 v23, v28, v29
    v_smfmac_f32_16x16x64_bf16 v[56:59], v[32:35], a[64:71], v3
    v_max3_u32 v23, v30, v31, v23
    v_smfmac_f32_16x16x64_bf16 v[60:63], v[32:35], a[72:79], v3
    v_max3_u32 v23, v32, v33, v23
    v_smfmac_f32_16x16x64_bf16 v[64:67], v[32:35], a[80:87], v3
    v_max3_u32 v23, v34, v35, v23
    v_smfmac_f32_16x16x64_bf16 v[68:71], v[32:35], a[88:95], v3
    v_cmp_eq_u32 vcc, -1, v23
    v_smfmac_f32_16x16x64_bf16 v[72:75], v[32:35], a[96:103], v3
    v_smfmac_f32_16x16x64_bf16 v[76:79], v[32:35], a[104:111], v3
    s_cbranch_vccnz B2_fix
    s_waitcnt lgkmcnt(0)
    s_barrier
    ds_read_b128 v[36:39], v7 offset:3072
    v_smfmac_f32_16x16x64_bf16 v[80:83], v[32:35], a[112:119], v3
    ds_read_b128 v[40:43], v7 offset:4096
    v_smfmac_f32_16x16x64_bf16 v[84:87], v[32:35], a[120:127], v3
    ds_read_b128 v[48:51], v7 offset:0
    s_waitcnt lgkmcnt(2)
    v_smfmac_f32_16x16x64_bf16 v[56:59], v[36:39], a[128:135], v3
    ds_read_b128 v[44:47], v7 offset:5120
    v_smfmac_f32_16x16x64_bf16 v[60:63], v[36:39], a[136:143], v3
    ds_read_b128 v[52:55], v7 offset:1024
    v_smfmac_f32_16x16x64_bf16 v[64:67], v[36:39], a[144:151], v3
    v_smfmac_f32_16x16x64_bf16 v[68:71], v[36:39], a[152:159], v3
    v_smfmac_f32_16x16x64_bf16 v[72:75], v[36:39], a[160:167], v3
    v_smfmac_f32_16x16x64_bf16 v[76:79], v[36:39], a[168:175], v3
    v_smfmac_f32_16x16x64_bf16 v[80:83], v[36:39], a[176:183], v3
    v_smfmac_f32_16x16x64_bf16 v[84:87], v[36:39], a[184:191], v3
    s_waitcnt lgkmcnt(0)
    v_smfmac_f32_16x16x64_bf16 v[56:59], v[40:43], a[192:199], v3
    s_nop 2
    v_smfmac_f32_16x16x64_bf16 v[56:59], v[48:51], v[120:127], v3
    s_nop 1
    ds_read_b128 v[120:123], v6 offset:8192
    v_smfmac_f32_16x16x64_bf16 v[56:59], v[44:47], v[190:197], v3
    s_nop 1
    ds_read_b128 v[124:127], v6 offset:9216
    v_smfmac_f32_16x16x64_bf16 v[56:59], v[52:55], v[128:135], v3
    s_nop 1
    ds_read_b128 v[128:131], v6 offset:10240
    v_smfmac_f32_16x16x64_bf16 v[60:63], v[40:43], a[200:207], v3
    s_nop 1
    ds_read_b128 v[132:135], v6 offset:11264
    v_smfmac_f32_16x16x64_bf16 v[60:63], v[48:51], v[136:143], v3
    s_nop 0
    ds_read_b128 v[136:139], v6 offset:12288
    v_add_f32 v56, v56, v57
    v_smfmac_f32_16x16x64_bf16 v[60:63], v[44:47], v[198:205], v3
    s_nop 0
    ds_read_b128 v[140:143], v6 offset:13312
    v_add_f32 v58, v58, v59
    v_smfmac_f32_16x16x64_bf16 v[60:63], v[52:55], v[144:151], v3
    s_nop 0
    ds_read_b128 v[144:147], v6 offset:14336
    v_cvt_pk_bf16_f32 v162, v56, v58
    v_smfmac_f32_16x16x64_bf16 v[64:67], v[40:43], a[208:215], v3
    s_nop 0
    s_waitcnt lgkmcnt(5)
    ds_read_b128 v[148:151], v6 offset:15360
    v_smfmac_f32_16x16x64_bf16 v[64:67], v[48:51], v[120:127], v3
    s_nop 0
    ds_read_b128 v[120:123], v6 offset:16384
    v_add_f32 v60, v60, v61
    v_smfmac_f32_16x16x64_bf16 v[64:67], v[44:47], v[206:213], v3
    s_waitcnt lgkmcnt(5)
    ds_read_b128 v[124:127], v6 offset:17408
    v_add_f32 v62, v62, v63
    v_smfmac_f32_16x16x64_bf16 v[64:67], v[52:55], v[128:135], v3
    s_nop 0
    ds_read_b128 v[128:131], v6 offset:18432
    v_cvt_pk_bf16_f32 v170, v60, v62
    v_smfmac_f32_16x16x64_bf16 v[68:71], v[40:43], a[216:223], v3
    s_nop 0
    s_waitcnt lgkmcnt(5)
    ds_read_b128 v[132:135], v6 offset:19456
    v_smfmac_f32_16x16x64_bf16 v[68:71], v[48:51], v[136:143], v3
    s_nop 0
    ds_read_b128 v[136:139], v6 offset:20480
    v_add_f32 v64, v64, v65
    v_smfmac_f32_16x16x64_bf16 v[68:71], v[44:47], v[214:221], v3
    s_waitcnt lgkmcnt(5)
    ds_read_b128 v[140:143], v6 offset:21504
    v_add_f32 v66, v66, v67
    v_smfmac_f32_16x16x64_bf16 v[68:71], v[52:55], v[144:151], v3
    s_nop 0
    ds_read_b128 v[144:147], v6 offset:22528
    v_cvt_pk_bf16_f32 v163, v64, v66
    v_smfmac_f32_16x16x64_bf16 v[72:75], v[40:43], a[224:231], v3
    s_nop 0
    s_waitcnt lgkmcnt(5)
    ds_read_b128 v[148:151], v6 offset:23552
    v_smfmac_f32_16x16x64_bf16 v[72:75], v[48:51], v[120:127], v3
    s_nop 0
    ds_read_b128 v[120:123], v6 offset:24576
    v_add_f32 v68, v68, v69
    v_smfmac_f32_16x16x64_bf16 v[72:75], v[44:47], v[222:229], v3
    s_waitcnt lgkmcnt(5)
    ds_read_b128 v[124:127], v6 offset:25600
    v_add_f32 v70, v70, v71
    v_smfmac_f32_16x16x64_bf16 v[72:75], v[52:55], v[128:135], v3
    s_nop 0
    ds_read_b128 v[128:131], v6 offset:26624
    v_cvt_pk_bf16_f32 v171, v68, v70
    v_smfmac_f32_16x16x64_bf16 v[76:79], v[40:43], a[232:239], v3
    s_nop 0
    s_waitcnt lgkmcnt(5)
    ds_read_b128 v[132:135], v6 offset:27648
    v_smfmac_f32_16x16x64_bf16 v[76:79], v[48:51], v[136:143], v3
    s_nop 0
    ds_read_b128 v[136:139], v6 offset:28672
    v_add_f32 v72, v72, v73
    v_smfmac_f32_16x16x64_bf16 v[76:79], v[44:47], v[230:237], v3
    s_waitcnt lgkmcnt(5)
    ds_read_b128 v[140:143], v6 offset:29696
    v_add_f32 v74, v74, v75
    v_smfmac_f32_16x16x64_bf16 v[76:79], v[52:55], v[144:151], v3
    s_nop 0
    ds_read_b128 v[144:147], v6 offset:30720
    v_cvt_pk_bf16_f32 v164, v72, v74
    v_smfmac_f32_16x16x64_bf16 v[80:83], v[40:43], a[240:247], v3
    s_nop 0
    s_waitcnt lgkmcnt(5)
    ds_read_b128 v[148:151], v6 offset:31744
    v_smfmac_f32_16x16x64_bf16 v[80:83], v[48:51], v[120:127], v3
    s_nop 1
    v_add_f32 v76, v76, v77
    v_smfmac_f32_16x16x64_bf16 v[80:83], v[44:47], v[238:245], v3
    s_nop 0
    s_waitcnt lgkmcnt(4)
    v_add_f32 v78, v78, v79
    v_smfmac_f32_16x16x64_bf16 v[80:83], v[52:55], v[128:135], v3
    s_nop 1
    v_cvt_pk_bf16_f32 v172, v76, v78
    v_smfmac_f32_16x16x64_bf16 v[84:87], v[40:43], a[248:255], v3
    s_nop 1
    s_waitcnt lgkmcnt(2)
    v_smfmac_f32_16x16x64_bf16 v[84:87], v[48:51], v[136:143], v3
    s_nop 1
    v_add_f32 v80, v80, v81
    v_smfmac_f32_16x16x64_bf16 v[84:87], v[44:47], v[246:253], v3
    s_nop 0
    s_waitcnt lgkmcnt(0)
    v_add_f32 v82, v82, v83
    v_smfmac_f32_16x16x64_bf16 v[84:87], v[52:55], v[144:151], v3
    s_nop 1
    v_cvt_pk_bf16_f32 v165, v80, v82
    v_mov_b64 v[174:175], 0
    v_mov_b64 v[176:177], 0
    v_mov_b64 v[178:179], 0
    v_mov_b64 v[180:181], 0
    s_add_u32 s22, s22, 1
    s_nop 0
    v_add_f32 v84, v84, v85
    v_add_f32 v86, v86, v87
    v_cvt_pk_bf16_f32 v173, v84, v86
    v_mov_b32 v20, s22
    v_mfma_f32_32x32x16_bf16 v[56:71], v[182:185], v[182:185], 0
    v_mfma_f32_32x32x16_bf16 v[72:87], v[182:185], v[182:185], 0
    ds_write_b128 v19, v[162:165] offset:4096
    ds_write_b128 v19, v[170:173] offset:5120
    s_waitcnt lgkmcnt(0)
    s_barrier
    s_and_b32 s26, s22, 7
    s_mul_i32 s26, s26, 7168
    s_add_u32 s24, s26, 18284544
    buffer_load_dwordx4 v[28:31], v15, s[8:11], s25 offen offset:0 sc1
    s_barrier
    buffer_load_dwordx4 v[32:35], v15, s[8:11], s25 offen offset:1024 sc1
    s_barrier
    ds_read_b128 v[120:123], v6 offset:0
    ds_read_b128 v[124:127], v6 offset:1024
    ds_read_b128 v[128:131], v6 offset:2048
    ds_read_b128 v[132:135], v6 offset:3072
    ds_read_b128 v[136:139], v6 offset:4096
    ds_read_b128 v[140:143], v6 offset:5120
    ds_read_b128 v[144:147], v6 offset:6144
    ds_read_b128 v[148:151], v6 offset:7168
    s_add_u32 s26, s22, 5
    s_and_b32 s26, s26, 7
    s_mul_i32 s26, s26, 7168
    s_add_u32 s32, s26, 18284544
    s_add_u32 s31, s31, 458752
B2_backP:
    s_waitcnt vmcnt(1)
    v_smfmac_f32_16x16x64_bf16 v[174:177], v[28:31], v[88:95], v3
    v_max3_u32 v23, v28, v29, v30
    v_smfmac_f32_16x16x64_bf16 v[178:181], v[28:31], v[96:103], v3
    v_max3_u32 v23, v30, v31, v23
    s_waitcnt vmcnt(0)
    v_smfmac_f32_16x16x64_bf16 v[174:177], v[32:35], v[104:111], v3
    s_nop 1
    v_max3_u32 v23, v32, v33, v23
    v_smfmac_f32_16x16x64_bf16 v[178:181], v[32:35], v[112:119], v3
    s_nop 1
    v_max3_u32 v23, v34, v35, v23
    v_cmp_eq_u32 vcc, -1, v23
    v_add_f32 v40, v174, v175
    v_add_f32 v42, v176, v177
    s_nop 0
    s_cbranch_vccnz B2_fixP
    v_add_f32 v41, v178, v179
    v_add_f32 v43, v180, v181
    ds_write_b128 v8, v[40:43]
    s_barrier
    buffer_load_dword v44, v22, s[8:11], 0 offen sc1
    s_and_b32 s26, s22, 3
    s_mul_i32 s26, s26, 10240
    s_add_u32 s25, s26, 18341888
    s_nop 2
    buffer_load_dword v45, v22, s[8:11], 0 offen sc1
    s_nop 5
    buffer_load_dword v46, v22, s[8:11], 0 offen sc1
    s_nop 5
    buffer_load_dword v47, v22, s[8:11], 0 offen sc1
    s_nop 5
    buffer_load_dword v48, v22, s[8:11], 0 offen sc1
    s_nop 5
B2_pg:
    s_waitcnt vmcnt(4)
    v_cmp_gt_u32 vcc, s22, v44
    buffer_load_dword v49, v22, s[8:11], 0 offen sc1
    s_cbranch_vccz B2_pg_ok
    s_waitcnt vmcnt(4)
    v_cmp_gt_u32 vcc, s22, v45
    buffer_load_dword v44, v22, s[8:11], 0 offen sc1
    s_cbranch_vccz B2_pg_ok
    s_waitcnt vmcnt(4)
    v_cmp_gt_u32 vcc, s22, v46
    buffer_load_dword v45, v22, s[8:11], 0 offen sc1
    s_cbranch_vccz B2_pg_ok
    s_waitcnt vmcnt(4)
    v_cmp_gt_u32 vcc, s22, v47
    buffer_load_dword v46, v22, s[8:11], 0 offen sc1
    s_cbranch_vccz B2_pg_ok
    s_waitcnt vmcnt(4)
    v_cmp_gt_u32 vcc, s22, v48
    buffer_load_dword v47, v22, s[8:11], 0 offen sc1
    s_cbranch_vccz B2_pg_ok
    s_waitcnt vmcnt(4)
    v_cmp_gt_u32 vcc, s22, v49
    buffer_load_dword v48, v22, s[8:11], 0 offen sc1
    s_cbranch_vccz B2_pg_ok
    s_waitcnt vmcnt(4)
    v_cmp_gt_u32 vcc, s22, v44
    buffer_load_dword v49, v22, s[8:11], 0 offen sc1
    s_cbranch_vccz B2_pg_ok
    s_waitcnt vmcnt(4)
    v_cmp_gt_u32 vcc, s22, v45
    buffer_load_dword v44, v22, s[8:11], 0 offen sc1
    s_cbranch_vccz B2_pg_ok
    s_waitcnt vmcnt(4)
    v_cmp_gt_u32 vcc, s22, v46
    buffer_load_dword v45, v22, s[8:11], 0 offen sc1
    s_cbranch_vccz B2_pg_ok
    s_waitcnt vmcnt(4)
    v_cmp_gt_u32 vcc, s22, v47
    buffer_load_dword v46, v22, s[8:11], 0 offen sc1
    s_cbranch_vccz B2_pg_ok
    s_waitcnt vmcnt(4)
    v_cmp_gt_u32 vcc, s22, v48
    buffer_load_dword v47, v22, s[8:11], 0 offen sc1
    s_cbranch_vccz B2_pg_ok
    s_waitcnt vmcnt(4)
    v_cmp_gt_u32 vcc, s22, v49
    buffer_load_dword v48, v22, s[8:11], 0 offen sc1
    s_cbranch_vccz B2_pg_ok
    s_sub_u32 s23, s23, 1
    s_cbranch_scc0 B2_pg
    s_mov_b32 s23, 0
B2_pg_ok:
    s_cmp_lt_u32 s22, 63
    s_cbranch_scc1 B2_top
    s_add_u32 s27, s24, 2048
    s_add_u32 s28, s24, 6144
    s_add_u32 s29, s24, 3072
    s_mov_b32 s34, 18382848
    v_mov_b32 v21, 2147483632
    s_barrier
    buffer_load_dwordx4 v[28:31], v4, s[8:11], s27 offen sc1
    buffer_load_dwordx4 v[32:35], v4, s[8:11], s28 offen sc1
    buffer_load_dwordx4 v[36:39], v4, s[8:11], s29 offen sc1
    s_barrier
    buffer_store_dwordx4 v[162:165], v17, s[8:11], s34 offen offset:0 sc1
    buffer_store_dwordx4 v[170:173], v17, s[8:11], s34 offen offset:256 sc1
    s_mov_b32 s34, 18497536
    s_waitcnt vmcnt(2)
    s_branch Bfol2_chk
B2_fix:
    buffer_load_dwordx4 v[28:31], v4, s[8:11], s27 offen sc1
    buffer_load_dwordx4 v[32:35], v4, s[8:11], s28 offen sc1
    buffer_load_dwordx4 v[36:39], v4, s[8:11], s29 offen sc1
    s_nop 3
    v_mov_b64 v[56:57], 0
    v_mov_b64 v[58:59], 0
    v_mov_b64 v[60:61], 0
    v_mov_b64 v[62:63], 0
    v_mov_b64 v[64:65], 0
    v_mov_b64 v[66:67], 0
    v_mov_b64 v[68:69], 0
    v_mov_b64 v[70:71], 0
    v_mov_b64 v[72:73], 0
    v_mov_b64 v[74:75], 0
    v_mov_b64 v[76:77], 0
    v_mov_b64 v[78:79], 0
    v_mov_b64 v[80:81], 0
    v_mov_b64 v[82:83], 0
    v_mov_b64 v[84:85], 0
    v_mov_b64 v[86:87], 0
    s_waitcnt vmcnt(0)
    s_sub_u32 s23, s23, 1
    s_cbranch_scc0 B2_retry
    s_branch B_done
B2_fixP:
    buffer_load_dwordx4 v[28:31], v15, s[8:11], s25 offen offset:0 sc1
    buffer_load_dwordx4 v[32:35], v15, s[8:11], s25 offen offset:1024 sc1
    v_mov_b64 v[174:175], 0
    v_mov_b64 v[176:177], 0
    v_mov_b64 v[178:179], 0
    v_mov_b64 v[180:181], 0
    s_sub_u32 s23, s23, 1
    s_cbranch_scc0 B2_backP
    s_branch B_done
.p2align 6
B3_top:
    s_add_u32 s27, s24, 3072
    s_add_u32 s28, s24, 1024
    s_add_u32 s29, s24, 4096
    s_add_u32 s26, s31, 4096
    s_barrier
    buffer_load_dwordx4 v[28:31], v4, s[8:11], s27 offen sc1
    ds_read_b128 v[120:123], v6 offset:0
    ds_read_b128 v[124:127], v6 offset:1024
    ds_read_b128 v[128:131], v6 offset:2048
    ds_read_b128 v[132:135], v6 offset:3072
    s_barrier
    buffer_load_dwordx4 v[32:35], v4, s[8:11], s28 offen sc1
    ds_read_b128 v[136:139], v6 offset:4096
    ds_read_b128 v[140:143], v6 offset:5120
    ds_read_b128 v[144:147], v6 offset:6144
    ds_read_b128 v[148:151], v6 offset:7168
    s_barrier
    buffer_load_dwordx4 v[88:91], v14, s[8:11], s31 offen offset:0 sc1
    buffer_load_dwordx4 v[96:99], v14, s[8:11], s31 offen offset:256 sc1
    buffer_load_dwordx4 v[92:95], v14, s[8:11], s31 offen offset:2048 sc1
    s_waitcnt vmcnt(4)
B3_retry:
    v_smfmac_f32_16x16x64_bf16 v[56:59], v[28:31], a[0:7], v3
    ds_write_b128 v7, v[28:31] offset:3072
    v_smfmac_f32_16x16x64_bf16 v[60:63], v[28:31], a[8:15], v3
    buffer_load_dwordx4 v[100:103], v14, s[8:11], s31 offen offset:2304 sc1
    v_smfmac_f32_16x16x64_bf16 v[64:67], v[28:31], a[16:23], v3
    buffer_load_dwordx4 v[104:107], v14, s[8:11], s26 offen offset:0 sc1
    v_smfmac_f32_16x16x64_bf16 v[68:71], v[28:31], a[24:31], v3
    buffer_load_dwordx4 v[112:115], v14, s[8:11], s26 offen offset:256 sc1
    v_smfmac_f32_16x16x64_bf16 v[72:75], v[28:31], a[32:39], v3
    s_waitcnt vmcnt(6)
    v_smfmac_f32_16x16x64_bf16 v[76:79], v[28:31], a[40:47], v3
    buffer_load_dwordx4 v[108:111], v14, s[8:11], s26 offen offset:2048 sc1
    v_smfmac_f32_16x16x64_bf16 v[80:83], v[28:31], a[48:55], v3
    buffer_load_dwordx4 v[116:119], v14, s[8:11], s26 offen offset:2304 sc1
    v_smfmac_f32_16x16x64_bf16 v[84:87], v[28:31], a[56:63], v3
    v_max_u32 v23, v28, v29
    v_smfmac_f32_16x16x64_bf16 v[56:59], v[32:35], a[64:71], v3
    v_max3_u32 v23, v30, v31, v23
    v_smfmac_f32_16x16x64_bf16 v[60:63], v[32:35], a[72:79], v3
    v_max3_u32 v23, v32, v33, v23
    v_smfmac_f32_16x16x64_bf16 v[64:67], v[32:35], a[80:87], v3
    v_max3_u32 v23, v34, v35, v23
    v_smfmac_f32_16x16x64_bf16 v[68:71], v[32:35], a[88:95], v3
    v_cmp_eq_u32 vcc, -1, v23
    v_smfmac_f32_16x16x64_bf16 v[72:75], v[32:35], a[96:103], v3
    v_smfmac_f32_16x16x64_bf16 v[76:79], v[32:35], a[104:111], v3
    s_cbranch_vccnz B3_fix
    s_waitcnt lgkmcnt(0)
    s_barrier
    ds_read_b128 v[36:39], v7 offset:4096
    v_smfmac_f32_16x16x64_bf16 v[80:83], v[32:35], a[112:119], v3
    ds_read_b128 v[40:43], v7 offset:5120
    v_smfmac_f32_16x16x64_bf16 v[84:87], v[32:35], a[120:127], v3
    ds_read_b128 v[48:51], v7 offset:0
    s_waitcnt lgkmcnt(2)
    v_smfmac_f32_16x16x64_bf16 v[56:59], v[36:39], a[128:135], v3
    ds_read_b128 v[44:47], v7 offset:6144
    v_smfmac_f32_16x16x64_bf16 v[60:63], v[36:39], a[136:143], v3
    ds_read_b128 v[52:55], v7 offset:2048
    v_smfmac_f32_16x16x64_bf16 v[64:67], v[36:39], a[144:151], v3
    v_smfmac_f32_16x16x64_bf16 v[68:71], v[36:39], a[152:159], v3
    v_smfmac_f32_16x16x64_bf16 v[72:75], v[36:39], a[160:167], v3
    v_smfmac_f32_16x16x64_bf16 v[76:79], v[36:39], a[168:175], v3
    v_smfmac_f32_16x16x64_bf16 v[80:83], v[36:39], a[176:183], v3
    v_smfmac_f32_16x16x64_bf16 v[84:87], v[36:39], a[184:191], v3
    s_waitcnt lgkmcnt(0)
    v_smfmac_f32_16x16x64_bf16 v[56:59], v[40:43], a[192:199], v3
    s_nop 2
    v_smfmac_f32_16x16x64_bf16 v[56:59], v[48:51], v[120:127], v3
    s_nop 1
    ds_read_b128 v[120:123], v6 offset:8192
    v_smfmac_f32_16x16x64_bf16 v[56:59], v[44:47], v[190:197], v3
    s_nop 1
    ds_read_b128 v[124:127], v6 offset:9216
    v_smfmac_f32_16x16x64_bf16 v[56:59], v[52:55], v[128:135], v3
    s_nop 1
    ds_read_b128 v[128:131], v6 offset:10240
    v_smfmac_f32_16x16x64_bf16 v[60:63], v[40:43], a[200:207], v3
    s_nop 1
    ds_read_b128 v[132:135], v6 offset:11264
    v_smfmac_f32_16x16x64_bf16 v[60:63], v[48:51], v[136:143], v3
    s_nop 0
    ds_read_b128 v[136:139], v6 offset:12288
    v_add_f32 v56, v56, v57
    v_smfmac_f32_16x16x64_bf16 v[60:63], v[44:47], v[198:205], v3
    s_nop 0
    ds_read_b128 v[140:143], v6 offset:13312
    v_add_f32 v58, v58, v59
    v_smfmac_f32_16x16x64_bf16 v[60:63], v[52:55], v[144:151], v3
    s_nop 0
    ds_read_b128 v[144:147], v6 offset:14336
    v_cvt_pk_bf16_f32 v162, v56, v58
    v_smfmac_f32_16x16x64_bf16 v[64:67], v[40:43], a[208:215], v3
    s_nop 0
    s_waitcnt lgkmcnt(5)
    ds_read_b128 v[148:151], v6 offset:15360
    v_smfmac_f32_16x16x64_bf16 v[64:67], v[48:51], v[120:127], v3
    s_nop 0
    ds_read_b128 v[120:123], v6 offset:16384
    v_add_f32 v60, v60, v61
    v_smfmac_f32_16x16x64_bf16 v[64:67], v[44:47], v[206:213], v3
    s_waitcnt lgkmcnt(5)
    ds_read_b128 v[124:127], v6 offset:17408
    v_add_f32 v62, v62, v63
    v_smfmac_f32_16x16x64_bf16 v[64:67], v[52:55], v[128:135], v3
    s_nop 0
    ds_read_b128 v[128:131], v6 offset:18432
    v_cvt_pk_bf16_f32 v170, v60, v62
    v_smfmac_f32_16x16x64_bf16 v[68:71], v[40:43], a[216:223], v3
    s_nop 0
    s_waitcnt lgkmcnt(5)
    ds_read_b128 v[132:135], v6 offset:19456
    v_smfmac_f32_16x16x64_bf16 v[68:71], v[48:51], v[136:143], v3
    s_nop 0
    ds_read_b128 v[136:139], v6 offset:20480
    v_add_f32 v64, v64, v65
    v_smfmac_f32_16x16x64_bf16 v[68:71], v[44:47], v[214:221], v3
    s_waitcnt lgkmcnt(5)
    ds_read_b128 v[140:143], v6 offset:21504
    v_add_f32 v66, v66, v67
    v_smfmac_f32_16x16x64_bf16 v[68:71], v[52:55], v[144:151], v3
    s_nop 0
    ds_read_b128 v[144:147], v6 offset:22528
    v_cvt_pk_bf16_f32 v163, v64, v66
    v_smfmac_f32_16x16x64_bf16 v[72:75], v[40:43], a[224:231], v3
    s_nop 0
    s_waitcnt lgkmcnt(5)
    ds_read_b128 v[148:151], v6 offset:23552
    v_smfmac_f32_16x16x64_bf16 v[72:75], v[48:51], v[120:127], v3
    s_nop 0
    ds_read_b128 v[120:123], v6 offset:24576
    v_add_f32 v68, v68, v69
    v_smfmac_f32_16x16x64_bf16 v[72:75], v[44:47], v[222:229], v3
    s_waitcnt lgkmcnt(5)
    ds_read_b128 v[124:127], v6 offset:25600
    v_add_f32 v70, v70, v71
    v_smfmac_f32_16x16x64_bf16 v[72:75], v[52:55], v[128:135], v3
    s_nop 0
    ds_read_b128 v[128:131], v6 offset:26624
    v_cvt_pk_bf16_f32 v171, v68, v70
    v_smfmac_f32_16x16x64_bf16 v[76:79], v[40:43], a[232:239], v3
    s_nop 0
    s_waitcnt lgkmcnt(5)
    ds_read_b128 v[132:135], v6 offset:27648
    v_smfmac_f32_16x16x64_bf16 v[76:79], v[48:51], v[136:143], v3
    s_nop 0
    ds_read_b128 v[136:139], v6 offset:28672
    v_add_f32 v72, v72, v73
    v_smfmac_f32_16x16x64_bf16 v[76:79], v[44:47], v[230:237], v3
    s_waitcnt lgkmcnt(5)
    ds_read_b128 v[140:143], v6 offset:29696
    v_add_f32 v74, v74, v75
    v_smfmac_f32_16x16x64_bf16 v[76:79], v[52:55], v[144:151], v3
    s_nop 0
    ds_read_b128 v[144:147], v6 offset:30720
    v_cvt_pk_bf16_f32 v164, v72, v74
    v_smfmac_f32_16x16x64_bf16 v[80:83], v[40:43], a[240:247], v3
    s_nop 0
    s_waitcnt lgkmcnt(5)
    ds_read_b128 v[148:151], v6 offset:31744
    v_smfmac_f32_16x16x64_bf16 v[80:83], v[48:51], v[120:127], v3
    s_nop 1
    v_add_f32 v76, v76, v77
    v_smfmac_f32_16x16x64_bf16 v[80:83], v[44:47], v[238:245], v3
    s_nop 0
    s_waitcnt lgkmcnt(4)
    v_add_f32 v78, v78, v79
    v_smfmac_f32_16x16x64_bf16 v[80:83], v[52:55], v[128:135], v3
    s_nop 1
    v_cvt_pk_bf16_f32 v172, v76, v78
    v_smfmac_f32_16x16x64_bf16 v[84:87], v[40:43], a[248:255], v3
    s_nop 1
    s_waitcnt lgkmcnt(2)
    v_smfmac_f32_16x16x64_bf16 v[84:87], v[48:51], v[136:143], v3
    s_nop 1
    v_add_f32 v80, v80, v81
    v_smfmac_f32_16x16x64_bf16 v[84:87], v[44:47], v[246:253], v3
    s_nop 0
    s_waitcnt lgkmcnt(0)
    v_add_f32 v82, v82, v83
    v_smfmac_f32_16x16x64_bf16 v[84:87], v[52:55], v[144:151], v3
    s_nop 1
    v_cvt_pk_bf16_f32 v165, v80, v82
    v_mov_b64 v[174:175], 0
    v_mov_b64 v[176:177], 0
    v_mov_b64 v[178:179], 0
    v_mov_b64 v[180:181], 0
    s_add_u32 s22, s22, 1
    s_nop 0
    v_add_f32 v84, v84, v85
    v_add_f32 v86, v86, v87
    v_cvt_pk_bf16_f32 v173, v84, v86
    v_mov_b32 v20, s22
    v_mfma_f32_32x32x16_bf16 v[56:71], v[182:185], v[182:185], 0
    v_mfma_f32_32x32x16_bf16 v[72:87], v[182:185], v[182:185], 0
    s_barrier
    s_and_b32 s26, s22, 7
    s_mul_i32 s26, s26, 7168
    s_add_u32 s24, s26, 18284544
    buffer_load_dwordx4 v[28:31], v15, s[8:11], s25 offen offset:1024 sc1
    s_barrier
    s_barrier
    buffer_load_dwordx4 v[32:35], v15, s[8:11], s25 offen offset:0 sc1
    buffer_load_dwordx4 v[36:39], v16, s[8:11], s25 offen offset:0 sc1
    buffer_load_dwordx4 v[40:43], v16, s[8:11], s25 offen offset:1024 sc1
    s_add_u32 s26, s22, 5
    s_and_b32 s26, s26, 7
    s_mul_i32 s26, s26, 7168
    s_add_u32 s32, s26, 18284544
    s_add_u32 s31, s31, 458752
    ds_read_b128 v[120:123], v19 offset:0
    ds_read_b128 v[128:131], v19 offset:1024
    ds_read_b128 v[124:127], v19 offset:2048
    ds_read_b128 v[132:135], v19 offset:3072
    ds_read_b128 v[158:161], v19 offset:4096
    ds_read_b128 v[166:169], v19 offset:5120
    s_waitcnt lgkmcnt(0)
B3_backP:
    s_waitcnt vmcnt(3)
    v_smfmac_f32_16x16x64_bf16 v[174:177], v[28:31], v[104:111], v3
    v_max3_u32 v23, v28, v29, v30
    v_smfmac_f32_16x16x64_bf16 v[178:181], v[28:31], v[112:119], v3
    v_max3_u32 v23, v30, v31, v23
    s_waitcnt vmcnt(2)
    v_smfmac_f32_16x16x64_bf16 v[174:177], v[32:35], v[88:95], v3
    buffer_store_dword v20, v12, s[8:11], 0 offen
    v_max3_u32 v23, v32, v33, v23
    v_smfmac_f32_16x16x64_bf16 v[178:181], v[32:35], v[96:103], v3
    v_max3_u32 v23, v34, v35, v23
    s_waitcnt vmcnt(2)
    v_smfmac_f32_16x16x64_bf16 v[174:177], v[36:39], v[120:127], v3
    v_max3_u32 v23, v36, v37, v23
    v_smfmac_f32_16x16x64_bf16 v[178:181], v[36:39], v[128:135], v3
    v_max3_u32 v23, v38, v39, v23
    s_waitcnt vmcnt(1)
    v_smfmac_f32_16x16x64_bf16 v[174:177], v[40:43], v[158:165], v3
    s_nop 1
    v_max3_u32 v23, v40, v41, v23
    v_smfmac_f32_16x16x64_bf16 v[178:181], v[40:43], v[166:173], v3
    s_barrier
    ds_read_b128 v[44:47], v9 offset:0
    ds_read_b128 v[48:51], v9 offset:1024
    ds_read_b128 v[52:55], v9 offset:2048
    v_max3_u32 v23, v42, v43, v23
    v_cmp_eq_u32 vcc, -1, v23
B3_own:
    v_add_f32 v136, v174, v175
    v_add_f32 v138, v176, v177
    v_add_f32 v137, v178, v179
    v_add_f32 v139, v180, v181
    s_cbranch_vccnz B3_fixP
B3_backS:
    s_waitcnt lgkmcnt(2)
    v_pk_add_f32 v[44:45], v[44:45], v[136:137]
    v_pk_add_f32 v[46:47], v[46:47], v[138:139]
    s_waitcnt lgkmcnt(1)
    v_pk_add_f32 v[48:49], v[48:49], v[44:45]
    v_pk_add_f32 v[50:51], v[50:51], v[46:47]
    s_waitcnt lgkmcnt(0)
    v_pk_add_f32 v[52:53], v[52:53], v[48:49]
    v_pk_add_f32 v[54:55], v[54:55], v[50:51]
    v_cvt_pk_bf16_f32 v156, v52, v53
    v_cvt_pk_bf16_f32 v157, v54, v55
    buffer_store_dword v156, v10, s[8:11], s24 offen offset:0
    buffer_store_dword v157, v10, s[8:11], s24 offen offset:32
    v_max_u32 v23, v156, v157
    v_cmp_eq_u32 vcc, -1, v23
    s_and_b32 s26, s22, 3
    s_mul_i32 s26, s26, 10240
    s_add_u32 s25, s26, 18341888
    s_cbranch_vccnz B3_fixS
    s_cmp_lt_u32 s22, 63
    s_cbranch_scc1 B3_top
    s_lshl_b32 s26, s20, 9
    s_sub_u32 s27, 142336, s26
    v_add_u32 v23, s27, v10
    v_lshrrev_b32 v24, 1, v4
    v_add_u32 v25, 142336, v24
    ds_write2_b32 v23, v156, v157 offset0:0 offset1:8
    ds_read_b64 v[156:157], v25
    s_add_u32 s26, s26, 18277376
    s_waitcnt lgkmcnt(0)
    buffer_store_dwordx2 v[156:157], v24, s[8:11], s26 offen sc1
    s_add_u32 s27, s24, 3072
    s_add_u32 s28, s24, 1024
    s_add_u32 s29, s24, 4096
    s_mov_b32 s34, 18382848
    v_mov_b32 v21, 2147483632
    s_barrier
    buffer_load_dwordx4 v[28:31], v4, s[8:11], s27 offen sc1
    buffer_load_dwordx4 v[32:35], v4, s[8:11], s28 offen sc1
    buffer_load_dwordx4 v[36:39], v4, s[8:11], s29 offen sc1
    s_barrier
    buffer_store_dwordx4 v[162:165], v17, s[8:11], s34 offen offset:0 sc1
    buffer_store_dwordx4 v[170:173], v17, s[8:11], s34 offen offset:256 sc1
    ds_read_b128 v[120:123], v6 offset:0
    ds_read_b128 v[124:127], v6 offset:1024
    ds_read_b128 v[128:131], v6 offset:2048
    ds_read_b128 v[132:135], v6 offset:3072
    ds_read_b128 v[136:139], v6 offset:4096
    ds_read_b128 v[140:143], v6 offset:5120
    ds_read_b128 v[144:147], v6 offset:6144
    ds_read_b128 v[148:151], v6 offset:7168
    s_mov_b32 s34, 18497536
    s_waitcnt vmcnt(2)
    s_branch Bfol3_chk
B3_fix:
    buffer_load_dwordx4 v[28:31], v4, s[8:11], s27 offen sc1
    buffer_load_dwordx4 v[32:35], v4, s[8:11], s28 offen sc1
    buffer_load_dwordx4 v[36:39], v4, s[8:11], s29 offen sc1
    s_nop 3
    v_mov_b64 v[56:57], 0
    v_mov_b64 v[58:59], 0
    v_mov_b64 v[60:61], 0
    v_mov_b64 v[62:63], 0
    v_mov_b64 v[64:65], 0
    v_mov_b64 v[66:67], 0
    v_mov_b64 v[68:69], 0
    v_mov_b64 v[70:71], 0
    v_mov_b64 v[72:73], 0
    v_mov_b64 v[74:75], 0
    v_mov_b64 v[76:77], 0
    v_mov_b64 v[78:79], 0
    v_mov_b64 v[80:81], 0
    v_mov_b64 v[82:83], 0
    v_mov_b64 v[84:85], 0
    v_mov_b64 v[86:87], 0
    s_waitcnt vmcnt(0)
    s_sub_u32 s23, s23, 1
    s_cbranch_scc0 B3_retry
    s_branch B_done
B3_fixS:
    ds_read_b128 v[44:47], v9 offset:0
    ds_read_b128 v[48:51], v9 offset:1024
    ds_read_b128 v[52:55], v9 offset:2048
    s_sub_u32 s23, s23, 1
    s_cbranch_scc0 B3_backS
    s_branch B_done
B3_fixP:
    buffer_load_dwordx4 v[28:31], v15, s[8:11], s25 offen offset:1024 sc1
    buffer_load_dwordx4 v[32:35], v15, s[8:11], s25 offen offset:0 sc1
    buffer_load_dwordx4 v[36:39], v16, s[8:11], s25 offen offset:0 sc1
    buffer_load_dwordx4 v[40:43], v16, s[8:11], s25 offen offset:1024 sc1
    v_mov_b64 v[174:175], 0
    v_mov_b64 v[176:177], 0
    v_mov_b64 v[178:179], 0
    v_mov_b64 v[180:181], 0
    s_sub_u32 s23, s23, 1
    s_cbranch_scc1 B_done
    s_waitcnt vmcnt(0)
    v_smfmac_f32_16x16x64_bf16 v[174:177], v[28:31], v[104:111], v3
    v_smfmac_f32_16x16x64_bf16 v[178:181], v[28:31], v[112:119], v3
    v_smfmac_f32_16x16x64_bf16 v[174:177], v[32:35], v[88:95], v3
    v_smfmac_f32_16x16x64_bf16 v[178:181], v[32:35], v[96:103], v3
    v_smfmac_f32_16x16x64_bf16 v[174:177], v[36:39], v[120:127], v3
    v_smfmac_f32_16x16x64_bf16 v[178:181], v[36:39], v[128:135], v3
    v_smfmac_f32_16x16x64_bf16 v[174:177], v[40:43], v[158:165], v3
    v_smfmac_f32_16x16x64_bf16 v[178:181], v[40:43], v[166:173], v3
    v_max3_u32 v23, v28, v29, v30
    v_max3_u32 v23, v30, v31, v23
    v_max3_u32 v23, v32, v33, v23
    v_max3_u32 v23, v34, v35, v23
    v_max3_u32 v23, v36, v37, v23
    v_max3_u32 v23, v38, v39, v23
    v_max3_u32 v23, v40, v41, v23
    v_max3_u32 v23, v42, v43, v23
    v_cmp_eq_u32 vcc, -1, v23
    s_branch B3_own
.p2align 6
Bsc10_top:
    s_add_u32 s27, s24, 0
    s_add_u32 s28, s24, 4096
    s_add_u32 s29, s24, 1024
    s_add_u32 s26, s31, 4096
    s_barrier
    buffer_load_dwordx4 v[28:31], v4, s[8:11], s27 offen sc1
    ds_write_b128 v8, v[152:155]
    s_barrier
    buffer_load_dwordx4 v[32:35], v4, s[8:11], s28 offen sc1
    s_barrier
    buffer_load_dwordx4 v[88:91], v14, s[8:11], s31 offen offset:0 sc1
    buffer_load_dwordx4 v[96:99], v14, s[8:11], s31 offen offset:256 sc1
    buffer_load_dwordx4 v[92:95], v14, s[8:11], s31 offen offset:2048 sc1
    s_waitcnt vmcnt(4)
Bsc10_retry:
    v_smfmac_f32_16x16x64_bf16 v[56:59], v[28:31], a[0:7], v3
    ds_write_b128 v7, v[28:31] offset:0
    v_smfmac_f32_16x16x64_bf16 v[60:63], v[28:31], a[8:15], v3
    buffer_load_dwordx4 v[100:103], v14, s[8:11], s31 offen offset:2304 sc1
    v_smfmac_f32_16x16x64_bf16 v[64:67], v[28:31], a[16:23], v3
    buffer_load_dwordx4 v[104:107], v14, s[8:11], s26 offen offset:0 sc1
    v_smfmac_f32_16x16x64_bf16 v[68:71], v[28:31], a[24:31], v3
    buffer_load_dwordx4 v[112:115], v14, s[8:11], s26 offen offset:256 sc1
    v_smfmac_f32_16x16x64_bf16 v[72:75], v[28:31], a[32:39], v3
    s_waitcnt vmcnt(6)
    ds_write_b128 v7, v[32:35] offset:4096
    v_smfmac_f32_16x16x64_bf16 v[76:79], v[28:31], a[40:47], v3
    buffer_load_dwordx4 v[108:111], v14, s[8:11], s26 offen offset:2048 sc1
    v_smfmac_f32_16x16x64_bf16 v[80:83], v[28:31], a[48:55], v3
    buffer_load_dwordx4 v[116:119], v14, s[8:11], s26 offen offset:2304 sc1
    v_smfmac_f32_16x16x64_bf16 v[84:87], v[28:31], a[56:63], v3
    v_max_u32 v23, v28, v29
    v_smfmac_f32_16x16x64_bf16 v[56:59], v[32:35], a[64:71], v3
    v_max3_u32 v23, v30, v31, v23
    v_smfmac_f32_16x16x64_bf16 v[60:63], v[32:35], a[72:79], v3
    v_max3_u32 v23, v32, v33, v23
    v_smfmac_f32_16x16x64_bf16 v[64:67], v[32:35], a[80:87], v3
    v_max3_u32 v23, v34, v35, v23
    v_smfmac_f32_16x16x64_bf16 v[68:71], v[32:35], a[88:95], v3
    v_cmp_eq_u32 vcc, -1, v23
    v_smfmac_f32_16x16x64_bf16 v[72:75], v[32:35], a[96:103], v3
    v_smfmac_f32_16x16x64_bf16 v[76:79], v[32:35], a[104:111], v3
    s_cbranch_vccnz Bsc10_fix
    s_waitcnt lgkmcnt(0)
    s_barrier
    ds_read_b128 v[36:39], v7 offset:1024
    v_smfmac_f32_16x16x64_bf16 v[80:83], v[32:35], a[112:119], v3
    ds_read_b128 v[40:43], v7 offset:2048
    v_smfmac_f32_16x16x64_bf16 v[84:87], v[32:35], a[120:127], v3
    ds_read_b128 v[48:51], v7 offset:5120
    s_waitcnt lgkmcnt(2)
    v_smfmac_f32_16x16x64_bf16 v[56:59], v[36:39], a[128:135], v3
    ds_read_b128 v[44:47], v7 offset:3072
    v_smfmac_f32_16x16x64_bf16 v[60:63], v[36:39], a[136:143], v3
    ds_read_b128 v[52:55], v7 offset:6144
    v_smfmac_f32_16x16x64_bf16 v[64:67], v[36:39], a[144:151], v3
    v_smfmac_f32_16x16x64_bf16 v[68:71], v[36:39], a[152:159], v3
    v_smfmac_f32_16x16x64_bf16 v[72:75], v[36:39], a[160:167], v3
    v_smfmac_f32_16x16x64_bf16 v[76:79], v[36:39], a[168:175], v3
    buffer_store_dword v18, v10, s[8:11], s32 offen sc1
    v_smfmac_f32_16x16x64_bf16 v[80:83], v[36:39], a[176:183], v3
    v_smfmac_f32_16x16x64_bf16 v[84:87], v[36:39], a[184:191], v3
    s_waitcnt lgkmcnt(0)
    v_smfmac_f32_16x16x64_bf16 v[56:59], v[40:43], a[192:199], v3
    s_nop 2
    v_smfmac_f32_16x16x64_bf16 v[56:59], v[48:51], v[120:127], v3
    s_nop 1
    ds_read_b128 v[120:123], v6 offset:8192
    v_smfmac_f32_16x16x64_bf16 v[56:59], v[44:47], v[190:197], v3
    s_nop 1
    ds_read_b128 v[124:127], v6 offset:9216
    v_smfmac_f32_16x16x64_bf16 v[56:59], v[52:55], v[128:135], v3
    s_nop 1
    ds_read_b128 v[128:131], v6 offset:10240
    v_smfmac_f32_16x16x64_bf16 v[60:63], v[40:43], a[200:207], v3
    s_nop 1
    ds_read_b128 v[132:135], v6 offset:11264
    v_smfmac_f32_16x16x64_bf16 v[60:63], v[48:51], v[136:143], v3
    s_nop 0
    ds_read_b128 v[136:139], v6 offset:12288
    v_add_f32 v56, v56, v57
    v_smfmac_f32_16x16x64_bf16 v[60:63], v[44:47], v[198:205], v3
    s_nop 0
    ds_read_b128 v[140:143], v6 offset:13312
    v_add_f32 v58, v58, v59
    v_smfmac_f32_16x16x64_bf16 v[60:63], v[52:55], v[144:151], v3
    s_nop 0
    ds_read_b128 v[144:147], v6 offset:14336
    v_cvt_pk_bf16_f32 v162, v56, v58
    v_smfmac_f32_16x16x64_bf16 v[64:67], v[40:43], a[208:215], v3
    s_nop 0
    s_waitcnt lgkmcnt(5)
    ds_read_b128 v[148:151], v6 offset:15360
    v_smfmac_f32_16x16x64_bf16 v[64:67], v[48:51], v[120:127], v3
    s_nop 0
    ds_read_b128 v[120:123], v6 offset:16384
    v_add_f32 v60, v60, v61
    v_smfmac_f32_16x16x64_bf16 v[64:67], v[44:47], v[206:213], v3
    s_waitcnt lgkmcnt(5)
    ds_read_b128 v[124:127], v6 offset:17408
    v_add_f32 v62, v62, v63
    v_smfmac_f32_16x16x64_bf16 v[64:67], v[52:55], v[128:135], v3
    s_nop 0
    ds_read_b128 v[128:131], v6 offset:18432
    v_cvt_pk_bf16_f32 v170, v60, v62
    v_smfmac_f32_16x16x64_bf16 v[68:71], v[40:43], a[216:223], v3
    s_nop 0
    s_waitcnt lgkmcnt(5)
    ds_read_b128 v[132:135], v6 offset:19456
    v_smfmac_f32_16x16x64_bf16 v[68:71], v[48:51], v[136:143], v3
    s_nop 0
    ds_read_b128 v[136:139], v6 offset:20480
    v_add_f32 v64, v64, v65
    v_smfmac_f32_16x16x64_bf16 v[68:71], v[44:47], v[214:221], v3
    s_waitcnt lgkmcnt(5)
    ds_read_b128 v[140:143], v6 offset:21504
    v_add_f32 v66, v66, v67
    v_smfmac_f32_16x16x64_bf16 v[68:71], v[52:55], v[144:151], v3
    s_nop 0
    ds_read_b128 v[144:147], v6 offset:22528
    v_cvt_pk_bf16_f32 v163, v64, v66
    v_smfmac_f32_16x16x64_bf16 v[72:75], v[40:43], a[224:231], v3
    s_nop 0
    s_waitcnt lgkmcnt(5)
    ds_read_b128 v[148:151], v6 offset:23552
    v_smfmac_f32_16x16x64_bf16 v[72:75], v[48:51], v[120:127], v3
    s_nop 0
    ds_read_b128 v[120:123], v6 offset:24576
    v_add_f32 v68, v68, v69
    v_smfmac_f32_16x16x64_bf16 v[72:75], v[44:47], v[222:229], v3
    s_waitcnt lgkmcnt(5)
    ds_read_b128 v[124:127], v6 offset:25600
    v_add_f32 v70, v70, v71
    v_smfmac_f32_16x16x64_bf16 v[72:75], v[52:55], v[128:135], v3
    s_nop 0
    ds_read_b128 v[128:131], v6 offset:26624
    v_cvt_pk_bf16_f32 v171, v68, v70
    v_smfmac_f32_16x16x64_bf16 v[76:79], v[40:43], a[232:239], v3
    s_nop 0
    s_waitcnt lgkmcnt(5)
    ds_read_b128 v[132:135], v6 offset:27648
    v_smfmac_f32_16x16x64_bf16 v[76:79], v[48:51], v[136:143], v3
    s_nop 0
    ds_read_b128 v[136:139], v6 offset:28672
    v_add_f32 v72, v72, v73
    v_smfmac_f32_16x16x64_bf16 v[76:79], v[44:47], v[230:237], v3
    s_waitcnt lgkmcnt(5)
    ds_read_b128 v[140:143], v6 offset:29696
    v_add_f32 v74, v74, v75
    v_smfmac_f32_16x16x64_bf16 v[76:79], v[52:55], v[144:151], v3
    s_nop 0
    ds_read_b128 v[144:147], v6 offset:30720
    v_cvt_pk_bf16_f32 v164, v72, v74
    v_smfmac_f32_16x16x64_bf16 v[80:83], v[40:43], a[240:247], v3
    s_nop 0
    s_waitcnt lgkmcnt(5)
    ds_read_b128 v[148:151], v6 offset:31744
    v_smfmac_f32_16x16x64_bf16 v[80:83], v[48:51], v[120:127], v3
    s_nop 1
    v_add_f32 v76, v76, v77
    v_smfmac_f32_16x16x64_bf16 v[80:83], v[44:47], v[238:245], v3
    s_nop 0
    s_waitcnt lgkmcnt(4)
    v_add_f32 v78, v78, v79
    v_smfmac_f32_16x16x64_bf16 v[80:83], v[52:55], v[128:135], v3
    s_nop 1
    v_cvt_pk_bf16_f32 v172, v76, v78
    v_smfmac_f32_16x16x64_bf16 v[84:87], v[40:43], a[248:255], v3
    s_nop 1
    s_waitcnt lgkmcnt(2)
    v_smfmac_f32_16x16x64_bf16 v[84:87], v[48:51], v[136:143], v3
    s_nop 1
    v_add_f32 v80, v80, v81
    v_smfmac_f32_16x16x64_bf16 v[84:87], v[44:47], v[246:253], v3
    s_nop 0
    s_waitcnt lgkmcnt(0)
    v_add_f32 v82, v82, v83
    v_smfmac_f32_16x16x64_bf16 v[84:87], v[52:55], v[144:151], v3
    s_nop 1
    v_cvt_pk_bf16_f32 v165, v80, v82
    v_mov_b64 v[174:175], 0
    v_mov_b64 v[176:177], 0
    v_mov_b64 v[178:179], 0
    v_mov_b64 v[180:181], 0
    s_add_u32 s22, s22, 1
    s_nop 0
    v_add_f32 v84, v84, v85
    v_add_f32 v86, v86, v87
    v_cvt_pk_bf16_f32 v173, v84, v86
    v_mov_b32 v20, s22
    v_mfma_f32_32x32x16_bf16 v[56:71], v[182:185], v[182:185], 0
    v_mfma_f32_32x32x16_bf16 v[72:87], v[182:185], v[182:185], 0
    ds_write_b128 v19, v[162:165] offset:0
    ds_write_b128 v19, v[170:173] offset:1024
    s_waitcnt lgkmcnt(0)
    s_nop 3
    buffer_load_dword v28, v13, s[8:11], 0 offen sc1
    s_nop 5
    buffer_load_dword v29, v13, s[8:11], 0 offen sc1
    s_nop 5
    buffer_load_dword v30, v13, s[8:11], 0 offen sc1
    s_nop 5
    buffer_load_dword v31, v13, s[8:11], 0 offen sc1
    s_nop 5
    buffer_load_dword v32, v13, s[8:11], 0 offen sc1
    s_nop 5
Bsc10_pf:
    s_waitcnt vmcnt(4)
    v_cmp_gt_u32 vcc, s22, v28
    buffer_load_dword v33, v13, s[8:11], 0 offen sc1
    s_cbranch_vccz Bsc10_pf_ok
    s_waitcnt vmcnt(4)
    v_cmp_gt_u32 vcc, s22, v29
    buffer_load_dword v28, v13, s[8:11], 0 offen sc1
    s_cbranch_vccz Bsc10_pf_ok
    s_waitcnt vmcnt(4)
    v_cmp_gt_u32 vcc, s22, v30
    buffer_load_dword v29, v13, s[8:11], 0 offen sc1
    s_cbranch_vccz Bsc10_pf_ok
    s_waitcnt vmcnt(4)
    v_cmp_gt_u32 vcc, s22, v31
    buffer_load_dword v30, v13, s[8:11], 0 offen sc1
    s_cbranch_vccz Bsc10_pf_ok
    s_waitcnt vmcnt(4)
    v_cmp_gt_u32 vcc, s22, v32
    buffer_load_dword v31, v13, s[8:11], 0 offen sc1
    s_cbranch_vccz Bsc10_pf_ok
    s_waitcnt vmcnt(4)
    v_cmp_gt_u32 vcc, s22, v33
    buffer_load_dword v32, v13, s[8:11], 0 offen sc1
    s_cbranch_vccz Bsc10_pf_ok
    s_waitcnt vmcnt(4)
    v_cmp_gt_u32 vcc, s22, v28
    buffer_load_dword v33, v13, s[8:11], 0 offen sc1
    s_cbranch_vccz Bsc10_pf_ok
    s_waitcnt vmcnt(4)
    v_cmp_gt_u32 vcc, s22, v29
    buffer_load_dword v28, v13, s[8:11], 0 offen sc1
    s_cbranch_vccz Bsc10_pf_ok
    s_waitcnt vmcnt(4)
    v_cmp_gt_u32 vcc, s22, v30
    buffer_load_dword v29, v13, s[8:11], 0 offen sc1
    s_cbranch_vccz Bsc10_pf_ok
    s_waitcnt vmcnt(4)
    v_cmp_gt_u32 vcc, s22, v31
    buffer_load_dword v30, v13, s[8:11], 0 offen sc1
    s_cbranch_vccz Bsc10_pf_ok
    s_waitcnt vmcnt(4)
    v_cmp_gt_u32 vcc, s22, v32
    buffer_load_dword v31, v13, s[8:11], 0 offen sc1
    s_cbranch_vccz Bsc10_pf_ok
    s_waitcnt vmcnt(4)
    v_cmp_gt_u32 vcc, s22, v33
    buffer_load_dword v32, v13, s[8:11], 0 offen sc1
    s_cbranch_vccz Bsc10_pf_ok
    s_sub_u32 s23, s23, 1
    s_cbranch_scc0 Bsc10_pf
    s_mov_b32 s23, 0
Bsc10_pf_ok:
    s_barrier
    s_and_b32 s26, s22, 7
    s_mul_i32 s26, s26, 7168
    s_add_u32 s24, s26, 18284544
    buffer_load_dwordx4 v[28:31], v15, s[8:11], s25 offen offset:0 sc1
    s_barrier
    buffer_load_dwordx4 v[32:35], v15, s[8:11], s25 offen offset:1024 sc1
    s_barrier
    ds_read_b128 v[120:123], v6 offset:0
    ds_read_b128 v[124:127], v6 offset:1024
    ds_read_b128 v[128:131], v6 offset:2048
    ds_read_b128 v[132:135], v6 offset:3072
    ds_read_b128 v[136:139], v6 offset:4096
    ds_read_b128 v[140:143], v6 offset:5120
    ds_read_b128 v[144:147], v6 offset:6144
    ds_read_b128 v[148:151], v6 offset:7168
    s_add_u32 s26, s22, 5
    s_and_b32 s26, s26, 7
    s_mul_i32 s26, s26, 7168
    s_add_u32 s32, s26, 18284544
    s_add_u32 s31, s31, 458752
Bsc10_backP:
    s_waitcnt vmcnt(1)
    v_smfmac_f32_16x16x64_bf16 v[174:177], v[28:31], v[88:95], v3
    v_max3_u32 v23, v28, v29, v30
    v_smfmac_f32_16x16x64_bf16 v[178:181], v[28:31], v[96:103], v3
    v_max3_u32 v23, v30, v31, v23
    s_waitcnt vmcnt(0)
    v_smfmac_f32_16x16x64_bf16 v[174:177], v[32:35], v[104:111], v3
    s_nop 1
    v_max3_u32 v23, v32, v33, v23
    v_smfmac_f32_16x16x64_bf16 v[178:181], v[32:35], v[112:119], v3
    s_nop 1
    v_max3_u32 v23, v34, v35, v23
    v_cmp_eq_u32 vcc, -1, v23
    v_add_f32 v40, v174, v175
    v_add_f32 v42, v176, v177
    s_nop 0
    s_cbranch_vccnz Bsc10_fixP
    v_add_f32 v41, v178, v179
    v_add_f32 v43, v180, v181
    ds_write_b128 v8, v[40:43]
    s_barrier
    s_and_b32 s26, s22, 3
    s_mul_i32 s26, s26, 10240
    s_add_u32 s25, s26, 18341888
    s_cmp_lt_u32 s22, 63
    s_cbranch_scc1 Bsc10_top
    s_add_u32 s27, s24, 0
    s_add_u32 s28, s24, 4096
    s_add_u32 s29, s24, 1024
    s_mov_b32 s34, 18382848
    v_mov_b32 v21, 2147483632
    s_barrier
    buffer_load_dwordx4 v[28:31], v4, s[8:11], s27 offen sc1
    buffer_load_dwordx4 v[32:35], v4, s[8:11], s28 offen sc1
    buffer_load_dwordx4 v[36:39], v4, s[8:11], s29 offen sc1
    s_barrier
    buffer_store_dwordx4 v[162:165], v17, s[8:11], s34 offen offset:0 sc1
    buffer_store_dwordx4 v[170:173], v17, s[8:11], s34 offen offset:256 sc1
    s_mov_b32 s34, 18497536
    s_waitcnt vmcnt(2)
    s_branch Bfol0_chk
Bsc10_fix:
    buffer_load_dwordx4 v[28:31], v4, s[8:11], s27 offen sc1
    buffer_load_dwordx4 v[32:35], v4, s[8:11], s28 offen sc1
    buffer_load_dwordx4 v[36:39], v4, s[8:11], s29 offen sc1
    s_nop 3
    v_mov_b64 v[56:57], 0
    v_mov_b64 v[58:59], 0
    v_mov_b64 v[60:61], 0
    v_mov_b64 v[62:63], 0
    v_mov_b64 v[64:65], 0
    v_mov_b64 v[66:67], 0
    v_mov_b64 v[68:69], 0
    v_mov_b64 v[70:71], 0
    v_mov_b64 v[72:73], 0
    v_mov_b64 v[74:75], 0
    v_mov_b64 v[76:77], 0
    v_mov_b64 v[78:79], 0
    v_mov_b64 v[80:81], 0
    v_mov_b64 v[82:83], 0
    v_mov_b64 v[84:85], 0
    v_mov_b64 v[86:87], 0
    s_waitcnt vmcnt(0)
    s_sub_u32 s23, s23, 1
    s_cbranch_scc0 Bsc10_retry
    s_branch B_done
Bsc10_fixP:
    buffer_load_dwordx4 v[28:31], v15, s[8:11], s25 offen offset:0 sc1
    buffer_load_dwordx4 v[32:35], v15, s[8:11], s25 offen offset:1024 sc1
    v_mov_b64 v[174:175], 0
    v_mov_b64 v[176:177], 0
    v_mov_b64 v[178:179], 0
    v_mov_b64 v[180:181], 0
    s_sub_u32 s23, s23, 1
    s_cbranch_scc0 Bsc10_backP
    s_branch B_done
.p2align 6
Bsc11_top:
    s_add_u32 s27, s24, 1024
    s_add_u32 s28, s24, 5120
    s_add_u32 s29, s24, 2048
    s_add_u32 s26, s31, 4096
    s_barrier
    buffer_load_dwordx4 v[28:31], v4, s[8:11], s27 offen sc1
    ds_write_b128 v8, v[152:155]
    s_barrier
    buffer_load_dwordx4 v[32:35], v4, s[8:11], s28 offen sc1
    s_barrier
    buffer_load_dwordx4 v[88:91], v14, s[8:11], s31 offen offset:0 sc1
    buffer_load_dwordx4 v[96:99], v14, s[8:11], s31 offen offset:256 sc1
    buffer_load_dwordx4 v[92:95], v14, s[8:11], s31 offen offset:2048 sc1
    s_waitcnt vmcnt(4)
Bsc11_retry:
    v_smfmac_f32_16x16x64_bf16 v[56:59], v[28:31], a[0:7], v3
    ds_write_b128 v7, v[28:31] offset:1024
    v_smfmac_f32_16x16x64_bf16 v[60:63], v[28:31], a[8:15], v3
    buffer_load_dwordx4 v[100:103], v14, s[8:11], s31 offen offset:2304 sc1
    v_smfmac_f32_16x16x64_bf16 v[64:67], v[28:31], a[16:23], v3
    buffer_load_dwordx4 v[104:107], v14, s[8:11], s26 offen offset:0 sc1
    v_smfmac_f32_16x16x64_bf16 v[68:71], v[28:31], a[24:31], v3
    buffer_load_dwordx4 v[112:115], v14, s[8:11], s26 offen offset:256 sc1
    v_smfmac_f32_16x16x64_bf16 v[72:75], v[28:31], a[32:39], v3
    s_waitcnt vmcnt(6)
    ds_write_b128 v7, v[32:35] offset:5120
    v_smfmac_f32_16x16x64_bf16 v[76:79], v[28:31], a[40:47], v3
    buffer_load_dwordx4 v[108:111], v14, s[8:11], s26 offen offset:2048 sc1
    v_smfmac_f32_16x16x64_bf16 v[80:83], v[28:31], a[48:55], v3
    buffer_load_dwordx4 v[116:119], v14, s[8:11], s26 offen offset:2304 sc1
    v_smfmac_f32_16x16x64_bf16 v[84:87], v[28:31], a[56:63], v3
    v_max_u32 v23, v28, v29
    v_smfmac_f32_16x16x64_bf16 v[56:59], v[32:35], a[64:71], v3
    v_max3_u32 v23, v30, v31, v23
    v_smfmac_f32_16x16x64_bf16 v[60:63], v[32:35], a[72:79], v3
    v_max3_u32 v23, v32, v33, v23
    v_smfmac_f32_16x16x64_bf16 v[64:67], v[32:35], a[80:87], v3
    v_max3_u32 v23, v34, v35, v23
    v_smfmac_f32_16x16x64_bf16 v[68:71], v[32:35], a[88:95], v3
    v_cmp_eq_u32 vcc, -1, v23
    v_smfmac_f32_16x16x64_bf16 v[72:75], v[32:35], a[96:103], v3
    v_smfmac_f32_16x16x64_bf16 v[76:79], v[32:35], a[104:111], v3
    s_cbranch_vccnz Bsc11_fix
    s_waitcnt lgkmcnt(0)
    s_barrier
    ds_read_b128 v[36:39], v7 offset:2048
    v_smfmac_f32_16x16x64_bf16 v[80:83], v[32:35], a[112:119], v3
    ds_read_b128 v[40:43], v7 offset:3072
    v_smfmac_f32_16x16x64_bf16 v[84:87], v[32:35], a[120:127], v3
    ds_read_b128 v[48:51], v7 offset:6144
    s_waitcnt lgkmcnt(2)
    v_smfmac_f32_16x16x64_bf16 v[56:59], v[36:39], a[128:135], v3
    ds_read_b128 v[44:47], v7 offset:4096
    v_smfmac_f32_16x16x64_bf16 v[60:63], v[36:39], a[136:143], v3
    ds_read_b128 v[52:55], v7 offset:0
    v_smfmac_f32_16x16x64_bf16 v[64:67], v[36:39], a[144:151], v3
    v_smfmac_f32_16x16x64_bf16 v[68:71], v[36:39], a[152:159], v3
    v_smfmac_f32_16x16x64_bf16 v[72:75], v[36:39], a[160:167], v3
    v_smfmac_f32_16x16x64_bf16 v[76:79], v[36:39], a[168:175], v3
    buffer_store_dword v18, v10, s[8:11], s32 offen sc1
    v_smfmac_f32_16x16x64_bf16 v[80:83], v[36:39], a[176:183], v3
    v_smfmac_f32_16x16x64_bf16 v[84:87], v[36:39], a[184:191], v3
    s_waitcnt lgkmcnt(0)
    v_smfmac_f32_16x16x64_bf16 v[56:59], v[40:43], a[192:199], v3
    s_nop 2
    v_smfmac_f32_16x16x64_bf16 v[56:59], v[48:51], v[120:127], v3
    s_nop 1
    ds_read_b128 v[120:123], v6 offset:8192
    v_smfmac_f32_16x16x64_bf16 v[56:59], v[44:47], v[190:197], v3
    s_nop 1
    ds_read_b128 v[124:127], v6 offset:9216
    v_smfmac_f32_16x16x64_bf16 v[56:59], v[52:55], v[128:135], v3
    s_nop 1
    ds_read_b128 v[128:131], v6 offset:10240
    v_smfmac_f32_16x16x64_bf16 v[60:63], v[40:43], a[200:207], v3
    s_nop 1
    ds_read_b128 v[132:135], v6 offset:11264
    v_smfmac_f32_16x16x64_bf16 v[60:63], v[48:51], v[136:143], v3
    s_nop 0
    ds_read_b128 v[136:139], v6 offset:12288
    v_add_f32 v56, v56, v57
    v_smfmac_f32_16x16x64_bf16 v[60:63], v[44:47], v[198:205], v3
    s_nop 0
    ds_read_b128 v[140:143], v6 offset:13312
    v_add_f32 v58, v58, v59
    v_smfmac_f32_16x16x64_bf16 v[60:63], v[52:55], v[144:151], v3
    s_nop 0
    ds_read_b128 v[144:147], v6 offset:14336
    v_cvt_pk_bf16_f32 v162, v56, v58
    v_smfmac_f32_16x16x64_bf16 v[64:67], v[40:43], a[208:215], v3
    s_nop 0
    s_waitcnt lgkmcnt(5)
    ds_read_b128 v[148:151], v6 offset:15360
    v_smfmac_f32_16x16x64_bf16 v[64:67], v[48:51], v[120:127], v3
    s_nop 0
    ds_read_b128 v[120:123], v6 offset:16384
    v_add_f32 v60, v60, v61
    v_smfmac_f32_16x16x64_bf16 v[64:67], v[44:47], v[206:213], v3
    s_waitcnt lgkmcnt(5)
    ds_read_b128 v[124:127], v6 offset:17408
    v_add_f32 v62, v62, v63
    v_smfmac_f32_16x16x64_bf16 v[64:67], v[52:55], v[128:135], v3
    s_nop 0
    ds_read_b128 v[128:131], v6 offset:18432
    v_cvt_pk_bf16_f32 v170, v60, v62
    v_smfmac_f32_16x16x64_bf16 v[68:71], v[40:43], a[216:223], v3
    s_nop 0
    s_waitcnt lgkmcnt(5)
    ds_read_b128 v[132:135], v6 offset:19456
    v_smfmac_f32_16x16x64_bf16 v[68:71], v[48:51], v[136:143], v3
    s_nop 0
    ds_read_b128 v[136:139], v6 offset:20480
    v_add_f32 v64, v64, v65
    v_smfmac_f32_16x16x64_bf16 v[68:71], v[44:47], v[214:221], v3
    s_waitcnt lgkmcnt(5)
    ds_read_b128 v[140:143], v6 offset:21504
    v_add_f32 v66, v66, v67
    v_smfmac_f32_16x16x64_bf16 v[68:71], v[52:55], v[144:151], v3
    s_nop 0
    ds_read_b128 v[144:147], v6 offset:22528
    v_cvt_pk_bf16_f32 v163, v64, v66
    v_smfmac_f32_16x16x64_bf16 v[72:75], v[40:43], a[224:231], v3
    s_nop 0
    s_waitcnt lgkmcnt(5)
    ds_read_b128 v[148:151], v6 offset:23552
    v_smfmac_f32_16x16x64_bf16 v[72:75], v[48:51], v[120:127], v3
    s_nop 0
    ds_read_b128 v[120:123], v6 offset:24576
    v_add_f32 v68, v68, v69
    v_smfmac_f32_16x16x64_bf16 v[72:75], v[44:47], v[222:229], v3
    s_waitcnt lgkmcnt(5)
    ds_read_b128 v[124:127], v6 offset:25600
    v_add_f32 v70, v70, v71
    v_smfmac_f32_16x16x64_bf16 v[72:75], v[52:55], v[128:135], v3
    s_nop 0
    ds_read_b128 v[128:131], v6 offset:26624
    v_cvt_pk_bf16_f32 v171, v68, v70
    v_smfmac_f32_16x16x64_bf16 v[76:79], v[40:43], a[232:239], v3
    s_nop 0
    s_waitcnt lgkmcnt(5)
    ds_read_b128 v[132:135], v6 offset:27648
    v_smfmac_f32_16x16x64_bf16 v[76:79], v[48:51], v[136:143], v3
    s_nop 0
    ds_read_b128 v[136:139], v6 offset:28672
    v_add_f32 v72, v72, v73
    v_smfmac_f32_16x16x64_bf16 v[76:79], v[44:47], v[230:237], v3
    s_waitcnt lgkmcnt(5)
    ds_read_b128 v[140:143], v6 offset:29696
    v_add_f32 v74, v74, v75
    v_smfmac_f32_16x16x64_bf16 v[76:79], v[52:55], v[144:151], v3
    s_nop 0
    ds_read_b128 v[144:147], v6 offset:30720
    v_cvt_pk_bf16_f32 v164, v72, v74
    v_smfmac_f32_16x16x64_bf16 v[80:83], v[40:43], a[240:247], v3
    s_nop 0
    s_waitcnt lgkmcnt(5)
    ds_read_b128 v[148:151], v6 offset:31744
    v_smfmac_f32_16x16x64_bf16 v[80:83], v[48:51], v[120:127], v3
    s_nop 1
    v_add_f32 v76, v76, v77
    v_smfmac_f32_16x16x64_bf16 v[80:83], v[44:47], v[238:245], v3
    s_nop 0
    s_waitcnt lgkmcnt(4)
    v_add_f32 v78, v78, v79
    v_smfmac_f32_16x16x64_bf16 v[80:83], v[52:55], v[128:135], v3
    s_nop 1
    v_cvt_pk_bf16_f32 v172, v76, v78
    v_smfmac_f32_16x16x64_bf16 v[84:87], v[40:43], a[248:255], v3
    s_nop 1
    s_waitcnt lgkmcnt(2)
    v_smfmac_f32_16x16x64_bf16 v[84:87], v[48:51], v[136:143], v3
    s_nop 1
    v_add_f32 v80, v80, v81
    v_smfmac_f32_16x16x64_bf16 v[84:87], v[44:47], v[246:253], v3
    s_nop 0
    s_waitcnt lgkmcnt(0)
    v_add_f32 v82, v82, v83
    v_smfmac_f32_16x16x64_bf16 v[84:87], v[52:55], v[144:151], v3
    s_nop 1
    v_cvt_pk_bf16_f32 v165, v80, v82
    v_mov_b64 v[174:175], 0
    v_mov_b64 v[176:177], 0
    v_mov_b64 v[178:179], 0
    v_mov_b64 v[180:181], 0
    s_add_u32 s22, s22, 1
    s_nop 0
    v_add_f32 v84, v84, v85
    v_add_f32 v86, v86, v87
    v_cvt_pk_bf16_f32 v173, v84, v86
    v_mov_b32 v20, s22
    v_mfma_f32_32x32x16_bf16 v[56:71], v[182:185], v[182:185], 0
    v_mfma_f32_32x32x16_bf16 v[72:87], v[182:185], v[182:185], 0
    ds_write_b128 v19, v[162:165] offset:2048
    ds_write_b128 v19, v[170:173] offset:3072
    s_waitcnt lgkmcnt(0)
    s_barrier
    s_and_b32 s26, s22, 7
    s_mul_i32 s26, s26, 7168
    s_add_u32 s24, s26, 18284544
    buffer_load_dwordx4 v[28:31], v15, s[8:11], s25 offen offset:1024 sc1
    s_barrier
    buffer_load_dwordx4 v[32:35], v15, s[8:11], s25 offen offset:0 sc1
    s_barrier
    ds_read_b128 v[120:123], v6 offset:0
    ds_read_b128 v[124:127], v6 offset:1024
    ds_read_b128 v[128:131], v6 offset:2048
    ds_read_b128 v[132:135], v6 offset:3072
    ds_read_b128 v[136:139], v6 offset:4096
    ds_read_b128 v[140:143], v6 offset:5120
    ds_read_b128 v[144:147], v6 offset:6144
    ds_read_b128 v[148:151], v6 offset:7168
    s_add_u32 s26, s22, 5
    s_and_b32 s26, s26, 7
    s_mul_i32 s26, s26, 7168
    s_add_u32 s32, s26, 18284544
    s_add_u32 s31, s31, 458752
Bsc11_backP:
    s_waitcnt vmcnt(1)
    v_smfmac_f32_16x16x64_bf16 v[174:177], v[28:31], v[104:111], v3
    v_max3_u32 v23, v28, v29, v30
    v_smfmac_f32_16x16x64_bf16 v[178:181], v[28:31], v[112:119], v3
    v_max3_u32 v23, v30, v31, v23
    s_waitcnt vmcnt(0)
    v_smfmac_f32_16x16x64_bf16 v[174:177], v[32:35], v[88:95], v3
    s_nop 1
    v_max3_u32 v23, v32, v33, v23
    v_smfmac_f32_16x16x64_bf16 v[178:181], v[32:35], v[96:103], v3
    s_nop 1
    v_max3_u32 v23, v34, v35, v23
    v_cmp_eq_u32 vcc, -1, v23
    v_add_f32 v40, v174, v175
    v_add_f32 v42, v176, v177
    s_nop 0
    s_cbranch_vccnz Bsc11_fixP
    v_add_f32 v41, v178, v179
    v_add_f32 v43, v180, v181
    ds_write_b128 v8, v[40:43]
    s_barrier
    s_and_b32 s26, s22, 3
    s_mul_i32 s26, s26, 10240
    s_add_u32 s25, s26, 18341888
    s_cmp_lt_u32 s22, 63
    s_cbranch_scc1 Bsc11_top
    s_add_u32 s27, s24, 1024
    s_add_u32 s28, s24, 5120
    s_add_u32 s29, s24, 2048
    s_mov_b32 s34, 18382848
    v_mov_b32 v21, 2147483632
    s_barrier
    buffer_load_dwordx4 v[28:31], v4, s[8:11], s27 offen sc1
    buffer_load_dwordx4 v[32:35], v4, s[8:11], s28 offen sc1
    buffer_load_dwordx4 v[36:39], v4, s[8:11], s29 offen sc1
    s_barrier
    buffer_store_dwordx4 v[162:165], v17, s[8:11], s34 offen offset:0 sc1
    buffer_store_dwordx4 v[170:173], v17, s[8:11], s34 offen offset:256 sc1
    s_mov_b32 s34, 18497536
    s_waitcnt vmcnt(2)
    s_branch Bfol1_chk
Bsc11_fix:
    buffer_load_dwordx4 v[28:31], v4, s[8:11], s27 offen sc1
    buffer_load_dwordx4 v[32:35], v4, s[8:11], s28 offen sc1
    buffer_load_dwordx4 v[36:39], v4, s[8:11], s29 offen sc1
    s_nop 3
    v_mov_b64 v[56:57], 0
    v_mov_b64 v[58:59], 0
    v_mov_b64 v[60:61], 0
    v_mov_b64 v[62:63], 0
    v_mov_b64 v[64:65], 0
    v_mov_b64 v[66:67], 0
    v_mov_b64 v[68:69], 0
    v_mov_b64 v[70:71], 0
    v_mov_b64 v[72:73], 0
    v_mov_b64 v[74:75], 0
    v_mov_b64 v[76:77], 0
    v_mov_b64 v[78:79], 0
    v_mov_b64 v[80:81], 0
    v_mov_b64 v[82:83], 0
    v_mov_b64 v[84:85], 0
    v_mov_b64 v[86:87], 0
    s_waitcnt vmcnt(0)
    s_sub_u32 s23, s23, 1
    s_cbranch_scc0 Bsc11_retry
    s_branch B_done
Bsc11_fixP:
    buffer_load_dwordx4 v[28:31], v15, s[8:11], s25 offen offset:1024 sc1
    buffer_load_dwordx4 v[32:35], v15, s[8:11], s25 offen offset:0 sc1
    v_mov_b64 v[174:175], 0
    v_mov_b64 v[176:177], 0
    v_mov_b64 v[178:179], 0
    v_mov_b64 v[180:181], 0
    s_sub_u32 s23, s23, 1
    s_cbranch_scc0 Bsc11_backP
    s_branch B_done
.p2align 6
Bsc12_top:
    s_add_u32 s27, s24, 2048
    s_add_u32 s28, s24, 6144
    s_add_u32 s29, s24, 3072
    s_add_u32 s26, s31, 4096
    s_barrier
    buffer_load_dwordx4 v[28:31], v4, s[8:11], s27 offen sc1
    ds_write_b128 v8, v[152:155]
    s_barrier
    buffer_load_dwordx4 v[32:35], v4, s[8:11], s28 offen sc1
    s_barrier
    buffer_load_dwordx4 v[88:91], v14, s[8:11], s31 offen offset:0 sc1
    buffer_load_dwordx4 v[96:99], v14, s[8:11], s31 offen offset:256 sc1
    buffer_load_dwordx4 v[92:95], v14, s[8:11], s31 offen offset:2048 sc1
    s_waitcnt vmcnt(4)
Bsc12_retry:
    v_smfmac_f32_16x16x64_bf16 v[56:59], v[28:31], a[0:7], v3
    ds_write_b128 v7, v[28:31] offset:2048
    v_smfmac_f32_16x16x64_bf16 v[60:63], v[28:31], a[8:15], v3
    buffer_load_dwordx4 v[100:103], v14, s[8:11], s31 offen offset:2304 sc1
    v_smfmac_f32_16x16x64_bf16 v[64:67], v[28:31], a[16:23], v3
    buffer_load_dwordx4 v[104:107], v14, s[8:11], s26 offen offset:0 sc1
    v_smfmac_f32_16x16x64_bf16 v[68:71], v[28:31], a[24:31], v3
    buffer_load_dwordx4 v[112:115], v14, s[8:11], s26 offen offset:256 sc1
    v_smfmac_f32_16x16x64_bf16 v[72:75], v[28:31], a[32:39], v3
    s_waitcnt vmcnt(6)
    ds_write_b128 v7, v[32:35] offset:6144
    v_smfmac_f32_16x16x64_bf16 v[76:79], v[28:31], a[40:47], v3
    buffer_load_dwordx4 v[108:111], v14, s[8:11], s26 offen offset:2048 sc1
    v_smfmac_f32_16x16x64_bf16 v[80:83], v[28:31], a[48:55], v3
    buffer_load_dwordx4 v[116:119], v14, s[8:11], s26 offen offset:2304 sc1
    v_smfmac_f32_16x16x64_bf16 v[84:87], v[28:31], a[56:63], v3
    v_max_u32 v23, v28, v29
    v_smfmac_f32_16x16x64_bf16 v[56:59], v[32:35], a[64:71], v3
    v_max3_u32 v23, v30, v31, v23
    v_smfmac_f32_16x16x64_bf16 v[60:63], v[32:35], a[72:79], v3
    v_max3_u32 v23, v32, v33, v23
    v_smfmac_f32_16x16x64_bf16 v[64:67], v[32:35], a[80:87], v3
    v_max3_u32 v23, v34, v35, v23
    v_smfmac_f32_16x16x64_bf16 v[68:71], v[32:35], a[88:95], v3
    v_cmp_eq_u32 vcc, -1, v23
    v_smfmac_f32_16x16x64_bf16 v[72:75], v[32:35], a[96:103], v3
    v_smfmac_f32_16x16x64_bf16 v[76:79], v[32:35], a[104:111], v3
    s_cbranch_vccnz Bsc12_fix
    s_waitcnt lgkmcnt(0)
    s_barrier
    ds_read_b128 v[36:39], v7 offset:3072
    v_smfmac_f32_16x16x64_bf16 v[80:83], v[32:35], a[112:119], v3
    ds_read_b128 v[40:43], v7 offset:4096
    v_smfmac_f32_16x16x64_bf16 v[84:87], v[32:35], a[120:127], v3
    ds_read_b128 v[48:51], v7 offset:0
    s_waitcnt lgkmcnt(2)
    v_smfmac_f32_16x16x64_bf16 v[56:59], v[36:39], a[128:135], v3
    ds_read_b128 v[44:47], v7 offset:5120
    v_smfmac_f32_16x16x64_bf16 v[60:63], v[36:39], a[136:143], v3
    ds_read_b128 v[52:55], v7 offset:1024
    v_smfmac_f32_16x16x64_bf16 v[64:67], v[36:39], a[144:151], v3
    v_smfmac_f32_16x16x64_bf16 v[68:71], v[36:39], a[152:159], v3
    v_smfmac_f32_16x16x64_bf16 v[72:75], v[36:39], a[160:167], v3
    v_smfmac_f32_16x16x64_bf16 v[76:79], v[36:39], a[168:175], v3
    v_smfmac_f32_16x16x64_bf16 v[80:83], v[36:39], a[176:183], v3
    v_smfmac_f32_16x16x64_bf16 v[84:87], v[36:39], a[184:191], v3
    s_waitcnt lgkmcnt(0)
    v_smfmac_f32_16x16x64_bf16 v[56:59], v[40:43], a[192:199], v3
    s_nop 2
    v_smfmac_f32_16x16x64_bf16 v[56:59], v[48:51], v[120:127], v3
    s_nop 1
    ds_read_b128 v[120:123], v6 offset:8192
    v_smfmac_f32_16x16x64_bf16 v[56:59], v[44:47], v[190:197], v3
    s_nop 1
    ds_read_b128 v[124:127], v6 offset:9216
    v_smfmac_f32_16x16x64_bf16 v[56:59], v[52:55], v[128:135], v3
    s_nop 1
    ds_read_b128 v[128:131], v6 offset:10240
    v_smfmac_f32_16x16x64_bf16 v[60:63], v[40:43], a[200:207], v3
    s_nop 1
    ds_read_b128 v[132:135], v6 offset:11264
    v_smfmac_f32_16x16x64_bf16 v[60:63], v[48:51], v[136:143], v3
    s_nop 0
    ds_read_b128 v[136:139], v6 offset:12288
    v_add_f32 v56, v56, v57
    v_smfmac_f32_16x16x64_bf16 v[60:63], v[44:47], v[198:205], v3
    s_nop 0
    ds_read_b128 v[140:143], v6 offset:13312
    v_add_f32 v58, v58, v59
    v_smfmac_f32_16x16x64_bf16 v[60:63], v[52:55], v[144:151], v3
    s_nop 0
    ds_read_b128 v[144:147], v6 offset:14336
    v_cvt_pk_bf16_f32 v162, v56, v58
    v_smfmac_f32_16x16x64_bf16 v[64:67], v[40:43], a[208:215], v3
    s_nop 0
    s_waitcnt lgkmcnt(5)
    ds_read_b128 v[148:151], v6 offset:15360
    v_smfmac_f32_16x16x64_bf16 v[64:67], v[48:51], v[120:127], v3
    s_nop 0
    ds_read_b128 v[120:123], v6 offset:16384
    v_add_f32 v60, v60, v61
    v_smfmac_f32_16x16x64_bf16 v[64:67], v[44:47], v[206:213], v3
    s_waitcnt lgkmcnt(5)
    ds_read_b128 v[124:127], v6 offset:17408
    v_add_f32 v62, v62, v63
    v_smfmac_f32_16x16x64_bf16 v[64:67], v[52:55], v[128:135], v3
    s_nop 0
    ds_read_b128 v[128:131], v6 offset:18432
    v_cvt_pk_bf16_f32 v170, v60, v62
    v_smfmac_f32_16x16x64_bf16 v[68:71], v[40:43], a[216:223], v3
    s_nop 0
    s_waitcnt lgkmcnt(5)
    ds_read_b128 v[132:135], v6 offset:19456
    v_smfmac_f32_16x16x64_bf16 v[68:71], v[48:51], v[136:143], v3
    s_nop 0
    ds_read_b128 v[136:139], v6 offset:20480
    v_add_f32 v64, v64, v65
    v_smfmac_f32_16x16x64_bf16 v[68:71], v[44:47], v[214:221], v3
    s_waitcnt lgkmcnt(5)
    ds_read_b128 v[140:143], v6 offset:21504
    v_add_f32 v66, v66, v67
    v_smfmac_f32_16x16x64_bf16 v[68:71], v[52:55], v[144:151], v3
    s_nop 0
    ds_read_b128 v[144:147], v6 offset:22528
    v_cvt_pk_bf16_f32 v163, v64, v66
    v_smfmac_f32_16x16x64_bf16 v[72:75], v[40:43], a[224:231], v3
    s_nop 0
    s_waitcnt lgkmcnt(5)
    ds_read_b128 v[148:151], v6 offset:23552
    v_smfmac_f32_16x16x64_bf16 v[72:75], v[48:51], v[120:127], v3
    s_nop 0
    ds_read_b128 v[120:123], v6 offset:24576
    v_add_f32 v68, v68, v69
    v_smfmac_f32_16x16x64_bf16 v[72:75], v[44:47], v[222:229], v3
    s_waitcnt lgkmcnt(5)
    ds_read_b128 v[124:127], v6 offset:25600
    v_add_f32 v70, v70, v71
    v_smfmac_f32_16x16x64_bf16 v[72:75], v[52:55], v[128:135], v3
    s_nop 0
    ds_read_b128 v[128:131], v6 offset:26624
    v_cvt_pk_bf16_f32 v171, v68, v70
    v_smfmac_f32_16x16x64_bf16 v[76:79], v[40:43], a[232:239], v3
    s_nop 0
    s_waitcnt lgkmcnt(5)
    ds_read_b128 v[132:135], v6 offset:27648
    v_smfmac_f32_16x16x64_bf16 v[76:79], v[48:51], v[136:143], v3
    s_nop 0
    ds_read_b128 v[136:139], v6 offset:28672
    v_add_f32 v72, v72, v73
    v_smfmac_f32_16x16x64_bf16 v[76:79], v[44:47], v[230:237], v3
    s_waitcnt lgkmcnt(5)
    ds_read_b128 v[140:143], v6 offset:29696
    v_add_f32 v74, v74, v75
    v_smfmac_f32_16x16x64_bf16 v[76:79], v[52:55], v[144:151], v3
    s_nop 0
    ds_read_b128 v[144:147], v6 offset:30720
    v_cvt_pk_bf16_f32 v164, v72, v74
    v_smfmac_f32_16x16x64_bf16 v[80:83], v[40:43], a[240:247], v3
    s_nop 0
    s_waitcnt lgkmcnt(5)
    ds_read_b128 v[148:151], v6 offset:31744
    v_smfmac_f32_16x16x64_bf16 v[80:83], v[48:51], v[120:127], v3
    s_nop 1
    v_add_f32 v76, v76, v77
    v_smfmac_f32_16x16x64_bf16 v[80:83], v[44:47], v[238:245], v3
    s_nop 0
    s_waitcnt lgkmcnt(4)
    v_add_f32 v78, v78, v79
    v_smfmac_f32_16x16x64_bf16 v[80:83], v[52:55], v[128:135], v3
    s_nop 1
    v_cvt_pk_bf16_f32 v172, v76, v78
    v_smfmac_f32_16x16x64_bf16 v[84:87], v[40:43], a[248:255], v3
    s_nop 1
    s_waitcnt lgkmcnt(2)
    v_smfmac_f32_16x16x64_bf16 v[84:87], v[48:51], v[136:143], v3
    s_nop 1
    v_add_f32 v80, v80, v81
    v_smfmac_f32_16x16x64_bf16 v[84:87], v[44:47], v[246:253], v3
    s_nop 0
    s_waitcnt lgkmcnt(0)
    v_add_f32 v82, v82, v83
    v_smfmac_f32_16x16x64_bf16 v[84:87], v[52:55], v[144:151], v3
    s_nop 1
    v_cvt_pk_bf16_f32 v165, v80, v82
    v_mov_b64 v[174:175], 0
    v_mov_b64 v[176:177], 0
    v_mov_b64 v[178:179], 0
    v_mov_b64 v[180:181], 0
    s_add_u32 s22, s22, 1
    s_nop 0
    v_add_f32 v84, v84, v85
    v_add_f32 v86, v86, v87
    v_cvt_pk_bf16_f32 v173, v84, v86
    v_mov_b32 v20, s22
    v_mfma_f32_32x32x16_bf16 v[56:71], v[182:185], v[182:185], 0
    v_mfma_f32_32x32x16_bf16 v[72:87], v[182:185], v[182:185], 0
    ds_write_b128 v19, v[162:165] offset:4096
    ds_write_b128 v19, v[170:173] offset:5120
    s_waitcnt lgkmcnt(0)
    s_barrier
    s_and_b32 s26, s22, 7
    s_mul_i32 s26, s26, 7168
    s_add_u32 s24, s26, 18284544
    buffer_load_dwordx4 v[28:31], v15, s[8:11], s25 offen offset:0 sc1
    s_barrier
    buffer_load_dwordx4 v[32:35], v15, s[8:11], s25 offen offset:1024 sc1
    s_barrier
    ds_read_b128 v[120:123], v6 offset:0
    ds_read_b128 v[124:127], v6 offset:1024
    ds_read_b128 v[128:131], v6 offset:2048
    ds_read_b128 v[132:135], v6 offset:3072
    ds_read_b128 v[136:139], v6 offset:4096
    ds_read_b128 v[140:143], v6 offset:5120
    ds_read_b128 v[144:147], v6 offset:6144
    ds_read_b128 v[148:151], v6 offset:7168
    s_add_u32 s26, s22, 5
    s_and_b32 s26, s26, 7
    s_mul_i32 s26, s26, 7168
    s_add_u32 s32, s26, 18284544
    s_add_u32 s31, s31, 458752
Bsc12_backP:
    s_waitcnt vmcnt(1)
    v_smfmac_f32_16x16x64_bf16 v[174:177], v[28:31], v[88:95], v3
    v_max3_u32 v23, v28, v29, v30
    v_smfmac_f32_16x16x64_bf16 v[178:181], v[28:31], v[96:103], v3
    v_max3_u32 v23, v30, v31, v23
    s_waitcnt vmcnt(0)
    v_smfmac_f32_16x16x64_bf16 v[174:177], v[32:35], v[104:111], v3
    s_nop 1
    v_max3_u32 v23, v32, v33, v23
    v_smfmac_f32_16x16x64_bf16 v[178:181], v[32:35], v[112:119], v3
    s_nop 1
    v_max3_u32 v23, v34, v35, v23
    v_cmp_eq_u32 vcc, -1, v23
    v_add_f32 v40, v174, v175
    v_add_f32 v42, v176, v177
    s_nop 0
    s_cbranch_vccnz Bsc12_fixP
    v_add_f32 v41, v178, v179
    v_add_f32 v43, v180, v181
    ds_write_b128 v8, v[40:43]
    s_barrier
    buffer_load_dword v44, v22, s[8:11], 0 offen sc1
    s_and_b32 s26, s22, 3
    s_mul_i32 s26, s26, 10240
    s_add_u32 s25, s26, 18341888
    s_nop 2
    buffer_load_dword v45, v22, s[8:11], 0 offen sc1
    s_nop 5
    buffer_load_dword v46, v22, s[8:11], 0 offen sc1
    s_nop 5
    buffer_load_dword v47, v22, s[8:11], 0 offen sc1
    s_nop 5
    buffer_load_dword v48, v22, s[8:11], 0 offen sc1
    s_nop 5
Bsc12_pg:
    s_waitcnt vmcnt(4)
    v_cmp_gt_u32 vcc, s22, v44
    buffer_load_dword v49, v22, s[8:11], 0 offen sc1
    s_cbranch_vccz Bsc12_pg_ok
    s_waitcnt vmcnt(4)
    v_cmp_gt_u32 vcc, s22, v45
    buffer_load_dword v44, v22, s[8:11], 0 offen sc1
    s_cbranch_vccz Bsc12_pg_ok
    s_waitcnt vmcnt(4)
    v_cmp_gt_u32 vcc, s22, v46
    buffer_load_dword v45, v22, s[8:11], 0 offen sc1
    s_cbranch_vccz Bsc12_pg_ok
    s_waitcnt vmcnt(4)
    v_cmp_gt_u32 vcc, s22, v47
    buffer_load_dword v46, v22, s[8:11], 0 offen sc1
    s_cbranch_vccz Bsc12_pg_ok
    s_waitcnt vmcnt(4)
    v_cmp_gt_u32 vcc, s22, v48
    buffer_load_dword v47, v22, s[8:11], 0 offen sc1
    s_cbranch_vccz Bsc12_pg_ok
    s_waitcnt vmcnt(4)
    v_cmp_gt_u32 vcc, s22, v49
    buffer_load_dword v48, v22, s[8:11], 0 offen sc1
    s_cbranch_vccz Bsc12_pg_ok
    s_waitcnt vmcnt(4)
    v_cmp_gt_u32 vcc, s22, v44
    buffer_load_dword v49, v22, s[8:11], 0 offen sc1
    s_cbranch_vccz Bsc12_pg_ok
    s_waitcnt vmcnt(4)
    v_cmp_gt_u32 vcc, s22, v45
    buffer_load_dword v44, v22, s[8:11], 0 offen sc1
    s_cbranch_vccz Bsc12_pg_ok
    s_waitcnt vmcnt(4)
    v_cmp_gt_u32 vcc, s22, v46
    buffer_load_dword v45, v22, s[8:11], 0 offen sc1
    s_cbranch_vccz Bsc12_pg_ok
    s_waitcnt vmcnt(4)
    v_cmp_gt_u32 vcc, s22, v47
    buffer_load_dword v46, v22, s[8:11], 0 offen sc1
    s_cbranch_vccz Bsc12_pg_ok
    s_waitcnt vmcnt(4)
    v_cmp_gt_u32 vcc, s22, v48
    buffer_load_dword v47, v22, s[8:11], 0 offen sc1
    s_cbranch_vccz Bsc12_pg_ok
    s_waitcnt vmcnt(4)
    v_cmp_gt_u32 vcc, s22, v49
    buffer_load_dword v48, v22, s[8:11], 0 offen sc1
    s_cbranch_vccz Bsc12_pg_ok
    s_sub_u32 s23, s23, 1
    s_cbranch_scc0 Bsc12_pg
    s_mov_b32 s23, 0
Bsc12_pg_ok:
    s_cmp_lt_u32 s22, 63
    s_cbranch_scc1 Bsc12_top
    s_add_u32 s27, s24, 2048
    s_add_u32 s28, s24, 6144
    s_add_u32 s29, s24, 3072
    s_mov_b32 s34, 18382848
    v_mov_b32 v21, 2147483632
    s_barrier
    buffer_load_dwordx4 v[28:31], v4, s[8:11], s27 offen sc1
    buffer_load_dwordx4 v[32:35], v4, s[8:11], s28 offen sc1
    buffer_load_dwordx4 v[36:39], v4, s[8:11], s29 offen sc1
    s_barrier
    buffer_store_dwordx4 v[162:165], v17, s[8:11], s34 offen offset:0 sc1
    buffer_store_dwordx4 v[170:173], v17, s[8:11], s34 offen offset:256 sc1
    s_mov_b32 s34, 18497536
    s_waitcnt vmcnt(2)
    s_branch Bfol2_chk
Bsc12_fix:
    buffer_load_dwordx4 v[28:31], v4, s[8:11], s27 offen sc1
    buffer_load_dwordx4 v[32:35], v4, s[8:11], s28 offen sc1
    buffer_load_dwordx4 v[36:39], v4, s[8:11], s29 offen sc1
    s_nop 3
    v_mov_b64 v[56:57], 0
    v_mov_b64 v[58:59], 0
    v_mov_b64 v[60:61], 0
    v_mov_b64 v[62:63], 0
    v_mov_b64 v[64:65], 0
    v_mov_b64 v[66:67], 0
    v_mov_b64 v[68:69], 0
    v_mov_b64 v[70:71], 0
    v_mov_b64 v[72:73], 0
    v_mov_b64 v[74:75], 0
    v_mov_b64 v[76:77], 0
    v_mov_b64 v[78:79], 0
    v_mov_b64 v[80:81], 0
    v_mov_b64 v[82:83], 0
    v_mov_b64 v[84:85], 0
    v_mov_b64 v[86:87], 0
    s_waitcnt vmcnt(0)
    s_sub_u32 s23, s23, 1
    s_cbranch_scc0 Bsc12_retry
    s_branch B_done
Bsc12_fixP:
    buffer_load_dwordx4 v[28:31], v15, s[8:11], s25 offen offset:0 sc1
    buffer_load_dwordx4 v[32:35], v15, s[8:11], s25 offen offset:1024 sc1
    v_mov_b64 v[174:175], 0
    v_mov_b64 v[176:177], 0
    v_mov_b64 v[178:179], 0
    v_mov_b64 v[180:181], 0
    s_sub_u32 s23, s23, 1
    s_cbranch_scc0 Bsc12_backP
    s_branch B_done
.p2align 6
Bsc13_top:
    s_add_u32 s27, s24, 3072
    s_add_u32 s28, s24, 1024
    s_add_u32 s29, s24, 4096
    s_add_u32 s26, s31, 4096
    s_barrier
    buffer_load_dwordx4 v[28:31], v4, s[8:11], s27 offen sc1
    ds_read_b128 v[120:123], v6 offset:0
    ds_read_b128 v[124:127], v6 offset:1024
    ds_read_b128 v[128:131], v6 offset:2048
    ds_read_b128 v[132:135], v6 offset:3072
    s_barrier
    buffer_load_dwordx4 v[32:35], v4, s[8:11], s28 offen sc1
    ds_read_b128 v[136:139], v6 offset:4096
    ds_read_b128 v[140:143], v6 offset:5120
    ds_read_b128 v[144:147], v6 offset:6144
    ds_read_b128 v[148:151], v6 offset:7168
    s_barrier
    buffer_load_dwordx4 v[88:91], v14, s[8:11], s31 offen offset:0 sc1
    buffer_load_dwordx4 v[96:99], v14, s[8:11], s31 offen offset:256 sc1
    buffer_load_dwordx4 v[92:95], v14, s[8:11], s31 offen offset:2048 sc1
    s_waitcnt vmcnt(4)
Bsc13_retry:
    v_smfmac_f32_16x16x64_bf16 v[56:59], v[28:31], a[0:7], v3
    ds_write_b128 v7, v[28:31] offset:3072
    v_smfmac_f32_16x16x64_bf16 v[60:63], v[28:31], a[8:15], v3
    buffer_load_dwordx4 v[100:103], v14, s[8:11], s31 offen offset:2304 sc1
    v_smfmac_f32_16x16x64_bf16 v[64:67], v[28:31], a[16:23], v3
    buffer_load_dwordx4 v[104:107], v14, s[8:11], s26 offen offset:0 sc1
    v_smfmac_f32_16x16x64_bf16 v[68:71], v[28:31], a[24:31], v3
    buffer_load_dwordx4 v[112:115], v14, s[8:11], s26 offen offset:256 sc1
    v_smfmac_f32_16x16x64_bf16 v[72:75], v[28:31], a[32:39], v3
    s_waitcnt vmcnt(6)
    v_smfmac_f32_16x16x64_bf16 v[76:79], v[28:31], a[40:47], v3
    buffer_load_dwordx4 v[108:111], v14, s[8:11], s26 offen offset:2048 sc1
    v_smfmac_f32_16x16x64_bf16 v[80:83], v[28:31], a[48:55], v3
    buffer_load_dwordx4 v[116:119], v14, s[8:11], s26 offen offset:2304 sc1
    v_smfmac_f32_16x16x64_bf16 v[84:87], v[28:31], a[56:63], v3
    v_max_u32 v23, v28, v29
    v_smfmac_f32_16x16x64_bf16 v[56:59], v[32:35], a[64:71], v3
    v_max3_u32 v23, v30, v31, v23
    v_smfmac_f32_16x16x64_bf16 v[60:63], v[32:35], a[72:79], v3
    v_max3_u32 v23, v32, v33, v23
    v_smfmac_f32_16x16x64_bf16 v[64:67], v[32:35], a[80:87], v3
    v_max3_u32 v23, v34, v35, v23
    v_smfmac_f32_16x16x64_bf16 v[68:71], v[32:35], a[88:95], v3
    v_cmp_eq_u32 vcc, -1, v23
    v_smfmac_f32_16x16x64_bf16 v[72:75], v[32:35], a[96:103], v3
    v_smfmac_f32_16x16x64_bf16 v[76:79], v[32:35], a[104:111], v3
    s_cbranch_vccnz Bsc13_fix
    s_waitcnt lgkmcnt(0)
    s_barrier
    ds_read_b128 v[36:39], v7 offset:4096
    v_smfmac_f32_16x16x64_bf16 v[80:83], v[32:35], a[112:119], v3
    ds_read_b128 v[40:43], v7 offset:5120
    v_smfmac_f32_16x16x64_bf16 v[84:87], v[32:35], a[120:127], v3
    ds_read_b128 v[48:51], v7 offset:0
    s_waitcnt lgkmcnt(2)
    v_smfmac_f32_16x16x64_bf16 v[56:59], v[36:39], a[128:135], v3
    ds_read_b128 v[44:47], v7 offset:6144
    v_smfmac_f32_16x16x64_bf16 v[60:63], v[36:39], a[136:143], v3
    ds_read_b128 v[52:55], v7 offset:2048
    v_smfmac_f32_16x16x64_bf16 v[64:67], v[36:39], a[144:151], v3
    v_smfmac_f32_16x16x64_bf16 v[68:71], v[36:39], a[152:159], v3
    v_smfmac_f32_16x16x64_bf16 v[72:75], v[36:39], a[160:167], v3
    v_smfmac_f32_16x16x64_bf16 v[76:79], v[36:39], a[168:175], v3
    v_smfmac_f32_16x16x64_bf16 v[80:83], v[36:39], a[176:183], v3
    v_smfmac_f32_16x16x64_bf16 v[84:87], v[36:39], a[184:191], v3
    s_waitcnt lgkmcnt(0)
    v_smfmac_f32_16x16x64_bf16 v[56:59], v[40:43], a[192:199], v3
    s_nop 2
    v_smfmac_f32_16x16x64_bf16 v[56:59], v[48:51], v[120:127], v3
    s_nop 1
    ds_read_b128 v[120:123], v6 offset:8192
    v_smfmac_f32_16x16x64_bf16 v[56:59], v[44:47], v[190:197], v3
    s_nop 1
    ds_read_b128 v[124:127], v6 offset:9216
    v_smfmac_f32_16x16x64_bf16 v[56:59], v[52:55], v[128:135], v3
    s_nop 1
    ds_read_b128 v[128:131], v6 offset:10240
    v_smfmac_f32_16x16x64_bf16 v[60:63], v[40:43], a[200:207], v3
    s_nop 1
    ds_read_b128 v[132:135], v6 offset:11264
    v_smfmac_f32_16x16x64_bf16 v[60:63], v[48:51], v[136:143], v3
    s_nop 0
    ds_read_b128 v[136:139], v6 offset:12288
    v_add_f32 v56, v56, v57
    v_smfmac_f32_16x16x64_bf16 v[60:63], v[44:47], v[198:205], v3
    s_nop 0
    ds_read_b128 v[140:143], v6 offset:13312
    v_add_f32 v58, v58, v59
    v_smfmac_f32_16x16x64_bf16 v[60:63], v[52:55], v[144:151], v3
    s_nop 0
    ds_read_b128 v[144:147], v6 offset:14336
    v_cvt_pk_bf16_f32 v162, v56, v58
    v_smfmac_f32_16x16x64_bf16 v[64:67], v[40:43], a[208:215], v3
    s_nop 0
    s_waitcnt lgkmcnt(5)
    ds_read_b128 v[148:151], v6 offset:15360
    v_smfmac_f32_16x16x64_bf16 v[64:67], v[48:51], v[120:127], v3
    s_nop 0
    ds_read_b128 v[120:123], v6 offset:16384
    v_add_f32 v60, v60, v61
    v_smfmac_f32_16x16x64_bf16 v[64:67], v[44:47], v[206:213], v3
    s_waitcnt lgkmcnt(5)
    ds_read_b128 v[124:127], v6 offset:17408
    v_add_f32 v62, v62, v63
    v_smfmac_f32_16x16x64_bf16 v[64:67], v[52:55], v[128:135], v3
    s_nop 0
    ds_read_b128 v[128:131], v6 offset:18432
    v_cvt_pk_bf16_f32 v170, v60, v62
    v_smfmac_f32_16x16x64_bf16 v[68:71], v[40:43], a[216:223], v3
    s_nop 0
    s_waitcnt lgkmcnt(5)
    ds_read_b128 v[132:135], v6 offset:19456
    v_smfmac_f32_16x16x64_bf16 v[68:71], v[48:51], v[136:143], v3
    s_nop 0
    ds_read_b128 v[136:139], v6 offset:20480
    v_add_f32 v64, v64, v65
    v_smfmac_f32_16x16x64_bf16 v[68:71], v[44:47], v[214:221], v3
    s_waitcnt lgkmcnt(5)
    ds_read_b128 v[140:143], v6 offset:21504
    v_add_f32 v66, v66, v67
    v_smfmac_f32_16x16x64_bf16 v[68:71], v[52:55], v[144:151], v3
    s_nop 0
    ds_read_b128 v[144:147], v6 offset:22528
    v_cvt_pk_bf16_f32 v163, v64, v66
    v_smfmac_f32_16x16x64_bf16 v[72:75], v[40:43], a[224:231], v3
    s_nop 0
    s_waitcnt lgkmcnt(5)
    ds_read_b128 v[148:151], v6 offset:23552
    v_smfmac_f32_16x16x64_bf16 v[72:75], v[48:51], v[120:127], v3
    s_nop 0
    ds_read_b128 v[120:123], v6 offset:24576
    v_add_f32 v68, v68, v69
    v_smfmac_f32_16x16x64_bf16 v[72:75], v[44:47], v[222:229], v3
    s_waitcnt lgkmcnt(5)
    ds_read_b128 v[124:127], v6 offset:25600
    v_add_f32 v70, v70, v71
    v_smfmac_f32_16x16x64_bf16 v[72:75], v[52:55], v[128:135], v3
    s_nop 0
    ds_read_b128 v[128:131], v6 offset:26624
    v_cvt_pk_bf16_f32 v171, v68, v70
    v_smfmac_f32_16x16x64_bf16 v[76:79], v[40:43], a[232:239], v3
    s_nop 0
    s_waitcnt lgkmcnt(5)
    ds_read_b128 v[132:135], v6 offset:27648
    v_smfmac_f32_16x16x64_bf16 v[76:79], v[48:51], v[136:143], v3
    s_nop 0
    ds_read_b128 v[136:139], v6 offset:28672
    v_add_f32 v72, v72, v73
    v_smfmac_f32_16x16x64_bf16 v[76:79], v[44:47], v[230:237], v3
    s_waitcnt lgkmcnt(5)
    ds_read_b128 v[140:143], v6 offset:29696
    v_add_f32 v74, v74, v75
    v_smfmac_f32_16x16x64_bf16 v[76:79], v[52:55], v[144:151], v3
    s_nop 0
    ds_read_b128 v[144:147], v6 offset:30720
    v_cvt_pk_bf16_f32 v164, v72, v74
    v_smfmac_f32_16x16x64_bf16 v[80:83], v[40:43], a[240:247], v3
    s_nop 0
    s_waitcnt lgkmcnt(5)
    ds_read_b128 v[148:151], v6 offset:31744
    v_smfmac_f32_16x16x64_bf16 v[80:83], v[48:51], v[120:127], v3
    s_nop 1
    v_add_f32 v76, v76, v77
    v_smfmac_f32_16x16x64_bf16 v[80:83], v[44:47], v[238:245], v3
    s_nop 0
    s_waitcnt lgkmcnt(4)
    v_add_f32 v78, v78, v79
    v_smfmac_f32_16x16x64_bf16 v[80:83], v[52:55], v[128:135], v3
    s_nop 1
    v_cvt_pk_bf16_f32 v172, v76, v78
    v_smfmac_f32_16x16x64_bf16 v[84:87], v[40:43], a[248:255], v3
    s_nop 1
    s_waitcnt lgkmcnt(2)
    v_smfmac_f32_16x16x64_bf16 v[84:87], v[48:51], v[136:143], v3
    s_nop 1
    v_add_f32 v80, v80, v81
    v_smfmac_f32_16x16x64_bf16 v[84:87], v[44:47], v[246:253], v3
    s_nop 0
    s_waitcnt lgkmcnt(0)
    v_add_f32 v82, v82, v83
    v_smfmac_f32_16x16x64_bf16 v[84:87], v[52:55], v[144:151], v3
    s_nop 1
    v_cvt_pk_bf16_f32 v165, v80, v82
    v_mov_b64 v[174:175], 0
    v_mov_b64 v[176:177], 0
    v_mov_b64 v[178:179], 0
    v_mov_b64 v[180:181], 0
    s_add_u32 s22, s22, 1
    s_nop 0
    v_add_f32 v84, v84, v85
    v_add_f32 v86, v86, v87
    v_cvt_pk_bf16_f32 v173, v84, v86
    v_mov_b32 v20, s22
    v_mfma_f32_32x32x16_bf16 v[56:71], v[182:185], v[182:185], 0
    v_mfma_f32_32x32x16_bf16 v[72:87], v[182:185], v[182:185], 0
    s_barrier
    s_and_b32 s26, s22, 7
    s_mul_i32 s26, s26, 7168
    s_add_u32 s24, s26, 18284544
    buffer_load_dwordx4 v[28:31], v15, s[8:11], s25 offen offset:1024 sc1
    s_barrier
    s_barrier
    buffer_load_dwordx4 v[32:35], v15, s[8:11], s25 offen offset:0 sc1
    buffer_load_dwordx4 v[36:39], v16, s[8:11], s25 offen offset:0 sc1
    buffer_load_dwordx4 v[40:43], v16, s[8:11], s25 offen offset:1024 sc1
    s_add_u32 s26, s22, 5
    s_and_b32 s26, s26, 7
    s_mul_i32 s26, s26, 7168
    s_add_u32 s32, s26, 18284544
    s_add_u32 s31, s31, 458752
    ds_read_b128 v[120:123], v19 offset:0
    ds_read_b128 v[128:131], v19 offset:1024
    ds_read_b128 v[124:127], v19 offset:2048
    ds_read_b128 v[132:135], v19 offset:3072
    ds_read_b128 v[158:161], v19 offset:4096
    ds_read_b128 v[166:169], v19 offset:5120
    s_waitcnt lgkmcnt(0)
Bsc13_backP:
    s_waitcnt vmcnt(3)
    v_smfmac_f32_16x16x64_bf16 v[174:177], v[28:31], v[104:111], v3
    v_max3_u32 v23, v28, v29, v30
    v_smfmac_f32_16x16x64_bf16 v[178:181], v[28:31], v[112:119], v3
    v_max3_u32 v23, v30, v31, v23
    s_waitcnt vmcnt(2)
    v_smfmac_f32_16x16x64_bf16 v[174:177], v[32:35], v[88:95], v3
    buffer_store_dword v20, v12, s[8:11], 0 offen sc1
    v_max3_u32 v23, v32, v33, v23
    v_smfmac_f32_16x16x64_bf16 v[178:181], v[32:35], v[96:103], v3
    v_max3_u32 v23, v34, v35, v23
    s_waitcnt vmcnt(2)
    v_smfmac_f32_16x16x64_bf16 v[174:177], v[36:39], v[120:127], v3
    v_max3_u32 v23, v36, v37, v23
    v_smfmac_f32_16x16x64_bf16 v[178:181], v[36:39], v[128:135], v3
    v_max3_u32 v23, v38, v39, v23
    s_waitcnt vmcnt(1)
    v_smfmac_f32_16x16x64_bf16 v[174:177], v[40:43], v[158:165], v3
    s_nop 1
    v_max3_u32 v23, v40, v41, v23
    v_smfmac_f32_16x16x64_bf16 v[178:181], v[40:43], v[166:173], v3
    s_barrier
    ds_read_b128 v[44:47], v9 offset:0
    ds_read_b128 v[48:51], v9 offset:1024
    ds_read_b128 v[52:55], v9 offset:2048
    v_max3_u32 v23, v42, v43, v23
    v_cmp_eq_u32 vcc, -1, v23
Bsc13_own:
    v_add_f32 v136, v174, v175
    v_add_f32 v138, v176, v177
    v_add_f32 v137, v178, v179
    v_add_f32 v139, v180, v181
    s_cbranch_vccnz Bsc13_fixP
Bsc13_backS:
    s_waitcnt lgkmcnt(2)
    v_pk_add_f32 v[44:45], v[44:45], v[136:137]
    v_pk_add_f32 v[46:47], v[46:47], v[138:139]
    s_waitcnt lgkmcnt(1)
    v_pk_add_f32 v[48:49], v[48:49], v[44:45]
    v_pk_add_f32 v[50:51], v[50:51], v[46:47]
    s_waitcnt lgkmcnt(0)
    v_pk_add_f32 v[52:53], v[52:53], v[48:49]
    v_pk_add_f32 v[54:55], v[54:55], v[50:51]
    v_cvt_pk_bf16_f32 v156, v52, v53
    v_cvt_pk_bf16_f32 v157, v54, v55
    buffer_store_dword v156, v10, s[8:11], s24 offen offset:0 sc1
    buffer_store_dword v157, v10, s[8:11], s24 offen offset:32 sc1
    v_max_u32 v23, v156, v157
    v_cmp_eq_u32 vcc, -1, v23
    s_and_b32 s26, s22, 3
    s_mul_i32 s26, s26, 10240
    s_add_u32 s25, s26, 18341888
    s_cbranch_vccnz Bsc13_fixS
    s_cmp_lt_u32 s22, 63
    s_cbranch_scc1 Bsc13_top
    s_lshl_b32 s26, s20, 9
    s_sub_u32 s27, 142336, s26
    v_add_u32 v23, s27, v10
    v_lshrrev_b32 v24, 1, v4
    v_add_u32 v25, 142336, v24
    ds_write2_b32 v23, v156, v157 offset0:0 offset1:8
    ds_read_b64 v[156:157], v25
    s_add_u32 s26, s26, 18277376
    s_waitcnt lgkmcnt(0)
    buffer_store_dwordx2 v[156:157], v24, s[8:11], s26 offen sc1
    s_add_u32 s27, s24, 3072
    s_add_u32 s28, s24, 1024
    s_add_u32 s29, s24, 4096
    s_mov_b32 s34, 18382848
    v_mov_b32 v21, 2147483632
    s_barrier
    buffer_load_dwordx4 v[28:31], v4, s[8:11], s27 offen sc1
    buffer_load_dwordx4 v[32:35], v4, s[8:11], s28 offen sc1
    buffer_load_dwordx4 v[36:39], v4, s[8:11], s29 offen sc1
    s_barrier
    buffer_store_dwordx4 v[162:165], v17, s[8:11], s34 offen offset:0 sc1
    buffer_store_dwordx4 v[170:173], v17, s[8:11], s34 offen offset:256 sc1
    ds_read_b128 v[120:123], v6 offset:0
    ds_read_b128 v[124:127], v6 offset:1024
    ds_read_b128 v[128:131], v6 offset:2048
    ds_read_b128 v[132:135], v6 offset:3072
    ds_read_b128 v[136:139], v6 offset:4096
    ds_read_b128 v[140:143], v6 offset:5120
    ds_read_b128 v[144:147], v6 offset:6144
    ds_read_b128 v[148:151], v6 offset:7168
    s_mov_b32 s34, 18497536
    s_waitcnt vmcnt(2)
    s_branch Bfol3_chk
Bsc13_fix:
    buffer_load_dwordx4 v[28:31], v4, s[8:11], s27 offen sc1
    buffer_load_dwordx4 v[32:35], v4, s[8:11], s28 offen sc1
    buffer_load_dwordx4 v[36:39], v4, s[8:11], s29 offen sc1
    s_nop 3
    v_mov_b64 v[56:57], 0
    v_mov_b64 v[58:59], 0
    v_mov_b64 v[60:61], 0
    v_mov_b64 v[62:63], 0
    v_mov_b64 v[64:65], 0
    v_mov_b64 v[66:67], 0
    v_mov_b64 v[68:69], 0
    v_mov_b64 v[70:71], 0
    v_mov_b64 v[72:73], 0
    v_mov_b64 v[74:75], 0
    v_mov_b64 v[76:77], 0
    v_mov_b64 v[78:79], 0
    v_mov_b64 v[80:81], 0
    v_mov_b64 v[82:83], 0
    v_mov_b64 v[84:85], 0
    v_mov_b64 v[86:87], 0
    s_waitcnt vmcnt(0)
    s_sub_u32 s23, s23, 1
    s_cbranch_scc0 Bsc13_retry
    s_branch B_done
Bsc13_fixS:
    ds_read_b128 v[44:47], v9 offset:0
    ds_read_b128 v[48:51], v9 offset:1024
    ds_read_b128 v[52:55], v9 offset:2048
    s_sub_u32 s23, s23, 1
    s_cbranch_scc0 Bsc13_backS
    s_branch B_done
Bsc13_fixP:
    buffer_load_dwordx4 v[28:31], v15, s[8:11], s25 offen offset:1024 sc1
    buffer_load_dwordx4 v[32:35], v15, s[8:11], s25 offen offset:0 sc1
    buffer_load_dwordx4 v[36:39], v16, s[8:11], s25 offen offset:0 sc1
    buffer_load_dwordx4 v[40:43], v16, s[8:11], s25 offen offset:1024 sc1
    v_mov_b64 v[174:175], 0
    v_mov_b64 v[176:177], 0
    v_mov_b64 v[178:179], 0
    v_mov_b64 v[180:181], 0
    s_sub_u32 s23, s23, 1
    s_cbranch_scc1 B_done
    s_waitcnt vmcnt(0)
    v_smfmac_f32_16x16x64_bf16 v[174:177], v[28:31], v[104:111], v3
    v_smfmac_f32_16x16x64_bf16 v[178:181], v[28:31], v[112:119], v3
    v_smfmac_f32_16x16x64_bf16 v[174:177], v[32:35], v[88:95], v3
    v_smfmac_f32_16x16x64_bf16 v[178:181], v[32:35], v[96:103], v3
    v_smfmac_f32_16x16x64_bf16 v[174:177], v[36:39], v[120:127], v3
    v_smfmac_f32_16x16x64_bf16 v[178:181], v[36:39], v[128:135], v3
    v_smfmac_f32_16x16x64_bf16 v[174:177], v[40:43], v[158:165], v3
    v_smfmac_f32_16x16x64_bf16 v[178:181], v[40:43], v[166:173], v3
    v_max3_u32 v23, v28, v29, v30
    v_max3_u32 v23, v30, v31, v23
    v_max3_u32 v23, v32, v33, v23
    v_max3_u32 v23, v34, v35, v23
    v_max3_u32 v23, v36, v37, v23
    v_max3_u32 v23, v38, v39, v23
    v_max3_u32 v23, v40, v41, v23
    v_max3_u32 v23, v42, v43, v23
    v_cmp_eq_u32 vcc, -1, v23
    s_branch Bsc13_own
.p2align 6
Bfol0_top:
    s_add_u32 s27, s24, 0
    s_add_u32 s28, s24, 4096
    s_add_u32 s29, s24, 1024
    s_add_u32 s26, s31, 4096
    buffer_load_dwordx4 v[28:31], v4, s[8:11], s27 offen sc1
    buffer_load_dwordx4 v[32:35], v4, s[8:11], s28 offen sc1
    buffer_load_dwordx4 v[36:39], v4, s[8:11], s29 offen sc1
    s_waitcnt vmcnt(0)
Bfol0_chk:
    v_max3_u32 v23, v28, v29, v30
    v_max3_u32 v23, v31, v32, v23
    v_max3_u32 v23, v33, v34, v23
    v_max3_u32 v23, v35, v36, v23
    v_max3_u32 v23, v37, v38, v23
    v_max_u32 v23, v39, v23
    v_cmp_eq_u32 vcc, -1, v23
    s_cbranch_vccnz Bfol0_fix
Bfol0_retry:
    v_smfmac_f32_16x16x64_bf16 v[56:59], v[28:31], a[0:7], v3
    ds_write_b128 v7, v[28:31] offset:0
    v_smfmac_f32_16x16x64_bf16 v[60:63], v[28:31], a[8:15], v3
    v_smfmac_f32_16x16x64_bf16 v[64:67], v[28:31], a[16:23], v3
    v_smfmac_f32_16x16x64_bf16 v[68:71], v[28:31], a[24:31], v3
    v_smfmac_f32_16x16x64_bf16 v[72:75], v[28:31], a[32:39], v3
    ds_write_b128 v7, v[32:35] offset:4096
    v_smfmac_f32_16x16x64_bf16 v[76:79], v[28:31], a[40:47], v3
    v_smfmac_f32_16x16x64_bf16 v[80:83], v[28:31], a[48:55], v3
    v_smfmac_f32_16x16x64_bf16 v[84:87], v[28:31], a[56:63], v3
    v_smfmac_f32_16x16x64_bf16 v[56:59], v[32:35], a[64:71], v3
    v_smfmac_f32_16x16x64_bf16 v[60:63], v[32:35], a[72:79], v3
    v_smfmac_f32_16x16x64_bf16 v[64:67], v[32:35], a[80:87], v3
    v_smfmac_f32_16x16x64_bf16 v[68:71], v[32:35], a[88:95], v3
    v_smfmac_f32_16x16x64_bf16 v[72:75], v[32:35], a[96:103], v3
    v_smfmac_f32_16x16x64_bf16 v[76:79], v[32:35], a[104:111], v3
    v_smfmac_f32_16x16x64_bf16 v[80:83], v[32:35], a[112:119], v3
    v_smfmac_f32_16x16x64_bf16 v[84:87], v[32:35], a[120:127], v3
    v_smfmac_f32_16x16x64_bf16 v[56:59], v[36:39], a[128:135], v3
    s_waitcnt lgkmcnt(0)
    s_barrier
    ds_read_b128 v[40:43], v7 offset:2048
    v_smfmac_f32_16x16x64_bf16 v[60:63], v[36:39], a[136:143], v3
    ds_read_b128 v[48:51], v7 offset:5120
    v_smfmac_f32_16x16x64_bf16 v[64:67], v[36:39], a[144:151], v3
    ds_read_b128 v[44:47], v7 offset:3072
    v_smfmac_f32_16x16x64_bf16 v[68:71], v[36:39], a[152:159], v3
    ds_read_b128 v[52:55], v7 offset:6144
    v_smfmac_f32_16x16x64_bf16 v[72:75], v[36:39], a[160:167], v3
    s_add_u32 s27, s27, 7168
    v_smfmac_f32_16x16x64_bf16 v[76:79], v[36:39], a[168:175], v3
    s_add_u32 s28, s28, 7168
    v_smfmac_f32_16x16x64_bf16 v[80:83], v[36:39], a[176:183], v3
    s_add_u32 s29, s29, 7168
    v_smfmac_f32_16x16x64_bf16 v[84:87], v[36:39], a[184:191], v3
    s_waitcnt lgkmcnt(0)
    v_smfmac_f32_16x16x64_bf16 v[56:59], v[40:43], a[192:199], v3
    s_nop 0
    buffer_load_dwordx4 v[28:31], v4, s[8:11], s27 offen sc1
    v_smfmac_f32_16x16x64_bf16 v[56:59], v[48:51], v[120:127], v3
    s_nop 1
    ds_read_b128 v[120:123], v6 offset:8192
    v_smfmac_f32_16x16x64_bf16 v[56:59], v[44:47], v[190:197], v3
    s_nop 1
    ds_read_b128 v[124:127], v6 offset:9216
    v_smfmac_f32_16x16x64_bf16 v[56:59], v[52:55], v[128:135], v3
    s_nop 1
    ds_read_b128 v[128:131], v6 offset:10240
    v_smfmac_f32_16x16x64_bf16 v[60:63], v[40:43], a[200:207], v3
    buffer_load_dwordx4 v[32:35], v4, s[8:11], s28 offen sc1
    ds_read_b128 v[132:135], v6 offset:11264
    v_smfmac_f32_16x16x64_bf16 v[60:63], v[48:51], v[136:143], v3
    s_nop 0
    ds_read_b128 v[136:139], v6 offset:12288
    v_add_f32 v56, v56, v57
    v_smfmac_f32_16x16x64_bf16 v[60:63], v[44:47], v[198:205], v3
    s_nop 0
    ds_read_b128 v[140:143], v6 offset:13312
    v_add_f32 v58, v58, v59
    v_smfmac_f32_16x16x64_bf16 v[60:63], v[52:55], v[144:151], v3
    s_nop 0
    ds_read_b128 v[144:147], v6 offset:14336
    v_cvt_pk_bf16_f32 v162, v56, v58
    v_smfmac_f32_16x16x64_bf16 v[64:67], v[40:43], a[208:215], v3
    s_waitcnt lgkmcnt(5)
    buffer_load_dwordx4 v[36:39], v4, s[8:11], s29 offen sc1
    ds_read_b128 v[148:151], v6 offset:15360
    v_smfmac_f32_16x16x64_bf16 v[64:67], v[48:51], v[120:127], v3
    s_nop 0
    ds_read_b128 v[120:123], v6 offset:16384
    v_add_f32 v60, v60, v61
    v_smfmac_f32_16x16x64_bf16 v[64:67], v[44:47], v[206:213], v3
    s_waitcnt lgkmcnt(5)
    ds_read_b128 v[124:127], v6 offset:17408
    v_add_f32 v62, v62, v63
    v_smfmac_f32_16x16x64_bf16 v[64:67], v[52:55], v[128:135], v3
    s_nop 0
    ds_read_b128 v[128:131], v6 offset:18432
    v_cvt_pk_bf16_f32 v170, v60, v62
    v_smfmac_f32_16x16x64_bf16 v[68:71], v[40:43], a[216:223], v3
    s_nop 0
    s_waitcnt lgkmcnt(5)
    ds_read_b128 v[132:135], v6 offset:19456
    v_smfmac_f32_16x16x64_bf16 v[68:71], v[48:51], v[136:143], v3
    s_nop 0
    ds_read_b128 v[136:139], v6 offset:20480
    v_add_f32 v64, v64, v65
    v_smfmac_f32_16x16x64_bf16 v[68:71], v[44:47], v[214:221], v3
    s_waitcnt lgkmcnt(5)
    ds_read_b128 v[140:143], v6 offset:21504
    v_add_f32 v66, v66, v67
    v_smfmac_f32_16x16x64_bf16 v[68:71], v[52:55], v[144:151], v3
    s_nop 0
    ds_read_b128 v[144:147], v6 offset:22528
    v_cvt_pk_bf16_f32 v163, v64, v66
    v_smfmac_f32_16x16x64_bf16 v[72:75], v[40:43], a[224:231], v3
    s_nop 0
    s_waitcnt lgkmcnt(5)
    ds_read_b128 v[148:151], v6 offset:23552
    v_smfmac_f32_16x16x64_bf16 v[72:75], v[48:51], v[120:127], v3
    s_nop 0
    ds_read_b128 v[120:123], v6 offset:24576
    v_add_f32 v68, v68, v69
    v_smfmac_f32_16x16x64_bf16 v[72:75], v[44:47], v[222:229], v3
    s_waitcnt lgkmcnt(5)
    ds_read_b128 v[124:127], v6 offset:25600
    v_add_f32 v70, v70, v71
    v_smfmac_f32_16x16x64_bf16 v[72:75], v[52:55], v[128:135], v3
    s_nop 0
    ds_read_b128 v[128:131], v6 offset:26624
    v_cvt_pk_bf16_f32 v171, v68, v70
    v_smfmac_f32_16x16x64_bf16 v[76:79], v[40:43], a[232:239], v3
    s_nop 0
    s_waitcnt lgkmcnt(5)
    ds_read_b128 v[132:135], v6 offset:27648
    v_smfmac_f32_16x16x64_bf16 v[76:79], v[48:51], v[136:143], v3
    s_nop 0
    ds_read_b128 v[136:139], v6 offset:28672
    v_add_f32 v72, v72, v73
    v_smfmac_f32_16x16x64_bf16 v[76:79], v[44:47], v[230:237], v3
    s_waitcnt lgkmcnt(5)
    ds_read_b128 v[140:143], v6 offset:29696
    v_add_f32 v74, v74, v75
    v_smfmac_f32_16x16x64_bf16 v[76:79], v[52:55], v[144:151], v3
    s_nop 0
    ds_read_b128 v[144:147], v6 offset:30720
    v_cvt_pk_bf16_f32 v164, v72, v74
    v_smfmac_f32_16x16x64_bf16 v[80:83], v[40:43], a[240:247], v3
    s_nop 0
    s_waitcnt lgkmcnt(5)
    ds_read_b128 v[148:151], v6 offset:31744
    v_smfmac_f32_16x16x64_bf16 v[80:83], v[48:51], v[120:127], v3
    s_nop 1
    v_add_f32 v76, v76, v77
    v_smfmac_f32_16x16x64_bf16 v[80:83], v[44:47], v[238:245], v3
    s_nop 0
    s_waitcnt lgkmcnt(4)
    v_add_f32 v78, v78, v79
    v_smfmac_f32_16x16x64_bf16 v[80:83], v[52:55], v[128:135], v3
    s_nop 1
    v_cvt_pk_bf16_f32 v172, v76, v78
    v_smfmac_f32_16x16x64_bf16 v[84:87], v[40:43], a[248:255], v3
    s_nop 1
    s_waitcnt lgkmcnt(2)
    v_smfmac_f32_16x16x64_bf16 v[84:87], v[48:51], v[136:143], v3
    s_nop 1
    v_add_f32 v80, v80, v81
    v_smfmac_f32_16x16x64_bf16 v[84:87], v[44:47], v[246:253], v3
    s_nop 0
    s_waitcnt lgkmcnt(0)
    v_add_f32 v82, v82, v83
    v_smfmac_f32_16x16x64_bf16 v[84:87], v[52:55], v[144:151], v3
    s_nop 1
    v_cvt_pk_bf16_f32 v165, v80, v82
    s_waitcnt vmcnt(0)
    s_barrier
    buffer_store_dword v20, v21, s[8:11], 0 offen sc1
    v_mov_b64 v[174:175], 0
    v_mov_b64 v[176:177], 0
    v_mov_b64 v[178:179], 0
    v_mov_b64 v[180:181], 0
    s_add_u32 s22, s22, 1
    s_nop 0
    v_add_f32 v84, v84, v85
    v_add_f32 v86, v86, v87
    v_cvt_pk_bf16_f32 v173, v84, v86
    v_mov_b32 v20, s22
    v_mfma_f32_32x32x16_bf16 v[56:71], v[182:185], v[182:185], 0
    v_mfma_f32_32x32x16_bf16 v[72:87], v[182:185], v[182:185], 0
    buffer_store_dwordx4 v[162:165], v17, s[8:11], s34 offen offset:0 sc1
    buffer_store_dwordx4 v[170:173], v17, s[8:11], s34 offen offset:256 sc1
    ds_read_b128 v[120:123], v6 offset:0
    ds_read_b128 v[124:127], v6 offset:1024
    ds_read_b128 v[128:131], v6 offset:2048
    ds_read_b128 v[132:135], v6 offset:3072
    ds_read_b128 v[136:139], v6 offset:4096
    ds_read_b128 v[140:143], v6 offset:5120
    ds_read_b128 v[144:147], v6 offset:6144
    ds_read_b128 v[148:151], v6 offset:7168
    s_add_u32 s34, s34, 114688
    s_cmp_lt_u32 s22, 62
    s_cbranch_scc1 Bfol0_chk
    s_waitcnt vmcnt(0)
    buffer_store_dword v20, v21, s[8:11], 0 offen sc1
    s_branch B_done
Bfol0_fix:
    s_waitcnt vmcnt(0)
    buffer_store_dword v20, v21, s[8:11], 0 offen sc1
Bfol0_fixl:
    s_sub_u32 s23, s23, 1
    s_cbranch_scc1 B_done
    buffer_load_dwordx4 v[28:31], v4, s[8:11], s27 offen sc1
    buffer_load_dwordx4 v[32:35], v4, s[8:11], s28 offen sc1
    buffer_load_dwordx4 v[36:39], v4, s[8:11], s29 offen sc1
    s_waitcnt vmcnt(0)
    v_max3_u32 v23, v28, v29, v30
    v_max3_u32 v23, v31, v32, v23
    v_max3_u32 v23, v33, v34, v23
    v_max3_u32 v23, v35, v36, v23
    v_max3_u32 v23, v37, v38, v23
    v_max_u32 v23, v39, v23
    v_cmp_eq_u32 vcc, -1, v23
    s_cbranch_vccz Bfol0_retry
    s_sleep 1
    s_branch Bfol0_fixl
.p2align 6
Bfol1_top:
    s_add_u32 s27, s24, 1024
    s_add_u32 s28, s24, 5120
    s_add_u32 s29, s24, 2048
    s_add_u32 s26, s31, 4096
    buffer_load_dwordx4 v[28:31], v4, s[8:11], s27 offen sc1
    buffer_load_dwordx4 v[32:35], v4, s[8:11], s28 offen sc1
    buffer_load_dwordx4 v[36:39], v4, s[8:11], s29 offen sc1
    s_waitcnt vmcnt(0)
Bfol1_chk:
    v_max3_u32 v23, v28, v29, v30
    v_max3_u32 v23, v31, v32, v23
    v_max3_u32 v23, v33, v34, v23
    v_max3_u32 v23, v35, v36, v23
    v_max3_u32 v23, v37, v38, v23
    v_max_u32 v23, v39, v23
    v_cmp_eq_u32 vcc, -1, v23
    s_cbranch_vccnz Bfol1_fix
Bfol1_retry:
    v_smfmac_f32_16x16x64_bf16 v[56:59], v[28:31], a[0:7], v3
    ds_write_b128 v7, v[28:31] offset:1024
    v_smfmac_f32_16x16x64_bf16 v[60:63], v[28:31], a[8:15], v3
    v_smfmac_f32_16x16x64_bf16 v[64:67], v[28:31], a[16:23], v3
    v_smfmac_f32_16x16x64_bf16 v[68:71], v[28:31], a[24:31], v3
    v_smfmac_f32_16x16x64_bf16 v[72:75], v[28:31], a[32:39], v3
    ds_write_b128 v7, v[32:35] offset:5120
    v_smfmac_f32_16x16x64_bf16 v[76:79], v[28:31], a[40:47], v3
    v_smfmac_f32_16x16x64_bf16 v[80:83], v[28:31], a[48:55], v3
    v_smfmac_f32_16x16x64_bf16 v[84:87], v[28:31], a[56:63], v3
    v_smfmac_f32_16x16x64_bf16 v[56:59], v[32:35], a[64:71], v3
    v_smfmac_f32_16x16x64_bf16 v[60:63], v[32:35], a[72:79], v3
    v_smfmac_f32_16x16x64_bf16 v[64:67], v[32:35], a[80:87], v3
    v_smfmac_f32_16x16x64_bf16 v[68:71], v[32:35], a[88:95], v3
    v_smfmac_f32_16x16x64_bf16 v[72:75], v[32:35], a[96:103], v3
    v_smfmac_f32_16x16x64_bf16 v[76:79], v[32:35], a[104:111], v3
    v_smfmac_f32_16x16x64_bf16 v[80:83], v[32:35], a[112:119], v3
    v_smfmac_f32_16x16x64_bf16 v[84:87], v[32:35], a[120:127], v3
    v_smfmac_f32_16x16x64_bf16 v[56:59], v[36:39], a[128:135], v3
    s_waitcnt lgkmcnt(0)
    s_barrier
    ds_read_b128 v[40:43], v7 offset:3072
    v_smfmac_f32_16x16x64_bf16 v[60:63], v[36:39], a[136:143], v3
    ds_read_b128 v[48:51], v7 offset:6144
    v_smfmac_f32_16x16x64_bf16 v[64:67], v[36:39], a[144:151], v3
    ds_read_b128 v[44:47], v7 offset:4096
    v_smfmac_f32_16x16x64_bf16 v[68:71], v[36:39], a[152:159], v3
    ds_read_b128 v[52:55], v7 offset:0
    v_smfmac_f32_16x16x64_bf16 v[72:75], v[36:39], a[160:167], v3
    s_add_u32 s27, s27, 7168
    v_smfmac_f32_16x16x64_bf16 v[76:79], v[36:39], a[168:175], v3
    s_add_u32 s28, s28, 7168
    v_smfmac_f32_16x16x64_bf16 v[80:83], v[36:39], a[176:183], v3
    s_add_u32 s29, s29, 7168
    v_smfmac_f32_16x16x64_bf16 v[84:87], v[36:39], a[184:191], v3
    s_waitcnt lgkmcnt(0)
    v_smfmac_f32_16x16x64_bf16 v[56:59], v[40:43], a[192:199], v3
    s_nop 0
    buffer_load_dwordx4 v[28:31], v4, s[8:11], s27 offen sc1
    v_smfmac_f32_16x16x64_bf16 v[56:59], v[48:51], v[120:127], v3
    s_nop 1
    ds_read_b128 v[120:123], v6 offset:8192
    v_smfmac_f32_16x16x64_bf16 v[56:59], v[44:47], v[190:197], v3
    s_nop 1
    ds_read_b128 v[124:127], v6 offset:9216
    v_smfmac_f32_16x16x64_bf16 v[56:59], v[52:55], v[128:135], v3
    s_nop 1
    ds_read_b128 v[128:131], v6 offset:10240
    v_smfmac_f32_16x16x64_bf16 v[60:63], v[40:43], a[200:207], v3
    buffer_load_dwordx4 v[32:35], v4, s[8:11], s28 offen sc1
    ds_read_b128 v[132:135], v6 offset:11264
    v_smfmac_f32_16x16x64_bf16 v[60:63], v[48:51], v[136:143], v3
    s_nop 0
    ds_read_b128 v[136:139], v6 offset:12288
    v_add_f32 v56, v56, v57
    v_smfmac_f32_16x16x64_bf16 v[60:63], v[44:47], v[198:205], v3
    s_nop 0
    ds_read_b128 v[140:143], v6 offset:13312
    v_add_f32 v58, v58, v59
    v_smfmac_f32_16x16x64_bf16 v[60:63], v[52:55], v[144:151], v3
    s_nop 0
    ds_read_b128 v[144:147], v6 offset:14336
    v_cvt_pk_bf16_f32 v162, v56, v58
    v_smfmac_f32_16x16x64_bf16 v[64:67], v[40:43], a[208:215], v3
    s_waitcnt lgkmcnt(5)
    buffer_load_dwordx4 v[36:39], v4, s[8:11], s29 offen sc1
    ds_read_b128 v[148:151], v6 offset:15360
    v_smfmac_f32_16x16x64_bf16 v[64:67], v[48:51], v[120:127], v3
    s_nop 0
    ds_read_b128 v[120:123], v6 offset:16384
    v_add_f32 v60, v60, v61
    v_smfmac_f32_16x16x64_bf16 v[64:67], v[44:47], v[206:213], v3
    s_waitcnt lgkmcnt(5)
    ds_read_b128 v[124:127], v6 offset:17408
    v_add_f32 v62, v62, v63
    v_smfmac_f32_16x16x64_bf16 v[64:67], v[52:55], v[128:135], v3
    s_nop 0
    ds_read_b128 v[128:131], v6 offset:18432
    v_cvt_pk_bf16_f32 v170, v60, v62
    v_smfmac_f32_16x16x64_bf16 v[68:71], v[40:43], a[216:223], v3
    s_nop 0
    s_waitcnt lgkmcnt(5)
    ds_read_b128 v[132:135], v6 offset:19456
    v_smfmac_f32_16x16x64_bf16 v[68:71], v[48:51], v[136:143], v3
    s_nop 0
    ds_read_b128 v[136:139], v6 offset:20480
    v_add_f32 v64, v64, v65
    v_smfmac_f32_16x16x64_bf16 v[68:71], v[44:47], v[214:221], v3
    s_waitcnt lgkmcnt(5)
    ds_read_b128 v[140:143], v6 offset:21504
    v_add_f32 v66, v66, v67
    v_smfmac_f32_16x16x64_bf16 v[68:71], v[52:55], v[144:151], v3
    s_nop 0
    ds_read_b128 v[144:147], v6 offset:22528
    v_cvt_pk_bf16_f32 v163, v64, v66
    v_smfmac_f32_16x16x64_bf16 v[72:75], v[40:43], a[224:231], v3
    s_nop 0
    s_waitcnt lgkmcnt(5)
    ds_read_b128 v[148:151], v6 offset:23552
    v_smfmac_f32_16x16x64_bf16 v[72:75], v[48:51], v[120:127], v3
    s_nop 0
    ds_read_b128 v[120:123], v6 offset:24576
    v_add_f32 v68, v68, v69
    v_smfmac_f32_16x16x64_bf16 v[72:75], v[44:47], v[222:229], v3
    s_waitcnt lgkmcnt(5)
    ds_read_b128 v[124:127], v6 offset:25600
    v_add_f32 v70, v70, v71
    v_smfmac_f32_16x16x64_bf16 v[72:75], v[52:55], v[128:135], v3
    s_nop 0
    ds_read_b128 v[128:131], v6 offset:26624
    v_cvt_pk_bf16_f32 v171, v68, v70
    v_smfmac_f32_16x16x64_bf16 v[76:79], v[40:43], a[232:239], v3
    s_nop 0
    s_waitcnt lgkmcnt(5)
    ds_read_b128 v[132:135], v6 offset:27648
    v_smfmac_f32_16x16x64_bf16 v[76:79], v[48:51], v[136:143], v3
    s_nop 0
    ds_read_b128 v[136:139], v6 offset:28672
    v_add_f32 v72, v72, v73
    v_smfmac_f32_16x16x64_bf16 v[76:79], v[44:47], v[230:237], v3
    s_waitcnt lgkmcnt(5)
    ds_read_b128 v[140:143], v6 offset:29696
    v_add_f32 v74, v74, v75
    v_smfmac_f32_16x16x64_bf16 v[76:79], v[52:55], v[144:151], v3
    s_nop 0
    ds_read_b128 v[144:147], v6 offset:30720
    v_cvt_pk_bf16_f32 v164, v72, v74
    v_smfmac_f32_16x16x64_bf16 v[80:83], v[40:43], a[240:247], v3
    s_nop 0
    s_waitcnt lgkmcnt(5)
    ds_read_b128 v[148:151], v6 offset:31744
    v_smfmac_f32_16x16x64_bf16 v[80:83], v[48:51], v[120:127], v3
    s_nop 1
    v_add_f32 v76, v76, v77
    v_smfmac_f32_16x16x64_bf16 v[80:83], v[44:47], v[238:245], v3
    s_nop 0
    s_waitcnt lgkmcnt(4)
    v_add_f32 v78, v78, v79
    v_smfmac_f32_16x16x64_bf16 v[80:83], v[52:55], v[128:135], v3
    s_nop 1
    v_cvt_pk_bf16_f32 v172, v76, v78
    v_smfmac_f32_16x16x64_bf16 v[84:87], v[40:43], a[248:255], v3
    s_nop 1
    s_waitcnt lgkmcnt(2)
    v_smfmac_f32_16x16x64_bf16 v[84:87], v[48:51], v[136:143], v3
    s_nop 1
    v_add_f32 v80, v80, v81
    v_smfmac_f32_16x16x64_bf16 v[84:87], v[44:47], v[246:253], v3
    s_nop 0
    s_waitcnt lgkmcnt(0)
    v_add_f32 v82, v82, v83
    v_smfmac_f32_16x16x64_bf16 v[84:87], v[52:55], v[144:151], v3
    s_nop 1
    v_cvt_pk_bf16_f32 v165, v80, v82
    s_waitcnt vmcnt(0)
    s_barrier
    buffer_store_dword v20, v21, s[8:11], 0 offen sc1
    v_mov_b64 v[174:175], 0
    v_mov_b64 v[176:177], 0
    v_mov_b64 v[178:179], 0
    v_mov_b64 v[180:181], 0
    s_add_u32 s22, s22, 1
    s_nop 0
    v_add_f32 v84, v84, v85
    v_add_f32 v86, v86, v87
    v_cvt_pk_bf16_f32 v173, v84, v86
    v_mov_b32 v20, s22
    v_mfma_f32_32x32x16_bf16 v[56:71], v[182:185], v[182:185], 0
    v_mfma_f32_32x32x16_bf16 v[72:87], v[182:185], v[182:185], 0
    buffer_store_dwordx4 v[162:165], v17, s[8:11], s34 offen offset:0 sc1
    buffer_store_dwordx4 v[170:173], v17, s[8:11], s34 offen offset:256 sc1
    ds_read_b128 v[120:123], v6 offset:0
    ds_read_b128 v[124:127], v6 offset:1024
    ds_read_b128 v[128:131], v6 offset:2048
    ds_read_b128 v[132:135], v6 offset:3072
    ds_read_b128 v[136:139], v6 offset:4096
    ds_read_b128 v[140:143], v6 offset:5120
    ds_read_b128 v[144:147], v6 offset:6144
    ds_read_b128 v[148:151], v6 offset:7168
    s_add_u32 s34, s34, 114688
    s_cmp_lt_u32 s22, 62
    s_cbranch_scc1 Bfol1_chk
    s_waitcnt vmcnt(0)
    buffer_store_dword v20, v21, s[8:11], 0 offen sc1
    s_branch B_done
Bfol1_fix:
    s_waitcnt vmcnt(0)
    buffer_store_dword v20, v21, s[8:11], 0 offen sc1
Bfol1_fixl:
    s_sub_u32 s23, s23, 1
    s_cbranch_scc1 B_done
    buffer_load_dwordx4 v[28:31], v4, s[8:11], s27 offen sc1
    buffer_load_dwordx4 v[32:35], v4, s[8:11], s28 offen sc1
    buffer_load_dwordx4 v[36:39], v4, s[8:11], s29 offen sc1
    s_waitcnt vmcnt(0)
    v_max3_u32 v23, v28, v29, v30
    v_max3_u32 v23, v31, v32, v23
    v_max3_u32 v23, v33, v34, v23
    v_max3_u32 v23, v35, v36, v23
    v_max3_u32 v23, v37, v38, v23
    v_max_u32 v23, v39, v23
    v_cmp_eq_u32 vcc, -1, v23
    s_cbranch_vccz Bfol1_retry
    s_sleep 1
    s_branch Bfol1_fixl
.p2align 6
Bfol2_top:
    s_add_u32 s27, s24, 2048
    s_add_u32 s28, s24, 6144
    s_add_u32 s29, s24, 3072
    s_add_u32 s26, s31, 4096
    buffer_load_dwordx4 v[28:31], v4, s[8:11], s27 offen sc1
    buffer_load_dwordx4 v[32:35], v4, s[8:11], s28 offen sc1
    buffer_load_dwordx4 v[36:39], v4, s[8:11], s29 offen sc1
    s_waitcnt vmcnt(0)
Bfol2_chk:
    v_max3_u32 v23, v28, v29, v30
    v_max3_u32 v23, v31, v32, v23
    v_max3_u32 v23, v33, v34, v23
    v_max3_u32 v23, v35, v36, v23
    v_max3_u32 v23, v37, v38, v23
    v_max_u32 v23, v39, v23
    v_cmp_eq_u32 vcc, -1, v23
    s_cbranch_vccnz Bfol2_fix
Bfol2_retry:
    v_smfmac_f32_16x16x64_bf16 v[56:59], v[28:31], a[0:7], v3
    ds_write_b128 v7, v[28:31] offset:2048
    v_smfmac_f32_16x16x64_bf16 v[60:63], v[28:31], a[8:15], v3
    v_smfmac_f32_16x16x64_bf16 v[64:67], v[28:31], a[16:23], v3
    v_smfmac_f32_16x16x64_bf16 v[68:71], v[28:31], a[24:31], v3
    v_smfmac_f32_16x16x64_bf16 v[72:75], v[28:31], a[32:39], v3
    ds_write_b128 v7, v[32:35] offset:6144
    v_smfmac_f32_16x16x64_bf16 v[76:79], v[28:31], a[40:47], v3
    v_smfmac_f32_16x16x64_bf16 v[80:83], v[28:31], a[48:55], v3
    v_smfmac_f32_16x16x64_bf16 v[84:87], v[28:31], a[56:63], v3
    v_smfmac_f32_16x16x64_bf16 v[56:59], v[32:35], a[64:71], v3
    v_smfmac_f32_16x16x64_bf16 v[60:63], v[32:35], a[72:79], v3
    v_smfmac_f32_16x16x64_bf16 v[64:67], v[32:35], a[80:87], v3
    v_smfmac_f32_16x16x64_bf16 v[68:71], v[32:35], a[88:95], v3
    v_smfmac_f32_16x16x64_bf16 v[72:75], v[32:35], a[96:103], v3
    v_smfmac_f32_16x16x64_bf16 v[76:79], v[32:35], a[104:111], v3
    v_smfmac_f32_16x16x64_bf16 v[80:83], v[32:35], a[112:119], v3
    v_smfmac_f32_16x16x64_bf16 v[84:87], v[32:35], a[120:127], v3
    v_smfmac_f32_16x16x64_bf16 v[56:59], v[36:39], a[128:135], v3
    s_waitcnt lgkmcnt(0)
    s_barrier
    ds_read_b128 v[40:43], v7 offset:4096
    v_smfmac_f32_16x16x64_bf16 v[60:63], v[36:39], a[136:143], v3
    ds_read_b128 v[48:51], v7 offset:0
    v_smfmac_f32_16x16x64_bf16 v[64:67], v[36:39], a[144:151], v3
    ds_read_b128 v[44:47], v7 offset:5120
    v_smfmac_f32_16x16x64_bf16 v[68:71], v[36:39], a[152:159], v3
    ds_read_b128 v[52:55], v7 offset:1024
    v_smfmac_f32_16x16x64_bf16 v[72:75], v[36:39], a[160:167], v3
    s_add_u32 s27, s27, 7168
    v_smfmac_f32_16x16x64_bf16 v[76:79], v[36:39], a[168:175], v3
    s_add_u32 s28, s28, 7168
    v_smfmac_f32_16x16x64_bf16 v[80:83], v[36:39], a[176:183], v3
    s_add_u32 s29, s29, 7168
    v_smfmac_f32_16x16x64_bf16 v[84:87], v[36:39], a[184:191], v3
    s_waitcnt lgkmcnt(0)
    v_smfmac_f32_16x16x64_bf16 v[56:59], v[40:43], a[192:199], v3
    s_nop 0
    buffer_load_dwordx4 v[28:31], v4, s[8:11], s27 offen sc1
    v_smfmac_f32_16x16x64_bf16 v[56:59], v[48:51], v[120:127], v3
    s_nop 1
    ds_read_b128 v[120:123], v6 offset:8192
    v_smfmac_f32_16x16x64_bf16 v[56:59], v[44:47], v[190:197], v3
    s_nop 1
    ds_read_b128 v[124:127], v6 offset:9216
    v_smfmac_f32_16x16x64_bf16 v[56:59], v[52:55], v[128:135], v3
    s_nop 1
    ds_read_b128 v[128:131], v6 offset:10240
    v_smfmac_f32_16x16x64_bf16 v[60:63], v[40:43], a[200:207], v3
    buffer_load_dwordx4 v[32:35], v4, s[8:11], s28 offen sc1
    ds_read_b128 v[132:135], v6 offset:11264
    v_smfmac_f32_16x16x64_bf16 v[60:63], v[48:51], v[136:143], v3
    s_nop 0
    ds_read_b128 v[136:139], v6 offset:12288
    v_add_f32 v56, v56, v57
    v_smfmac_f32_16x16x64_bf16 v[60:63], v[44:47], v[198:205], v3
    s_nop 0
    ds_read_b128 v[140:143], v6 offset:13312
    v_add_f32 v58, v58, v59
    v_smfmac_f32_16x16x64_bf16 v[60:63], v[52:55], v[144:151], v3
    s_nop 0
    ds_read_b128 v[144:147], v6 offset:14336
    v_cvt_pk_bf16_f32 v162, v56, v58
    v_smfmac_f32_16x16x64_bf16 v[64:67], v[40:43], a[208:215], v3
    s_waitcnt lgkmcnt(5)
    buffer_load_dwordx4 v[36:39], v4, s[8:11], s29 offen sc1
    ds_read_b128 v[148:151], v6 offset:15360
    v_smfmac_f32_16x16x64_bf16 v[64:67], v[48:51], v[120:127], v3
    s_nop 0
    ds_read_b128 v[120:123], v6 offset:16384
    v_add_f32 v60, v60, v61
    v_smfmac_f32_16x16x64_bf16 v[64:67], v[44:47], v[206:213], v3
    s_waitcnt lgkmcnt(5)
    ds_read_b128 v[124:127], v6 offset:17408
    v_add_f32 v62, v62, v63
    v_smfmac_f32_16x16x64_bf16 v[64:67], v[52:55], v[128:135], v3
    s_nop 0
    ds_read_b128 v[128:131], v6 offset:18432
    v_cvt_pk_bf16_f32 v170, v60, v62
    v_smfmac_f32_16x16x64_bf16 v[68:71], v[40:43], a[216:223], v3
    s_nop 0
    s_waitcnt lgkmcnt(5)
    ds_read_b128 v[132:135], v6 offset:19456
    v_smfmac_f32_16x16x64_bf16 v[68:71], v[48:51], v[136:143], v3
    s_nop 0
    ds_read_b128 v[136:139], v6 offset:20480
    v_add_f32 v64, v64, v65
    v_smfmac_f32_16x16x64_bf16 v[68:71], v[44:47], v[214:221], v3
    s_waitcnt lgkmcnt(5)
    ds_read_b128 v[140:143], v6 offset:21504
    v_add_f32 v66, v66, v67
    v_smfmac_f32_16x16x64_bf16 v[68:71], v[52:55], v[144:151], v3
    s_nop 0
    ds_read_b128 v[144:147], v6 offset:22528
    v_cvt_pk_bf16_f32 v163, v64, v66
    v_smfmac_f32_16x16x64_bf16 v[72:75], v[40:43], a[224:231], v3
    s_nop 0
    s_waitcnt lgkmcnt(5)
    ds_read_b128 v[148:151], v6 offset:23552
    v_smfmac_f32_16x16x64_bf16 v[72:75], v[48:51], v[120:127], v3
    s_nop 0
    ds_read_b128 v[120:123], v6 offset:24576
    v_add_f32 v68, v68, v69
    v_smfmac_f32_16x16x64_bf16 v[72:75], v[44:47], v[222:229], v3
    s_waitcnt lgkmcnt(5)
    ds_read_b128 v[124:127], v6 offset:25600
    v_add_f32 v70, v70, v71
    v_smfmac_f32_16x16x64_bf16 v[72:75], v[52:55], v[128:135], v3
    s_nop 0
    ds_read_b128 v[128:131], v6 offset:26624
    v_cvt_pk_bf16_f32 v171, v68, v70
    v_smfmac_f32_16x16x64_bf16 v[76:79], v[40:43], a[232:239], v3
    s_nop 0
    s_waitcnt lgkmcnt(5)
    ds_read_b128 v[132:135], v6 offset:27648
    v_smfmac_f32_16x16x64_bf16 v[76:79], v[48:51], v[136:143], v3
    s_nop 0
    ds_read_b128 v[136:139], v6 offset:28672
    v_add_f32 v72, v72, v73
    v_smfmac_f32_16x16x64_bf16 v[76:79], v[44:47], v[230:237], v3
    s_waitcnt lgkmcnt(5)
    ds_read_b128 v[140:143], v6 offset:29696
    v_add_f32 v74, v74, v75
    v_smfmac_f32_16x16x64_bf16 v[76:79], v[52:55], v[144:151], v3
    s_nop 0
    ds_read_b128 v[144:147], v6 offset:30720
    v_cvt_pk_bf16_f32 v164, v72, v74
    v_smfmac_f32_16x16x64_bf16 v[80:83], v[40:43], a[240:247], v3
    s_nop 0
    s_waitcnt lgkmcnt(5)
    ds_read_b128 v[148:151], v6 offset:31744
    v_smfmac_f32_16x16x64_bf16 v[80:83], v[48:51], v[120:127], v3
    s_nop 1
    v_add_f32 v76, v76, v77
    v_smfmac_f32_16x16x64_bf16 v[80:83], v[44:47], v[238:245], v3
    s_nop 0
    s_waitcnt lgkmcnt(4)
    v_add_f32 v78, v78, v79
    v_smfmac_f32_16x16x64_bf16 v[80:83], v[52:55], v[128:135], v3
    s_nop 1
    v_cvt_pk_bf16_f32 v172, v76, v78
    v_smfmac_f32_16x16x64_bf16 v[84:87], v[40:43], a[248:255], v3
    s_nop 1
    s_waitcnt lgkmcnt(2)
    v_smfmac_f32_16x16x64_bf16 v[84:87], v[48:51], v[136:143], v3
    s_nop 1
    v_add_f32 v80, v80, v81
    v_smfmac_f32_16x16x64_bf16 v[84:87], v[44:47], v[246:253], v3
    s_nop 0
    s_waitcnt lgkmcnt(0)
    v_add_f32 v82, v82, v83
    v_smfmac_f32_16x16x64_bf16 v[84:87], v[52:55], v[144:151], v3
    s_nop 1
    v_cvt_pk_bf16_f32 v165, v80, v82
    s_waitcnt vmcnt(0)
    s_barrier
    buffer_store_dword v20, v21, s[8:11], 0 offen sc1
    v_mov_b64 v[174:175], 0
    v_mov_b64 v[176:177], 0
    v_mov_b64 v[178:179], 0
    v_mov_b64 v[180:181], 0
    s_add_u32 s22, s22, 1
    s_nop 0
    v_add_f32 v84, v84, v85
    v_add_f32 v86, v86, v87
    v_cvt_pk_bf16_f32 v173, v84, v86
    v_mov_b32 v20, s22
    v_mfma_f32_32x32x16_bf16 v[56:71], v[182:185], v[182:185], 0
    v_mfma_f32_32x32x16_bf16 v[72:87], v[182:185], v[182:185], 0
    buffer_store_dwordx4 v[162:165], v17, s[8:11], s34 offen offset:0 sc1
    buffer_store_dwordx4 v[170:173], v17, s[8:11], s34 offen offset:256 sc1
    ds_read_b128 v[120:123], v6 offset:0
    ds_read_b128 v[124:127], v6 offset:1024
    ds_read_b128 v[128:131], v6 offset:2048
    ds_read_b128 v[132:135], v6 offset:3072
    ds_read_b128 v[136:139], v6 offset:4096
    ds_read_b128 v[140:143], v6 offset:5120
    ds_read_b128 v[144:147], v6 offset:6144
    ds_read_b128 v[148:151], v6 offset:7168
    s_add_u32 s34, s34, 114688
    s_cmp_lt_u32 s22, 62
    s_cbranch_scc1 Bfol2_chk
    s_waitcnt vmcnt(0)
    buffer_store_dword v20, v21, s[8:11], 0 offen sc1
    s_branch B_done
Bfol2_fix:
    s_waitcnt vmcnt(0)
    buffer_store_dword v20, v21, s[8:11], 0 offen sc1
Bfol2_fixl:
    s_sub_u32 s23, s23, 1
    s_cbranch_scc1 B_done
    buffer_load_dwordx4 v[28:31], v4, s[8:11], s27 offen sc1
    buffer_load_dwordx4 v[32:35], v4, s[8:11], s28 offen sc1
    buffer_load_dwordx4 v[36:39], v4, s[8:11], s29 offen sc1
    s_waitcnt vmcnt(0)
    v_max3_u32 v23, v28, v29, v30
    v_max3_u32 v23, v31, v32, v23
    v_max3_u32 v23, v33, v34, v23
    v_max3_u32 v23, v35, v36, v23
    v_max3_u32 v23, v37, v38, v23
    v_max_u32 v23, v39, v23
    v_cmp_eq_u32 vcc, -1, v23
    s_cbranch_vccz Bfol2_retry
    s_sleep 1
    s_branch Bfol2_fixl
.p2align 6
Bfol3_top:
    s_add_u32 s27, s24, 3072
    s_add_u32 s28, s24, 1024
    s_add_u32 s29, s24, 4096
    s_add_u32 s26, s31, 4096
    buffer_load_dwordx4 v[28:31], v4, s[8:11], s27 offen sc1
    buffer_load_dwordx4 v[32:35], v4, s[8:11], s28 offen sc1
    buffer_load_dwordx4 v[36:39], v4, s[8:11], s29 offen sc1
    s_waitcnt vmcnt(0)
Bfol3_chk:
    v_max3_u32 v23, v28, v29, v30
    v_max3_u32 v23, v31, v32, v23
    v_max3_u32 v23, v33, v34, v23
    v_max3_u32 v23, v35, v36, v23
    v_max3_u32 v23, v37, v38, v23
    v_max_u32 v23, v39, v23
    v_cmp_eq_u32 vcc, -1, v23
    s_cbranch_vccnz Bfol3_fix
Bfol3_retry:
    v_smfmac_f32_16x16x64_bf16 v[56:59], v[28:31], a[0:7], v3
    ds_write_b128 v7, v[28:31] offset:3072
    v_smfmac_f32_16x16x64_bf16 v[60:63], v[28:31], a[8:15], v3
    v_smfmac_f32_16x16x64_bf16 v[64:67], v[28:31], a[16:23], v3
    v_smfmac_f32_16x16x64_bf16 v[68:71], v[28:31], a[24:31], v3
    v_smfmac_f32_16x16x64_bf16 v[72:75], v[28:31], a[32:39], v3
    v_smfmac_f32_16x16x64_bf16 v[76:79], v[28:31], a[40:47], v3
    v_smfmac_f32_16x16x64_bf16 v[80:83], v[28:31], a[48:55], v3
    v_smfmac_f32_16x16x64_bf16 v[84:87], v[28:31], a[56:63], v3
    v_smfmac_f32_16x16x64_bf16 v[56:59], v[32:35], a[64:71], v3
    v_smfmac_f32_16x16x64_bf16 v[60:63], v[32:35], a[72:79], v3
    v_smfmac_f32_16x16x64_bf16 v[64:67], v[32:35], a[80:87], v3
    v_smfmac_f32_16x16x64_bf16 v[68:71], v[32:35], a[88:95], v3
    v_smfmac_f32_16x16x64_bf16 v[72:75], v[32:35], a[96:103], v3
    v_smfmac_f32_16x16x64_bf16 v[76:79], v[32:35], a[104:111], v3
    v_smfmac_f32_16x16x64_bf16 v[80:83], v[32:35], a[112:119], v3
    v_smfmac_f32_16x16x64_bf16 v[84:87], v[32:35], a[120:127], v3
    v_smfmac_f32_16x16x64_bf16 v[56:59], v[36:39], a[128:135], v3
    s_waitcnt lgkmcnt(0)
    s_barrier
    ds_read_b128 v[40:43], v7 offset:5120
    v_smfmac_f32_16x16x64_bf16 v[60:63], v[36:39], a[136:143], v3
    ds_read_b128 v[48:51], v7 offset:0
    v_smfmac_f32_16x16x64_bf16 v[64:67], v[36:39], a[144:151], v3
    ds_read_b128 v[44:47], v7 offset:6144
    v_smfmac_f32_16x16x64_bf16 v[68:71], v[36:39], a[152:159], v3
    ds_read_b128 v[52:55], v7 offset:2048
    v_smfmac_f32_16x16x64_bf16 v[72:75], v[36:39], a[160:167], v3
    s_add_u32 s27, s27, 7168
    v_smfmac_f32_16x16x64_bf16 v[76:79], v[36:39], a[168:175], v3
    s_add_u32 s28, s28, 7168
    v_smfmac_f32_16x16x64_bf16 v[80:83], v[36:39], a[176:183], v3
    s_add_u32 s29, s29, 7168
    v_smfmac_f32_16x16x64_bf16 v[84:87], v[36:39], a[184:191], v3
    s_waitcnt lgkmcnt(0)
    v_smfmac_f32_16x16x64_bf16 v[56:59], v[40:43], a[192:199], v3
    s_nop 0
    buffer_load_dwordx4 v[28:31], v4, s[8:11], s27 offen sc1
    v_smfmac_f32_16x16x64_bf16 v[56:59], v[48:51], v[120:127], v3
    s_nop 1
    ds_read_b128 v[120:123], v6 offset:8192
    v_smfmac_f32_16x16x64_bf16 v[56:59], v[44:47], v[190:197], v3
    s_nop 1
    ds_read_b128 v[124:127], v6 offset:9216
    v_smfmac_f32_16x16x64_bf16 v[56:59], v[52:55], v[128:135], v3
    s_nop 1
    ds_read_b128 v[128:131], v6 offset:10240
    v_smfmac_f32_16x16x64_bf16 v[60:63], v[40:43], a[200:207], v3
    buffer_load_dwordx4 v[32:35], v4, s[8:11], s28 offen sc1
    ds_read_b128 v[132:135], v6 offset:11264
    v_smfmac_f32_16x16x64_bf16 v[60:63], v[48:51], v[136:143], v3
    s_nop 0
    ds_read_b128 v[136:139], v6 offset:12288
    v_add_f32 v56, v56, v57
    v_smfmac_f32_16x16x64_bf16 v[60:63], v[44:47], v[198:205], v3
    s_nop 0
    ds_read_b128 v[140:143], v6 offset:13312
    v_add_f32 v58, v58, v59
    v_smfmac_f32_16x16x64_bf16 v[60:63], v[52:55], v[144:151], v3
    s_nop 0
    ds_read_b128 v[144:147], v6 offset:14336
    v_cvt_pk_bf16_f32 v162, v56, v58
    v_smfmac_f32_16x16x64_bf16 v[64:67], v[40:43], a[208:215], v3
    s_waitcnt lgkmcnt(5)
    buffer_load_dwordx4 v[36:39], v4, s[8:11], s29 offen sc1
    ds_read_b128 v[148:151], v6 offset:15360
    v_smfmac_f32_16x16x64_bf16 v[64:67], v[48:51], v[120:127], v3
    s_nop 0
    ds_read_b128 v[120:123], v6 offset:16384
    v_add_f32 v60, v60, v61
    v_smfmac_f32_16x16x64_bf16 v[64:67], v[44:47], v[206:213], v3
    s_waitcnt lgkmcnt(5)
    ds_read_b128 v[124:127], v6 offset:17408
    v_add_f32 v62, v62, v63
    v_smfmac_f32_16x16x64_bf16 v[64:67], v[52:55], v[128:135], v3
    s_nop 0
    ds_read_b128 v[128:131], v6 offset:18432
    v_cvt_pk_bf16_f32 v170, v60, v62
    v_smfmac_f32_16x16x64_bf16 v[68:71], v[40:43], a[216:223], v3
    s_nop 0
    s_waitcnt lgkmcnt(5)
    ds_read_b128 v[132:135], v6 offset:19456
    v_smfmac_f32_16x16x64_bf16 v[68:71], v[48:51], v[136:143], v3
    s_nop 0
    ds_read_b128 v[136:139], v6 offset:20480
    v_add_f32 v64, v64, v65
    v_smfmac_f32_16x16x64_bf16 v[68:71], v[44:47], v[214:221], v3
    s_waitcnt lgkmcnt(5)
    ds_read_b128 v[140:143], v6 offset:21504
    v_add_f32 v66, v66, v67
    v_smfmac_f32_16x16x64_bf16 v[68:71], v[52:55], v[144:151], v3
    s_nop 0
    ds_read_b128 v[144:147], v6 offset:22528
    v_cvt_pk_bf16_f32 v163, v64, v66
    v_smfmac_f32_16x16x64_bf16 v[72:75], v[40:43], a[224:231], v3
    s_nop 0
    s_waitcnt lgkmcnt(5)
    ds_read_b128 v[148:151], v6 offset:23552
    v_smfmac_f32_16x16x64_bf16 v[72:75], v[48:51], v[120:127], v3
    s_nop 0
    ds_read_b128 v[120:123], v6 offset:24576
    v_add_f32 v68, v68, v69
    v_smfmac_f32_16x16x64_bf16 v[72:75], v[44:47], v[222:229], v3
    s_waitcnt lgkmcnt(5)
    ds_read_b128 v[124:127], v6 offset:25600
    v_add_f32 v70, v70, v71
    v_smfmac_f32_16x16x64_bf16 v[72:75], v[52:55], v[128:135], v3
    s_nop 0
    ds_read_b128 v[128:131], v6 offset:26624
    v_cvt_pk_bf16_f32 v171, v68, v70
    v_smfmac_f32_16x16x64_bf16 v[76:79], v[40:43], a[232:239], v3
    s_nop 0
    s_waitcnt lgkmcnt(5)
    ds_read_b128 v[132:135], v6 offset:27648
    v_smfmac_f32_16x16x64_bf16 v[76:79], v[48:51], v[136:143], v3
    s_nop 0
    ds_read_b128 v[136:139], v6 offset:28672
    v_add_f32 v72, v72, v73
    v_smfmac_f32_16x16x64_bf16 v[76:79], v[44:47], v[230:237], v3
    s_waitcnt lgkmcnt(5)
    ds_read_b128 v[140:143], v6 offset:29696
    v_add_f32 v74, v74, v75
    v_smfmac_f32_16x16x64_bf16 v[76:79], v[52:55], v[144:151], v3
    s_nop 0
    ds_read_b128 v[144:147], v6 offset:30720
    v_cvt_pk_bf16_f32 v164, v72, v74
    v_smfmac_f32_16x16x64_bf16 v[80:83], v[40:43], a[240:247], v3
    s_nop 0
    s_waitcnt lgkmcnt(5)
    ds_read_b128 v[148:151], v6 offset:31744
    v_smfmac_f32_16x16x64_bf16 v[80:83], v[48:51], v[120:127], v3
    s_nop 1
    v_add_f32 v76, v76, v77
    v_smfmac_f32_16x16x64_bf16 v[80:83], v[44:47], v[238:245], v3
    s_nop 0
    s_waitcnt lgkmcnt(4)
    v_add_f32 v78, v78, v79
    v_smfmac_f32_16x16x64_bf16 v[80:83], v[52:55], v[128:135], v3
    s_nop 1
    v_cvt_pk_bf16_f32 v172, v76, v78
    v_smfmac_f32_16x16x64_bf16 v[84:87], v[40:43], a[248:255], v3
    s_nop 1
    s_waitcnt lgkmcnt(2)
    v_smfmac_f32_16x16x64_bf16 v[84:87], v[48:51], v[136:143], v3
    s_nop 1
    v_add_f32 v80, v80, v81
    v_smfmac_f32_16x16x64_bf16 v[84:87], v[44:47], v[246:253], v3
    s_nop 0
    s_waitcnt lgkmcnt(0)
    v_add_f32 v82, v82, v83
    v_smfmac_f32_16x16x64_bf16 v[84:87], v[52:55], v[144:151], v3
    s_nop 1
    v_cvt_pk_bf16_f32 v165, v80, v82
    s_waitcnt vmcnt(0)
    s_barrier
    buffer_store_dword v20, v21, s[8:11], 0 offen sc1
    v_mov_b64 v[174:175], 0
    v_mov_b64 v[176:177], 0
    v_mov_b64 v[178:179], 0
    v_mov_b64 v[180:181], 0
    s_add_u32 s22, s22, 1
    s_nop 0
    v_add_f32 v84, v84, v85
    v_add_f32 v86, v86, v87
    v_cvt_pk_bf16_f32 v173, v84, v86
    v_mov_b32 v20, s22
    v_mfma_f32_32x32x16_bf16 v[56:71], v[182:185], v[182:185], 0
    v_mfma_f32_32x32x16_bf16 v[72:87], v[182:185], v[182:185], 0
    buffer_store_dwordx4 v[162:165], v17, s[8:11], s34 offen offset:0 sc1
    buffer_store_dwordx4 v[170:173], v17, s[8:11], s34 offen offset:256 sc1
    ds_read_b128 v[120:123], v6 offset:0
    ds_read_b128 v[124:127], v6 offset:1024
    ds_read_b128 v[128:131], v6 offset:2048
    ds_read_b128 v[132:135], v6 offset:3072
    ds_read_b128 v[136:139], v6 offset:4096
    ds_read_b128 v[140:143], v6 offset:5120
    ds_read_b128 v[144:147], v6 offset:6144
    ds_read_b128 v[148:151], v6 offset:7168
    s_add_u32 s34, s34, 114688
    s_cmp_lt_u32 s22, 62
    s_cbranch_scc1 Bfol3_chk
    s_waitcnt vmcnt(0)
    buffer_store_dword v20, v21, s[8:11], 0 offen sc1
    s_branch B_done
Bfol3_fix:
    s_waitcnt vmcnt(0)
    buffer_store_dword v20, v21, s[8:11], 0 offen sc1
Bfol3_fixl:
    s_sub_u32 s23, s23, 1
    s_cbranch_scc1 B_done
    buffer_load_dwordx4 v[28:31], v4, s[8:11], s27 offen sc1
    buffer_load_dwordx4 v[32:35], v4, s[8:11], s28 offen sc1
    buffer_load_dwordx4 v[36:39], v4, s[8:11], s29 offen sc1
    s_waitcnt vmcnt(0)
    v_max3_u32 v23, v28, v29, v30
    v_max3_u32 v23, v31, v32, v23
    v_max3_u32 v23, v33, v34, v23
    v_max3_u32 v23, v35, v36, v23
    v_max3_u32 v23, v37, v38, v23
    v_max_u32 v23, v39, v23
    v_cmp_eq_u32 vcc, -1, v23
    s_cbranch_vccz Bfol3_retry
    s_sleep 1
    s_branch Bfol3_fixl
B_done:
    s_branch main_fin
main_P:
    s_sub_u32 s20, s20, 30
    s_mov_b32 s22, 0
    s_mov_b32 s23, 400000
    v_mov_b32 v5, 18623488
    v_mov_b32 v6, 0
    s_cmp_lg_u32 s20, 0
    s_cbranch_scc1 P_one
    v_and_b32 v4, 255, v0
    v_lshlrev_b32 v3, 7, v0
    s_mov_b32 s26, 536870913
    v_add_u32 v7, 0, v4
    v_min_u32 v7, 447, v7
    v_mul_hi_u32 v8, v7, s26
    v_mul_u32_u24 v9, 56, v8
    v_add_u32 v7, v7, v9
    v_add_u32 v7, 56, v7
    v_lshlrev_b32 v12, 7, v7
    v_add_u32 v7, 256, v4
    v_min_u32 v7, 447, v7
    v_mul_hi_u32 v8, v7, s26
    v_mul_u32_u24 v9, 56, v8
    v_add_u32 v7, v7, v9
    v_add_u32 v7, 56, v7
    v_lshlrev_b32 v13, 7, v7
    s_mov_b32 s40, 18621056
    s_cmp_eq_u32 s21, 0
    s_cselect_b32 s40, s40, 2147483632
    v_mov_b32 v8, 18616320
ww_49:
    buffer_load_dword v7, v8, s[8:11], 0 offen sc1
    s_waitcnt vmcnt(0)
    v_cmp_gt_u32 vcc, 66, v7
    s_cbranch_vccz ww_49k
    s_sleep 3
    s_sub_u32 s23, s23, 1
    s_cbranch_scc0 ww_49
    s_mov_b32 s23, 0
ww_49k:
    s_mov_b32 s26, 13631488
    buffer_load_dword v9, v3, s[8:11], s26 offen sc1
    v_lshlrev_b32 v8, 5, v0
    s_mov_b32 s26, 18284544
    buffer_load_dword v9, v8, s[8:11], s26 offen sc1
    s_mov_b32 s26, 18284544
    buffer_load_dword v9, v3, s[8:11], s26 offen sc1
    s_mov_b32 s26, 18317312
    buffer_load_dword v9, v3, s[8:11], s26 offen sc1
    s_mov_b32 s26, 18350080
    buffer_load_dword v9, v3, s[8:11], s26 offen sc1
P_f0w:
    s_sub_u32 s27, s22, 2
    s_cselect_b32 s27, 0, s27
    s_add_u32 s26, s22, 1
    s_min_u32 s26, s26, 63
    s_lshr_b32 s26, s26, 2
    s_lshl_b32 s26, s26, 7
    s_add_u32 s26, s26, 18616320
    buffer_load_dword v7, v5, s[8:11], 0 offen sc1
    buffer_load_dword v8, v6, s[8:11], s26 offen sc1
    s_sub_u32 s23, s23, 1
    s_cbranch_scc1 P_done
    s_waitcnt vmcnt(0)
P_f0:
    v_cmp_gt_u32 vcc, s27, v7
    s_cbranch_vccnz P_f0w
    v_cmp_gt_u32 vcc, 66, v8
    s_cbranch_vccnz P_f0w
    s_mul_i32 s28, s22, 458752
    s_add_u32 s28, s28, 27262976
    s_lshl_b32 s29, s22, 15
    s_add_u32 s29, s29, 13664256
    s_add_u32 s22, s22, 1
    s_cmp_le_u32 s22, 8
    s_cselect_b32 s26, s40, 2147483632
    v_mov_b32 v10, s22
    v_mov_b32 v11, s26
    s_mov_b64 exec, 1
    buffer_store_dword v10, v11, s[8:11], 0 offen sc1
    s_mov_b64 exec, -1
    s_sub_u32 s26, s22, 1
    v_cmp_gt_u32 vcc, s26, v7
    s_cbranch_vccnz P_f0f
    s_sub_u32 s27, s22, 2
    s_cselect_b32 s27, 0, s27
    s_add_u32 s26, s22, 1
    s_min_u32 s26, s26, 63
    s_lshr_b32 s26, s26, 2
    s_lshl_b32 s26, s26, 7
    s_add_u32 s26, s26, 18616320
    buffer_load_dword v7, v5, s[8:11], 0 offen sc1
    buffer_load_dword v8, v6, s[8:11], s26 offen sc1
    buffer_load_dword v9, v3, s[8:11], s29 offen sc1
    s_waitcnt vmcnt(1)
    s_branch P_f0e
P_f0f:
    s_sub_u32 s27, s22, 2
    s_cselect_b32 s27, 0, s27
    s_add_u32 s26, s22, 1
    s_min_u32 s26, s26, 63
    s_lshr_b32 s26, s26, 2
    s_lshl_b32 s26, s26, 7
    s_add_u32 s26, s26, 18616320
    buffer_load_dword v7, v5, s[8:11], 0 offen sc1
    buffer_load_dword v8, v6, s[8:11], s26 offen sc1
    buffer_load_dword v9, v3, s[8:11], s29 offen sc1
    buffer_load_dword v9, v12, s[8:11], s28 offen sc1
    buffer_load_dword v9, v13, s[8:11], s28 offen sc1
    s_waitcnt vmcnt(3)
P_f0e:
    s_cmp_lt_u32 s22, 63
    s_cbranch_scc1 P_f0
    v_mul_u32_u24 v4, 24, v0
    v_add_u32 v4, Bfol0_top-main_pc, v4
    global_load_dword v9, v4, s[98:99]
    s_branch P_done
P_one:
    s_cmp_lt_u32 s21, 2
    s_cbranch_scc1 P_relay
    v_and_b32 v4, 127, v0
    v_lshlrev_b32 v3, 7, v0
    s_mov_b32 s26, 2147483649
    s_branch P_done
P_f1w:
    s_sub_u32 s27, s22, 2
    s_cselect_b32 s27, 0, s27
    s_add_u32 s26, s22, 1
    s_min_u32 s26, s26, 63
    s_lshr_b32 s26, s26, 2
    s_lshl_b32 s26, s26, 7
    s_add_u32 s26, s26, 18616320
    buffer_load_dword v7, v5, s[8:11], 0 offen sc1
    buffer_load_dword v8, v6, s[8:11], s26 offen sc1
    s_sub_u32 s23, s23, 1
    s_cbranch_scc1 P_done
    s_waitcnt vmcnt(0)
P_f1:
    v_cmp_gt_u32 vcc, s27, v7
    s_cbranch_vccnz P_f1w
    v_cmp_gt_u32 vcc, 66, v8
    s_cbranch_vccnz P_f1w
    s_mul_i32 s28, s22, 458752
    s_add_u32 s28, s28, 27262976
    s_lshl_b32 s29, s22, 15
    s_add_u32 s29, s29, 13664256
    s_add_u32 s22, s22, 1
    s_sub_u32 s26, s22, 1
    v_cmp_gt_u32 vcc, s26, v7
    s_cbranch_vccnz P_f1f
    s_sub_u32 s27, s22, 2
    s_cselect_b32 s27, 0, s27
    s_add_u32 s26, s22, 1
    s_min_u32 s26, s26, 63
    s_lshr_b32 s26, s26, 2
    s_lshl_b32 s26, s26, 7
    s_add_u32 s26, s26, 18616320
    buffer_load_dword v7, v5, s[8:11], 0 offen sc1
    buffer_load_dword v8, v6, s[8:11], s26 offen sc1
    s_waitcnt vmcnt(0)
    s_branch P_f1e
P_f1f:
    s_sub_u32 s27, s22, 2
    s_cselect_b32 s27, 0, s27
    s_add_u32 s26, s22, 1
    s_min_u32 s26, s26, 63
    s_lshr_b32 s26, s26, 2
    s_lshl_b32 s26, s26, 7
    s_add_u32 s26, s26, 18616320
    buffer_load_dword v7, v5, s[8:11], 0 offen sc1
    buffer_load_dword v8, v6, s[8:11], s26 offen sc1
    s_waitcnt vmcnt(0)
P_f1e:
    s_cmp_lt_u32 s22, 63
    s_cbranch_scc1 P_f1
    s_branch P_done
P_relay:
    v_bfe_u32 v6, v0, 0, 6
    v_lshlrev_b32 v3, 4, v6
    v_bfe_u32 v6, v0, 6, 1
    v_mul_u32_u24 v6, 3584, v6
    v_add_u32 v3, v6, v3
    v_and_b32 v6, 32, v0
    v_cmp_eq_u32 vcc, 0, v6
    v_mov_b32 v6, 2147483632
    s_lshl_b32 s26, s21, 2
    v_cndmask_b32 v10, v6, v3, vcc
    s_add_u32 s29, s26, 18612736
P_rl:
    s_add_u32 s22, s22, 1
    s_and_b32 s26, s22, 7
    s_mul_i32 s26, s26, 7168
    s_add_u32 s26, s26, 18284544
    s_mul_i32 s27, s22, 7168
    s_add_u32 s27, s27, 17825792
    v_mov_b32 v11, s22
P_rlp:
    buffer_load_dwordx4 v[12:15], v3, s[8:11], s26 offen offset:0 sc1
    buffer_load_dwordx4 v[16:19], v3, s[8:11], s26 offen offset:1024 sc1
    buffer_load_dwordx4 v[20:23], v3, s[8:11], s26 offen offset:2048 sc1
    buffer_load_dwordx4 v[24:27], v10, s[8:11], s26 offen offset:3072 sc1
    s_sub_u32 s23, s23, 1
    s_cbranch_scc1 P_done
    s_waitcnt vmcnt(0)
    v_max_u32 v6, v12, v13
    v_max3_u32 v6, v14, v15, v6
    v_max3_u32 v6, v16, v17, v6
    v_max3_u32 v6, v18, v19, v6
    v_max3_u32 v6, v20, v21, v6
    v_max3_u32 v6, v22, v23, v6
    v_max3_u32 v6, v24, v25, v6
    v_max3_u32 v6, v26, v27, v6
    v_cmp_eq_u32 vcc, -1, v6
    s_cbranch_vccz P_rlk
    s_sleep 3
    s_branch P_rlp
P_rlk:
    buffer_store_dwordx4 v[12:15], v3, s[8:11], s27 offen offset:0 sc1
    buffer_store_dwordx4 v[16:19], v3, s[8:11], s27 offen offset:1024 sc1
    buffer_store_dwordx4 v[20:23], v3, s[8:11], s27 offen offset:2048 sc1
    buffer_store_dwordx4 v[24:27], v10, s[8:11], s27 offen offset:3072 sc1
    s_mov_b64 exec, 1
    s_cmp_lg_u32 s17, 0
    s_cbranch_scc1 P_rls
    buffer_store_dword v11, off, s[8:11], s29
    s_branch P_rlt
P_rls:
    buffer_store_dword v11, off, s[8:11], s29 sc1
P_rlt:
    s_mov_b64 exec, -1
    s_cmp_lt_u32 s22, 62
    s_cbranch_scc1 P_rl
P_done:
    s_branch main_fin
main_w:
    s_add_u32 s6, s6, job_table-main_pc
    s_addc_u32 s7, s7, 0
    s_sub_u32 s4, s20, 32
    s_min_u32 s4, s4, 223
    s_lshl_b32 s4, s4, 6
main_next:
    s_load_dword s3, s[6:7], s4
    s_add_u32 s4, s4, 4
    v_and_b32 v2, 63, v0
    v_lshlrev_b32 v2, 4, v2
    s_waitcnt lgkmcnt(0)
    s_bfe_u32 s24, s3, 0x80008
    s_bfe_u32 s25, s3, 0x80010
    s_and_b32 s3, s3, 15
    s_cmp_eq_u32 s3, 1
    s_cbranch_scc1 job_1
    s_cmp_eq_u32 s3, 8
    s_cbranch_scc1 job_8
    s_cmp_eq_u32 s3, 11
    s_cbranch_scc1 job_11
    s_cmp_eq_u32 s3, 2
    s_cbranch_scc1 job_2
    s_cmp_eq_u32 s3, 3
    s_cbranch_scc1 job_3
    s_cmp_eq_u32 s3, 4
    s_cbranch_scc1 job_4
    s_cmp_eq_u32 s3, 5
    s_cbranch_scc1 job_5
    s_cmp_eq_u32 s3, 6
    s_cbranch_scc1 job_6
    s_cmp_eq_u32 s3, 9
    s_cbranch_scc1 job_9
    s_cmp_eq_u32 s3, 10
    s_cbranch_scc1 job_10
    s_cmp_eq_u32 s3, 12
    s_cbranch_scc1 job_12
    s_cmp_lg_u32 s3, 7
    s_cbranch_scc1 main_end
    s_min_u32 s20, s24, 13
    s_mov_b32 s17, 2
    s_branch main_Bf
job_1:
    s_lshl_b32 s33, s25, 2
    s_add_u32 s33, s33, s21
    s_lshr_b32 s31, s24, 4
    s_and_b32 s24, s24, 15
    s_mul_i32 s31, s31, 14
    s_min_u32 s31, s31, 11
    s_mul_i32 s26, s24, 14
    s_add_u32 s26, s26, s31
    s_mul_i32 s26, s26, 28672
    s_add_u32 s26, s26, 6422528
    s_mul_i32 s29, s33, 14
    s_add_u32 s29, s29, s31
    s_lshl_b32 s29, s29, 15
    s_lshl_b32 s30, s24, 11
    s_add_u32 s29, s29, s30
    s_add_u32 s29, s29, 27262976
    s_mov_b32 s34, s26
    s_add_u32 s35, s26, 401408
    s_mov_b32 s36, s29
    s_add_u32 s37, s29, 458752
    s_mul_i32 s31, s25, 5
    s_mul_i32 s30, s31, 147
    s_lshr_b32 s30, s30, 11
    s_mul_i32 s30, s30, 14
    s_sub_u32 s31, s31, s30
    s_mul_i32 s30, s31, 28672
    s_add_u32 s26, s26, s30
    s_lshl_b32 s30, s31, 15
    s_add_u32 s29, s29, s30
    s_lshl_b32 s28, s24, 7
    s_add_u32 s28, s28, 18636800
    v_mov_b32 v7, v2
    s_mul_i32 s32, s21, 7168
    v_add_u32 v4, s32, v2
    v_add_u32 v8, 57344, v7
    s_mul_i32 s27, s33, 28672
    s_add_u32 s27, s27, 15728640
    s_lshr_b32 s3, s33, 2
    s_lshl_b32 s3, s3, 7
    s_add_u32 s3, s3, 18614272
    v_mov_b32 v6, s28
    v_writelane_b32 v6, s3, 0
    v_mov_b32 v12, 10922
    v_writelane_b32 v12, 2, 0
gw_50:
    buffer_load_dword v3, v6, s[8:11], 0 offen sc1
    s_waitcnt vmcnt(0)
    v_cmp_gt_u32 vcc, v12, v3
    s_cbranch_vccz gw_50k
    s_sleep 2
    s_sub_u32 s23, s23, 1
    s_cbranch_scc0 gw_50
    s_mov_b32 s23, 0
gw_50k:
    s_add_u32 m0, s32, 0
    s_add_u32 s28, s26, 0
    buffer_load_dwordx4 v4, s[8:11], s28 offen offset:0 sc1 lds
    buffer_load_dwordx4 v4, s[8:11], s28 offen offset:1024 sc1 lds
    buffer_load_dwordx4 v4, s[8:11], s28 offen offset:2048 sc1 lds
    buffer_load_dwordx4 v4, s[8:11], s28 offen offset:3072 sc1 lds
    s_add_u32 m0, s32, 4096
    s_add_u32 s28, s26, 4096
    buffer_load_dwordx4 v4, s[8:11], s28 offen offset:0 sc1 lds
    buffer_load_dwordx4 v4, s[8:11], s28 offen offset:1024 sc1 lds
    s_add_u32 s26, s26, 28672
    s_cmp_ge_u32 s26, s35
    s_cselect_b32 s26, s34, s26
    buffer_load_dwordx4 v4, s[8:11], s28 offen offset:2048 sc1 lds
    buffer_load_dwordx4 a[0:3], v2, s[8:11], s27 offen offset:0 sc1
    buffer_load_dwordx4 a[4:7], v2, s[8:11], s27 offen offset:1024 sc1
    buffer_load_dwordx4 a[8:11], v2, s[8:11], s27 offen offset:2048 sc1
    buffer_load_dwordx4 a[12:15], v2, s[8:11], s27 offen offset:3072 sc1
    s_add_u32 s27, s27, 4096
    buffer_load_dwordx4 a[16:19], v2, s[8:11], s27 offen offset:0 sc1
    buffer_load_dwordx4 a[20:23], v2, s[8:11], s27 offen offset:1024 sc1
    buffer_load_dwordx4 a[24:27], v2, s[8:11], s27 offen offset:2048 sc1
    buffer_load_dwordx4 a[28:31], v2, s[8:11], s27 offen offset:3072 sc1
    s_add_u32 s27, s27, 4096
    buffer_load_dwordx4 a[32:35], v2, s[8:11], s27 offen offset:0 sc1
    buffer_load_dwordx4 a[36:39], v2, s[8:11], s27 offen offset:1024 sc1
    buffer_load_dwordx4 a[40:43], v2, s[8:11], s27 offen offset:2048 sc1
    buffer_load_dwordx4 a[44:47], v2, s[8:11], s27 offen offset:3072 sc1
    s_add_u32 s27, s27, 4096
    buffer_load_dwordx4 a[48:51], v2, s[8:11], s27 offen offset:0 sc1
    buffer_load_dwordx4 a[52:55], v2, s[8:11], s27 offen offset:1024 sc1
    buffer_load_dwordx4 a[56:59], v2, s[8:11], s27 offen offset:2048 sc1
    buffer_load_dwordx4 a[60:63], v2, s[8:11], s27 offen offset:3072 sc1
    s_add_u32 s27, s27, 4096
    buffer_load_dwordx4 a[64:67], v2, s[8:11], s27 offen offset:0 sc1
    buffer_load_dwordx4 a[68:71], v2, s[8:11], s27 offen offset:1024 sc1
    buffer_load_dwordx4 a[72:75], v2, s[8:11], s27 offen offset:2048 sc1
    buffer_load_dwordx4 a[76:79], v2, s[8:11], s27 offen offset:3072 sc1
    s_add_u32 s27, s27, 4096
    buffer_load_dwordx4 a[80:83], v2, s[8:11], s27 offen offset:0 sc1
    buffer_load_dwordx4 a[84:87], v2, s[8:11], s27 offen offset:1024 sc1
    buffer_load_dwordx4 a[88:91], v2, s[8:11], s27 offen offset:2048 sc1
    buffer_load_dwordx4 a[92:95], v2, s[8:11], s27 offen offset:3072 sc1
    s_add_u32 s27, s27, 4096
    buffer_load_dwordx4 a[96:99], v2, s[8:11], s27 offen offset:0 sc1
    buffer_load_dwordx4 a[100:103], v2, s[8:11], s27 offen offset:1024 sc1
    buffer_load_dwordx4 a[104:107], v2, s[8:11], s27 offen offset:2048 sc1
    buffer_load_dwordx4 a[108:111], v2, s[8:11], s27 offen offset:3072 sc1
    s_add_u32 m0, s32, 28672
    s_add_u32 s28, s26, 0
    buffer_load_dwordx4 v4, s[8:11], s28 offen offset:0 sc1 lds
    buffer_load_dwordx4 v4, s[8:11], s28 offen offset:1024 sc1 lds
    buffer_load_dwordx4 v4, s[8:11], s28 offen offset:2048 sc1 lds
    buffer_load_dwordx4 v4, s[8:11], s28 offen offset:3072 sc1 lds
    s_add_u32 m0, s32, 32768
    s_add_u32 s28, s26, 4096
    buffer_load_dwordx4 v4, s[8:11], s28 offen offset:0 sc1 lds
    buffer_load_dwordx4 v4, s[8:11], s28 offen offset:1024 sc1 lds
    s_add_u32 s26, s26, 28672
    s_cmp_ge_u32 s26, s35
    s_cselect_b32 s26, s34, s26
    buffer_load_dwordx4 v4, s[8:11], s28 offen offset:2048 sc1 lds
    s_waitcnt vmcnt(7)
    s_barrier
    ds_read_b128 v[12:15], v7 offset:0
    ds_read_b128 v[16:19], v7 offset:1024
    ds_read_b128 v[20:23], v7 offset:2048
    ds_read_b128 v[24:27], v7 offset:3072
    ds_read_b128 v[28:31], v7 offset:4096
    ds_read_b128 v[32:35], v7 offset:5120
    s_waitcnt lgkmcnt(5)
    v_mfma_f32_32x32x16_bf16 v[44:59], a[0:3], v[12:15], 0
    ds_read_b128 v[36:39], v7 offset:6144
    s_add_u32 m0, s32, 57344
    s_add_u32 s28, s26, 0
    buffer_load_dwordx4 v4, s[8:11], s28 offen offset:0 sc1 lds
    s_waitcnt lgkmcnt(5)
    v_mfma_f32_32x32x16_bf16 v[44:59], a[4:7], v[16:19], v[44:59]
    ds_read_b128 v[40:43], v7 offset:7168
    s_waitcnt lgkmcnt(5)
    v_mfma_f32_32x32x16_bf16 v[44:59], a[8:11], v[20:23], v[44:59]
    ds_read_b128 v[12:15], v7 offset:8192
    buffer_load_dwordx4 v4, s[8:11], s28 offen offset:1024 sc1 lds
    s_waitcnt lgkmcnt(5)
    v_mfma_f32_32x32x16_bf16 v[44:59], a[12:15], v[24:27], v[44:59]
    ds_read_b128 v[16:19], v7 offset:9216
    s_waitcnt lgkmcnt(5)
    v_mfma_f32_32x32x16_bf16 v[44:59], a[16:19], v[28:31], v[44:59]
    ds_read_b128 v[20:23], v7 offset:10240
    buffer_load_dwordx4 v4, s[8:11], s28 offen offset:2048 sc1 lds
    s_waitcnt lgkmcnt(5)
    v_mfma_f32_32x32x16_bf16 v[44:59], a[20:23], v[32:35], v[44:59]
    ds_read_b128 v[24:27], v7 offset:11264
    s_waitcnt lgkmcnt(5)
    v_mfma_f32_32x32x16_bf16 v[44:59], a[24:27], v[36:39], v[44:59]
    ds_read_b128 v[28:31], v7 offset:12288
    buffer_load_dwordx4 v4, s[8:11], s28 offen offset:3072 sc1 lds
    s_waitcnt lgkmcnt(5)
    v_mfma_f32_32x32x16_bf16 v[44:59], a[28:31], v[40:43], v[44:59]
    ds_read_b128 v[32:35], v7 offset:13312
    s_waitcnt lgkmcnt(5)
    v_mfma_f32_32x32x16_bf16 v[44:59], a[32:35], v[12:15], v[44:59]
    ds_read_b128 v[36:39], v7 offset:14336
    s_add_u32 m0, s32, 61440
    s_add_u32 s28, s26, 4096
    buffer_load_dwordx4 v4, s[8:11], s28 offen offset:0 sc1 lds
    s_waitcnt lgkmcnt(5)
    v_mfma_f32_32x32x16_bf16 v[44:59], a[36:39], v[16:19], v[44:59]
    ds_read_b128 v[40:43], v7 offset:15360
    s_waitcnt lgkmcnt(5)
    v_mfma_f32_32x32x16_bf16 v[44:59], a[40:43], v[20:23], v[44:59]
    ds_read_b128 v[12:15], v7 offset:16384
    buffer_load_dwordx4 v4, s[8:11], s28 offen offset:1024 sc1 lds
    s_waitcnt lgkmcnt(5)
    v_mfma_f32_32x32x16_bf16 v[44:59], a[44:47], v[24:27], v[44:59]
    ds_read_b128 v[16:19], v7 offset:17408
    s_waitcnt lgkmcnt(5)
    v_mfma_f32_32x32x16_bf16 v[44:59], a[48:51], v[28:31], v[44:59]
    ds_read_b128 v[20:23], v7 offset:18432
    s_add_u32 s26, s26, 28672
    s_cmp_ge_u32 s26, s35
    s_cselect_b32 s26, s34, s26
    buffer_load_dwordx4 v4, s[8:11], s28 offen offset:2048 sc1 lds
    s_waitcnt lgkmcnt(5)
    v_mfma_f32_32x32x16_bf16 v[44:59], a[52:55], v[32:35], v[44:59]
    ds_read_b128 v[24:27], v7 offset:19456
    s_waitcnt lgkmcnt(5)
    v_mfma_f32_32x32x16_bf16 v[44:59], a[56:59], v[36:39], v[44:59]
    ds_read_b128 v[28:31], v7 offset:20480
    s_waitcnt lgkmcnt(5)
    v_mfma_f32_32x32x16_bf16 v[44:59], a[60:63], v[40:43], v[44:59]
    ds_read_b128 v[32:35], v7 offset:21504
    s_waitcnt lgkmcnt(5)
    v_mfma_f32_32x32x16_bf16 v[44:59], a[64:67], v[12:15], v[44:59]
    ds_read_b128 v[36:39], v7 offset:22528
    s_waitcnt lgkmcnt(5)
    v_mfma_f32_32x32x16_bf16 v[44:59], a[68:71], v[16:19], v[44:59]
    ds_read_b128 v[40:43], v7 offset:23552
    s_waitcnt lgkmcnt(5)
    v_mfma_f32_32x32x16_bf16 v[44:59], a[72:75], v[20:23], v[44:59]
    ds_read_b128 v[12:15], v7 offset:24576
    s_waitcnt lgkmcnt(5)
    v_mfma_f32_32x32x16_bf16 v[44:59], a[76:79], v[24:27], v[44:59]
    ds_read_b128 v[16:19], v7 offset:25600
    s_waitcnt lgkmcnt(5)
    v_mfma_f32_32x32x16_bf16 v[44:59], a[80:83], v[28:31], v[44:59]
    ds_read_b128 v[20:23], v7 offset:26624
    s_waitcnt vmcnt(7)
    s_barrier
    s_waitcnt lgkmcnt(5)
    v_mfma_f32_32x32x16_bf16 v[44:59], a[84:87], v[32:35], v[44:59]
    ds_read_b128 v[24:27], v7 offset:27648
    s_add_u32 m0, s32, 86016
    s_add_u32 s28, s26, 0
    buffer_load_dwordx4 v4, s[8:11], s28 offen offset:0 sc1 lds
    s_waitcnt lgkmcnt(5)
    v_mfma_f32_32x32x16_bf16 v[44:59], a[88:91], v[36:39], v[44:59]
    ds_read_b128 v[28:31], v7 offset:28672
    s_waitcnt lgkmcnt(5)
    v_mfma_f32_32x32x16_bf16 v[44:59], a[92:95], v[40:43], v[44:59]
    ds_read_b128 v[32:35], v7 offset:29696
    buffer_load_dwordx4 v4, s[8:11], s28 offen offset:1024 sc1 lds
    s_waitcnt lgkmcnt(5)
    v_mfma_f32_32x32x16_bf16 v[44:59], a[96:99], v[12:15], v[44:59]
    ds_read_b128 v[36:39], v7 offset:30720
    s_waitcnt lgkmcnt(5)
    v_mfma_f32_32x32x16_bf16 v[44:59], a[100:103], v[16:19], v[44:59]
    ds_read_b128 v[40:43], v7 offset:31744
    buffer_load_dwordx4 v4, s[8:11], s28 offen offset:2048 sc1 lds
    s_waitcnt lgkmcnt(5)
    v_mfma_f32_32x32x16_bf16 v[44:59], a[104:107], v[20:23], v[44:59]
    ds_read_b128 v[12:15], v7 offset:32768
    s_waitcnt lgkmcnt(5)
    v_mfma_f32_32x32x16_bf16 v[44:59], a[108:111], v[24:27], v[44:59]
    ds_read_b128 v[16:19], v7 offset:33792
    buffer_load_dwordx4 v4, s[8:11], s28 offen offset:3072 sc1 lds
    s_waitcnt lgkmcnt(5)
    v_mfma_f32_32x32x16_bf16 v[60:75], a[0:3], v[28:31], 0
    ds_read_b128 v[20:23], v7 offset:34816
    s_waitcnt lgkmcnt(5)
    v_mfma_f32_32x32x16_bf16 v[60:75], a[4:7], v[32:35], v[60:75]
    ds_read_b128 v[24:27], v7 offset:35840
    s_add_u32 m0, s32, 90112
    s_add_u32 s28, s26, 4096
    buffer_load_dwordx4 v4, s[8:11], s28 offen offset:0 sc1 lds
    s_waitcnt lgkmcnt(5)
    v_mfma_f32_32x32x16_bf16 v[60:75], a[8:11], v[36:39], v[60:75]
    ds_read_b128 v[28:31], v7 offset:36864
    s_waitcnt lgkmcnt(5)
    v_mfma_f32_32x32x16_bf16 v[60:75], a[12:15], v[40:43], v[60:75]
    ds_read_b128 v[32:35], v7 offset:37888
    buffer_load_dwordx4 v4, s[8:11], s28 offen offset:1024 sc1 lds
    s_waitcnt lgkmcnt(5)
    v_mfma_f32_32x32x16_bf16 v[60:75], a[16:19], v[12:15], v[60:75]
    ds_read_b128 v[36:39], v7 offset:38912
    v_cvt_pk_bf16_f32 v76, v44, v45
    v_cvt_pk_bf16_f32 v77, v46, v47
    s_waitcnt lgkmcnt(5)
    v_mfma_f32_32x32x16_bf16 v[60:75], a[20:23], v[16:19], v[60:75]
    ds_read_b128 v[40:43], v7 offset:39936
    s_add_u32 s26, s26, 28672
    s_cmp_ge_u32 s26, s35
    s_cselect_b32 s26, s34, s26
    buffer_load_dwordx4 v4, s[8:11], s28 offen offset:2048 sc1 lds
    v_cvt_pk_bf16_f32 v78, v48, v49
    v_cvt_pk_bf16_f32 v79, v50, v51
    s_waitcnt lgkmcnt(5)
    v_mfma_f32_32x32x16_bf16 v[60:75], a[24:27], v[20:23], v[60:75]
    ds_read_b128 v[12:15], v7 offset:40960
    v_cvt_pk_bf16_f32 v80, v52, v53
    v_cvt_pk_bf16_f32 v81, v54, v55
    s_waitcnt lgkmcnt(5)
    v_mfma_f32_32x32x16_bf16 v[60:75], a[28:31], v[24:27], v[60:75]
    ds_read_b128 v[16:19], v7 offset:41984
    v_cvt_pk_bf16_f32 v82, v56, v57
    v_cvt_pk_bf16_f32 v83, v58, v59
    s_waitcnt lgkmcnt(5)
    v_mfma_f32_32x32x16_bf16 v[60:75], a[32:35], v[28:31], v[60:75]
    ds_read_b128 v[20:23], v7 offset:43008
    buffer_store_dwordx4 v[76:79], v2, s[8:11], s29 offen offset:0 sc1
    s_waitcnt lgkmcnt(5)
    v_mfma_f32_32x32x16_bf16 v[60:75], a[36:39], v[32:35], v[60:75]
    ds_read_b128 v[24:27], v7 offset:44032
    buffer_store_dwordx4 v[80:83], v2, s[8:11], s29 offen offset:1024 sc1
    s_waitcnt lgkmcnt(5)
    v_mfma_f32_32x32x16_bf16 v[60:75], a[40:43], v[36:39], v[60:75]
    ds_read_b128 v[28:31], v7 offset:45056
    s_add_u32 s29, s29, 32768
    s_cmp_ge_u32 s29, s37
    s_cselect_b32 s29, s36, s29
    s_waitcnt lgkmcnt(5)
    v_mfma_f32_32x32x16_bf16 v[60:75], a[44:47], v[40:43], v[60:75]
    ds_read_b128 v[32:35], v7 offset:46080
    s_waitcnt lgkmcnt(5)
    v_mfma_f32_32x32x16_bf16 v[60:75], a[48:51], v[12:15], v[60:75]
    ds_read_b128 v[36:39], v7 offset:47104
    s_waitcnt lgkmcnt(5)
    v_mfma_f32_32x32x16_bf16 v[60:75], a[52:55], v[16:19], v[60:75]
    ds_read_b128 v[40:43], v7 offset:48128
    s_waitcnt lgkmcnt(5)
    v_mfma_f32_32x32x16_bf16 v[60:75], a[56:59], v[20:23], v[60:75]
    ds_read_b128 v[12:15], v7 offset:49152
    s_waitcnt lgkmcnt(5)
    v_mfma_f32_32x32x16_bf16 v[60:75], a[60:63], v[24:27], v[60:75]
    ds_read_b128 v[16:19], v7 offset:50176
    s_waitcnt lgkmcnt(5)
    v_mfma_f32_32x32x16_bf16 v[60:75], a[64:67], v[28:31], v[60:75]
    ds_read_b128 v[20:23], v7 offset:51200
    s_waitcnt lgkmcnt(5)
    v_mfma_f32_32x32x16_bf16 v[60:75], a[68:71], v[32:35], v[60:75]
    ds_read_b128 v[24:27], v7 offset:52224
    s_waitcnt lgkmcnt(5)
    v_mfma_f32_32x32x16_bf16 v[60:75], a[72:75], v[36:39], v[60:75]
    ds_read_b128 v[28:31], v7 offset:53248
    s_waitcnt lgkmcnt(5)
    v_mfma_f32_32x32x16_bf16 v[60:75], a[76:79], v[40:43], v[60:75]
    ds_read_b128 v[32:35], v7 offset:54272
    s_waitcnt lgkmcnt(5)
    v_mfma_f32_32x32x16_bf16 v[60:75], a[80:83], v[12:15], v[60:75]
    ds_read_b128 v[36:39], v7 offset:55296
    s_waitcnt vmcnt(9)
    s_barrier
    s_waitcnt lgkmcnt(5)
    v_mfma_f32_32x32x16_bf16 v[60:75], a[84:87], v[16:19], v[60:75]
    ds_read_b128 v[40:43], v7 offset:56320
    s_add_u32 m0, s32, 0
    s_add_u32 s28, s26, 0
    buffer_load_dwordx4 v4, s[8:11], s28 offen offset:0 sc1 lds
    s_waitcnt lgkmcnt(5)
    v_mfma_f32_32x32x16_bf16 v[60:75], a[88:91], v[20:23], v[60:75]
    ds_read_b128 v[12:15], v8 offset:0
    s_waitcnt lgkmcnt(5)
    v_mfma_f32_32x32x16_bf16 v[60:75], a[92:95], v[24:27], v[60:75]
    ds_read_b128 v[16:19], v8 offset:1024
    buffer_load_dwordx4 v4, s[8:11], s28 offen offset:1024 sc1 lds
    s_waitcnt lgkmcnt(5)
    v_mfma_f32_32x32x16_bf16 v[60:75], a[96:99], v[28:31], v[60:75]
    ds_read_b128 v[20:23], v8 offset:2048
    s_waitcnt lgkmcnt(5)
    v_mfma_f32_32x32x16_bf16 v[60:75], a[100:103], v[32:35], v[60:75]
    ds_read_b128 v[24:27], v8 offset:3072
    buffer_load_dwordx4 v4, s[8:11], s28 offen offset:2048 sc1 lds
    s_waitcnt lgkmcnt(5)
    v_mfma_f32_32x32x16_bf16 v[60:75], a[104:107], v[36:39], v[60:75]
    ds_read_b128 v[28:31], v8 offset:4096
    s_waitcnt lgkmcnt(5)
    v_mfma_f32_32x32x16_bf16 v[60:75], a[108:111], v[40:43], v[60:75]
    ds_read_b128 v[32:35], v8 offset:5120
    buffer_load_dwordx4 v4, s[8:11], s28 offen offset:3072 sc1 lds
    s_waitcnt lgkmcnt(5)
    v_mfma_f32_32x32x16_bf16 v[44:59], a[0:3], v[12:15], 0
    ds_read_b128 v[36:39], v8 offset:6144
    s_waitcnt lgkmcnt(5)
    v_mfma_f32_32x32x16_bf16 v[44:59], a[4:7], v[16:19], v[44:59]
    ds_read_b128 v[40:43], v8 offset:7168
    s_add_u32 m0, s32, 4096
    s_add_u32 s28, s26, 4096
    buffer_load_dwordx4 v4, s[8:11], s28 offen offset:0 sc1 lds
    s_waitcnt lgkmcnt(5)
    v_mfma_f32_32x32x16_bf16 v[44:59], a[8:11], v[20:23], v[44:59]
    ds_read_b128 v[12:15], v8 offset:8192
    s_waitcnt lgkmcnt(5)
    v_mfma_f32_32x32x16_bf16 v[44:59], a[12:15], v[24:27], v[44:59]
    ds_read_b128 v[16:19], v8 offset:9216
    buffer_load_dwordx4 v4, s[8:11], s28 offen offset:1024 sc1 lds
    s_waitcnt lgkmcnt(5)
    v_mfma_f32_32x32x16_bf16 v[44:59], a[16:19], v[28:31], v[44:59]
    ds_read_b128 v[20:23], v8 offset:10240
    v_cvt_pk_bf16_f32 v76, v60, v61
    v_cvt_pk_bf16_f32 v77, v62, v63
    s_waitcnt lgkmcnt(5)
    v_mfma_f32_32x32x16_bf16 v[44:59], a[20:23], v[32:35], v[44:59]
    ds_read_b128 v[24:27], v8 offset:11264
    s_add_u32 s26, s26, 28672
    s_cmp_ge_u32 s26, s35
    s_cselect_b32 s26, s34, s26
    buffer_load_dwordx4 v4, s[8:11], s28 offen offset:2048 sc1 lds
    v_cvt_pk_bf16_f32 v78, v64, v65
    v_cvt_pk_bf16_f32 v79, v66, v67
    s_waitcnt lgkmcnt(5)
    v_mfma_f32_32x32x16_bf16 v[44:59], a[24:27], v[36:39], v[44:59]
    ds_read_b128 v[28:31], v8 offset:12288
    v_cvt_pk_bf16_f32 v80, v68, v69
    v_cvt_pk_bf16_f32 v81, v70, v71
    s_waitcnt lgkmcnt(5)
    v_mfma_f32_32x32x16_bf16 v[44:59], a[28:31], v[40:43], v[44:59]
    ds_read_b128 v[32:35], v8 offset:13312
    v_cvt_pk_bf16_f32 v82, v72, v73
    v_cvt_pk_bf16_f32 v83, v74, v75
    s_waitcnt lgkmcnt(5)
    v_mfma_f32_32x32x16_bf16 v[44:59], a[32:35], v[12:15], v[44:59]
    ds_read_b128 v[36:39], v8 offset:14336
    buffer_store_dwordx4 v[76:79], v2, s[8:11], s29 offen offset:0 sc1
    s_waitcnt lgkmcnt(5)
    v_mfma_f32_32x32x16_bf16 v[44:59], a[36:39], v[16:19], v[44:59]
    ds_read_b128 v[40:43], v8 offset:15360
    buffer_store_dwordx4 v[80:83], v2, s[8:11], s29 offen offset:1024 sc1
    s_waitcnt lgkmcnt(5)
    v_mfma_f32_32x32x16_bf16 v[44:59], a[40:43], v[20:23], v[44:59]
    ds_read_b128 v[12:15], v8 offset:16384
    s_add_u32 s29, s29, 32768
    s_cmp_ge_u32 s29, s37
    s_cselect_b32 s29, s36, s29
    s_waitcnt lgkmcnt(5)
    v_mfma_f32_32x32x16_bf16 v[44:59], a[44:47], v[24:27], v[44:59]
    ds_read_b128 v[16:19], v8 offset:17408
    s_waitcnt lgkmcnt(5)
    v_mfma_f32_32x32x16_bf16 v[44:59], a[48:51], v[28:31], v[44:59]
    ds_read_b128 v[20:23], v8 offset:18432
    s_waitcnt lgkmcnt(5)
    v_mfma_f32_32x32x16_bf16 v[44:59], a[52:55], v[32:35], v[44:59]
    ds_read_b128 v[24:27], v8 offset:19456
    s_waitcnt lgkmcnt(5)
    v_mfma_f32_32x32x16_bf16 v[44:59], a[56:59], v[36:39], v[44:59]
    ds_read_b128 v[28:31], v8 offset:20480
    s_waitcnt lgkmcnt(5)
    v_mfma_f32_32x32x16_bf16 v[44:59], a[60:63], v[40:43], v[44:59]
    ds_read_b128 v[32:35], v8 offset:21504
    s_waitcnt lgkmcnt(5)
    v_mfma_f32_32x32x16_bf16 v[44:59], a[64:67], v[12:15], v[44:59]
    ds_read_b128 v[36:39], v8 offset:22528
    s_waitcnt lgkmcnt(5)
    v_mfma_f32_32x32x16_bf16 v[44:59], a[68:71], v[16:19], v[44:59]
    ds_read_b128 v[40:43], v8 offset:23552
    s_waitcnt lgkmcnt(5)
    v_mfma_f32_32x32x16_bf16 v[44:59], a[72:75], v[20:23], v[44:59]
    ds_read_b128 v[12:15], v8 offset:24576
    s_waitcnt lgkmcnt(5)
    v_mfma_f32_32x32x16_bf16 v[44:59], a[76:79], v[24:27], v[44:59]
    ds_read_b128 v[16:19], v8 offset:25600
    s_waitcnt lgkmcnt(5)
    v_mfma_f32_32x32x16_bf16 v[44:59], a[80:83], v[28:31], v[44:59]
    ds_read_b128 v[20:23], v8 offset:26624
    s_waitcnt vmcnt(11)
    s_barrier
    s_waitcnt lgkmcnt(5)
    v_mfma_f32_32x32x16_bf16 v[44:59], a[84:87], v[32:35], v[44:59]
    ds_read_b128 v[24:27], v8 offset:27648
    s_add_u32 m0, s32, 28672
    s_add_u32 s28, s26, 0
    buffer_load_dwordx4 v4, s[8:11], s28 offen offset:0 sc1 lds
    s_waitcnt lgkmcnt(5)
    v_mfma_f32_32x32x16_bf16 v[44:59], a[88:91], v[36:39], v[44:59]
    ds_read_b128 v[28:31], v8 offset:28672
    s_waitcnt lgkmcnt(5)
    v_mfma_f32_32x32x16_bf16 v[44:59], a[92:95], v[40:43], v[44:59]
    ds_read_b128 v[32:35], v8 offset:29696
    buffer_load_dwordx4 v4, s[8:11], s28 offen offset:1024 sc1 lds
    s_waitcnt lgkmcnt(5)
    v_mfma_f32_32x32x16_bf16 v[44:59], a[96:99], v[12:15], v[44:59]
    ds_read_b128 v[36:39], v8 offset:30720
    s_waitcnt lgkmcnt(5)
    v_mfma_f32_32x32x16_bf16 v[44:59], a[100:103], v[16:19], v[44:59]
    ds_read_b128 v[40:43], v8 offset:31744
    buffer_load_dwordx4 v4, s[8:11], s28 offen offset:2048 sc1 lds
    s_waitcnt lgkmcnt(5)
    v_mfma_f32_32x32x16_bf16 v[44:59], a[104:107], v[20:23], v[44:59]
    ds_read_b128 v[12:15], v8 offset:32768
    s_waitcnt lgkmcnt(5)
    v_mfma_f32_32x32x16_bf16 v[44:59], a[108:111], v[24:27], v[44:59]
    ds_read_b128 v[16:19], v8 offset:33792
    buffer_load_dwordx4 v4, s[8:11], s28 offen offset:3072 sc1 lds
    s_waitcnt lgkmcnt(5)
    v_mfma_f32_32x32x16_bf16 v[60:75], a[0:3], v[28:31], 0
    ds_read_b128 v[20:23], v8 offset:34816
    s_waitcnt lgkmcnt(5)
    v_mfma_f32_32x32x16_bf16 v[60:75], a[4:7], v[32:35], v[60:75]
    ds_read_b128 v[24:27], v8 offset:35840
    s_add_u32 m0, s32, 32768
    s_add_u32 s28, s26, 4096
    buffer_load_dwordx4 v4, s[8:11], s28 offen offset:0 sc1 lds
    s_waitcnt lgkmcnt(5)
    v_mfma_f32_32x32x16_bf16 v[60:75], a[8:11], v[36:39], v[60:75]
    ds_read_b128 v[28:31], v8 offset:36864
    s_waitcnt lgkmcnt(5)
    v_mfma_f32_32x32x16_bf16 v[60:75], a[12:15], v[40:43], v[60:75]
    ds_read_b128 v[32:35], v8 offset:37888
    buffer_load_dwordx4 v4, s[8:11], s28 offen offset:1024 sc1 lds
    s_waitcnt lgkmcnt(5)
    v_mfma_f32_32x32x16_bf16 v[60:75], a[16:19], v[12:15], v[60:75]
    ds_read_b128 v[36:39], v8 offset:38912
    v_cvt_pk_bf16_f32 v76, v44, v45
    v_cvt_pk_bf16_f32 v77, v46, v47
    s_waitcnt lgkmcnt(5)
    v_mfma_f32_32x32x16_bf16 v[60:75], a[20:23], v[16:19], v[60:75]
    ds_read_b128 v[40:43], v8 offset:39936
    s_add_u32 s26, s26, 28672
    s_cmp_ge_u32 s26, s35
    s_cselect_b32 s26, s34, s26
    buffer_load_dwordx4 v4, s[8:11], s28 offen offset:2048 sc1 lds
    v_cvt_pk_bf16_f32 v78, v48, v49
    v_cvt_pk_bf16_f32 v79, v50, v51
    s_waitcnt lgkmcnt(5)
    v_mfma_f32_32x32x16_bf16 v[60:75], a[24:27], v[20:23], v[60:75]
    ds_read_b128 v[12:15], v8 offset:40960
    v_cvt_pk_bf16_f32 v80, v52, v53
    v_cvt_pk_bf16_f32 v81, v54, v55
    s_waitcnt lgkmcnt(5)
    v_mfma_f32_32x32x16_bf16 v[60:75], a[28:31], v[24:27], v[60:75]
    ds_read_b128 v[16:19], v8 offset:41984
    v_cvt_pk_bf16_f32 v82, v56, v57
    v_cvt_pk_bf16_f32 v83, v58, v59
    s_waitcnt lgkmcnt(5)
    v_mfma_f32_32x32x16_bf16 v[60:75], a[32:35], v[28:31], v[60:75]
    ds_read_b128 v[20:23], v8 offset:43008
    buffer_store_dwordx4 v[76:79], v2, s[8:11], s29 offen offset:0 sc1
    s_waitcnt lgkmcnt(5)
    v_mfma_f32_32x32x16_bf16 v[60:75], a[36:39], v[32:35], v[60:75]
    ds_read_b128 v[24:27], v8 offset:44032
    buffer_store_dwordx4 v[80:83], v2, s[8:11], s29 offen offset:1024 sc1
    s_waitcnt lgkmcnt(5)
    v_mfma_f32_32x32x16_bf16 v[60:75], a[40:43], v[36:39], v[60:75]
    ds_read_b128 v[28:31], v8 offset:45056
    s_add_u32 s29, s29, 32768
    s_cmp_ge_u32 s29, s37
    s_cselect_b32 s29, s36, s29
    s_waitcnt lgkmcnt(5)
    v_mfma_f32_32x32x16_bf16 v[60:75], a[44:47], v[40:43], v[60:75]
    ds_read_b128 v[32:35], v8 offset:46080
    s_waitcnt lgkmcnt(5)
    v_mfma_f32_32x32x16_bf16 v[60:75], a[48:51], v[12:15], v[60:75]
    ds_read_b128 v[36:39], v8 offset:47104
    s_waitcnt lgkmcnt(5)
    v_mfma_f32_32x32x16_bf16 v[60:75], a[52:55], v[16:19], v[60:75]
    ds_read_b128 v[40:43], v8 offset:48128
    s_waitcnt lgkmcnt(5)
    v_mfma_f32_32x32x16_bf16 v[60:75], a[56:59], v[20:23], v[60:75]
    ds_read_b128 v[12:15], v8 offset:49152
    s_waitcnt lgkmcnt(5)
    v_mfma_f32_32x32x16_bf16 v[60:75], a[60:63], v[24:27], v[60:75]
    ds_read_b128 v[16:19], v8 offset:50176
    s_waitcnt lgkmcnt(5)
    v_mfma_f32_32x32x16_bf16 v[60:75], a[64:67], v[28:31], v[60:75]
    ds_read_b128 v[20:23], v8 offset:51200
    s_waitcnt lgkmcnt(5)
    v_mfma_f32_32x32x16_bf16 v[60:75], a[68:71], v[32:35], v[60:75]
    ds_read_b128 v[24:27], v8 offset:52224
    s_waitcnt lgkmcnt(5)
    v_mfma_f32_32x32x16_bf16 v[60:75], a[72:75], v[36:39], v[60:75]
    ds_read_b128 v[28:31], v8 offset:53248
    s_waitcnt lgkmcnt(5)
    v_mfma_f32_32x32x16_bf16 v[60:75], a[76:79], v[40:43], v[60:75]
    ds_read_b128 v[32:35], v8 offset:54272
    s_waitcnt lgkmcnt(5)
    v_mfma_f32_32x32x16_bf16 v[60:75], a[80:83], v[12:15], v[60:75]
    ds_read_b128 v[36:39], v8 offset:55296
    s_waitcnt vmcnt(11)
    s_barrier
    s_waitcnt lgkmcnt(5)
    v_mfma_f32_32x32x16_bf16 v[60:75], a[84:87], v[16:19], v[60:75]
    ds_read_b128 v[40:43], v8 offset:56320
    s_add_u32 m0, s32, 57344
    s_add_u32 s28, s26, 0
    buffer_load_dwordx4 v4, s[8:11], s28 offen offset:0 sc1 lds
    s_waitcnt lgkmcnt(5)
    v_mfma_f32_32x32x16_bf16 v[60:75], a[88:91], v[20:23], v[60:75]
    ds_read_b128 v[12:15], v7 offset:0
    s_waitcnt lgkmcnt(5)
    v_mfma_f32_32x32x16_bf16 v[60:75], a[92:95], v[24:27], v[60:75]
    ds_read_b128 v[16:19], v7 offset:1024
    buffer_load_dwordx4 v4, s[8:11], s28 offen offset:1024 sc1 lds
    s_waitcnt lgkmcnt(5)
    v_mfma_f32_32x32x16_bf16 v[60:75], a[96:99], v[28:31], v[60:75]
    ds_read_b128 v[20:23], v7 offset:2048
    s_waitcnt lgkmcnt(5)
    v_mfma_f32_32x32x16_bf16 v[60:75], a[100:103], v[32:35], v[60:75]
    ds_read_b128 v[24:27], v7 offset:3072
    buffer_load_dwordx4 v4, s[8:11], s28 offen offset:2048 sc1 lds
    s_waitcnt lgkmcnt(5)
    v_mfma_f32_32x32x16_bf16 v[60:75], a[104:107], v[36:39], v[60:75]
    ds_read_b128 v[28:31], v7 offset:4096
    s_waitcnt lgkmcnt(5)
    v_mfma_f32_32x32x16_bf16 v[60:75], a[108:111], v[40:43], v[60:75]
    ds_read_b128 v[32:35], v7 offset:5120
    buffer_load_dwordx4 v4, s[8:11], s28 offen offset:3072 sc1 lds
    s_waitcnt lgkmcnt(5)
    v_mfma_f32_32x32x16_bf16 v[44:59], a[0:3], v[12:15], 0
    ds_read_b128 v[36:39], v7 offset:6144
    s_waitcnt lgkmcnt(5)
    v_mfma_f32_32x32x16_bf16 v[44:59], a[4:7], v[16:19], v[44:59]
    ds_read_b128 v[40:43], v7 offset:7168
    s_add_u32 m0, s32, 61440
    s_add_u32 s28, s26, 4096
    buffer_load_dwordx4 v4, s[8:11], s28 offen offset:0 sc1 lds
    s_waitcnt lgkmcnt(5)
    v_mfma_f32_32x32x16_bf16 v[44:59], a[8:11], v[20:23], v[44:59]
    ds_read_b128 v[12:15], v7 offset:8192
    s_waitcnt lgkmcnt(5)
    v_mfma_f32_32x32x16_bf16 v[44:59], a[12:15], v[24:27], v[44:59]
    ds_read_b128 v[16:19], v7 offset:9216
    buffer_load_dwordx4 v4, s[8:11], s28 offen offset:1024 sc1 lds
    s_waitcnt lgkmcnt(5)
    v_mfma_f32_32x32x16_bf16 v[44:59], a[16:19], v[28:31], v[44:59]
    ds_read_b128 v[20:23], v7 offset:10240
    v_cvt_pk_bf16_f32 v76, v60, v61
    v_cvt_pk_bf16_f32 v77, v62, v63
    s_waitcnt lgkmcnt(5)
    v_mfma_f32_32x32x16_bf16 v[44:59], a[20:23], v[32:35], v[44:59]
    ds_read_b128 v[24:27], v7 offset:11264
    s_add_u32 s26, s26, 28672
    s_cmp_ge_u32 s26, s35
    s_cselect_b32 s26, s34, s26
    buffer_load_dwordx4 v4, s[8:11], s28 offen offset:2048 sc1 lds
    v_cvt_pk_bf16_f32 v78, v64, v65
    v_cvt_pk_bf16_f32 v79, v66, v67
    s_waitcnt lgkmcnt(5)
    v_mfma_f32_32x32x16_bf16 v[44:59], a[24:27], v[36:39], v[44:59]
    ds_read_b128 v[28:31], v7 offset:12288
    v_cvt_pk_bf16_f32 v80, v68, v69
    v_cvt_pk_bf16_f32 v81, v70, v71
    s_waitcnt lgkmcnt(5)
    v_mfma_f32_32x32x16_bf16 v[44:59], a[28:31], v[40:43], v[44:59]
    ds_read_b128 v[32:35], v7 offset:13312
    v_cvt_pk_bf16_f32 v82, v72, v73
    v_cvt_pk_bf16_f32 v83, v74, v75
    s_waitcnt lgkmcnt(5)
    v_mfma_f32_32x32x16_bf16 v[44:59], a[32:35], v[12:15], v[44:59]
    ds_read_b128 v[36:39], v7 offset:14336
    buffer_store_dwordx4 v[76:79], v2, s[8:11], s29 offen offset:0 sc1
    s_waitcnt lgkmcnt(5)
    v_mfma_f32_32x32x16_bf16 v[44:59], a[36:39], v[16:19], v[44:59]
    ds_read_b128 v[40:43], v7 offset:15360
    buffer_store_dwordx4 v[80:83], v2, s[8:11], s29 offen offset:1024 sc1
    s_waitcnt lgkmcnt(5)
    v_mfma_f32_32x32x16_bf16 v[44:59], a[40:43], v[20:23], v[44:59]
    ds_read_b128 v[12:15], v7 offset:16384
    s_add_u32 s29, s29, 32768
    s_cmp_ge_u32 s29, s37
    s_cselect_b32 s29, s36, s29
    s_waitcnt lgkmcnt(5)
    v_mfma_f32_32x32x16_bf16 v[44:59], a[44:47], v[24:27], v[44:59]
    ds_read_b128 v[16:19], v7 offset:17408
    s_waitcnt lgkmcnt(5)
    v_mfma_f32_32x32x16_bf16 v[44:59], a[48:51], v[28:31], v[44:59]
    ds_read_b128 v[20:23], v7 offset:18432
    s_waitcnt lgkmcnt(5)
    v_mfma_f32_32x32x16_bf16 v[44:59], a[52:55], v[32:35], v[44:59]
    ds_read_b128 v[24:27], v7 offset:19456
    s_waitcnt lgkmcnt(5)
    v_mfma_f32_32x32x16_bf16 v[44:59], a[56:59], v[36:39], v[44:59]
    ds_read_b128 v[28:31], v7 offset:20480
    s_waitcnt lgkmcnt(5)
    v_mfma_f32_32x32x16_bf16 v[44:59], a[60:63], v[40:43], v[44:59]
    ds_read_b128 v[32:35], v7 offset:21504
    s_waitcnt lgkmcnt(5)
    v_mfma_f32_32x32x16_bf16 v[44:59], a[64:67], v[12:15], v[44:59]
    ds_read_b128 v[36:39], v7 offset:22528
    s_waitcnt lgkmcnt(5)
    v_mfma_f32_32x32x16_bf16 v[44:59], a[68:71], v[16:19], v[44:59]
    ds_read_b128 v[40:43], v7 offset:23552
    s_waitcnt lgkmcnt(5)
    v_mfma_f32_32x32x16_bf16 v[44:59], a[72:75], v[20:23], v[44:59]
    ds_read_b128 v[12:15], v7 offset:24576
    s_waitcnt lgkmcnt(5)
    v_mfma_f32_32x32x16_bf16 v[44:59], a[76:79], v[24:27], v[44:59]
    ds_read_b128 v[16:19], v7 offset:25600
    s_waitcnt lgkmcnt(5)
    v_mfma_f32_32x32x16_bf16 v[44:59], a[80:83], v[28:31], v[44:59]
    ds_read_b128 v[20:23], v7 offset:26624
    s_waitcnt vmcnt(11)
    s_barrier
    s_waitcnt lgkmcnt(5)
    v_mfma_f32_32x32x16_bf16 v[44:59], a[84:87], v[32:35], v[44:59]
    ds_read_b128 v[24:27], v7 offset:27648
    s_add_u32 m0, s32, 86016
    s_add_u32 s28, s26, 0
    buffer_load_dwordx4 v4, s[8:11], s28 offen offset:0 sc1 lds
    s_waitcnt lgkmcnt(5)
    v_mfma_f32_32x32x16_bf16 v[44:59], a[88:91], v[36:39], v[44:59]
    ds_read_b128 v[28:31], v7 offset:28672
    s_waitcnt lgkmcnt(5)
    v_mfma_f32_32x32x16_bf16 v[44:59], a[92:95], v[40:43], v[44:59]
    ds_read_b128 v[32:35], v7 offset:29696
    buffer_load_dwordx4 v4, s[8:11], s28 offen offset:1024 sc1 lds
    s_waitcnt lgkmcnt(5)
    v_mfma_f32_32x32x16_bf16 v[44:59], a[96:99], v[12:15], v[44:59]
    ds_read_b128 v[36:39], v7 offset:30720
    s_waitcnt lgkmcnt(5)
    v_mfma_f32_32x32x16_bf16 v[44:59], a[100:103], v[16:19], v[44:59]
    ds_read_b128 v[40:43], v7 offset:31744
    buffer_load_dwordx4 v4, s[8:11], s28 offen offset:2048 sc1 lds
    s_waitcnt lgkmcnt(5)
    v_mfma_f32_32x32x16_bf16 v[44:59], a[104:107], v[20:23], v[44:59]
    ds_read_b128 v[12:15], v7 offset:32768
    s_waitcnt lgkmcnt(5)
    v_mfma_f32_32x32x16_bf16 v[44:59], a[108:111], v[24:27], v[44:59]
    ds_read_b128 v[16:19], v7 offset:33792
    buffer_load_dwordx4 v4, s[8:11], s28 offen offset:3072 sc1 lds
    s_waitcnt lgkmcnt(5)
    v_mfma_f32_32x32x16_bf16 v[60:75], a[0:3], v[28:31], 0
    ds_read_b128 v[20:23], v7 offset:34816
    s_waitcnt lgkmcnt(5)
    v_mfma_f32_32x32x16_bf16 v[60:75], a[4:7], v[32:35], v[60:75]
    ds_read_b128 v[24:27], v7 offset:35840
    s_add_u32 m0, s32, 90112
    s_add_u32 s28, s26, 4096
    buffer_load_dwordx4 v4, s[8:11], s28 offen offset:0 sc1 lds
    s_waitcnt lgkmcnt(5)
    v_mfma_f32_32x32x16_bf16 v[60:75], a[8:11], v[36:39], v[60:75]
    ds_read_b128 v[28:31], v7 offset:36864
    s_waitcnt lgkmcnt(5)
    v_mfma_f32_32x32x16_bf16 v[60:75], a[12:15], v[40:43], v[60:75]
    ds_read_b128 v[32:35], v7 offset:37888
    buffer_load_dwordx4 v4, s[8:11], s28 offen offset:1024 sc1 lds
    s_waitcnt lgkmcnt(5)
    v_mfma_f32_32x32x16_bf16 v[60:75], a[16:19], v[12:15], v[60:75]
    ds_read_b128 v[36:39], v7 offset:38912
    v_cvt_pk_bf16_f32 v76, v44, v45
    v_cvt_pk_bf16_f32 v77, v46, v47
    s_waitcnt lgkmcnt(5)
    v_mfma_f32_32x32x16_bf16 v[60:75], a[20:23], v[16:19], v[60:75]
    ds_read_b128 v[40:43], v7 offset:39936
    s_add_u32 s26, s26, 28672
    s_cmp_ge_u32 s26, s35
    s_cselect_b32 s26, s34, s26
    buffer_load_dwordx4 v4, s[8:11], s28 offen offset:2048 sc1 lds
    v_cvt_pk_bf16_f32 v78, v48, v49
    v_cvt_pk_bf16_f32 v79, v50, v51
    s_waitcnt lgkmcnt(5)
    v_mfma_f32_32x32x16_bf16 v[60:75], a[24:27], v[20:23], v[60:75]
    ds_read_b128 v[12:15], v7 offset:40960
    v_cvt_pk_bf16_f32 v80, v52, v53
    v_cvt_pk_bf16_f32 v81, v54, v55
    s_waitcnt lgkmcnt(5)
    v_mfma_f32_32x32x16_bf16 v[60:75], a[28:31], v[24:27], v[60:75]
    ds_read_b128 v[16:19], v7 offset:41984
    v_cvt_pk_bf16_f32 v82, v56, v57
    v_cvt_pk_bf16_f32 v83, v58, v59
    s_waitcnt lgkmcnt(5)
    v_mfma_f32_32x32x16_bf16 v[60:75], a[32:35], v[28:31], v[60:75]
    ds_read_b128 v[20:23], v7 offset:43008
    buffer_store_dwordx4 v[76:79], v2, s[8:11], s29 offen offset:0 sc1
    s_waitcnt lgkmcnt(5)
    v_mfma_f32_32x32x16_bf16 v[60:75], a[36:39], v[32:35], v[60:75]
    ds_read_b128 v[24:27], v7 offset:44032
    buffer_store_dwordx4 v[80:83], v2, s[8:11], s29 offen offset:1024 sc1
    s_waitcnt lgkmcnt(5)
    v_mfma_f32_32x32x16_bf16 v[60:75], a[40:43], v[36:39], v[60:75]
    ds_read_b128 v[28:31], v7 offset:45056
    s_add_u32 s29, s29, 32768
    s_cmp_ge_u32 s29, s37
    s_cselect_b32 s29, s36, s29
    s_waitcnt lgkmcnt(5)
    v_mfma_f32_32x32x16_bf16 v[60:75], a[44:47], v[40:43], v[60:75]
    ds_read_b128 v[32:35], v7 offset:46080
    s_waitcnt lgkmcnt(5)
    v_mfma_f32_32x32x16_bf16 v[60:75], a[48:51], v[12:15], v[60:75]
    ds_read_b128 v[36:39], v7 offset:47104
    s_waitcnt lgkmcnt(5)
    v_mfma_f32_32x32x16_bf16 v[60:75], a[52:55], v[16:19], v[60:75]
    ds_read_b128 v[40:43], v7 offset:48128
    s_waitcnt lgkmcnt(5)
    v_mfma_f32_32x32x16_bf16 v[60:75], a[56:59], v[20:23], v[60:75]
    ds_read_b128 v[12:15], v7 offset:49152
    s_waitcnt lgkmcnt(5)
    v_mfma_f32_32x32x16_bf16 v[60:75], a[60:63], v[24:27], v[60:75]
    ds_read_b128 v[16:19], v7 offset:50176
    s_waitcnt lgkmcnt(5)
    v_mfma_f32_32x32x16_bf16 v[60:75], a[64:67], v[28:31], v[60:75]
    ds_read_b128 v[20:23], v7 offset:51200
    s_waitcnt lgkmcnt(5)
    v_mfma_f32_32x32x16_bf16 v[60:75], a[68:71], v[32:35], v[60:75]
    ds_read_b128 v[24:27], v7 offset:52224
    s_waitcnt lgkmcnt(5)
    v_mfma_f32_32x32x16_bf16 v[60:75], a[72:75], v[36:39], v[60:75]
    ds_read_b128 v[28:31], v7 offset:53248
    s_waitcnt lgkmcnt(5)
    v_mfma_f32_32x32x16_bf16 v[60:75], a[76:79], v[40:43], v[60:75]
    ds_read_b128 v[32:35], v7 offset:54272
    s_waitcnt lgkmcnt(5)
    v_mfma_f32_32x32x16_bf16 v[60:75], a[80:83], v[12:15], v[60:75]
    ds_read_b128 v[36:39], v7 offset:55296
    s_waitcnt vmcnt(11)
    s_barrier
    s_waitcnt lgkmcnt(5)
    v_mfma_f32_32x32x16_bf16 v[60:75], a[84:87], v[16:19], v[60:75]
    ds_read_b128 v[40:43], v7 offset:56320
    s_add_u32 m0, s32, 0
    s_add_u32 s28, s26, 0
    buffer_load_dwordx4 v4, s[8:11], s28 offen offset:0 sc1 lds
    s_waitcnt lgkmcnt(5)
    v_mfma_f32_32x32x16_bf16 v[60:75], a[88:91], v[20:23], v[60:75]
    ds_read_b128 v[12:15], v8 offset:0
    s_waitcnt lgkmcnt(5)
    v_mfma_f32_32x32x16_bf16 v[60:75], a[92:95], v[24:27], v[60:75]
    ds_read_b128 v[16:19], v8 offset:1024
    buffer_load_dwordx4 v4, s[8:11], s28 offen offset:1024 sc1 lds
    s_waitcnt lgkmcnt(5)
    v_mfma_f32_32x32x16_bf16 v[60:75], a[96:99], v[28:31], v[60:75]
    ds_read_b128 v[20:23], v8 offset:2048
    s_waitcnt lgkmcnt(5)
    v_mfma_f32_32x32x16_bf16 v[60:75], a[100:103], v[32:35], v[60:75]
    ds_read_b128 v[24:27], v8 offset:3072
    buffer_load_dwordx4 v4, s[8:11], s28 offen offset:2048 sc1 lds
    s_waitcnt lgkmcnt(5)
    v_mfma_f32_32x32x16_bf16 v[60:75], a[104:107], v[36:39], v[60:75]
    ds_read_b128 v[28:31], v8 offset:4096
    s_waitcnt lgkmcnt(5)
    v_mfma_f32_32x32x16_bf16 v[60:75], a[108:111], v[40:43], v[60:75]
    ds_read_b128 v[32:35], v8 offset:5120
    buffer_load_dwordx4 v4, s[8:11], s28 offen offset:3072 sc1 lds
    s_waitcnt lgkmcnt(5)
    v_mfma_f32_32x32x16_bf16 v[44:59], a[0:3], v[12:15], 0
    ds_read_b128 v[36:39], v8 offset:6144
    s_waitcnt lgkmcnt(5)
    v_mfma_f32_32x32x16_bf16 v[44:59], a[4:7], v[16:19], v[44:59]
    ds_read_b128 v[40:43], v8 offset:7168
    s_add_u32 m0, s32, 4096
    s_add_u32 s28, s26, 4096
    buffer_load_dwordx4 v4, s[8:11], s28 offen offset:0 sc1 lds
    s_waitcnt lgkmcnt(5)
    v_mfma_f32_32x32x16_bf16 v[44:59], a[8:11], v[20:23], v[44:59]
    ds_read_b128 v[12:15], v8 offset:8192
    s_waitcnt lgkmcnt(5)
    v_mfma_f32_32x32x16_bf16 v[44:59], a[12:15], v[24:27], v[44:59]
    ds_read_b128 v[16:19], v8 offset:9216
    buffer_load_dwordx4 v4, s[8:11], s28 offen offset:1024 sc1 lds
    s_waitcnt lgkmcnt(5)
    v_mfma_f32_32x32x16_bf16 v[44:59], a[16:19], v[28:31], v[44:59]
    ds_read_b128 v[20:23], v8 offset:10240
    v_cvt_pk_bf16_f32 v76, v60, v61
    v_cvt_pk_bf16_f32 v77, v62, v63
    s_waitcnt lgkmcnt(5)
    v_mfma_f32_32x32x16_bf16 v[44:59], a[20:23], v[32:35], v[44:59]
    ds_read_b128 v[24:27], v8 offset:11264
    s_add_u32 s26, s26, 28672
    s_cmp_ge_u32 s26, s35
    s_cselect_b32 s26, s34, s26
    buffer_load_dwordx4 v4, s[8:11], s28 offen offset:2048 sc1 lds
    v_cvt_pk_bf16_f32 v78, v64, v65
    v_cvt_pk_bf16_f32 v79, v66, v67
    s_waitcnt lgkmcnt(5)
    v_mfma_f32_32x32x16_bf16 v[44:59], a[24:27], v[36:39], v[44:59]
    ds_read_b128 v[28:31], v8 offset:12288
    v_cvt_pk_bf16_f32 v80, v68, v69
    v_cvt_pk_bf16_f32 v81, v70, v71
    s_waitcnt lgkmcnt(5)
    v_mfma_f32_32x32x16_bf16 v[44:59], a[28:31], v[40:43], v[44:59]
    ds_read_b128 v[32:35], v8 offset:13312
    v_cvt_pk_bf16_f32 v82, v72, v73
    v_cvt_pk_bf16_f32 v83, v74, v75
    s_waitcnt lgkmcnt(5)
    v_mfma_f32_32x32x16_bf16 v[44:59], a[32:35], v[12:15], v[44:59]
    ds_read_b128 v[36:39], v8 offset:14336
    buffer_store_dwordx4 v[76:79], v2, s[8:11], s29 offen offset:0 sc1
    s_waitcnt lgkmcnt(5)
    v_mfma_f32_32x32x16_bf16 v[44:59], a[36:39], v[16:19], v[44:59]
    ds_read_b128 v[40:43], v8 offset:15360
    buffer_store_dwordx4 v[80:83], v2, s[8:11], s29 offen offset:1024 sc1
    s_waitcnt lgkmcnt(5)
    v_mfma_f32_32x32x16_bf16 v[44:59], a[40:43], v[20:23], v[44:59]
    ds_read_b128 v[12:15], v8 offset:16384
    s_add_u32 s29, s29, 32768
    s_cmp_ge_u32 s29, s37
    s_cselect_b32 s29, s36, s29
    s_waitcnt lgkmcnt(5)
    v_mfma_f32_32x32x16_bf16 v[44:59], a[44:47], v[24:27], v[44:59]
    ds_read_b128 v[16:19], v8 offset:17408
    s_waitcnt lgkmcnt(5)
    v_mfma_f32_32x32x16_bf16 v[44:59], a[48:51], v[28:31], v[44:59]
    ds_read_b128 v[20:23], v8 offset:18432
    s_waitcnt lgkmcnt(5)
    v_mfma_f32_32x32x16_bf16 v[44:59], a[52:55], v[32:35], v[44:59]
    ds_read_b128 v[24:27], v8 offset:19456
    s_waitcnt lgkmcnt(5)
    v_mfma_f32_32x32x16_bf16 v[44:59], a[56:59], v[36:39], v[44:59]
    ds_read_b128 v[28:31], v8 offset:20480
    s_waitcnt lgkmcnt(5)
    v_mfma_f32_32x32x16_bf16 v[44:59], a[60:63], v[40:43], v[44:59]
    ds_read_b128 v[32:35], v8 offset:21504
    s_waitcnt lgkmcnt(5)
    v_mfma_f32_32x32x16_bf16 v[44:59], a[64:67], v[12:15], v[44:59]
    ds_read_b128 v[36:39], v8 offset:22528
    s_waitcnt lgkmcnt(5)
    v_mfma_f32_32x32x16_bf16 v[44:59], a[68:71], v[16:19], v[44:59]
    ds_read_b128 v[40:43], v8 offset:23552
    s_waitcnt lgkmcnt(5)
    v_mfma_f32_32x32x16_bf16 v[44:59], a[72:75], v[20:23], v[44:59]
    ds_read_b128 v[12:15], v8 offset:24576
    s_waitcnt lgkmcnt(5)
    v_mfma_f32_32x32x16_bf16 v[44:59], a[76:79], v[24:27], v[44:59]
    ds_read_b128 v[16:19], v8 offset:25600
    s_waitcnt lgkmcnt(5)
    v_mfma_f32_32x32x16_bf16 v[44:59], a[80:83], v[28:31], v[44:59]
    ds_read_b128 v[20:23], v8 offset:26624
    s_waitcnt vmcnt(11)
    s_barrier
    s_waitcnt lgkmcnt(5)
    v_mfma_f32_32x32x16_bf16 v[44:59], a[84:87], v[32:35], v[44:59]
    ds_read_b128 v[24:27], v8 offset:27648
    s_add_u32 m0, s32, 28672
    s_add_u32 s28, s26, 0
    buffer_load_dwordx4 v4, s[8:11], s28 offen offset:0 sc1 lds
    s_waitcnt lgkmcnt(5)
    v_mfma_f32_32x32x16_bf16 v[44:59], a[88:91], v[36:39], v[44:59]
    ds_read_b128 v[28:31], v8 offset:28672
    s_waitcnt lgkmcnt(5)
    v_mfma_f32_32x32x16_bf16 v[44:59], a[92:95], v[40:43], v[44:59]
    ds_read_b128 v[32:35], v8 offset:29696
    buffer_load_dwordx4 v4, s[8:11], s28 offen offset:1024 sc1 lds
    s_waitcnt lgkmcnt(5)
    v_mfma_f32_32x32x16_bf16 v[44:59], a[96:99], v[12:15], v[44:59]
    ds_read_b128 v[36:39], v8 offset:30720
    s_waitcnt lgkmcnt(5)
    v_mfma_f32_32x32x16_bf16 v[44:59], a[100:103], v[16:19], v[44:59]
    ds_read_b128 v[40:43], v8 offset:31744
    buffer_load_dwordx4 v4, s[8:11], s28 offen offset:2048 sc1 lds
    s_waitcnt lgkmcnt(5)
    v_mfma_f32_32x32x16_bf16 v[44:59], a[104:107], v[20:23], v[44:59]
    ds_read_b128 v[12:15], v8 offset:32768
    s_waitcnt lgkmcnt(5)
    v_mfma_f32_32x32x16_bf16 v[44:59], a[108:111], v[24:27], v[44:59]
    ds_read_b128 v[16:19], v8 offset:33792
    buffer_load_dwordx4 v4, s[8:11], s28 offen offset:3072 sc1 lds
    s_waitcnt lgkmcnt(5)
    v_mfma_f32_32x32x16_bf16 v[60:75], a[0:3], v[28:31], 0
    ds_read_b128 v[20:23], v8 offset:34816
    s_waitcnt lgkmcnt(5)
    v_mfma_f32_32x32x16_bf16 v[60:75], a[4:7], v[32:35], v[60:75]
    ds_read_b128 v[24:27], v8 offset:35840
    s_add_u32 m0, s32, 32768
    s_add_u32 s28, s26, 4096
    buffer_load_dwordx4 v4, s[8:11], s28 offen offset:0 sc1 lds
    s_waitcnt lgkmcnt(5)
    v_mfma_f32_32x32x16_bf16 v[60:75], a[8:11], v[36:39], v[60:75]
    ds_read_b128 v[28:31], v8 offset:36864
    s_waitcnt lgkmcnt(5)
    v_mfma_f32_32x32x16_bf16 v[60:75], a[12:15], v[40:43], v[60:75]
    ds_read_b128 v[32:35], v8 offset:37888
    buffer_load_dwordx4 v4, s[8:11], s28 offen offset:1024 sc1 lds
    s_waitcnt lgkmcnt(5)
    v_mfma_f32_32x32x16_bf16 v[60:75], a[16:19], v[12:15], v[60:75]
    ds_read_b128 v[36:39], v8 offset:38912
    v_cvt_pk_bf16_f32 v76, v44, v45
    v_cvt_pk_bf16_f32 v77, v46, v47
    s_waitcnt lgkmcnt(5)
    v_mfma_f32_32x32x16_bf16 v[60:75], a[20:23], v[16:19], v[60:75]
    ds_read_b128 v[40:43], v8 offset:39936
    s_add_u32 s26, s26, 28672
    s_cmp_ge_u32 s26, s35
    s_cselect_b32 s26, s34, s26
    buffer_load_dwordx4 v4, s[8:11], s28 offen offset:2048 sc1 lds
    v_cvt_pk_bf16_f32 v78, v48, v49
    v_cvt_pk_bf16_f32 v79, v50, v51
    s_waitcnt lgkmcnt(5)
    v_mfma_f32_32x32x16_bf16 v[60:75], a[24:27], v[20:23], v[60:75]
    ds_read_b128 v[12:15], v8 offset:40960
    v_cvt_pk_bf16_f32 v80, v52, v53
    v_cvt_pk_bf16_f32 v81, v54, v55
    s_waitcnt lgkmcnt(5)
    v_mfma_f32_32x32x16_bf16 v[60:75], a[28:31], v[24:27], v[60:75]
    ds_read_b128 v[16:19], v8 offset:41984
    v_cvt_pk_bf16_f32 v82, v56, v57
    v_cvt_pk_bf16_f32 v83, v58, v59
    s_waitcnt lgkmcnt(5)
    v_mfma_f32_32x32x16_bf16 v[60:75], a[32:35], v[28:31], v[60:75]
    ds_read_b128 v[20:23], v8 offset:43008
    buffer_store_dwordx4 v[76:79], v2, s[8:11], s29 offen offset:0 sc1
    s_waitcnt lgkmcnt(5)
    v_mfma_f32_32x32x16_bf16 v[60:75], a[36:39], v[32:35], v[60:75]
    ds_read_b128 v[24:27], v8 offset:44032
    buffer_store_dwordx4 v[80:83], v2, s[8:11], s29 offen offset:1024 sc1
    s_waitcnt lgkmcnt(5)
    v_mfma_f32_32x32x16_bf16 v[60:75], a[40:43], v[36:39], v[60:75]
    ds_read_b128 v[28:31], v8 offset:45056
    s_add_u32 s29, s29, 32768
    s_cmp_ge_u32 s29, s37
    s_cselect_b32 s29, s36, s29
    s_waitcnt lgkmcnt(5)
    v_mfma_f32_32x32x16_bf16 v[60:75], a[44:47], v[40:43], v[60:75]
    ds_read_b128 v[32:35], v8 offset:46080
    s_waitcnt lgkmcnt(5)
    v_mfma_f32_32x32x16_bf16 v[60:75], a[48:51], v[12:15], v[60:75]
    ds_read_b128 v[36:39], v8 offset:47104
    s_waitcnt lgkmcnt(5)
    v_mfma_f32_32x32x16_bf16 v[60:75], a[52:55], v[16:19], v[60:75]
    ds_read_b128 v[40:43], v8 offset:48128
    s_waitcnt lgkmcnt(5)
    v_mfma_f32_32x32x16_bf16 v[60:75], a[56:59], v[20:23], v[60:75]
    ds_read_b128 v[12:15], v8 offset:49152
    s_waitcnt lgkmcnt(5)
    v_mfma_f32_32x32x16_bf16 v[60:75], a[60:63], v[24:27], v[60:75]
    ds_read_b128 v[16:19], v8 offset:50176
    s_waitcnt lgkmcnt(5)
    v_mfma_f32_32x32x16_bf16 v[60:75], a[64:67], v[28:31], v[60:75]
    ds_read_b128 v[20:23], v8 offset:51200
    s_waitcnt lgkmcnt(5)
    v_mfma_f32_32x32x16_bf16 v[60:75], a[68:71], v[32:35], v[60:75]
    ds_read_b128 v[24:27], v8 offset:52224
    s_waitcnt lgkmcnt(5)
    v_mfma_f32_32x32x16_bf16 v[60:75], a[72:75], v[36:39], v[60:75]
    ds_read_b128 v[28:31], v8 offset:53248
    s_waitcnt lgkmcnt(5)
    v_mfma_f32_32x32x16_bf16 v[60:75], a[76:79], v[40:43], v[60:75]
    ds_read_b128 v[32:35], v8 offset:54272
    s_waitcnt lgkmcnt(5)
    v_mfma_f32_32x32x16_bf16 v[60:75], a[80:83], v[12:15], v[60:75]
    ds_read_b128 v[36:39], v8 offset:55296
    s_waitcnt vmcnt(11)
    s_barrier
    s_waitcnt lgkmcnt(5)
    v_mfma_f32_32x32x16_bf16 v[60:75], a[84:87], v[16:19], v[60:75]
    ds_read_b128 v[40:43], v8 offset:56320
    s_add_u32 m0, s32, 57344
    s_add_u32 s28, s26, 0
    buffer_load_dwordx4 v4, s[8:11], s28 offen offset:0 sc1 lds
    s_waitcnt lgkmcnt(5)
    v_mfma_f32_32x32x16_bf16 v[60:75], a[88:91], v[20:23], v[60:75]
    ds_read_b128 v[12:15], v7 offset:0
    s_waitcnt lgkmcnt(5)
    v_mfma_f32_32x32x16_bf16 v[60:75], a[92:95], v[24:27], v[60:75]
    ds_read_b128 v[16:19], v7 offset:1024
    buffer_load_dwordx4 v4, s[8:11], s28 offen offset:1024 sc1 lds
    s_waitcnt lgkmcnt(5)
    v_mfma_f32_32x32x16_bf16 v[60:75], a[96:99], v[28:31], v[60:75]
    ds_read_b128 v[20:23], v7 offset:2048
    s_waitcnt lgkmcnt(5)
    v_mfma_f32_32x32x16_bf16 v[60:75], a[100:103], v[32:35], v[60:75]
    ds_read_b128 v[24:27], v7 offset:3072
    buffer_load_dwordx4 v4, s[8:11], s28 offen offset:2048 sc1 lds
    s_waitcnt lgkmcnt(5)
    v_mfma_f32_32x32x16_bf16 v[60:75], a[104:107], v[36:39], v[60:75]
    ds_read_b128 v[28:31], v7 offset:4096
    s_waitcnt lgkmcnt(5)
    v_mfma_f32_32x32x16_bf16 v[60:75], a[108:111], v[40:43], v[60:75]
    ds_read_b128 v[32:35], v7 offset:5120
    buffer_load_dwordx4 v4, s[8:11], s28 offen offset:3072 sc1 lds
    s_waitcnt lgkmcnt(5)
    v_mfma_f32_32x32x16_bf16 v[44:59], a[0:3], v[12:15], 0
    ds_read_b128 v[36:39], v7 offset:6144
    s_waitcnt lgkmcnt(5)
    v_mfma_f32_32x32x16_bf16 v[44:59], a[4:7], v[16:19], v[44:59]
    ds_read_b128 v[40:43], v7 offset:7168
    s_add_u32 m0, s32, 61440
    s_add_u32 s28, s26, 4096
    buffer_load_dwordx4 v4, s[8:11], s28 offen offset:0 sc1 lds
    s_waitcnt lgkmcnt(5)
    v_mfma_f32_32x32x16_bf16 v[44:59], a[8:11], v[20:23], v[44:59]
    ds_read_b128 v[12:15], v7 offset:8192
    s_waitcnt lgkmcnt(5)
    v_mfma_f32_32x32x16_bf16 v[44:59], a[12:15], v[24:27], v[44:59]
    ds_read_b128 v[16:19], v7 offset:9216
    buffer_load_dwordx4 v4, s[8:11], s28 offen offset:1024 sc1 lds
    s_waitcnt lgkmcnt(5)
    v_mfma_f32_32x32x16_bf16 v[44:59], a[16:19], v[28:31], v[44:59]
    ds_read_b128 v[20:23], v7 offset:10240
    v_cvt_pk_bf16_f32 v76, v60, v61
    v_cvt_pk_bf16_f32 v77, v62, v63
    s_waitcnt lgkmcnt(5)
    v_mfma_f32_32x32x16_bf16 v[44:59], a[20:23], v[32:35], v[44:59]
    ds_read_b128 v[24:27], v7 offset:11264
    s_add_u32 s26, s26, 28672
    s_cmp_ge_u32 s26, s35
    s_cselect_b32 s26, s34, s26
    buffer_load_dwordx4 v4, s[8:11], s28 offen offset:2048 sc1 lds
    v_cvt_pk_bf16_f32 v78, v64, v65
    v_cvt_pk_bf16_f32 v79, v66, v67
    s_waitcnt lgkmcnt(5)
    v_mfma_f32_32x32x16_bf16 v[44:59], a[24:27], v[36:39], v[44:59]
    ds_read_b128 v[28:31], v7 offset:12288
    v_cvt_pk_bf16_f32 v80, v68, v69
    v_cvt_pk_bf16_f32 v81, v70, v71
    s_waitcnt lgkmcnt(5)
    v_mfma_f32_32x32x16_bf16 v[44:59], a[28:31], v[40:43], v[44:59]
    ds_read_b128 v[32:35], v7 offset:13312
    v_cvt_pk_bf16_f32 v82, v72, v73
    v_cvt_pk_bf16_f32 v83, v74, v75
    s_waitcnt lgkmcnt(5)
    v_mfma_f32_32x32x16_bf16 v[44:59], a[32:35], v[12:15], v[44:59]
    ds_read_b128 v[36:39], v7 offset:14336
    buffer_store_dwordx4 v[76:79], v2, s[8:11], s29 offen offset:0 sc1
    s_waitcnt lgkmcnt(5)
    v_mfma_f32_32x32x16_bf16 v[44:59], a[36:39], v[16:19], v[44:59]
    ds_read_b128 v[40:43], v7 offset:15360
    buffer_store_dwordx4 v[80:83], v2, s[8:11], s29 offen offset:1024 sc1
    s_waitcnt lgkmcnt(5)
    v_mfma_f32_32x32x16_bf16 v[44:59], a[40:43], v[20:23], v[44:59]
    ds_read_b128 v[12:15], v7 offset:16384
    s_add_u32 s29, s29, 32768
    s_cmp_ge_u32 s29, s37
    s_cselect_b32 s29, s36, s29
    s_waitcnt lgkmcnt(5)
    v_mfma_f32_32x32x16_bf16 v[44:59], a[44:47], v[24:27], v[44:59]
    ds_read_b128 v[16:19], v7 offset:17408
    s_waitcnt lgkmcnt(5)
    v_mfma_f32_32x32x16_bf16 v[44:59], a[48:51], v[28:31], v[44:59]
    ds_read_b128 v[20:23], v7 offset:18432
    s_waitcnt lgkmcnt(5)
    v_mfma_f32_32x32x16_bf16 v[44:59], a[52:55], v[32:35], v[44:59]
    ds_read_b128 v[24:27], v7 offset:19456
    s_waitcnt lgkmcnt(5)
    v_mfma_f32_32x32x16_bf16 v[44:59], a[56:59], v[36:39], v[44:59]
    ds_read_b128 v[28:31], v7 offset:20480
    s_waitcnt lgkmcnt(5)
    v_mfma_f32_32x32x16_bf16 v[44:59], a[60:63], v[40:43], v[44:59]
    ds_read_b128 v[32:35], v7 offset:21504
    s_waitcnt lgkmcnt(5)
    v_mfma_f32_32x32x16_bf16 v[44:59], a[64:67], v[12:15], v[44:59]
    ds_read_b128 v[36:39], v7 offset:22528
    s_waitcnt lgkmcnt(5)
    v_mfma_f32_32x32x16_bf16 v[44:59], a[68:71], v[16:19], v[44:59]
    ds_read_b128 v[40:43], v7 offset:23552
    s_waitcnt lgkmcnt(5)
    v_mfma_f32_32x32x16_bf16 v[44:59], a[72:75], v[20:23], v[44:59]
    ds_read_b128 v[12:15], v7 offset:24576
    s_waitcnt lgkmcnt(5)
    v_mfma_f32_32x32x16_bf16 v[44:59], a[76:79], v[24:27], v[44:59]
    ds_read_b128 v[16:19], v7 offset:25600
    s_waitcnt lgkmcnt(5)
    v_mfma_f32_32x32x16_bf16 v[44:59], a[80:83], v[28:31], v[44:59]
    ds_read_b128 v[20:23], v7 offset:26624
    s_waitcnt vmcnt(11)
    s_barrier
    s_waitcnt lgkmcnt(5)
    v_mfma_f32_32x32x16_bf16 v[44:59], a[84:87], v[32:35], v[44:59]
    ds_read_b128 v[24:27], v7 offset:27648
    s_add_u32 m0, s32, 86016
    s_add_u32 s28, s26, 0
    buffer_load_dwordx4 v4, s[8:11], s28 offen offset:0 sc1 lds
    s_waitcnt lgkmcnt(5)
    v_mfma_f32_32x32x16_bf16 v[44:59], a[88:91], v[36:39], v[44:59]
    ds_read_b128 v[28:31], v7 offset:28672
    s_waitcnt lgkmcnt(5)
    v_mfma_f32_32x32x16_bf16 v[44:59], a[92:95], v[40:43], v[44:59]
    ds_read_b128 v[32:35], v7 offset:29696
    buffer_load_dwordx4 v4, s[8:11], s28 offen offset:1024 sc1 lds
    s_waitcnt lgkmcnt(5)
    v_mfma_f32_32x32x16_bf16 v[44:59], a[96:99], v[12:15], v[44:59]
    ds_read_b128 v[36:39], v7 offset:30720
    s_waitcnt lgkmcnt(5)
    v_mfma_f32_32x32x16_bf16 v[44:59], a[100:103], v[16:19], v[44:59]
    ds_read_b128 v[40:43], v7 offset:31744
    buffer_load_dwordx4 v4, s[8:11], s28 offen offset:2048 sc1 lds
    s_waitcnt lgkmcnt(5)
    v_mfma_f32_32x32x16_bf16 v[44:59], a[104:107], v[20:23], v[44:59]
    ds_read_b128 v[12:15], v7 offset:32768
    s_waitcnt lgkmcnt(5)
    v_mfma_f32_32x32x16_bf16 v[44:59], a[108:111], v[24:27], v[44:59]
    ds_read_b128 v[16:19], v7 offset:33792
    buffer_load_dwordx4 v4, s[8:11], s28 offen offset:3072 sc1 lds
    s_waitcnt lgkmcnt(5)
    v_mfma_f32_32x32x16_bf16 v[60:75], a[0:3], v[28:31], 0
    ds_read_b128 v[20:23], v7 offset:34816
    s_waitcnt lgkmcnt(5)
    v_mfma_f32_32x32x16_bf16 v[60:75], a[4:7], v[32:35], v[60:75]
    ds_read_b128 v[24:27], v7 offset:35840
    s_add_u32 m0, s32, 90112
    s_add_u32 s28, s26, 4096
    buffer_load_dwordx4 v4, s[8:11], s28 offen offset:0 sc1 lds
    s_waitcnt lgkmcnt(5)
    v_mfma_f32_32x32x16_bf16 v[60:75], a[8:11], v[36:39], v[60:75]
    ds_read_b128 v[28:31], v7 offset:36864
    s_waitcnt lgkmcnt(5)
    v_mfma_f32_32x32x16_bf16 v[60:75], a[12:15], v[40:43], v[60:75]
    ds_read_b128 v[32:35], v7 offset:37888
    buffer_load_dwordx4 v4, s[8:11], s28 offen offset:1024 sc1 lds
    s_waitcnt lgkmcnt(5)
    v_mfma_f32_32x32x16_bf16 v[60:75], a[16:19], v[12:15], v[60:75]
    ds_read_b128 v[36:39], v7 offset:38912
    v_cvt_pk_bf16_f32 v76, v44, v45
    v_cvt_pk_bf16_f32 v77, v46, v47
    s_waitcnt lgkmcnt(5)
    v_mfma_f32_32x32x16_bf16 v[60:75], a[20:23], v[16:19], v[60:75]
    ds_read_b128 v[40:43], v7 offset:39936
    s_add_u32 s26, s26, 28672
    s_cmp_ge_u32 s26, s35
    s_cselect_b32 s26, s34, s26
    buffer_load_dwordx4 v4, s[8:11], s28 offen offset:2048 sc1 lds
    v_cvt_pk_bf16_f32 v78, v48, v49
    v_cvt_pk_bf16_f32 v79, v50, v51
    s_waitcnt lgkmcnt(5)
    v_mfma_f32_32x32x16_bf16 v[60:75], a[24:27], v[20:23], v[60:75]
    ds_read_b128 v[12:15], v7 offset:40960
    v_cvt_pk_bf16_f32 v80, v52, v53
    v_cvt_pk_bf16_f32 v81, v54, v55
    s_waitcnt lgkmcnt(5)
    v_mfma_f32_32x32x16_bf16 v[60:75], a[28:31], v[24:27], v[60:75]
    ds_read_b128 v[16:19], v7 offset:41984
    v_cvt_pk_bf16_f32 v82, v56, v57
    v_cvt_pk_bf16_f32 v83, v58, v59
    s_waitcnt lgkmcnt(5)
    v_mfma_f32_32x32x16_bf16 v[60:75], a[32:35], v[28:31], v[60:75]
    ds_read_b128 v[20:23], v7 offset:43008
    buffer_store_dwordx4 v[76:79], v2, s[8:11], s29 offen offset:0 sc1
    s_waitcnt lgkmcnt(5)
    v_mfma_f32_32x32x16_bf16 v[60:75], a[36:39], v[32:35], v[60:75]
    ds_read_b128 v[24:27], v7 offset:44032
    buffer_store_dwordx4 v[80:83], v2, s[8:11], s29 offen offset:1024 sc1
    s_waitcnt lgkmcnt(5)
    v_mfma_f32_32x32x16_bf16 v[60:75], a[40:43], v[36:39], v[60:75]
    ds_read_b128 v[28:31], v7 offset:45056
    s_add_u32 s29, s29, 32768
    s_cmp_ge_u32 s29, s37
    s_cselect_b32 s29, s36, s29
    s_waitcnt lgkmcnt(5)
    v_mfma_f32_32x32x16_bf16 v[60:75], a[44:47], v[40:43], v[60:75]
    ds_read_b128 v[32:35], v7 offset:46080
    s_waitcnt lgkmcnt(5)
    v_mfma_f32_32x32x16_bf16 v[60:75], a[48:51], v[12:15], v[60:75]
    ds_read_b128 v[36:39], v7 offset:47104
    s_waitcnt lgkmcnt(5)
    v_mfma_f32_32x32x16_bf16 v[60:75], a[52:55], v[16:19], v[60:75]
    ds_read_b128 v[40:43], v7 offset:48128
    s_waitcnt lgkmcnt(5)
    v_mfma_f32_32x32x16_bf16 v[60:75], a[56:59], v[20:23], v[60:75]
    ds_read_b128 v[12:15], v7 offset:49152
    s_waitcnt lgkmcnt(5)
    v_mfma_f32_32x32x16_bf16 v[60:75], a[60:63], v[24:27], v[60:75]
    ds_read_b128 v[16:19], v7 offset:50176
    s_waitcnt lgkmcnt(5)
    v_mfma_f32_32x32x16_bf16 v[60:75], a[64:67], v[28:31], v[60:75]
    ds_read_b128 v[20:23], v7 offset:51200
    s_waitcnt lgkmcnt(5)
    v_mfma_f32_32x32x16_bf16 v[60:75], a[68:71], v[32:35], v[60:75]
    ds_read_b128 v[24:27], v7 offset:52224
    s_waitcnt lgkmcnt(5)
    v_mfma_f32_32x32x16_bf16 v[60:75], a[72:75], v[36:39], v[60:75]
    ds_read_b128 v[28:31], v7 offset:53248
    s_waitcnt lgkmcnt(5)
    v_mfma_f32_32x32x16_bf16 v[60:75], a[76:79], v[40:43], v[60:75]
    ds_read_b128 v[32:35], v7 offset:54272
    s_waitcnt lgkmcnt(5)
    v_mfma_f32_32x32x16_bf16 v[60:75], a[80:83], v[12:15], v[60:75]
    ds_read_b128 v[36:39], v7 offset:55296
    s_waitcnt vmcnt(11)
    s_barrier
    s_waitcnt lgkmcnt(5)
    v_mfma_f32_32x32x16_bf16 v[60:75], a[84:87], v[16:19], v[60:75]
    ds_read_b128 v[40:43], v7 offset:56320
    s_add_u32 m0, s32, 0
    s_add_u32 s28, s26, 0
    buffer_load_dwordx4 v4, s[8:11], s28 offen offset:0 sc1 lds
    s_waitcnt lgkmcnt(5)
    v_mfma_f32_32x32x16_bf16 v[60:75], a[88:91], v[20:23], v[60:75]
    ds_read_b128 v[12:15], v8 offset:0
    s_waitcnt lgkmcnt(5)
    v_mfma_f32_32x32x16_bf16 v[60:75], a[92:95], v[24:27], v[60:75]
    ds_read_b128 v[16:19], v8 offset:1024
    buffer_load_dwordx4 v4, s[8:11], s28 offen offset:1024 sc1 lds
    s_waitcnt lgkmcnt(5)
    v_mfma_f32_32x32x16_bf16 v[60:75], a[96:99], v[28:31], v[60:75]
    ds_read_b128 v[20:23], v8 offset:2048
    s_waitcnt lgkmcnt(5)
    v_mfma_f32_32x32x16_bf16 v[60:75], a[100:103], v[32:35], v[60:75]
    ds_read_b128 v[24:27], v8 offset:3072
    buffer_load_dwordx4 v4, s[8:11], s28 offen offset:2048 sc1 lds
    s_waitcnt lgkmcnt(5)
    v_mfma_f32_32x32x16_bf16 v[60:75], a[104:107], v[36:39], v[60:75]
    ds_read_b128 v[28:31], v8 offset:4096
    s_waitcnt lgkmcnt(5)
    v_mfma_f32_32x32x16_bf16 v[60:75], a[108:111], v[40:43], v[60:75]
    ds_read_b128 v[32:35], v8 offset:5120
    buffer_load_dwordx4 v4, s[8:11], s28 offen offset:3072 sc1 lds
    s_waitcnt lgkmcnt(5)
    v_mfma_f32_32x32x16_bf16 v[44:59], a[0:3], v[12:15], 0
    ds_read_b128 v[36:39], v8 offset:6144
    s_waitcnt lgkmcnt(5)
    v_mfma_f32_32x32x16_bf16 v[44:59], a[4:7], v[16:19], v[44:59]
    ds_read_b128 v[40:43], v8 offset:7168
    s_add_u32 m0, s32, 4096
    s_add_u32 s28, s26, 4096
    buffer_load_dwordx4 v4, s[8:11], s28 offen offset:0 sc1 lds
    s_waitcnt lgkmcnt(5)
    v_mfma_f32_32x32x16_bf16 v[44:59], a[8:11], v[20:23], v[44:59]
    ds_read_b128 v[12:15], v8 offset:8192
    s_waitcnt lgkmcnt(5)
    v_mfma_f32_32x32x16_bf16 v[44:59], a[12:15], v[24:27], v[44:59]
    ds_read_b128 v[16:19], v8 offset:9216
    buffer_load_dwordx4 v4, s[8:11], s28 offen offset:1024 sc1 lds
    s_waitcnt lgkmcnt(5)
    v_mfma_f32_32x32x16_bf16 v[44:59], a[16:19], v[28:31], v[44:59]
    ds_read_b128 v[20:23], v8 offset:10240
    v_cvt_pk_bf16_f32 v76, v60, v61
    v_cvt_pk_bf16_f32 v77, v62, v63
    s_waitcnt lgkmcnt(5)
    v_mfma_f32_32x32x16_bf16 v[44:59], a[20:23], v[32:35], v[44:59]
    ds_read_b128 v[24:27], v8 offset:11264
    s_add_u32 s26, s26, 28672
    s_cmp_ge_u32 s26, s35
    s_cselect_b32 s26, s34, s26
    buffer_load_dwordx4 v4, s[8:11], s28 offen offset:2048 sc1 lds
    v_cvt_pk_bf16_f32 v78, v64, v65
    v_cvt_pk_bf16_f32 v79, v66, v67
    s_waitcnt lgkmcnt(5)
    v_mfma_f32_32x32x16_bf16 v[44:59], a[24:27], v[36:39], v[44:59]
    ds_read_b128 v[28:31], v8 offset:12288
    v_cvt_pk_bf16_f32 v80, v68, v69
    v_cvt_pk_bf16_f32 v81, v70, v71
    s_waitcnt lgkmcnt(5)
    v_mfma_f32_32x32x16_bf16 v[44:59], a[28:31], v[40:43], v[44:59]
    ds_read_b128 v[32:35], v8 offset:13312
    v_cvt_pk_bf16_f32 v82, v72, v73
    v_cvt_pk_bf16_f32 v83, v74, v75
    s_waitcnt lgkmcnt(5)
    v_mfma_f32_32x32x16_bf16 v[44:59], a[32:35], v[12:15], v[44:59]
    ds_read_b128 v[36:39], v8 offset:14336
    buffer_store_dwordx4 v[76:79], v2, s[8:11], s29 offen offset:0 sc1
    s_waitcnt lgkmcnt(5)
    v_mfma_f32_32x32x16_bf16 v[44:59], a[36:39], v[16:19], v[44:59]
    ds_read_b128 v[40:43], v8 offset:15360
    buffer_store_dwordx4 v[80:83], v2, s[8:11], s29 offen offset:1024 sc1
    s_waitcnt lgkmcnt(5)
    v_mfma_f32_32x32x16_bf16 v[44:59], a[40:43], v[20:23], v[44:59]
    ds_read_b128 v[12:15], v8 offset:16384
    s_add_u32 s29, s29, 32768
    s_cmp_ge_u32 s29, s37
    s_cselect_b32 s29, s36, s29
    s_waitcnt lgkmcnt(5)
    v_mfma_f32_32x32x16_bf16 v[44:59], a[44:47], v[24:27], v[44:59]
    ds_read_b128 v[16:19], v8 offset:17408
    s_waitcnt lgkmcnt(5)
    v_mfma_f32_32x32x16_bf16 v[44:59], a[48:51], v[28:31], v[44:59]
    ds_read_b128 v[20:23], v8 offset:18432
    s_waitcnt lgkmcnt(5)
    v_mfma_f32_32x32x16_bf16 v[44:59], a[52:55], v[32:35], v[44:59]
    ds_read_b128 v[24:27], v8 offset:19456
    s_waitcnt lgkmcnt(5)
    v_mfma_f32_32x32x16_bf16 v[44:59], a[56:59], v[36:39], v[44:59]
    ds_read_b128 v[28:31], v8 offset:20480
    s_waitcnt lgkmcnt(5)
    v_mfma_f32_32x32x16_bf16 v[44:59], a[60:63], v[40:43], v[44:59]
    ds_read_b128 v[32:35], v8 offset:21504
    s_waitcnt lgkmcnt(5)
    v_mfma_f32_32x32x16_bf16 v[44:59], a[64:67], v[12:15], v[44:59]
    ds_read_b128 v[36:39], v8 offset:22528
    s_waitcnt lgkmcnt(5)
    v_mfma_f32_32x32x16_bf16 v[44:59], a[68:71], v[16:19], v[44:59]
    ds_read_b128 v[40:43], v8 offset:23552
    s_waitcnt lgkmcnt(5)
    v_mfma_f32_32x32x16_bf16 v[44:59], a[72:75], v[20:23], v[44:59]
    ds_read_b128 v[12:15], v8 offset:24576
    s_waitcnt lgkmcnt(5)
    v_mfma_f32_32x32x16_bf16 v[44:59], a[76:79], v[24:27], v[44:59]
    ds_read_b128 v[16:19], v8 offset:25600
    s_waitcnt lgkmcnt(5)
    v_mfma_f32_32x32x16_bf16 v[44:59], a[80:83], v[28:31], v[44:59]
    ds_read_b128 v[20:23], v8 offset:26624
    s_waitcnt vmcnt(11)
    s_barrier
    s_waitcnt lgkmcnt(5)
    v_mfma_f32_32x32x16_bf16 v[44:59], a[84:87], v[32:35], v[44:59]
    ds_read_b128 v[24:27], v8 offset:27648
    s_add_u32 m0, s32, 28672
    s_add_u32 s28, s26, 0
    buffer_load_dwordx4 v4, s[8:11], s28 offen offset:0 sc1 lds
    s_waitcnt lgkmcnt(5)
    v_mfma_f32_32x32x16_bf16 v[44:59], a[88:91], v[36:39], v[44:59]
    ds_read_b128 v[28:31], v8 offset:28672
    s_waitcnt lgkmcnt(5)
    v_mfma_f32_32x32x16_bf16 v[44:59], a[92:95], v[40:43], v[44:59]
    ds_read_b128 v[32:35], v8 offset:29696
    buffer_load_dwordx4 v4, s[8:11], s28 offen offset:1024 sc1 lds
    s_waitcnt lgkmcnt(5)
    v_mfma_f32_32x32x16_bf16 v[44:59], a[96:99], v[12:15], v[44:59]
    ds_read_b128 v[36:39], v8 offset:30720
    s_waitcnt lgkmcnt(5)
    v_mfma_f32_32x32x16_bf16 v[44:59], a[100:103], v[16:19], v[44:59]
    ds_read_b128 v[40:43], v8 offset:31744
    buffer_load_dwordx4 v4, s[8:11], s28 offen offset:2048 sc1 lds
    s_waitcnt lgkmcnt(5)
    v_mfma_f32_32x32x16_bf16 v[44:59], a[104:107], v[20:23], v[44:59]
    ds_read_b128 v[12:15], v8 offset:32768
    s_waitcnt lgkmcnt(5)
    v_mfma_f32_32x32x16_bf16 v[44:59], a[108:111], v[24:27], v[44:59]
    ds_read_b128 v[16:19], v8 offset:33792
    buffer_load_dwordx4 v4, s[8:11], s28 offen offset:3072 sc1 lds
    s_waitcnt lgkmcnt(5)
    v_mfma_f32_32x32x16_bf16 v[60:75], a[0:3], v[28:31], 0
    ds_read_b128 v[20:23], v8 offset:34816
    s_waitcnt lgkmcnt(5)
    v_mfma_f32_32x32x16_bf16 v[60:75], a[4:7], v[32:35], v[60:75]
    ds_read_b128 v[24:27], v8 offset:35840
    s_add_u32 m0, s32, 32768
    s_add_u32 s28, s26, 4096
    buffer_load_dwordx4 v4, s[8:11], s28 offen offset:0 sc1 lds
    s_waitcnt lgkmcnt(5)
    v_mfma_f32_32x32x16_bf16 v[60:75], a[8:11], v[36:39], v[60:75]
    ds_read_b128 v[28:31], v8 offset:36864
    s_waitcnt lgkmcnt(5)
    v_mfma_f32_32x32x16_bf16 v[60:75], a[12:15], v[40:43], v[60:75]
    ds_read_b128 v[32:35], v8 offset:37888
    buffer_load_dwordx4 v4, s[8:11], s28 offen offset:1024 sc1 lds
    s_waitcnt lgkmcnt(5)
    v_mfma_f32_32x32x16_bf16 v[60:75], a[16:19], v[12:15], v[60:75]
    ds_read_b128 v[36:39], v8 offset:38912
    v_cvt_pk_bf16_f32 v76, v44, v45
    v_cvt_pk_bf16_f32 v77, v46, v47
    s_waitcnt lgkmcnt(5)
    v_mfma_f32_32x32x16_bf16 v[60:75], a[20:23], v[16:19], v[60:75]
    ds_read_b128 v[40:43], v8 offset:39936
    s_add_u32 s26, s26, 28672
    s_cmp_ge_u32 s26, s35
    s_cselect_b32 s26, s34, s26
    buffer_load_dwordx4 v4, s[8:11], s28 offen offset:2048 sc1 lds
    v_cvt_pk_bf16_f32 v78, v48, v49
    v_cvt_pk_bf16_f32 v79, v50, v51
    s_waitcnt lgkmcnt(5)
    v_mfma_f32_32x32x16_bf16 v[60:75], a[24:27], v[20:23], v[60:75]
    ds_read_b128 v[12:15], v8 offset:40960
    v_cvt_pk_bf16_f32 v80, v52, v53
    v_cvt_pk_bf16_f32 v81, v54, v55
    s_waitcnt lgkmcnt(5)
    v_mfma_f32_32x32x16_bf16 v[60:75], a[28:31], v[24:27], v[60:75]
    ds_read_b128 v[16:19], v8 offset:41984
    v_cvt_pk_bf16_f32 v82, v56, v57
    v_cvt_pk_bf16_f32 v83, v58, v59
    s_waitcnt lgkmcnt(5)
    v_mfma_f32_32x32x16_bf16 v[60:75], a[32:35], v[28:31], v[60:75]
    ds_read_b128 v[20:23], v8 offset:43008
    buffer_store_dwordx4 v[76:79], v2, s[8:11], s29 offen offset:0 sc1
    s_waitcnt lgkmcnt(5)
    v_mfma_f32_32x32x16_bf16 v[60:75], a[36:39], v[32:35], v[60:75]
    ds_read_b128 v[24:27], v8 offset:44032
    buffer_store_dwordx4 v[80:83], v2, s[8:11], s29 offen offset:1024 sc1
    s_waitcnt lgkmcnt(5)
    v_mfma_f32_32x32x16_bf16 v[60:75], a[40:43], v[36:39], v[60:75]
    ds_read_b128 v[28:31], v8 offset:45056
    s_add_u32 s29, s29, 32768
    s_cmp_ge_u32 s29, s37
    s_cselect_b32 s29, s36, s29
    s_waitcnt lgkmcnt(5)
    v_mfma_f32_32x32x16_bf16 v[60:75], a[44:47], v[40:43], v[60:75]
    ds_read_b128 v[32:35], v8 offset:46080
    s_waitcnt lgkmcnt(5)
    v_mfma_f32_32x32x16_bf16 v[60:75], a[48:51], v[12:15], v[60:75]
    ds_read_b128 v[36:39], v8 offset:47104
    s_waitcnt lgkmcnt(5)
    v_mfma_f32_32x32x16_bf16 v[60:75], a[52:55], v[16:19], v[60:75]
    ds_read_b128 v[40:43], v8 offset:48128
    s_waitcnt lgkmcnt(5)
    v_mfma_f32_32x32x16_bf16 v[60:75], a[56:59], v[20:23], v[60:75]
    ds_read_b128 v[12:15], v8 offset:49152
    s_waitcnt lgkmcnt(5)
    v_mfma_f32_32x32x16_bf16 v[60:75], a[60:63], v[24:27], v[60:75]
    ds_read_b128 v[16:19], v8 offset:50176
    s_waitcnt lgkmcnt(5)
    v_mfma_f32_32x32x16_bf16 v[60:75], a[64:67], v[28:31], v[60:75]
    ds_read_b128 v[20:23], v8 offset:51200
    s_waitcnt lgkmcnt(5)
    v_mfma_f32_32x32x16_bf16 v[60:75], a[68:71], v[32:35], v[60:75]
    ds_read_b128 v[24:27], v8 offset:52224
    s_waitcnt lgkmcnt(5)
    v_mfma_f32_32x32x16_bf16 v[60:75], a[72:75], v[36:39], v[60:75]
    ds_read_b128 v[28:31], v8 offset:53248
    s_waitcnt lgkmcnt(5)
    v_mfma_f32_32x32x16_bf16 v[60:75], a[76:79], v[40:43], v[60:75]
    ds_read_b128 v[32:35], v8 offset:54272
    s_waitcnt lgkmcnt(5)
    v_mfma_f32_32x32x16_bf16 v[60:75], a[80:83], v[12:15], v[60:75]
    ds_read_b128 v[36:39], v8 offset:55296
    s_waitcnt vmcnt(11)
    s_barrier
    s_waitcnt lgkmcnt(5)
    v_mfma_f32_32x32x16_bf16 v[60:75], a[84:87], v[16:19], v[60:75]
    ds_read_b128 v[40:43], v8 offset:56320
    s_waitcnt lgkmcnt(5)
    v_mfma_f32_32x32x16_bf16 v[60:75], a[88:91], v[20:23], v[60:75]
    ds_read_b128 v[12:15], v7 offset:0
    s_waitcnt lgkmcnt(5)
    v_mfma_f32_32x32x16_bf16 v[60:75], a[92:95], v[24:27], v[60:75]
    ds_read_b128 v[16:19], v7 offset:1024
    s_waitcnt lgkmcnt(5)
    v_mfma_f32_32x32x16_bf16 v[60:75], a[96:99], v[28:31], v[60:75]
    ds_read_b128 v[20:23], v7 offset:2048
    s_waitcnt lgkmcnt(5)
    v_mfma_f32_32x32x16_bf16 v[60:75], a[100:103], v[32:35], v[60:75]
    ds_read_b128 v[24:27], v7 offset:3072
    s_waitcnt lgkmcnt(5)
    v_mfma_f32_32x32x16_bf16 v[60:75], a[104:107], v[36:39], v[60:75]
    ds_read_b128 v[28:31], v7 offset:4096
    s_waitcnt lgkmcnt(5)
    v_mfma_f32_32x32x16_bf16 v[60:75], a[108:111], v[40:43], v[60:75]
    ds_read_b128 v[32:35], v7 offset:5120
    s_waitcnt lgkmcnt(5)
    v_mfma_f32_32x32x16_bf16 v[44:59], a[0:3], v[12:15], 0
    ds_read_b128 v[36:39], v7 offset:6144
    s_waitcnt lgkmcnt(5)
    v_mfma_f32_32x32x16_bf16 v[44:59], a[4:7], v[16:19], v[44:59]
    ds_read_b128 v[40:43], v7 offset:7168
    s_waitcnt lgkmcnt(5)
    v_mfma_f32_32x32x16_bf16 v[44:59], a[8:11], v[20:23], v[44:59]
    ds_read_b128 v[12:15], v7 offset:8192
    s_waitcnt lgkmcnt(5)
    v_mfma_f32_32x32x16_bf16 v[44:59], a[12:15], v[24:27], v[44:59]
    ds_read_b128 v[16:19], v7 offset:9216
    s_waitcnt lgkmcnt(5)
    v_mfma_f32_32x32x16_bf16 v[44:59], a[16:19], v[28:31], v[44:59]
    ds_read_b128 v[20:23], v7 offset:10240
    v_cvt_pk_bf16_f32 v76, v60, v61
    v_cvt_pk_bf16_f32 v77, v62, v63
    s_waitcnt lgkmcnt(5)
    v_mfma_f32_32x32x16_bf16 v[44:59], a[20:23], v[32:35], v[44:59]
    ds_read_b128 v[24:27], v7 offset:11264
    v_cvt_pk_bf16_f32 v78, v64, v65
    v_cvt_pk_bf16_f32 v79, v66, v67
    s_waitcnt lgkmcnt(5)
    v_mfma_f32_32x32x16_bf16 v[44:59], a[24:27], v[36:39], v[44:59]
    ds_read_b128 v[28:31], v7 offset:12288
    v_cvt_pk_bf16_f32 v80, v68, v69
    v_cvt_pk_bf16_f32 v81, v70, v71
    s_waitcnt lgkmcnt(5)
    v_mfma_f32_32x32x16_bf16 v[44:59], a[28:31], v[40:43], v[44:59]
    ds_read_b128 v[32:35], v7 offset:13312
    v_cvt_pk_bf16_f32 v82, v72, v73
    v_cvt_pk_bf16_f32 v83, v74, v75
    s_waitcnt lgkmcnt(5)
    v_mfma_f32_32x32x16_bf16 v[44:59], a[32:35], v[12:15], v[44:59]
    ds_read_b128 v[36:39], v7 offset:14336
    buffer_store_dwordx4 v[76:79], v2, s[8:11], s29 offen offset:0 sc1
    s_waitcnt lgkmcnt(5)
    v_mfma_f32_32x32x16_bf16 v[44:59], a[36:39], v[16:19], v[44:59]
    ds_read_b128 v[40:43], v7 offset:15360
    buffer_store_dwordx4 v[80:83], v2, s[8:11], s29 offen offset:1024 sc1
    s_waitcnt lgkmcnt(5)
    v_mfma_f32_32x32x16_bf16 v[44:59], a[40:43], v[20:23], v[44:59]
    ds_read_b128 v[12:15], v7 offset:16384
    s_add_u32 s29, s29, 32768
    s_cmp_ge_u32 s29, s37
    s_cselect_b32 s29, s36, s29
    s_waitcnt lgkmcnt(5)
    v_mfma_f32_32x32x16_bf16 v[44:59], a[44:47], v[24:27], v[44:59]
    ds_read_b128 v[16:19], v7 offset:17408
    s_waitcnt lgkmcnt(5)
    v_mfma_f32_32x32x16_bf16 v[44:59], a[48:51], v[28:31], v[44:59]
    ds_read_b128 v[20:23], v7 offset:18432
    s_waitcnt lgkmcnt(5)
    v_mfma_f32_32x32x16_bf16 v[44:59], a[52:55], v[32:35], v[44:59]
    ds_read_b128 v[24:27], v7 offset:19456
    s_waitcnt lgkmcnt(5)
    v_mfma_f32_32x32x16_bf16 v[44:59], a[56:59], v[36:39], v[44:59]
    ds_read_b128 v[28:31], v7 offset:20480
    s_waitcnt lgkmcnt(5)
    v_mfma_f32_32x32x16_bf16 v[44:59], a[60:63], v[40:43], v[44:59]
    ds_read_b128 v[32:35], v7 offset:21504
    s_waitcnt lgkmcnt(5)
    v_mfma_f32_32x32x16_bf16 v[44:59], a[64:67], v[12:15], v[44:59]
    ds_read_b128 v[36:39], v7 offset:22528
    s_waitcnt lgkmcnt(5)
    v_mfma_f32_32x32x16_bf16 v[44:59], a[68:71], v[16:19], v[44:59]
    ds_read_b128 v[40:43], v7 offset:23552
    s_waitcnt lgkmcnt(5)
    v_mfma_f32_32x32x16_bf16 v[44:59], a[72:75], v[20:23], v[44:59]
    ds_read_b128 v[12:15], v7 offset:24576
    s_waitcnt lgkmcnt(5)
    v_mfma_f32_32x32x16_bf16 v[44:59], a[76:79], v[24:27], v[44:59]
    ds_read_b128 v[16:19], v7 offset:25600
    s_waitcnt lgkmcnt(5)
    v_mfma_f32_32x32x16_bf16 v[44:59], a[80:83], v[28:31], v[44:59]
    ds_read_b128 v[20:23], v7 offset:26624
    s_waitcnt vmcnt(4)
    s_barrier
    s_waitcnt lgkmcnt(5)
    v_mfma_f32_32x32x16_bf16 v[44:59], a[84:87], v[32:35], v[44:59]
    ds_read_b128 v[24:27], v7 offset:27648
    s_waitcnt lgkmcnt(5)
    v_mfma_f32_32x32x16_bf16 v[44:59], a[88:91], v[36:39], v[44:59]
    ds_read_b128 v[28:31], v7 offset:28672
    s_waitcnt lgkmcnt(5)
    v_mfma_f32_32x32x16_bf16 v[44:59], a[92:95], v[40:43], v[44:59]
    ds_read_b128 v[32:35], v7 offset:29696
    s_waitcnt lgkmcnt(5)
    v_mfma_f32_32x32x16_bf16 v[44:59], a[96:99], v[12:15], v[44:59]
    ds_read_b128 v[36:39], v7 offset:30720
    s_waitcnt lgkmcnt(5)
    v_mfma_f32_32x32x16_bf16 v[44:59], a[100:103], v[16:19], v[44:59]
    ds_read_b128 v[40:43], v7 offset:31744
    s_waitcnt lgkmcnt(5)
    v_mfma_f32_32x32x16_bf16 v[44:59], a[104:107], v[20:23], v[44:59]
    ds_read_b128 v[12:15], v7 offset:32768
    s_waitcnt lgkmcnt(5)
    v_mfma_f32_32x32x16_bf16 v[44:59], a[108:111], v[24:27], v[44:59]
    ds_read_b128 v[16:19], v7 offset:33792
    s_waitcnt lgkmcnt(5)
    v_mfma_f32_32x32x16_bf16 v[60:75], a[0:3], v[28:31], 0
    ds_read_b128 v[20:23], v7 offset:34816
    s_waitcnt lgkmcnt(5)
    v_mfma_f32_32x32x16_bf16 v[60:75], a[4:7], v[32:35], v[60:75]
    ds_read_b128 v[24:27], v7 offset:35840
    s_waitcnt lgkmcnt(5)
    v_mfma_f32_32x32x16_bf16 v[60:75], a[8:11], v[36:39], v[60:75]
    ds_read_b128 v[28:31], v7 offset:36864
    s_waitcnt lgkmcnt(5)
    v_mfma_f32_32x32x16_bf16 v[60:75], a[12:15], v[40:43], v[60:75]
    ds_read_b128 v[32:35], v7 offset:37888
    s_waitcnt lgkmcnt(5)
    v_mfma_f32_32x32x16_bf16 v[60:75], a[16:19], v[12:15], v[60:75]
    ds_read_b128 v[36:39], v7 offset:38912
    v_cvt_pk_bf16_f32 v76, v44, v45
    v_cvt_pk_bf16_f32 v77, v46, v47
    s_waitcnt lgkmcnt(5)
    v_mfma_f32_32x32x16_bf16 v[60:75], a[20:23], v[16:19], v[60:75]
    ds_read_b128 v[40:43], v7 offset:39936
    v_cvt_pk_bf16_f32 v78, v48, v49
    v_cvt_pk_bf16_f32 v79, v50, v51
    s_waitcnt lgkmcnt(5)
    v_mfma_f32_32x32x16_bf16 v[60:75], a[24:27], v[20:23], v[60:75]
    ds_read_b128 v[12:15], v7 offset:40960
    v_cvt_pk_bf16_f32 v80, v52, v53
    v_cvt_pk_bf16_f32 v81, v54, v55
    s_waitcnt lgkmcnt(5)
    v_mfma_f32_32x32x16_bf16 v[60:75], a[28:31], v[24:27], v[60:75]
    ds_read_b128 v[16:19], v7 offset:41984
    v_cvt_pk_bf16_f32 v82, v56, v57
    v_cvt_pk_bf16_f32 v83, v58, v59
    s_waitcnt lgkmcnt(5)
    v_mfma_f32_32x32x16_bf16 v[60:75], a[32:35], v[28:31], v[60:75]
    ds_read_b128 v[20:23], v7 offset:43008
    buffer_store_dwordx4 v[76:79], v2, s[8:11], s29 offen offset:0 sc1
    s_waitcnt lgkmcnt(5)
    v_mfma_f32_32x32x16_bf16 v[60:75], a[36:39], v[32:35], v[60:75]
    ds_read_b128 v[24:27], v7 offset:44032
    buffer_store_dwordx4 v[80:83], v2, s[8:11], s29 offen offset:1024 sc1
    s_waitcnt lgkmcnt(5)
    v_mfma_f32_32x32x16_bf16 v[60:75], a[40:43], v[36:39], v[60:75]
    ds_read_b128 v[28:31], v7 offset:45056
    s_add_u32 s29, s29, 32768
    s_cmp_ge_u32 s29, s37
    s_cselect_b32 s29, s36, s29
    s_waitcnt lgkmcnt(5)
    v_mfma_f32_32x32x16_bf16 v[60:75], a[44:47], v[40:43], v[60:75]
    ds_read_b128 v[32:35], v7 offset:46080
    s_waitcnt lgkmcnt(5)
    v_mfma_f32_32x32x16_bf16 v[60:75], a[48:51], v[12:15], v[60:75]
    ds_read_b128 v[36:39], v7 offset:47104
    s_waitcnt lgkmcnt(5)
    v_mfma_f32_32x32x16_bf16 v[60:75], a[52:55], v[16:19], v[60:75]
    ds_read_b128 v[40:43], v7 offset:48128
    s_waitcnt lgkmcnt(5)
    v_mfma_f32_32x32x16_bf16 v[60:75], a[56:59], v[20:23], v[60:75]
    ds_read_b128 v[12:15], v7 offset:49152
    s_waitcnt lgkmcnt(5)
    v_mfma_f32_32x32x16_bf16 v[60:75], a[60:63], v[24:27], v[60:75]
    ds_read_b128 v[16:19], v7 offset:50176
    s_waitcnt lgkmcnt(5)
    v_mfma_f32_32x32x16_bf16 v[60:75], a[64:67], v[28:31], v[60:75]
    ds_read_b128 v[20:23], v7 offset:51200
    s_waitcnt lgkmcnt(5)
    v_mfma_f32_32x32x16_bf16 v[60:75], a[68:71], v[32:35], v[60:75]
    ds_read_b128 v[24:27], v7 offset:52224
    s_waitcnt lgkmcnt(5)
    v_mfma_f32_32x32x16_bf16 v[60:75], a[72:75], v[36:39], v[60:75]
    ds_read_b128 v[28:31], v7 offset:53248
    s_waitcnt lgkmcnt(5)
    v_mfma_f32_32x32x16_bf16 v[60:75], a[76:79], v[40:43], v[60:75]
    ds_read_b128 v[32:35], v7 offset:54272
    s_waitcnt lgkmcnt(5)
    v_mfma_f32_32x32x16_bf16 v[60:75], a[80:83], v[12:15], v[60:75]
    ds_read_b128 v[36:39], v7 offset:55296
    s_waitcnt lgkmcnt(5)
    v_mfma_f32_32x32x16_bf16 v[60:75], a[84:87], v[16:19], v[60:75]
    ds_read_b128 v[40:43], v7 offset:56320
    s_waitcnt lgkmcnt(5)
    v_mfma_f32_32x32x16_bf16 v[60:75], a[88:91], v[20:23], v[60:75]
    s_waitcnt lgkmcnt(4)
    v_mfma_f32_32x32x16_bf16 v[60:75], a[92:95], v[24:27], v[60:75]
    s_waitcnt lgkmcnt(3)
    v_mfma_f32_32x32x16_bf16 v[60:75], a[96:99], v[28:31], v[60:75]
    s_waitcnt lgkmcnt(2)
    v_mfma_f32_32x32x16_bf16 v[60:75], a[100:103], v[32:35], v[60:75]
    s_waitcnt lgkmcnt(1)
    v_mfma_f32_32x32x16_bf16 v[60:75], a[104:107], v[36:39], v[60:75]
    s_waitcnt lgkmcnt(0)
    v_mfma_f32_32x32x16_bf16 v[60:75], a[108:111], v[40:43], v[60:75]
    s_nop 11
    v_cvt_pk_bf16_f32 v76, v60, v61
    v_cvt_pk_bf16_f32 v77, v62, v63
    s_nop 0
    v_cvt_pk_bf16_f32 v78, v64, v65
    v_cvt_pk_bf16_f32 v79, v66, v67
    s_nop 0
    v_cvt_pk_bf16_f32 v80, v68, v69
    v_cvt_pk_bf16_f32 v81, v70, v71
    s_nop 0
    v_cvt_pk_bf16_f32 v82, v72, v73
    v_cvt_pk_bf16_f32 v83, v74, v75
    s_nop 0
    buffer_store_dwordx4 v[76:79], v2, s[8:11], s29 offen offset:0 sc1
    s_nop 0
    buffer_store_dwordx4 v[80:83], v2, s[8:11], s29 offen offset:1024 sc1
    s_nop 0
    s_add_u32 s29, s29, 32768
    s_cmp_ge_u32 s29, s37
    s_cselect_b32 s29, s36, s29
    s_nop 0
    s_lshl_b32 s30, s25, 7
    s_add_u32 s30, s30, 18616320
    s_waitcnt vmcnt(0)
    s_barrier
    s_cmp_lg_u32 s21, 0
    s_cbranch_scc1 sig_51
    v_mov_b32 v3, 4
    s_mov_b64 exec, 1
    buffer_atomic_add v3, off, s[8:11], s30 sc1
    s_mov_b64 exec, -1
sig_51:
    s_branch main_next
job_8:
    s_lshl_b32 s33, s25, 2
    s_add_u32 s33, s33, s21
    s_lshr_b32 s31, s24, 4
    s_and_b32 s24, s24, 15
    s_mul_i32 s31, s31, 7
    s_min_u32 s31, s31, 11
    s_mul_i32 s26, s24, 14
    s_add_u32 s26, s26, s31
    s_mul_i32 s26, s26, 28672
    s_add_u32 s26, s26, 6422528
    s_mul_i32 s29, s33, 14
    s_add_u32 s29, s29, s31
    s_lshl_b32 s29, s29, 15
    s_lshl_b32 s30, s24, 11
    s_add_u32 s29, s29, s30
    s_add_u32 s29, s29, 27262976
    s_mov_b32 s34, s26
    s_add_u32 s35, s26, 200704
    s_mov_b32 s36, s29
    s_add_u32 s37, s29, 229376
    s_mul_i32 s31, s25, 5
    s_mul_i32 s30, s31, 147
    s_lshr_b32 s30, s30, 10
    s_mul_i32 s30, s30, 7
    s_sub_u32 s31, s31, s30
    s_mul_i32 s30, s31, 28672
    s_add_u32 s26, s26, s30
    s_lshl_b32 s30, s31, 15
    s_add_u32 s29, s29, s30
    s_lshl_b32 s28, s24, 7
    s_add_u32 s28, s28, 18636800
    v_mov_b32 v7, v2
    s_mul_i32 s32, s21, 7168
    v_add_u32 v4, s32, v2
    v_add_u32 v8, 57344, v7
    s_mul_i32 s27, s33, 28672
    s_add_u32 s27, s27, 15728640
    s_lshr_b32 s3, s33, 2
    s_lshl_b32 s3, s3, 7
    s_add_u32 s3, s3, 18614272
    v_mov_b32 v6, s28
    v_writelane_b32 v6, s3, 0
    v_mov_b32 v12, 10922
    v_writelane_b32 v12, 2, 0
gw_52:
    buffer_load_dword v3, v6, s[8:11], 0 offen sc1
    s_waitcnt vmcnt(0)
    v_cmp_gt_u32 vcc, v12, v3
    s_cbranch_vccz gw_52k
    s_sleep 2
    s_sub_u32 s23, s23, 1
    s_cbranch_scc0 gw_52
    s_mov_b32 s23, 0
gw_52k:
    s_add_u32 m0, s32, 0
    s_add_u32 s28, s26, 0
    buffer_load_dwordx4 v4, s[8:11], s28 offen offset:0 sc1 lds
    buffer_load_dwordx4 v4, s[8:11], s28 offen offset:1024 sc1 lds
    buffer_load_dwordx4 v4, s[8:11], s28 offen offset:2048 sc1 lds
    buffer_load_dwordx4 v4, s[8:11], s28 offen offset:3072 sc1 lds
    s_add_u32 m0, s32, 4096
    s_add_u32 s28, s26, 4096
    buffer_load_dwordx4 v4, s[8:11], s28 offen offset:0 sc1 lds
    buffer_load_dwordx4 v4, s[8:11], s28 offen offset:1024 sc1 lds
    s_add_u32 s26, s26, 28672
    s_cmp_ge_u32 s26, s35
    s_cselect_b32 s26, s34, s26
    buffer_load_dwordx4 v4, s[8:11], s28 offen offset:2048 sc1 lds
    buffer_load_dwordx4 a[0:3], v2, s[8:11], s27 offen offset:0 sc1
    buffer_load_dwordx4 a[4:7], v2, s[8:11], s27 offen offset:1024 sc1
    buffer_load_dwordx4 a[8:11], v2, s[8:11], s27 offen offset:2048 sc1
    buffer_load_dwordx4 a[12:15], v2, s[8:11], s27 offen offset:3072 sc1
    s_add_u32 s27, s27, 4096
    buffer_load_dwordx4 a[16:19], v2, s[8:11], s27 offen offset:0 sc1
    buffer_load_dwordx4 a[20:23], v2, s[8:11], s27 offen offset:1024 sc1
    buffer_load_dwordx4 a[24:27], v2, s[8:11], s27 offen offset:2048 sc1
    buffer_load_dwordx4 a[28:31], v2, s[8:11], s27 offen offset:3072 sc1
    s_add_u32 s27, s27, 4096
    buffer_load_dwordx4 a[32:35], v2, s[8:11], s27 offen offset:0 sc1
    buffer_load_dwordx4 a[36:39], v2, s[8:11], s27 offen offset:1024 sc1
    buffer_load_dwordx4 a[40:43], v2, s[8:11], s27 offen offset:2048 sc1
    buffer_load_dwordx4 a[44:47], v2, s[8:11], s27 offen offset:3072 sc1
    s_add_u32 s27, s27, 4096
    buffer_load_dwordx4 a[48:51], v2, s[8:11], s27 offen offset:0 sc1
    buffer_load_dwordx4 a[52:55], v2, s[8:11], s27 offen offset:1024 sc1
    buffer_load_dwordx4 a[56:59], v2, s[8:11], s27 offen offset:2048 sc1
    buffer_load_dwordx4 a[60:63], v2, s[8:11], s27 offen offset:3072 sc1
    s_add_u32 s27, s27, 4096
    buffer_load_dwordx4 a[64:67], v2, s[8:11], s27 offen offset:0 sc1
    buffer_load_dwordx4 a[68:71], v2, s[8:11], s27 offen offset:1024 sc1
    buffer_load_dwordx4 a[72:75], v2, s[8:11], s27 offen offset:2048 sc1
    buffer_load_dwordx4 a[76:79], v2, s[8:11], s27 offen offset:3072 sc1
    s_add_u32 s27, s27, 4096
    buffer_load_dwordx4 a[80:83], v2, s[8:11], s27 offen offset:0 sc1
    buffer_load_dwordx4 a[84:87], v2, s[8:11], s27 offen offset:1024 sc1
    buffer_load_dwordx4 a[88:91], v2, s[8:11], s27 offen offset:2048 sc1
    buffer_load_dwordx4 a[92:95], v2, s[8:11], s27 offen offset:3072 sc1
    s_add_u32 s27, s27, 4096
    buffer_load_dwordx4 a[96:99], v2, s[8:11], s27 offen offset:0 sc1
    buffer_load_dwordx4 a[100:103], v2, s[8:11], s27 offen offset:1024 sc1
    buffer_load_dwordx4 a[104:107], v2, s[8:11], s27 offen offset:2048 sc1
    buffer_load_dwordx4 a[108:111], v2, s[8:11], s27 offen offset:3072 sc1
    s_add_u32 m0, s32, 28672
    s_add_u32 s28, s26, 0
    buffer_load_dwordx4 v4, s[8:11], s28 offen offset:0 sc1 lds
    buffer_load_dwordx4 v4, s[8:11], s28 offen offset:1024 sc1 lds
    buffer_load_dwordx4 v4, s[8:11], s28 offen offset:2048 sc1 lds
    buffer_load_dwordx4 v4, s[8:11], s28 offen offset:3072 sc1 lds
    s_add_u32 m0, s32, 32768
    s_add_u32 s28, s26, 4096
    buffer_load_dwordx4 v4, s[8:11], s28 offen offset:0 sc1 lds
    buffer_load_dwordx4 v4, s[8:11], s28 offen offset:1024 sc1 lds
    s_add_u32 s26, s26, 28672
    s_cmp_ge_u32 s26, s35
    s_cselect_b32 s26, s34, s26
    buffer_load_dwordx4 v4, s[8:11], s28 offen offset:2048 sc1 lds
    s_waitcnt vmcnt(7)
    s_barrier
    ds_read_b128 v[12:15], v7 offset:0
    ds_read_b128 v[16:19], v7 offset:1024
    ds_read_b128 v[20:23], v7 offset:2048
    ds_read_b128 v[24:27], v7 offset:3072
    ds_read_b128 v[28:31], v7 offset:4096
    ds_read_b128 v[32:35], v7 offset:5120
    s_waitcnt lgkmcnt(5)
    v_mfma_f32_32x32x16_bf16 v[44:59], a[0:3], v[12:15], 0
    ds_read_b128 v[36:39], v7 offset:6144
    s_add_u32 m0, s32, 57344
    s_add_u32 s28, s26, 0
    buffer_load_dwordx4 v4, s[8:11], s28 offen offset:0 sc1 lds
    s_waitcnt lgkmcnt(5)
    v_mfma_f32_32x32x16_bf16 v[44:59], a[4:7], v[16:19], v[44:59]
    ds_read_b128 v[40:43], v7 offset:7168
    s_waitcnt lgkmcnt(5)
    v_mfma_f32_32x32x16_bf16 v[44:59], a[8:11], v[20:23], v[44:59]
    ds_read_b128 v[12:15], v7 offset:8192
    buffer_load_dwordx4 v4, s[8:11], s28 offen offset:1024 sc1 lds
    s_waitcnt lgkmcnt(5)
    v_mfma_f32_32x32x16_bf16 v[44:59], a[12:15], v[24:27], v[44:59]
    ds_read_b128 v[16:19], v7 offset:9216
    s_waitcnt lgkmcnt(5)
    v_mfma_f32_32x32x16_bf16 v[44:59], a[16:19], v[28:31], v[44:59]
    ds_read_b128 v[20:23], v7 offset:10240
    buffer_load_dwordx4 v4, s[8:11], s28 offen offset:2048 sc1 lds
    s_waitcnt lgkmcnt(5)
    v_mfma_f32_32x32x16_bf16 v[44:59], a[20:23], v[32:35], v[44:59]
    ds_read_b128 v[24:27], v7 offset:11264
    s_waitcnt lgkmcnt(5)
    v_mfma_f32_32x32x16_bf16 v[44:59], a[24:27], v[36:39], v[44:59]
    ds_read_b128 v[28:31], v7 offset:12288
    buffer_load_dwordx4 v4, s[8:11], s28 offen offset:3072 sc1 lds
    s_waitcnt lgkmcnt(5)
    v_mfma_f32_32x32x16_bf16 v[44:59], a[28:31], v[40:43], v[44:59]
    ds_read_b128 v[32:35], v7 offset:13312
    s_waitcnt lgkmcnt(5)
    v_mfma_f32_32x32x16_bf16 v[44:59], a[32:35], v[12:15], v[44:59]
    ds_read_b128 v[36:39], v7 offset:14336
    s_add_u32 m0, s32, 61440
    s_add_u32 s28, s26, 4096
    buffer_load_dwordx4 v4, s[8:11], s28 offen offset:0 sc1 lds
    s_waitcnt lgkmcnt(5)
    v_mfma_f32_32x32x16_bf16 v[44:59], a[36:39], v[16:19], v[44:59]
    ds_read_b128 v[40:43], v7 offset:15360
    s_waitcnt lgkmcnt(5)
    v_mfma_f32_32x32x16_bf16 v[44:59], a[40:43], v[20:23], v[44:59]
    ds_read_b128 v[12:15], v7 offset:16384
    buffer_load_dwordx4 v4, s[8:11], s28 offen offset:1024 sc1 lds
    s_waitcnt lgkmcnt(5)
    v_mfma_f32_32x32x16_bf16 v[44:59], a[44:47], v[24:27], v[44:59]
    ds_read_b128 v[16:19], v7 offset:17408
    s_waitcnt lgkmcnt(5)
    v_mfma_f32_32x32x16_bf16 v[44:59], a[48:51], v[28:31], v[44:59]
    ds_read_b128 v[20:23], v7 offset:18432
    s_add_u32 s26, s26, 28672
    s_cmp_ge_u32 s26, s35
    s_cselect_b32 s26, s34, s26
    buffer_load_dwordx4 v4, s[8:11], s28 offen offset:2048 sc1 lds
    s_waitcnt lgkmcnt(5)
    v_mfma_f32_32x32x16_bf16 v[44:59], a[52:55], v[32:35], v[44:59]
    ds_read_b128 v[24:27], v7 offset:19456
    s_waitcnt lgkmcnt(5)
    v_mfma_f32_32x32x16_bf16 v[44:59], a[56:59], v[36:39], v[44:59]
    ds_read_b128 v[28:31], v7 offset:20480
    s_waitcnt lgkmcnt(5)
    v_mfma_f32_32x32x16_bf16 v[44:59], a[60:63], v[40:43], v[44:59]
    ds_read_b128 v[32:35], v7 offset:21504
    s_waitcnt lgkmcnt(5)
    v_mfma_f32_32x32x16_bf16 v[44:59], a[64:67], v[12:15], v[44:59]
    ds_read_b128 v[36:39], v7 offset:22528
    s_waitcnt lgkmcnt(5)
    v_mfma_f32_32x32x16_bf16 v[44:59], a[68:71], v[16:19], v[44:59]
    ds_read_b128 v[40:43], v7 offset:23552
    s_waitcnt lgkmcnt(5)
    v_mfma_f32_32x32x16_bf16 v[44:59], a[72:75], v[20:23], v[44:59]
    ds_read_b128 v[12:15], v7 offset:24576
    s_waitcnt lgkmcnt(5)
    v_mfma_f32_32x32x16_bf16 v[44:59], a[76:79], v[24:27], v[44:59]
    ds_read_b128 v[16:19], v7 offset:25600
    s_waitcnt lgkmcnt(5)
    v_mfma_f32_32x32x16_bf16 v[44:59], a[80:83], v[28:31], v[44:59]
    ds_read_b128 v[20:23], v7 offset:26624
    s_waitcnt vmcnt(7)
    s_barrier
    s_waitcnt lgkmcnt(5)
    v_mfma_f32_32x32x16_bf16 v[44:59], a[84:87], v[32:35], v[44:59]
    ds_read_b128 v[24:27], v7 offset:27648
    s_add_u32 m0, s32, 86016
    s_add_u32 s28, s26, 0
    buffer_load_dwordx4 v4, s[8:11], s28 offen offset:0 sc1 lds
    s_waitcnt lgkmcnt(5)
    v_mfma_f32_32x32x16_bf16 v[44:59], a[88:91], v[36:39], v[44:59]
    ds_read_b128 v[28:31], v7 offset:28672
    s_waitcnt lgkmcnt(5)
    v_mfma_f32_32x32x16_bf16 v[44:59], a[92:95], v[40:43], v[44:59]
    ds_read_b128 v[32:35], v7 offset:29696
    buffer_load_dwordx4 v4, s[8:11], s28 offen offset:1024 sc1 lds
    s_waitcnt lgkmcnt(5)
    v_mfma_f32_32x32x16_bf16 v[44:59], a[96:99], v[12:15], v[44:59]
    ds_read_b128 v[36:39], v7 offset:30720
    s_waitcnt lgkmcnt(5)
    v_mfma_f32_32x32x16_bf16 v[44:59], a[100:103], v[16:19], v[44:59]
    ds_read_b128 v[40:43], v7 offset:31744
    buffer_load_dwordx4 v4, s[8:11], s28 offen offset:2048 sc1 lds
    s_waitcnt lgkmcnt(5)
    v_mfma_f32_32x32x16_bf16 v[44:59], a[104:107], v[20:23], v[44:59]
    ds_read_b128 v[12:15], v7 offset:32768
    s_waitcnt lgkmcnt(5)
    v_mfma_f32_32x32x16_bf16 v[44:59], a[108:111], v[24:27], v[44:59]
    ds_read_b128 v[16:19], v7 offset:33792
    buffer_load_dwordx4 v4, s[8:11], s28 offen offset:3072 sc1 lds
    s_waitcnt lgkmcnt(5)
    v_mfma_f32_32x32x16_bf16 v[60:75], a[0:3], v[28:31], 0
    ds_read_b128 v[20:23], v7 offset:34816
    s_waitcnt lgkmcnt(5)
    v_mfma_f32_32x32x16_bf16 v[60:75], a[4:7], v[32:35], v[60:75]
    ds_read_b128 v[24:27], v7 offset:35840
    s_add_u32 m0, s32, 90112
    s_add_u32 s28, s26, 4096
    buffer_load_dwordx4 v4, s[8:11], s28 offen offset:0 sc1 lds
    s_waitcnt lgkmcnt(5)
    v_mfma_f32_32x32x16_bf16 v[60:75], a[8:11], v[36:39], v[60:75]
    ds_read_b128 v[28:31], v7 offset:36864
    s_waitcnt lgkmcnt(5)
    v_mfma_f32_32x32x16_bf16 v[60:75], a[12:15], v[40:43], v[60:75]
    ds_read_b128 v[32:35], v7 offset:37888
    buffer_load_dwordx4 v4, s[8:11], s28 offen offset:1024 sc1 lds
    s_waitcnt lgkmcnt(5)
    v_mfma_f32_32x32x16_bf16 v[60:75], a[16:19], v[12:15], v[60:75]
    ds_read_b128 v[36:39], v7 offset:38912
    v_cvt_pk_bf16_f32 v76, v44, v45
    v_cvt_pk_bf16_f32 v77, v46, v47
    s_waitcnt lgkmcnt(5)
    v_mfma_f32_32x32x16_bf16 v[60:75], a[20:23], v[16:19], v[60:75]
    ds_read_b128 v[40:43], v7 offset:39936
    s_add_u32 s26, s26, 28672
    s_cmp_ge_u32 s26, s35
    s_cselect_b32 s26, s34, s26
    buffer_load_dwordx4 v4, s[8:11], s28 offen offset:2048 sc1 lds
    v_cvt_pk_bf16_f32 v78, v48, v49
    v_cvt_pk_bf16_f32 v79, v50, v51
    s_waitcnt lgkmcnt(5)
    v_mfma_f32_32x32x16_bf16 v[60:75], a[24:27], v[20:23], v[60:75]
    ds_read_b128 v[12:15], v7 offset:40960
    v_cvt_pk_bf16_f32 v80, v52, v53
    v_cvt_pk_bf16_f32 v81, v54, v55
    s_waitcnt lgkmcnt(5)
    v_mfma_f32_32x32x16_bf16 v[60:75], a[28:31], v[24:27], v[60:75]
    ds_read_b128 v[16:19], v7 offset:41984
    v_cvt_pk_bf16_f32 v82, v56, v57
    v_cvt_pk_bf16_f32 v83, v58, v59
    s_waitcnt lgkmcnt(5)
    v_mfma_f32_32x32x16_bf16 v[60:75], a[32:35], v[28:31], v[60:75]
    ds_read_b128 v[20:23], v7 offset:43008
    buffer_store_dwordx4 v[76:79], v2, s[8:11], s29 offen offset:0 sc1
    s_waitcnt lgkmcnt(5)
    v_mfma_f32_32x32x16_bf16 v[60:75], a[36:39], v[32:35], v[60:75]
    ds_read_b128 v[24:27], v7 offset:44032
    buffer_store_dwordx4 v[80:83], v2, s[8:11], s29 offen offset:1024 sc1
    s_waitcnt lgkmcnt(5)
    v_mfma_f32_32x32x16_bf16 v[60:75], a[40:43], v[36:39], v[60:75]
    ds_read_b128 v[28:31], v7 offset:45056
    s_add_u32 s29, s29, 32768
    s_cmp_ge_u32 s29, s37
    s_cselect_b32 s29, s36, s29
    s_waitcnt lgkmcnt(5)
    v_mfma_f32_32x32x16_bf16 v[60:75], a[44:47], v[40:43], v[60:75]
    ds_read_b128 v[32:35], v7 offset:46080
    s_waitcnt lgkmcnt(5)
    v_mfma_f32_32x32x16_bf16 v[60:75], a[48:51], v[12:15], v[60:75]
    ds_read_b128 v[36:39], v7 offset:47104
    s_waitcnt lgkmcnt(5)
    v_mfma_f32_32x32x16_bf16 v[60:75], a[52:55], v[16:19], v[60:75]
    ds_read_b128 v[40:43], v7 offset:48128
    s_waitcnt lgkmcnt(5)
    v_mfma_f32_32x32x16_bf16 v[60:75], a[56:59], v[20:23], v[60:75]
    ds_read_b128 v[12:15], v7 offset:49152
    s_waitcnt lgkmcnt(5)
    v_mfma_f32_32x32x16_bf16 v[60:75], a[60:63], v[24:27], v[60:75]
    ds_read_b128 v[16:19], v7 offset:50176
    s_waitcnt lgkmcnt(5)
    v_mfma_f32_32x32x16_bf16 v[60:75], a[64:67], v[28:31], v[60:75]
    ds_read_b128 v[20:23], v7 offset:51200
    s_waitcnt lgkmcnt(5)
    v_mfma_f32_32x32x16_bf16 v[60:75], a[68:71], v[32:35], v[60:75]
    ds_read_b128 v[24:27], v7 offset:52224
    s_waitcnt lgkmcnt(5)
    v_mfma_f32_32x32x16_bf16 v[60:75], a[72:75], v[36:39], v[60:75]
    ds_read_b128 v[28:31], v7 offset:53248
    s_waitcnt lgkmcnt(5)
    v_mfma_f32_32x32x16_bf16 v[60:75], a[76:79], v[40:43], v[60:75]
    ds_read_b128 v[32:35], v7 offset:54272
    s_waitcnt lgkmcnt(5)
    v_mfma_f32_32x32x16_bf16 v[60:75], a[80:83], v[12:15], v[60:75]
    ds_read_b128 v[36:39], v7 offset:55296
    s_waitcnt vmcnt(9)
    s_barrier
    s_waitcnt lgkmcnt(5)
    v_mfma_f32_32x32x16_bf16 v[60:75], a[84:87], v[16:19], v[60:75]
    ds_read_b128 v[40:43], v7 offset:56320
    s_add_u32 m0, s32, 0
    s_add_u32 s28, s26, 0
    buffer_load_dwordx4 v4, s[8:11], s28 offen offset:0 sc1 lds
    s_waitcnt lgkmcnt(5)
    v_mfma_f32_32x32x16_bf16 v[60:75], a[88:91], v[20:23], v[60:75]
    ds_read_b128 v[12:15], v8 offset:0
    s_waitcnt lgkmcnt(5)
    v_mfma_f32_32x32x16_bf16 v[60:75], a[92:95], v[24:27], v[60:75]
    ds_read_b128 v[16:19], v8 offset:1024
    buffer_load_dwordx4 v4, s[8:11], s28 offen offset:1024 sc1 lds
    s_waitcnt lgkmcnt(5)
    v_mfma_f32_32x32x16_bf16 v[60:75], a[96:99], v[28:31], v[60:75]
    ds_read_b128 v[20:23], v8 offset:2048
    s_waitcnt lgkmcnt(5)
    v_mfma_f32_32x32x16_bf16 v[60:75], a[100:103], v[32:35], v[60:75]
    ds_read_b128 v[24:27], v8 offset:3072
    buffer_load_dwordx4 v4, s[8:11], s28 offen offset:2048 sc1 lds
    s_waitcnt lgkmcnt(5)
    v_mfma_f32_32x32x16_bf16 v[60:75], a[104:107], v[36:39], v[60:75]
    ds_read_b128 v[28:31], v8 offset:4096
    s_waitcnt lgkmcnt(5)
    v_mfma_f32_32x32x16_bf16 v[60:75], a[108:111], v[40:43], v[60:75]
    ds_read_b128 v[32:35], v8 offset:5120
    buffer_load_dwordx4 v4, s[8:11], s28 offen offset:3072 sc1 lds
    s_waitcnt lgkmcnt(5)
    v_mfma_f32_32x32x16_bf16 v[44:59], a[0:3], v[12:15], 0
    ds_read_b128 v[36:39], v8 offset:6144
    s_waitcnt lgkmcnt(5)
    v_mfma_f32_32x32x16_bf16 v[44:59], a[4:7], v[16:19], v[44:59]
    ds_read_b128 v[40:43], v8 offset:7168
    s_add_u32 m0, s32, 4096
    s_add_u32 s28, s26, 4096
    buffer_load_dwordx4 v4, s[8:11], s28 offen offset:0 sc1 lds
    s_waitcnt lgkmcnt(5)
    v_mfma_f32_32x32x16_bf16 v[44:59], a[8:11], v[20:23], v[44:59]
    ds_read_b128 v[12:15], v8 offset:8192
    s_waitcnt lgkmcnt(5)
    v_mfma_f32_32x32x16_bf16 v[44:59], a[12:15], v[24:27], v[44:59]
    ds_read_b128 v[16:19], v8 offset:9216
    buffer_load_dwordx4 v4, s[8:11], s28 offen offset:1024 sc1 lds
    s_waitcnt lgkmcnt(5)
    v_mfma_f32_32x32x16_bf16 v[44:59], a[16:19], v[28:31], v[44:59]
    ds_read_b128 v[20:23], v8 offset:10240
    v_cvt_pk_bf16_f32 v76, v60, v61
    v_cvt_pk_bf16_f32 v77, v62, v63
    s_waitcnt lgkmcnt(5)
    v_mfma_f32_32x32x16_bf16 v[44:59], a[20:23], v[32:35], v[44:59]
    ds_read_b128 v[24:27], v8 offset:11264
    s_add_u32 s26, s26, 28672
    s_cmp_ge_u32 s26, s35
    s_cselect_b32 s26, s34, s26
    buffer_load_dwordx4 v4, s[8:11], s28 offen offset:2048 sc1 lds
    v_cvt_pk_bf16_f32 v78, v64, v65
    v_cvt_pk_bf16_f32 v79, v66, v67
    s_waitcnt lgkmcnt(5)
    v_mfma_f32_32x32x16_bf16 v[44:59], a[24:27], v[36:39], v[44:59]
    ds_read_b128 v[28:31], v8 offset:12288
    v_cvt_pk_bf16_f32 v80, v68, v69
    v_cvt_pk_bf16_f32 v81, v70, v71
    s_waitcnt lgkmcnt(5)
    v_mfma_f32_32x32x16_bf16 v[44:59], a[28:31], v[40:43], v[44:59]
    ds_read_b128 v[32:35], v8 offset:13312
    v_cvt_pk_bf16_f32 v82, v72, v73
    v_cvt_pk_bf16_f32 v83, v74, v75
    s_waitcnt lgkmcnt(5)
    v_mfma_f32_32x32x16_bf16 v[44:59], a[32:35], v[12:15], v[44:59]
    ds_read_b128 v[36:39], v8 offset:14336
    buffer_store_dwordx4 v[76:79], v2, s[8:11], s29 offen offset:0 sc1
    s_waitcnt lgkmcnt(5)
    v_mfma_f32_32x32x16_bf16 v[44:59], a[36:39], v[16:19], v[44:59]
    ds_read_b128 v[40:43], v8 offset:15360
    buffer_store_dwordx4 v[80:83], v2, s[8:11], s29 offen offset:1024 sc1
    s_waitcnt lgkmcnt(5)
    v_mfma_f32_32x32x16_bf16 v[44:59], a[40:43], v[20:23], v[44:59]
    ds_read_b128 v[12:15], v8 offset:16384
    s_add_u32 s29, s29, 32768
    s_cmp_ge_u32 s29, s37
    s_cselect_b32 s29, s36, s29
    s_waitcnt lgkmcnt(5)
    v_mfma_f32_32x32x16_bf16 v[44:59], a[44:47], v[24:27], v[44:59]
    ds_read_b128 v[16:19], v8 offset:17408
    s_waitcnt lgkmcnt(5)
    v_mfma_f32_32x32x16_bf16 v[44:59], a[48:51], v[28:31], v[44:59]
    ds_read_b128 v[20:23], v8 offset:18432
    s_waitcnt lgkmcnt(5)
    v_mfma_f32_32x32x16_bf16 v[44:59], a[52:55], v[32:35], v[44:59]
    ds_read_b128 v[24:27], v8 offset:19456
    s_waitcnt lgkmcnt(5)
    v_mfma_f32_32x32x16_bf16 v[44:59], a[56:59], v[36:39], v[44:59]
    ds_read_b128 v[28:31], v8 offset:20480
    s_waitcnt lgkmcnt(5)
    v_mfma_f32_32x32x16_bf16 v[44:59], a[60:63], v[40:43], v[44:59]
    ds_read_b128 v[32:35], v8 offset:21504
    s_waitcnt lgkmcnt(5)
    v_mfma_f32_32x32x16_bf16 v[44:59], a[64:67], v[12:15], v[44:59]
    ds_read_b128 v[36:39], v8 offset:22528
    s_waitcnt lgkmcnt(5)
    v_mfma_f32_32x32x16_bf16 v[44:59], a[68:71], v[16:19], v[44:59]
    ds_read_b128 v[40:43], v8 offset:23552
    s_waitcnt lgkmcnt(5)
    v_mfma_f32_32x32x16_bf16 v[44:59], a[72:75], v[20:23], v[44:59]
    ds_read_b128 v[12:15], v8 offset:24576
    s_waitcnt lgkmcnt(5)
    v_mfma_f32_32x32x16_bf16 v[44:59], a[76:79], v[24:27], v[44:59]
    ds_read_b128 v[16:19], v8 offset:25600
    s_waitcnt lgkmcnt(5)
    v_mfma_f32_32x32x16_bf16 v[44:59], a[80:83], v[28:31], v[44:59]
    ds_read_b128 v[20:23], v8 offset:26624
    s_waitcnt vmcnt(11)
    s_barrier
    s_waitcnt lgkmcnt(5)
    v_mfma_f32_32x32x16_bf16 v[44:59], a[84:87], v[32:35], v[44:59]
    ds_read_b128 v[24:27], v8 offset:27648
    s_add_u32 m0, s32, 28672
    s_add_u32 s28, s26, 0
    buffer_load_dwordx4 v4, s[8:11], s28 offen offset:0 sc1 lds
    s_waitcnt lgkmcnt(5)
    v_mfma_f32_32x32x16_bf16 v[44:59], a[88:91], v[36:39], v[44:59]
    ds_read_b128 v[28:31], v8 offset:28672
    s_waitcnt lgkmcnt(5)
    v_mfma_f32_32x32x16_bf16 v[44:59], a[92:95], v[40:43], v[44:59]
    ds_read_b128 v[32:35], v8 offset:29696
    buffer_load_dwordx4 v4, s[8:11], s28 offen offset:1024 sc1 lds
    s_waitcnt lgkmcnt(5)
    v_mfma_f32_32x32x16_bf16 v[44:59], a[96:99], v[12:15], v[44:59]
    ds_read_b128 v[36:39], v8 offset:30720
    s_waitcnt lgkmcnt(5)
    v_mfma_f32_32x32x16_bf16 v[44:59], a[100:103], v[16:19], v[44:59]
    ds_read_b128 v[40:43], v8 offset:31744
    buffer_load_dwordx4 v4, s[8:11], s28 offen offset:2048 sc1 lds
    s_waitcnt lgkmcnt(5)
    v_mfma_f32_32x32x16_bf16 v[44:59], a[104:107], v[20:23], v[44:59]
    ds_read_b128 v[12:15], v8 offset:32768
    s_waitcnt lgkmcnt(5)
    v_mfma_f32_32x32x16_bf16 v[44:59], a[108:111], v[24:27], v[44:59]
    ds_read_b128 v[16:19], v8 offset:33792
    buffer_load_dwordx4 v4, s[8:11], s28 offen offset:3072 sc1 lds
    s_waitcnt lgkmcnt(5)
    v_mfma_f32_32x32x16_bf16 v[60:75], a[0:3], v[28:31], 0
    ds_read_b128 v[20:23], v8 offset:34816
    s_waitcnt lgkmcnt(5)
    v_mfma_f32_32x32x16_bf16 v[60:75], a[4:7], v[32:35], v[60:75]
    ds_read_b128 v[24:27], v8 offset:35840
    s_add_u32 m0, s32, 32768
    s_add_u32 s28, s26, 4096
    buffer_load_dwordx4 v4, s[8:11], s28 offen offset:0 sc1 lds
    s_waitcnt lgkmcnt(5)
    v_mfma_f32_32x32x16_bf16 v[60:75], a[8:11], v[36:39], v[60:75]
    ds_read_b128 v[28:31], v8 offset:36864
    s_waitcnt lgkmcnt(5)
    v_mfma_f32_32x32x16_bf16 v[60:75], a[12:15], v[40:43], v[60:75]
    ds_read_b128 v[32:35], v8 offset:37888
    buffer_load_dwordx4 v4, s[8:11], s28 offen offset:1024 sc1 lds
    s_waitcnt lgkmcnt(5)
    v_mfma_f32_32x32x16_bf16 v[60:75], a[16:19], v[12:15], v[60:75]
    ds_read_b128 v[36:39], v8 offset:38912
    v_cvt_pk_bf16_f32 v76, v44, v45
    v_cvt_pk_bf16_f32 v77, v46, v47
    s_waitcnt lgkmcnt(5)
    v_mfma_f32_32x32x16_bf16 v[60:75], a[20:23], v[16:19], v[60:75]
    ds_read_b128 v[40:43], v8 offset:39936
    s_add_u32 s26, s26, 28672
    s_cmp_ge_u32 s26, s35
    s_cselect_b32 s26, s34, s26
    buffer_load_dwordx4 v4, s[8:11], s28 offen offset:2048 sc1 lds
    v_cvt_pk_bf16_f32 v78, v48, v49
    v_cvt_pk_bf16_f32 v79, v50, v51
    s_waitcnt lgkmcnt(5)
    v_mfma_f32_32x32x16_bf16 v[60:75], a[24:27], v[20:23], v[60:75]
    ds_read_b128 v[12:15], v8 offset:40960
    v_cvt_pk_bf16_f32 v80, v52, v53
    v_cvt_pk_bf16_f32 v81, v54, v55
    s_waitcnt lgkmcnt(5)
    v_mfma_f32_32x32x16_bf16 v[60:75], a[28:31], v[24:27], v[60:75]
    ds_read_b128 v[16:19], v8 offset:41984
    v_cvt_pk_bf16_f32 v82, v56, v57
    v_cvt_pk_bf16_f32 v83, v58, v59
    s_waitcnt lgkmcnt(5)
    v_mfma_f32_32x32x16_bf16 v[60:75], a[32:35], v[28:31], v[60:75]
    ds_read_b128 v[20:23], v8 offset:43008
    buffer_store_dwordx4 v[76:79], v2, s[8:11], s29 offen offset:0 sc1
    s_waitcnt lgkmcnt(5)
    v_mfma_f32_32x32x16_bf16 v[60:75], a[36:39], v[32:35], v[60:75]
    ds_read_b128 v[24:27], v8 offset:44032
    buffer_store_dwordx4 v[80:83], v2, s[8:11], s29 offen offset:1024 sc1
    s_waitcnt lgkmcnt(5)
    v_mfma_f32_32x32x16_bf16 v[60:75], a[40:43], v[36:39], v[60:75]
    ds_read_b128 v[28:31], v8 offset:45056
    s_add_u32 s29, s29, 32768
    s_cmp_ge_u32 s29, s37
    s_cselect_b32 s29, s36, s29
    s_waitcnt lgkmcnt(5)
    v_mfma_f32_32x32x16_bf16 v[60:75], a[44:47], v[40:43], v[60:75]
    ds_read_b128 v[32:35], v8 offset:46080
    s_waitcnt lgkmcnt(5)
    v_mfma_f32_32x32x16_bf16 v[60:75], a[48:51], v[12:15], v[60:75]
    ds_read_b128 v[36:39], v8 offset:47104
    s_waitcnt lgkmcnt(5)
    v_mfma_f32_32x32x16_bf16 v[60:75], a[52:55], v[16:19], v[60:75]
    ds_read_b128 v[40:43], v8 offset:48128
    s_waitcnt lgkmcnt(5)
    v_mfma_f32_32x32x16_bf16 v[60:75], a[56:59], v[20:23], v[60:75]
    ds_read_b128 v[12:15], v8 offset:49152
    s_waitcnt lgkmcnt(5)
    v_mfma_f32_32x32x16_bf16 v[60:75], a[60:63], v[24:27], v[60:75]
    ds_read_b128 v[16:19], v8 offset:50176
    s_waitcnt lgkmcnt(5)
    v_mfma_f32_32x32x16_bf16 v[60:75], a[64:67], v[28:31], v[60:75]
    ds_read_b128 v[20:23], v8 offset:51200
    s_waitcnt lgkmcnt(5)
    v_mfma_f32_32x32x16_bf16 v[60:75], a[68:71], v[32:35], v[60:75]
    ds_read_b128 v[24:27], v8 offset:52224
    s_waitcnt lgkmcnt(5)
    v_mfma_f32_32x32x16_bf16 v[60:75], a[72:75], v[36:39], v[60:75]
    ds_read_b128 v[28:31], v8 offset:53248
    s_waitcnt lgkmcnt(5)
    v_mfma_f32_32x32x16_bf16 v[60:75], a[76:79], v[40:43], v[60:75]
    ds_read_b128 v[32:35], v8 offset:54272
    s_waitcnt lgkmcnt(5)
    v_mfma_f32_32x32x16_bf16 v[60:75], a[80:83], v[12:15], v[60:75]
    ds_read_b128 v[36:39], v8 offset:55296
    s_waitcnt vmcnt(11)
    s_barrier
    s_waitcnt lgkmcnt(5)
    v_mfma_f32_32x32x16_bf16 v[60:75], a[84:87], v[16:19], v[60:75]
    ds_read_b128 v[40:43], v8 offset:56320
    s_add_u32 m0, s32, 57344
    s_add_u32 s28, s26, 0
    buffer_load_dwordx4 v4, s[8:11], s28 offen offset:0 sc1 lds
    s_waitcnt lgkmcnt(5)
    v_mfma_f32_32x32x16_bf16 v[60:75], a[88:91], v[20:23], v[60:75]
    ds_read_b128 v[12:15], v7 offset:0
    s_waitcnt lgkmcnt(5)
    v_mfma_f32_32x32x16_bf16 v[60:75], a[92:95], v[24:27], v[60:75]
    ds_read_b128 v[16:19], v7 offset:1024
    buffer_load_dwordx4 v4, s[8:11], s28 offen offset:1024 sc1 lds
    s_waitcnt lgkmcnt(5)
    v_mfma_f32_32x32x16_bf16 v[60:75], a[96:99], v[28:31], v[60:75]
    ds_read_b128 v[20:23], v7 offset:2048
    s_waitcnt lgkmcnt(5)
    v_mfma_f32_32x32x16_bf16 v[60:75], a[100:103], v[32:35], v[60:75]
    ds_read_b128 v[24:27], v7 offset:3072
    buffer_load_dwordx4 v4, s[8:11], s28 offen offset:2048 sc1 lds
    s_waitcnt lgkmcnt(5)
    v_mfma_f32_32x32x16_bf16 v[60:75], a[104:107], v[36:39], v[60:75]
    ds_read_b128 v[28:31], v7 offset:4096
    s_waitcnt lgkmcnt(5)
    v_mfma_f32_32x32x16_bf16 v[60:75], a[108:111], v[40:43], v[60:75]
    ds_read_b128 v[32:35], v7 offset:5120
    buffer_load_dwordx4 v4, s[8:11], s28 offen offset:3072 sc1 lds
    s_waitcnt lgkmcnt(5)
    v_mfma_f32_32x32x16_bf16 v[44:59], a[0:3], v[12:15], 0
    ds_read_b128 v[36:39], v7 offset:6144
    s_waitcnt lgkmcnt(5)
    v_mfma_f32_32x32x16_bf16 v[44:59], a[4:7], v[16:19], v[44:59]
    ds_read_b128 v[40:43], v7 offset:7168
    s_add_u32 m0, s32, 61440
    s_add_u32 s28, s26, 4096
    buffer_load_dwordx4 v4, s[8:11], s28 offen offset:0 sc1 lds
    s_waitcnt lgkmcnt(5)
    v_mfma_f32_32x32x16_bf16 v[44:59], a[8:11], v[20:23], v[44:59]
    ds_read_b128 v[12:15], v7 offset:8192
    s_waitcnt lgkmcnt(5)
    v_mfma_f32_32x32x16_bf16 v[44:59], a[12:15], v[24:27], v[44:59]
    ds_read_b128 v[16:19], v7 offset:9216
    buffer_load_dwordx4 v4, s[8:11], s28 offen offset:1024 sc1 lds
    s_waitcnt lgkmcnt(5)
    v_mfma_f32_32x32x16_bf16 v[44:59], a[16:19], v[28:31], v[44:59]
    ds_read_b128 v[20:23], v7 offset:10240
    v_cvt_pk_bf16_f32 v76, v60, v61
    v_cvt_pk_bf16_f32 v77, v62, v63
    s_waitcnt lgkmcnt(5)
    v_mfma_f32_32x32x16_bf16 v[44:59], a[20:23], v[32:35], v[44:59]
    ds_read_b128 v[24:27], v7 offset:11264
    s_add_u32 s26, s26, 28672
    s_cmp_ge_u32 s26, s35
    s_cselect_b32 s26, s34, s26
    buffer_load_dwordx4 v4, s[8:11], s28 offen offset:2048 sc1 lds
    v_cvt_pk_bf16_f32 v78, v64, v65
    v_cvt_pk_bf16_f32 v79, v66, v67
    s_waitcnt lgkmcnt(5)
    v_mfma_f32_32x32x16_bf16 v[44:59], a[24:27], v[36:39], v[44:59]
    ds_read_b128 v[28:31], v7 offset:12288
    v_cvt_pk_bf16_f32 v80, v68, v69
    v_cvt_pk_bf16_f32 v81, v70, v71
    s_waitcnt lgkmcnt(5)
    v_mfma_f32_32x32x16_bf16 v[44:59], a[28:31], v[40:43], v[44:59]
    ds_read_b128 v[32:35], v7 offset:13312
    v_cvt_pk_bf16_f32 v82, v72, v73
    v_cvt_pk_bf16_f32 v83, v74, v75
    s_waitcnt lgkmcnt(5)
    v_mfma_f32_32x32x16_bf16 v[44:59], a[32:35], v[12:15], v[44:59]
    ds_read_b128 v[36:39], v7 offset:14336
    buffer_store_dwordx4 v[76:79], v2, s[8:11], s29 offen offset:0 sc1
    s_waitcnt lgkmcnt(5)
    v_mfma_f32_32x32x16_bf16 v[44:59], a[36:39], v[16:19], v[44:59]
    ds_read_b128 v[40:43], v7 offset:15360
    buffer_store_dwordx4 v[80:83], v2, s[8:11], s29 offen offset:1024 sc1
    s_waitcnt lgkmcnt(5)
    v_mfma_f32_32x32x16_bf16 v[44:59], a[40:43], v[20:23], v[44:59]
    ds_read_b128 v[12:15], v7 offset:16384
    s_add_u32 s29, s29, 32768
    s_cmp_ge_u32 s29, s37
    s_cselect_b32 s29, s36, s29
    s_waitcnt lgkmcnt(5)
    v_mfma_f32_32x32x16_bf16 v[44:59], a[44:47], v[24:27], v[44:59]
    ds_read_b128 v[16:19], v7 offset:17408
    s_waitcnt lgkmcnt(5)
    v_mfma_f32_32x32x16_bf16 v[44:59], a[48:51], v[28:31], v[44:59]
    ds_read_b128 v[20:23], v7 offset:18432
    s_waitcnt lgkmcnt(5)
    v_mfma_f32_32x32x16_bf16 v[44:59], a[52:55], v[32:35], v[44:59]
    ds_read_b128 v[24:27], v7 offset:19456
    s_waitcnt lgkmcnt(5)
    v_mfma_f32_32x32x16_bf16 v[44:59], a[56:59], v[36:39], v[44:59]
    ds_read_b128 v[28:31], v7 offset:20480
    s_waitcnt lgkmcnt(5)
    v_mfma_f32_32x32x16_bf16 v[44:59], a[60:63], v[40:43], v[44:59]
    ds_read_b128 v[32:35], v7 offset:21504
    s_waitcnt lgkmcnt(5)
    v_mfma_f32_32x32x16_bf16 v[44:59], a[64:67], v[12:15], v[44:59]
    ds_read_b128 v[36:39], v7 offset:22528
    s_waitcnt lgkmcnt(5)
    v_mfma_f32_32x32x16_bf16 v[44:59], a[68:71], v[16:19], v[44:59]
    ds_read_b128 v[40:43], v7 offset:23552
    s_waitcnt lgkmcnt(5)
    v_mfma_f32_32x32x16_bf16 v[44:59], a[72:75], v[20:23], v[44:59]
    ds_read_b128 v[12:15], v7 offset:24576
    s_waitcnt lgkmcnt(5)
    v_mfma_f32_32x32x16_bf16 v[44:59], a[76:79], v[24:27], v[44:59]
    ds_read_b128 v[16:19], v7 offset:25600
    s_waitcnt lgkmcnt(5)
    v_mfma_f32_32x32x16_bf16 v[44:59], a[80:83], v[28:31], v[44:59]
    ds_read_b128 v[20:23], v7 offset:26624
    s_waitcnt vmcnt(11)
    s_barrier
    s_waitcnt lgkmcnt(5)
    v_mfma_f32_32x32x16_bf16 v[44:59], a[84:87], v[32:35], v[44:59]
    ds_read_b128 v[24:27], v7 offset:27648
    s_waitcnt lgkmcnt(5)
    v_mfma_f32_32x32x16_bf16 v[44:59], a[88:91], v[36:39], v[44:59]
    ds_read_b128 v[28:31], v7 offset:28672
    s_waitcnt lgkmcnt(5)
    v_mfma_f32_32x32x16_bf16 v[44:59], a[92:95], v[40:43], v[44:59]
    ds_read_b128 v[32:35], v7 offset:29696
    s_waitcnt lgkmcnt(5)
    v_mfma_f32_32x32x16_bf16 v[44:59], a[96:99], v[12:15], v[44:59]
    ds_read_b128 v[36:39], v7 offset:30720
    s_waitcnt lgkmcnt(5)
    v_mfma_f32_32x32x16_bf16 v[44:59], a[100:103], v[16:19], v[44:59]
    ds_read_b128 v[40:43], v7 offset:31744
    s_waitcnt lgkmcnt(5)
    v_mfma_f32_32x32x16_bf16 v[44:59], a[104:107], v[20:23], v[44:59]
    ds_read_b128 v[12:15], v7 offset:32768
    s_waitcnt lgkmcnt(5)
    v_mfma_f32_32x32x16_bf16 v[44:59], a[108:111], v[24:27], v[44:59]
    ds_read_b128 v[16:19], v7 offset:33792
    s_waitcnt lgkmcnt(5)
    v_mfma_f32_32x32x16_bf16 v[60:75], a[0:3], v[28:31], 0
    ds_read_b128 v[20:23], v7 offset:34816
    s_waitcnt lgkmcnt(5)
    v_mfma_f32_32x32x16_bf16 v[60:75], a[4:7], v[32:35], v[60:75]
    ds_read_b128 v[24:27], v7 offset:35840
    s_waitcnt lgkmcnt(5)
    v_mfma_f32_32x32x16_bf16 v[60:75], a[8:11], v[36:39], v[60:75]
    ds_read_b128 v[28:31], v7 offset:36864
    s_waitcnt lgkmcnt(5)
    v_mfma_f32_32x32x16_bf16 v[60:75], a[12:15], v[40:43], v[60:75]
    ds_read_b128 v[32:35], v7 offset:37888
    s_waitcnt lgkmcnt(5)
    v_mfma_f32_32x32x16_bf16 v[60:75], a[16:19], v[12:15], v[60:75]
    ds_read_b128 v[36:39], v7 offset:38912
    v_cvt_pk_bf16_f32 v76, v44, v45
    v_cvt_pk_bf16_f32 v77, v46, v47
    s_waitcnt lgkmcnt(5)
    v_mfma_f32_32x32x16_bf16 v[60:75], a[20:23], v[16:19], v[60:75]
    ds_read_b128 v[40:43], v7 offset:39936
    v_cvt_pk_bf16_f32 v78, v48, v49
    v_cvt_pk_bf16_f32 v79, v50, v51
    s_waitcnt lgkmcnt(5)
    v_mfma_f32_32x32x16_bf16 v[60:75], a[24:27], v[20:23], v[60:75]
    ds_read_b128 v[12:15], v7 offset:40960
    v_cvt_pk_bf16_f32 v80, v52, v53
    v_cvt_pk_bf16_f32 v81, v54, v55
    s_waitcnt lgkmcnt(5)
    v_mfma_f32_32x32x16_bf16 v[60:75], a[28:31], v[24:27], v[60:75]
    ds_read_b128 v[16:19], v7 offset:41984
    v_cvt_pk_bf16_f32 v82, v56, v57
    v_cvt_pk_bf16_f32 v83, v58, v59
    s_waitcnt lgkmcnt(5)
    v_mfma_f32_32x32x16_bf16 v[60:75], a[32:35], v[28:31], v[60:75]
    ds_read_b128 v[20:23], v7 offset:43008
    buffer_store_dwordx4 v[76:79], v2, s[8:11], s29 offen offset:0 sc1
    s_waitcnt lgkmcnt(5)
    v_mfma_f32_32x32x16_bf16 v[60:75], a[36:39], v[32:35], v[60:75]
    ds_read_b128 v[24:27], v7 offset:44032
    buffer_store_dwordx4 v[80:83], v2, s[8:11], s29 offen offset:1024 sc1
    s_waitcnt lgkmcnt(5)
    v_mfma_f32_32x32x16_bf16 v[60:75], a[40:43], v[36:39], v[60:75]
    ds_read_b128 v[28:31], v7 offset:45056
    s_add_u32 s29, s29, 32768
    s_cmp_ge_u32 s29, s37
    s_cselect_b32 s29, s36, s29
    s_waitcnt lgkmcnt(5)
    v_mfma_f32_32x32x16_bf16 v[60:75], a[44:47], v[40:43], v[60:75]
    ds_read_b128 v[32:35], v7 offset:46080
    s_waitcnt lgkmcnt(5)
    v_mfma_f32_32x32x16_bf16 v[60:75], a[48:51], v[12:15], v[60:75]
    ds_read_b128 v[36:39], v7 offset:47104
    s_waitcnt lgkmcnt(5)
    v_mfma_f32_32x32x16_bf16 v[60:75], a[52:55], v[16:19], v[60:75]
    ds_read_b128 v[40:43], v7 offset:48128
    s_waitcnt lgkmcnt(5)
    v_mfma_f32_32x32x16_bf16 v[60:75], a[56:59], v[20:23], v[60:75]
    ds_read_b128 v[12:15], v7 offset:49152
    s_waitcnt lgkmcnt(5)
    v_mfma_f32_32x32x16_bf16 v[60:75], a[60:63], v[24:27], v[60:75]
    ds_read_b128 v[16:19], v7 offset:50176
    s_waitcnt lgkmcnt(5)
    v_mfma_f32_32x32x16_bf16 v[60:75], a[64:67], v[28:31], v[60:75]
    ds_read_b128 v[20:23], v7 offset:51200
    s_waitcnt lgkmcnt(5)
    v_mfma_f32_32x32x16_bf16 v[60:75], a[68:71], v[32:35], v[60:75]
    ds_read_b128 v[24:27], v7 offset:52224
    s_waitcnt lgkmcnt(5)
    v_mfma_f32_32x32x16_bf16 v[60:75], a[72:75], v[36:39], v[60:75]
    ds_read_b128 v[28:31], v7 offset:53248
    s_waitcnt lgkmcnt(5)
    v_mfma_f32_32x32x16_bf16 v[60:75], a[76:79], v[40:43], v[60:75]
    ds_read_b128 v[32:35], v7 offset:54272
    s_waitcnt lgkmcnt(5)
    v_mfma_f32_32x32x16_bf16 v[60:75], a[80:83], v[12:15], v[60:75]
    ds_read_b128 v[36:39], v7 offset:55296
    s_waitcnt vmcnt(4)
    s_barrier
    s_waitcnt lgkmcnt(5)
    v_mfma_f32_32x32x16_bf16 v[60:75], a[84:87], v[16:19], v[60:75]
    ds_read_b128 v[40:43], v7 offset:56320
    s_waitcnt lgkmcnt(5)
    v_mfma_f32_32x32x16_bf16 v[60:75], a[88:91], v[20:23], v[60:75]
    ds_read_b128 v[12:15], v8 offset:0
    s_waitcnt lgkmcnt(5)
    v_mfma_f32_32x32x16_bf16 v[60:75], a[92:95], v[24:27], v[60:75]
    ds_read_b128 v[16:19], v8 offset:1024
    s_waitcnt lgkmcnt(5)
    v_mfma_f32_32x32x16_bf16 v[60:75], a[96:99], v[28:31], v[60:75]
    ds_read_b128 v[20:23], v8 offset:2048
    s_waitcnt lgkmcnt(5)
    v_mfma_f32_32x32x16_bf16 v[60:75], a[100:103], v[32:35], v[60:75]
    ds_read_b128 v[24:27], v8 offset:3072
    s_waitcnt lgkmcnt(5)
    v_mfma_f32_32x32x16_bf16 v[60:75], a[104:107], v[36:39], v[60:75]
    ds_read_b128 v[28:31], v8 offset:4096
    s_waitcnt lgkmcnt(5)
    v_mfma_f32_32x32x16_bf16 v[60:75], a[108:111], v[40:43], v[60:75]
    ds_read_b128 v[32:35], v8 offset:5120
    s_waitcnt lgkmcnt(5)
    v_mfma_f32_32x32x16_bf16 v[44:59], a[0:3], v[12:15], 0
    ds_read_b128 v[36:39], v8 offset:6144
    s_waitcnt lgkmcnt(5)
    v_mfma_f32_32x32x16_bf16 v[44:59], a[4:7], v[16:19], v[44:59]
    ds_read_b128 v[40:43], v8 offset:7168
    s_waitcnt lgkmcnt(5)
    v_mfma_f32_32x32x16_bf16 v[44:59], a[8:11], v[20:23], v[44:59]
    ds_read_b128 v[12:15], v8 offset:8192
    s_waitcnt lgkmcnt(5)
    v_mfma_f32_32x32x16_bf16 v[44:59], a[12:15], v[24:27], v[44:59]
    ds_read_b128 v[16:19], v8 offset:9216
    s_waitcnt lgkmcnt(5)
    v_mfma_f32_32x32x16_bf16 v[44:59], a[16:19], v[28:31], v[44:59]
    ds_read_b128 v[20:23], v8 offset:10240
    v_cvt_pk_bf16_f32 v76, v60, v61
    v_cvt_pk_bf16_f32 v77, v62, v63
    s_waitcnt lgkmcnt(5)
    v_mfma_f32_32x32x16_bf16 v[44:59], a[20:23], v[32:35], v[44:59]
    ds_read_b128 v[24:27], v8 offset:11264
    v_cvt_pk_bf16_f32 v78, v64, v65
    v_cvt_pk_bf16_f32 v79, v66, v67
    s_waitcnt lgkmcnt(5)
    v_mfma_f32_32x32x16_bf16 v[44:59], a[24:27], v[36:39], v[44:59]
    ds_read_b128 v[28:31], v8 offset:12288
    v_cvt_pk_bf16_f32 v80, v68, v69
    v_cvt_pk_bf16_f32 v81, v70, v71
    s_waitcnt lgkmcnt(5)
    v_mfma_f32_32x32x16_bf16 v[44:59], a[28:31], v[40:43], v[44:59]
    ds_read_b128 v[32:35], v8 offset:13312
    v_cvt_pk_bf16_f32 v82, v72, v73
    v_cvt_pk_bf16_f32 v83, v74, v75
    s_waitcnt lgkmcnt(5)
    v_mfma_f32_32x32x16_bf16 v[44:59], a[32:35], v[12:15], v[44:59]
    ds_read_b128 v[36:39], v8 offset:14336
    buffer_store_dwordx4 v[76:79], v2, s[8:11], s29 offen offset:0 sc1
    s_waitcnt lgkmcnt(5)
    v_mfma_f32_32x32x16_bf16 v[44:59], a[36:39], v[16:19], v[44:59]
    ds_read_b128 v[40:43], v8 offset:15360
    buffer_store_dwordx4 v[80:83], v2, s[8:11], s29 offen offset:1024 sc1
    s_waitcnt lgkmcnt(5)
    v_mfma_f32_32x32x16_bf16 v[44:59], a[40:43], v[20:23], v[44:59]
    ds_read_b128 v[12:15], v8 offset:16384
    s_add_u32 s29, s29, 32768
    s_cmp_ge_u32 s29, s37
    s_cselect_b32 s29, s36, s29
    s_waitcnt lgkmcnt(5)
    v_mfma_f32_32x32x16_bf16 v[44:59], a[44:47], v[24:27], v[44:59]
    ds_read_b128 v[16:19], v8 offset:17408
    s_waitcnt lgkmcnt(5)
    v_mfma_f32_32x32x16_bf16 v[44:59], a[48:51], v[28:31], v[44:59]
    ds_read_b128 v[20:23], v8 offset:18432
    s_waitcnt lgkmcnt(5)
    v_mfma_f32_32x32x16_bf16 v[44:59], a[52:55], v[32:35], v[44:59]
    ds_read_b128 v[24:27], v8 offset:19456
    s_waitcnt lgkmcnt(5)
    v_mfma_f32_32x32x16_bf16 v[44:59], a[56:59], v[36:39], v[44:59]
    ds_read_b128 v[28:31], v8 offset:20480
    s_waitcnt lgkmcnt(5)
    v_mfma_f32_32x32x16_bf16 v[44:59], a[60:63], v[40:43], v[44:59]
    ds_read_b128 v[32:35], v8 offset:21504
    s_waitcnt lgkmcnt(5)
    v_mfma_f32_32x32x16_bf16 v[44:59], a[64:67], v[12:15], v[44:59]
    ds_read_b128 v[36:39], v8 offset:22528
    s_waitcnt lgkmcnt(5)
    v_mfma_f32_32x32x16_bf16 v[44:59], a[68:71], v[16:19], v[44:59]
    ds_read_b128 v[40:43], v8 offset:23552
    s_waitcnt lgkmcnt(5)
    v_mfma_f32_32x32x16_bf16 v[44:59], a[72:75], v[20:23], v[44:59]
    ds_read_b128 v[12:15], v8 offset:24576
    s_waitcnt lgkmcnt(5)
    v_mfma_f32_32x32x16_bf16 v[44:59], a[76:79], v[24:27], v[44:59]
    ds_read_b128 v[16:19], v8 offset:25600
    s_waitcnt lgkmcnt(5)
    v_mfma_f32_32x32x16_bf16 v[44:59], a[80:83], v[28:31], v[44:59]
    ds_read_b128 v[20:23], v8 offset:26624
    s_waitcnt lgkmcnt(5)
    v_mfma_f32_32x32x16_bf16 v[44:59], a[84:87], v[32:35], v[44:59]
    ds_read_b128 v[24:27], v8 offset:27648
    s_waitcnt lgkmcnt(5)
    v_mfma_f32_32x32x16_bf16 v[44:59], a[88:91], v[36:39], v[44:59]
    s_waitcnt lgkmcnt(4)
    v_mfma_f32_32x32x16_bf16 v[44:59], a[92:95], v[40:43], v[44:59]
    s_waitcnt lgkmcnt(3)
    v_mfma_f32_32x32x16_bf16 v[44:59], a[96:99], v[12:15], v[44:59]
    s_waitcnt lgkmcnt(2)
    v_mfma_f32_32x32x16_bf16 v[44:59], a[100:103], v[16:19], v[44:59]
    s_waitcnt lgkmcnt(1)
    v_mfma_f32_32x32x16_bf16 v[44:59], a[104:107], v[20:23], v[44:59]
    s_waitcnt lgkmcnt(0)
    v_mfma_f32_32x32x16_bf16 v[44:59], a[108:111], v[24:27], v[44:59]
    s_nop 11
    v_cvt_pk_bf16_f32 v76, v44, v45
    v_cvt_pk_bf16_f32 v77, v46, v47
    s_nop 0
    v_cvt_pk_bf16_f32 v78, v48, v49
    v_cvt_pk_bf16_f32 v79, v50, v51
    s_nop 0
    v_cvt_pk_bf16_f32 v80, v52, v53
    v_cvt_pk_bf16_f32 v81, v54, v55
    s_nop 0
    v_cvt_pk_bf16_f32 v82, v56, v57
    v_cvt_pk_bf16_f32 v83, v58, v59
    s_nop 0
    buffer_store_dwordx4 v[76:79], v2, s[8:11], s29 offen offset:0 sc1
    s_nop 0
    buffer_store_dwordx4 v[80:83], v2, s[8:11], s29 offen offset:1024 sc1
    s_nop 0
    s_add_u32 s29, s29, 32768
    s_cmp_ge_u32 s29, s37
    s_cselect_b32 s29, s36, s29
    s_nop 0
    s_lshl_b32 s30, s25, 7
    s_add_u32 s30, s30, 18616320
    s_waitcnt vmcnt(0)
    s_barrier
    s_cmp_lg_u32 s21, 0
    s_cbranch_scc1 sig_53
    v_mov_b32 v3, 2
    s_mov_b64 exec, 1
    buffer_atomic_add v3, off, s[8:11], s30 sc1
    s_mov_b64 exec, -1
sig_53:
    s_branch main_next
job_11:
    s_lshl_b32 s33, s25, 2
    s_add_u32 s33, s33, s21
    s_lshr_b32 s31, s24, 4
    s_and_b32 s24, s24, 15
    s_cmp_lt_u32 s31, 2
    s_cselect_b32 s30, 0, 2147483632
    v_or_b32 v5, s30, v2
    s_mul_i32 s31, s31, 4
    s_min_u32 s31, s31, 11
    s_mul_i32 s26, s24, 14
    s_add_u32 s26, s26, s31
    s_mul_i32 s26, s26, 28672
    s_add_u32 s26, s26, 6422528
    s_mul_i32 s29, s33, 14
    s_add_u32 s29, s29, s31
    s_lshl_b32 s29, s29, 15
    s_lshl_b32 s30, s24, 11
    s_add_u32 s29, s29, s30
    s_add_u32 s29, s29, 27262976
    s_mov_b32 s34, s26
    s_add_u32 s35, s26, 114688
    s_mov_b32 s36, s29
    s_add_u32 s37, s29, 131072
    s_cmp_lt_u32 s31, 8
    s_cselect_b32 s30, 0, 28672
    s_sub_u32 s35, s35, s30
    s_lshl_b32 s28, s24, 7
    s_add_u32 s28, s28, 18636800
    v_mov_b32 v7, v2
    s_mul_i32 s32, s21, 7168
    v_add_u32 v4, s32, v2
    v_add_u32 v8, 57344, v7
    s_mul_i32 s27, s33, 28672
    s_add_u32 s27, s27, 15728640
    s_lshr_b32 s3, s33, 2
    s_lshl_b32 s3, s3, 7
    s_add_u32 s3, s3, 18614272
    v_mov_b32 v6, s28
    v_writelane_b32 v6, s3, 0
    v_mov_b32 v12, 10922
    v_writelane_b32 v12, 2, 0
gw_54:
    buffer_load_dword v3, v6, s[8:11], 0 offen sc1
    s_waitcnt vmcnt(0)
    v_cmp_gt_u32 vcc, v12, v3
    s_cbranch_vccz gw_54k
    s_sleep 2
    s_sub_u32 s23, s23, 1
    s_cbranch_scc0 gw_54
    s_mov_b32 s23, 0
gw_54k:
    s_add_u32 m0, s32, 0
    s_add_u32 s28, s26, 0
    buffer_load_dwordx4 v4, s[8:11], s28 offen offset:0 sc1 lds
    buffer_load_dwordx4 v4, s[8:11], s28 offen offset:1024 sc1 lds
    buffer_load_dwordx4 v4, s[8:11], s28 offen offset:2048 sc1 lds
    buffer_load_dwordx4 v4, s[8:11], s28 offen offset:3072 sc1 lds
    s_add_u32 m0, s32, 4096
    s_add_u32 s28, s26, 4096
    buffer_load_dwordx4 v4, s[8:11], s28 offen offset:0 sc1 lds
    buffer_load_dwordx4 v4, s[8:11], s28 offen offset:1024 sc1 lds
    s_add_u32 s26, s26, 28672
    s_cmp_ge_u32 s26, s35
    s_cselect_b32 s26, s34, s26
    buffer_load_dwordx4 v4, s[8:11], s28 offen offset:2048 sc1 lds
    buffer_load_dwordx4 a[0:3], v2, s[8:11], s27 offen offset:0 sc1
    buffer_load_dwordx4 a[4:7], v2, s[8:11], s27 offen offset:1024 sc1
    buffer_load_dwordx4 a[8:11], v2, s[8:11], s27 offen offset:2048 sc1
    buffer_load_dwordx4 a[12:15], v2, s[8:11], s27 offen offset:3072 sc1
    s_add_u32 s27, s27, 4096
    buffer_load_dwordx4 a[16:19], v2, s[8:11], s27 offen offset:0 sc1
    buffer_load_dwordx4 a[20:23], v2, s[8:11], s27 offen offset:1024 sc1
    buffer_load_dwordx4 a[24:27], v2, s[8:11], s27 offen offset:2048 sc1
    buffer_load_dwordx4 a[28:31], v2, s[8:11], s27 offen offset:3072 sc1
    s_add_u32 s27, s27, 4096
    buffer_load_dwordx4 a[32:35], v2, s[8:11], s27 offen offset:0 sc1
    buffer_load_dwordx4 a[36:39], v2, s[8:11], s27 offen offset:1024 sc1
    buffer_load_dwordx4 a[40:43], v2, s[8:11], s27 offen offset:2048 sc1
    buffer_load_dwordx4 a[44:47], v2, s[8:11], s27 offen offset:3072 sc1
    s_add_u32 s27, s27, 4096
    buffer_load_dwordx4 a[48:51], v2, s[8:11], s27 offen offset:0 sc1
    buffer_load_dwordx4 a[52:55], v2, s[8:11], s27 offen offset:1024 sc1
    buffer_load_dwordx4 a[56:59], v2, s[8:11], s27 offen offset:2048 sc1
    buffer_load_dwordx4 a[60:63], v2, s[8:11], s27 offen offset:3072 sc1
    s_add_u32 s27, s27, 4096
    buffer_load_dwordx4 a[64:67], v2, s[8:11], s27 offen offset:0 sc1
    buffer_load_dwordx4 a[68:71], v2, s[8:11], s27 offen offset:1024 sc1
    buffer_load_dwordx4 a[72:75], v2, s[8:11], s27 offen offset:2048 sc1
    buffer_load_dwordx4 a[76:79], v2, s[8:11], s27 offen offset:3072 sc1
    s_add_u32 s27, s27, 4096
    buffer_load_dwordx4 a[80:83], v2, s[8:11], s27 offen offset:0 sc1
    buffer_load_dwordx4 a[84:87], v2, s[8:11], s27 offen offset:1024 sc1
    buffer_load_dwordx4 a[88:91], v2, s[8:11], s27 offen offset:2048 sc1
    buffer_load_dwordx4 a[92:95], v2, s[8:11], s27 offen offset:3072 sc1
    s_add_u32 s27, s27, 4096
    buffer_load_dwordx4 a[96:99], v2, s[8:11], s27 offen offset:0 sc1
    buffer_load_dwordx4 a[100:103], v2, s[8:11], s27 offen offset:1024 sc1
    buffer_load_dwordx4 a[104:107], v2, s[8:11], s27 offen offset:2048 sc1
    buffer_load_dwordx4 a[108:111], v2, s[8:11], s27 offen offset:3072 sc1
    s_add_u32 m0, s32, 28672
    s_add_u32 s28, s26, 0
    buffer_load_dwordx4 v4, s[8:11], s28 offen offset:0 sc1 lds
    buffer_load_dwordx4 v4, s[8:11], s28 offen offset:1024 sc1 lds
    buffer_load_dwordx4 v4, s[8:11], s28 offen offset:2048 sc1 lds
    buffer_load_dwordx4 v4, s[8:11], s28 offen offset:3072 sc1 lds
    s_add_u32 m0, s32, 32768
    s_add_u32 s28, s26, 4096
    buffer_load_dwordx4 v4, s[8:11], s28 offen offset:0 sc1 lds
    buffer_load_dwordx4 v4, s[8:11], s28 offen offset:1024 sc1 lds
    s_add_u32 s26, s26, 28672
    s_cmp_ge_u32 s26, s35
    s_cselect_b32 s26, s34, s26
    buffer_load_dwordx4 v4, s[8:11], s28 offen offset:2048 sc1 lds
    s_waitcnt vmcnt(7)
    s_barrier
    ds_read_b128 v[12:15], v7 offset:0
    ds_read_b128 v[16:19], v7 offset:1024
    ds_read_b128 v[20:23], v7 offset:2048
    ds_read_b128 v[24:27], v7 offset:3072
    ds_read_b128 v[28:31], v7 offset:4096
    ds_read_b128 v[32:35], v7 offset:5120
    s_waitcnt lgkmcnt(5)
    v_mfma_f32_32x32x16_bf16 v[44:59], a[0:3], v[12:15], 0
    ds_read_b128 v[36:39], v7 offset:6144
    s_add_u32 m0, s32, 57344
    s_add_u32 s28, s26, 0
    buffer_load_dwordx4 v4, s[8:11], s28 offen offset:0 sc1 lds
    s_waitcnt lgkmcnt(5)
    v_mfma_f32_32x32x16_bf16 v[44:59], a[4:7], v[16:19], v[44:59]
    ds_read_b128 v[40:43], v7 offset:7168
    s_waitcnt lgkmcnt(5)
    v_mfma_f32_32x32x16_bf16 v[44:59], a[8:11], v[20:23], v[44:59]
    ds_read_b128 v[12:15], v7 offset:8192
    buffer_load_dwordx4 v4, s[8:11], s28 offen offset:1024 sc1 lds
    s_waitcnt lgkmcnt(5)
    v_mfma_f32_32x32x16_bf16 v[44:59], a[12:15], v[24:27], v[44:59]
    ds_read_b128 v[16:19], v7 offset:9216
    s_waitcnt lgkmcnt(5)
    v_mfma_f32_32x32x16_bf16 v[44:59], a[16:19], v[28:31], v[44:59]
    ds_read_b128 v[20:23], v7 offset:10240
    buffer_load_dwordx4 v4, s[8:11], s28 offen offset:2048 sc1 lds
    s_waitcnt lgkmcnt(5)
    v_mfma_f32_32x32x16_bf16 v[44:59], a[20:23], v[32:35], v[44:59]
    ds_read_b128 v[24:27], v7 offset:11264
    s_waitcnt lgkmcnt(5)
    v_mfma_f32_32x32x16_bf16 v[44:59], a[24:27], v[36:39], v[44:59]
    ds_read_b128 v[28:31], v7 offset:12288
    buffer_load_dwordx4 v4, s[8:11], s28 offen offset:3072 sc1 lds
    s_waitcnt lgkmcnt(5)
    v_mfma_f32_32x32x16_bf16 v[44:59], a[28:31], v[40:43], v[44:59]
    ds_read_b128 v[32:35], v7 offset:13312
    s_waitcnt lgkmcnt(5)
    v_mfma_f32_32x32x16_bf16 v[44:59], a[32:35], v[12:15], v[44:59]
    ds_read_b128 v[36:39], v7 offset:14336
    s_add_u32 m0, s32, 61440
    s_add_u32 s28, s26, 4096
    buffer_load_dwordx4 v4, s[8:11], s28 offen offset:0 sc1 lds
    s_waitcnt lgkmcnt(5)
    v_mfma_f32_32x32x16_bf16 v[44:59], a[36:39], v[16:19], v[44:59]
    ds_read_b128 v[40:43], v7 offset:15360
    s_waitcnt lgkmcnt(5)
    v_mfma_f32_32x32x16_bf16 v[44:59], a[40:43], v[20:23], v[44:59]
    ds_read_b128 v[12:15], v7 offset:16384
    buffer_load_dwordx4 v4, s[8:11], s28 offen offset:1024 sc1 lds
    s_waitcnt lgkmcnt(5)
    v_mfma_f32_32x32x16_bf16 v[44:59], a[44:47], v[24:27], v[44:59]
    ds_read_b128 v[16:19], v7 offset:17408
    s_waitcnt lgkmcnt(5)
    v_mfma_f32_32x32x16_bf16 v[44:59], a[48:51], v[28:31], v[44:59]
    ds_read_b128 v[20:23], v7 offset:18432
    s_add_u32 s26, s26, 28672
    s_cmp_ge_u32 s26, s35
    s_cselect_b32 s26, s34, s26
    buffer_load_dwordx4 v4, s[8:11], s28 offen offset:2048 sc1 lds
    s_waitcnt lgkmcnt(5)
    v_mfma_f32_32x32x16_bf16 v[44:59], a[52:55], v[32:35], v[44:59]
    ds_read_b128 v[24:27], v7 offset:19456
    s_waitcnt lgkmcnt(5)
    v_mfma_f32_32x32x16_bf16 v[44:59], a[56:59], v[36:39], v[44:59]
    ds_read_b128 v[28:31], v7 offset:20480
    s_waitcnt lgkmcnt(5)
    v_mfma_f32_32x32x16_bf16 v[44:59], a[60:63], v[40:43], v[44:59]
    ds_read_b128 v[32:35], v7 offset:21504
    s_waitcnt lgkmcnt(5)
    v_mfma_f32_32x32x16_bf16 v[44:59], a[64:67], v[12:15], v[44:59]
    ds_read_b128 v[36:39], v7 offset:22528
    s_waitcnt lgkmcnt(5)
    v_mfma_f32_32x32x16_bf16 v[44:59], a[68:71], v[16:19], v[44:59]
    ds_read_b128 v[40:43], v7 offset:23552
    s_waitcnt lgkmcnt(5)
    v_mfma_f32_32x32x16_bf16 v[44:59], a[72:75], v[20:23], v[44:59]
    ds_read_b128 v[12:15], v7 offset:24576
    s_waitcnt lgkmcnt(5)
    v_mfma_f32_32x32x16_bf16 v[44:59], a[76:79], v[24:27], v[44:59]
    ds_read_b128 v[16:19], v7 offset:25600
    s_waitcnt lgkmcnt(5)
    v_mfma_f32_32x32x16_bf16 v[44:59], a[80:83], v[28:31], v[44:59]
    ds_read_b128 v[20:23], v7 offset:26624
    s_waitcnt vmcnt(7)
    s_barrier
    s_waitcnt lgkmcnt(5)
    v_mfma_f32_32x32x16_bf16 v[44:59], a[84:87], v[32:35], v[44:59]
    ds_read_b128 v[24:27], v7 offset:27648
    s_add_u32 m0, s32, 86016
    s_add_u32 s28, s26, 0
    buffer_load_dwordx4 v4, s[8:11], s28 offen offset:0 sc1 lds
    s_waitcnt lgkmcnt(5)
    v_mfma_f32_32x32x16_bf16 v[44:59], a[88:91], v[36:39], v[44:59]
    ds_read_b128 v[28:31], v7 offset:28672
    s_waitcnt lgkmcnt(5)
    v_mfma_f32_32x32x16_bf16 v[44:59], a[92:95], v[40:43], v[44:59]
    ds_read_b128 v[32:35], v7 offset:29696
    buffer_load_dwordx4 v4, s[8:11], s28 offen offset:1024 sc1 lds
    s_waitcnt lgkmcnt(5)
    v_mfma_f32_32x32x16_bf16 v[44:59], a[96:99], v[12:15], v[44:59]
    ds_read_b128 v[36:39], v7 offset:30720
    s_waitcnt lgkmcnt(5)
    v_mfma_f32_32x32x16_bf16 v[44:59], a[100:103], v[16:19], v[44:59]
    ds_read_b128 v[40:43], v7 offset:31744
    buffer_load_dwordx4 v4, s[8:11], s28 offen offset:2048 sc1 lds
    s_waitcnt lgkmcnt(5)
    v_mfma_f32_32x32x16_bf16 v[44:59], a[104:107], v[20:23], v[44:59]
    ds_read_b128 v[12:15], v7 offset:32768
    s_waitcnt lgkmcnt(5)
    v_mfma_f32_32x32x16_bf16 v[44:59], a[108:111], v[24:27], v[44:59]
    ds_read_b128 v[16:19], v7 offset:33792
    buffer_load_dwordx4 v4, s[8:11], s28 offen offset:3072 sc1 lds
    s_waitcnt lgkmcnt(5)
    v_mfma_f32_32x32x16_bf16 v[60:75], a[0:3], v[28:31], 0
    ds_read_b128 v[20:23], v7 offset:34816
    s_waitcnt lgkmcnt(5)
    v_mfma_f32_32x32x16_bf16 v[60:75], a[4:7], v[32:35], v[60:75]
    ds_read_b128 v[24:27], v7 offset:35840
    s_add_u32 m0, s32, 90112
    s_add_u32 s28, s26, 4096
    buffer_load_dwordx4 v4, s[8:11], s28 offen offset:0 sc1 lds
    s_waitcnt lgkmcnt(5)
    v_mfma_f32_32x32x16_bf16 v[60:75], a[8:11], v[36:39], v[60:75]
    ds_read_b128 v[28:31], v7 offset:36864
    s_waitcnt lgkmcnt(5)
    v_mfma_f32_32x32x16_bf16 v[60:75], a[12:15], v[40:43], v[60:75]
    ds_read_b128 v[32:35], v7 offset:37888
    buffer_load_dwordx4 v4, s[8:11], s28 offen offset:1024 sc1 lds
    s_waitcnt lgkmcnt(5)
    v_mfma_f32_32x32x16_bf16 v[60:75], a[16:19], v[12:15], v[60:75]
    ds_read_b128 v[36:39], v7 offset:38912
    v_cvt_pk_bf16_f32 v76, v44, v45
    v_cvt_pk_bf16_f32 v77, v46, v47
    s_waitcnt lgkmcnt(5)
    v_mfma_f32_32x32x16_bf16 v[60:75], a[20:23], v[16:19], v[60:75]
    ds_read_b128 v[40:43], v7 offset:39936
    s_add_u32 s26, s26, 28672
    s_cmp_ge_u32 s26, s35
    s_cselect_b32 s26, s34, s26
    buffer_load_dwordx4 v4, s[8:11], s28 offen offset:2048 sc1 lds
    v_cvt_pk_bf16_f32 v78, v48, v49
    v_cvt_pk_bf16_f32 v79, v50, v51
    s_waitcnt lgkmcnt(5)
    v_mfma_f32_32x32x16_bf16 v[60:75], a[24:27], v[20:23], v[60:75]
    ds_read_b128 v[12:15], v7 offset:40960
    v_cvt_pk_bf16_f32 v80, v52, v53
    v_cvt_pk_bf16_f32 v81, v54, v55
    s_waitcnt lgkmcnt(5)
    v_mfma_f32_32x32x16_bf16 v[60:75], a[28:31], v[24:27], v[60:75]
    ds_read_b128 v[16:19], v7 offset:41984
    v_cvt_pk_bf16_f32 v82, v56, v57
    v_cvt_pk_bf16_f32 v83, v58, v59
    s_waitcnt lgkmcnt(5)
    v_mfma_f32_32x32x16_bf16 v[60:75], a[32:35], v[28:31], v[60:75]
    ds_read_b128 v[20:23], v7 offset:43008
    buffer_store_dwordx4 v[76:79], v2, s[8:11], s29 offen offset:0 sc1
    s_waitcnt lgkmcnt(5)
    v_mfma_f32_32x32x16_bf16 v[60:75], a[36:39], v[32:35], v[60:75]
    ds_read_b128 v[24:27], v7 offset:44032
    buffer_store_dwordx4 v[80:83], v2, s[8:11], s29 offen offset:1024 sc1
    s_waitcnt lgkmcnt(5)
    v_mfma_f32_32x32x16_bf16 v[60:75], a[40:43], v[36:39], v[60:75]
    ds_read_b128 v[28:31], v7 offset:45056
    s_add_u32 s29, s29, 32768
    s_cmp_ge_u32 s29, s37
    s_cselect_b32 s29, s36, s29
    s_waitcnt lgkmcnt(5)
    v_mfma_f32_32x32x16_bf16 v[60:75], a[44:47], v[40:43], v[60:75]
    ds_read_b128 v[32:35], v7 offset:46080
    s_waitcnt lgkmcnt(5)
    v_mfma_f32_32x32x16_bf16 v[60:75], a[48:51], v[12:15], v[60:75]
    ds_read_b128 v[36:39], v7 offset:47104
    s_waitcnt lgkmcnt(5)
    v_mfma_f32_32x32x16_bf16 v[60:75], a[52:55], v[16:19], v[60:75]
    ds_read_b128 v[40:43], v7 offset:48128
    s_waitcnt lgkmcnt(5)
    v_mfma_f32_32x32x16_bf16 v[60:75], a[56:59], v[20:23], v[60:75]
    ds_read_b128 v[12:15], v7 offset:49152
    s_waitcnt lgkmcnt(5)
    v_mfma_f32_32x32x16_bf16 v[60:75], a[60:63], v[24:27], v[60:75]
    ds_read_b128 v[16:19], v7 offset:50176
    s_waitcnt lgkmcnt(5)
    v_mfma_f32_32x32x16_bf16 v[60:75], a[64:67], v[28:31], v[60:75]
    ds_read_b128 v[20:23], v7 offset:51200
    s_waitcnt lgkmcnt(5)
    v_mfma_f32_32x32x16_bf16 v[60:75], a[68:71], v[32:35], v[60:75]
    ds_read_b128 v[24:27], v7 offset:52224
    s_waitcnt lgkmcnt(5)
    v_mfma_f32_32x32x16_bf16 v[60:75], a[72:75], v[36:39], v[60:75]
    ds_read_b128 v[28:31], v7 offset:53248
    s_waitcnt lgkmcnt(5)
    v_mfma_f32_32x32x16_bf16 v[60:75], a[76:79], v[40:43], v[60:75]
    ds_read_b128 v[32:35], v7 offset:54272
    s_waitcnt lgkmcnt(5)
    v_mfma_f32_32x32x16_bf16 v[60:75], a[80:83], v[12:15], v[60:75]
    ds_read_b128 v[36:39], v7 offset:55296
    s_waitcnt vmcnt(9)
    s_barrier
    s_waitcnt lgkmcnt(5)
    v_mfma_f32_32x32x16_bf16 v[60:75], a[84:87], v[16:19], v[60:75]
    ds_read_b128 v[40:43], v7 offset:56320
    s_waitcnt lgkmcnt(5)
    v_mfma_f32_32x32x16_bf16 v[60:75], a[88:91], v[20:23], v[60:75]
    ds_read_b128 v[12:15], v8 offset:0
    s_waitcnt lgkmcnt(5)
    v_mfma_f32_32x32x16_bf16 v[60:75], a[92:95], v[24:27], v[60:75]
    ds_read_b128 v[16:19], v8 offset:1024
    s_waitcnt lgkmcnt(5)
    v_mfma_f32_32x32x16_bf16 v[60:75], a[96:99], v[28:31], v[60:75]
    ds_read_b128 v[20:23], v8 offset:2048
    s_waitcnt lgkmcnt(5)
    v_mfma_f32_32x32x16_bf16 v[60:75], a[100:103], v[32:35], v[60:75]
    ds_read_b128 v[24:27], v8 offset:3072
    s_waitcnt lgkmcnt(5)
    v_mfma_f32_32x32x16_bf16 v[60:75], a[104:107], v[36:39], v[60:75]
    ds_read_b128 v[28:31], v8 offset:4096
    s_waitcnt lgkmcnt(5)
    v_mfma_f32_32x32x16_bf16 v[60:75], a[108:111], v[40:43], v[60:75]
    ds_read_b128 v[32:35], v8 offset:5120
    s_waitcnt lgkmcnt(5)
    v_mfma_f32_32x32x16_bf16 v[44:59], a[0:3], v[12:15], 0
    ds_read_b128 v[36:39], v8 offset:6144
    s_waitcnt lgkmcnt(5)
    v_mfma_f32_32x32x16_bf16 v[44:59], a[4:7], v[16:19], v[44:59]
    ds_read_b128 v[40:43], v8 offset:7168
    s_waitcnt lgkmcnt(5)
    v_mfma_f32_32x32x16_bf16 v[44:59], a[8:11], v[20:23], v[44:59]
    ds_read_b128 v[12:15], v8 offset:8192
    s_waitcnt lgkmcnt(5)
    v_mfma_f32_32x32x16_bf16 v[44:59], a[12:15], v[24:27], v[44:59]
    ds_read_b128 v[16:19], v8 offset:9216
    s_waitcnt lgkmcnt(5)
    v_mfma_f32_32x32x16_bf16 v[44:59], a[16:19], v[28:31], v[44:59]
    ds_read_b128 v[20:23], v8 offset:10240
    v_cvt_pk_bf16_f32 v76, v60, v61
    v_cvt_pk_bf16_f32 v77, v62, v63
    s_waitcnt lgkmcnt(5)
    v_mfma_f32_32x32x16_bf16 v[44:59], a[20:23], v[32:35], v[44:59]
    ds_read_b128 v[24:27], v8 offset:11264
    v_cvt_pk_bf16_f32 v78, v64, v65
    v_cvt_pk_bf16_f32 v79, v66, v67
    s_waitcnt lgkmcnt(5)
    v_mfma_f32_32x32x16_bf16 v[44:59], a[24:27], v[36:39], v[44:59]
    ds_read_b128 v[28:31], v8 offset:12288
    v_cvt_pk_bf16_f32 v80, v68, v69
    v_cvt_pk_bf16_f32 v81, v70, v71
    s_waitcnt lgkmcnt(5)
    v_mfma_f32_32x32x16_bf16 v[44:59], a[28:31], v[40:43], v[44:59]
    ds_read_b128 v[32:35], v8 offset:13312
    v_cvt_pk_bf16_f32 v82, v72, v73
    v_cvt_pk_bf16_f32 v83, v74, v75
    s_waitcnt lgkmcnt(5)
    v_mfma_f32_32x32x16_bf16 v[44:59], a[32:35], v[12:15], v[44:59]
    ds_read_b128 v[36:39], v8 offset:14336
    buffer_store_dwordx4 v[76:79], v2, s[8:11], s29 offen offset:0 sc1
    s_waitcnt lgkmcnt(5)
    v_mfma_f32_32x32x16_bf16 v[44:59], a[36:39], v[16:19], v[44:59]
    ds_read_b128 v[40:43], v8 offset:15360
    buffer_store_dwordx4 v[80:83], v2, s[8:11], s29 offen offset:1024 sc1
    s_waitcnt lgkmcnt(5)
    v_mfma_f32_32x32x16_bf16 v[44:59], a[40:43], v[20:23], v[44:59]
    ds_read_b128 v[12:15], v8 offset:16384
    s_add_u32 s29, s29, 32768
    s_cmp_ge_u32 s29, s37
    s_cselect_b32 s29, s36, s29
    s_waitcnt lgkmcnt(5)
    v_mfma_f32_32x32x16_bf16 v[44:59], a[44:47], v[24:27], v[44:59]
    ds_read_b128 v[16:19], v8 offset:17408
    s_waitcnt lgkmcnt(5)
    v_mfma_f32_32x32x16_bf16 v[44:59], a[48:51], v[28:31], v[44:59]
    ds_read_b128 v[20:23], v8 offset:18432
    s_waitcnt lgkmcnt(5)
    v_mfma_f32_32x32x16_bf16 v[44:59], a[52:55], v[32:35], v[44:59]
    ds_read_b128 v[24:27], v8 offset:19456
    s_waitcnt lgkmcnt(5)
    v_mfma_f32_32x32x16_bf16 v[44:59], a[56:59], v[36:39], v[44:59]
    ds_read_b128 v[28:31], v8 offset:20480
    s_waitcnt lgkmcnt(5)
    v_mfma_f32_32x32x16_bf16 v[44:59], a[60:63], v[40:43], v[44:59]
    ds_read_b128 v[32:35], v8 offset:21504
    s_waitcnt lgkmcnt(5)
    v_mfma_f32_32x32x16_bf16 v[44:59], a[64:67], v[12:15], v[44:59]
    ds_read_b128 v[36:39], v8 offset:22528
    s_waitcnt lgkmcnt(5)
    v_mfma_f32_32x32x16_bf16 v[44:59], a[68:71], v[16:19], v[44:59]
    ds_read_b128 v[40:43], v8 offset:23552
    s_waitcnt lgkmcnt(5)
    v_mfma_f32_32x32x16_bf16 v[44:59], a[72:75], v[20:23], v[44:59]
    ds_read_b128 v[12:15], v8 offset:24576
    s_waitcnt lgkmcnt(5)
    v_mfma_f32_32x32x16_bf16 v[44:59], a[76:79], v[24:27], v[44:59]
    ds_read_b128 v[16:19], v8 offset:25600
    s_waitcnt lgkmcnt(5)
    v_mfma_f32_32x32x16_bf16 v[44:59], a[80:83], v[28:31], v[44:59]
    ds_read_b128 v[20:23], v8 offset:26624
    s_waitcnt vmcnt(4)
    s_barrier
    s_waitcnt lgkmcnt(5)
    v_mfma_f32_32x32x16_bf16 v[44:59], a[84:87], v[32:35], v[44:59]
    ds_read_b128 v[24:27], v8 offset:27648
    s_waitcnt lgkmcnt(5)
    v_mfma_f32_32x32x16_bf16 v[44:59], a[88:91], v[36:39], v[44:59]
    ds_read_b128 v[28:31], v8 offset:28672
    s_waitcnt lgkmcnt(5)
    v_mfma_f32_32x32x16_bf16 v[44:59], a[92:95], v[40:43], v[44:59]
    ds_read_b128 v[32:35], v8 offset:29696
    s_waitcnt lgkmcnt(5)
    v_mfma_f32_32x32x16_bf16 v[44:59], a[96:99], v[12:15], v[44:59]
    ds_read_b128 v[36:39], v8 offset:30720
    s_waitcnt lgkmcnt(5)
    v_mfma_f32_32x32x16_bf16 v[44:59], a[100:103], v[16:19], v[44:59]
    ds_read_b128 v[40:43], v8 offset:31744
    s_waitcnt lgkmcnt(5)
    v_mfma_f32_32x32x16_bf16 v[44:59], a[104:107], v[20:23], v[44:59]
    ds_read_b128 v[12:15], v8 offset:32768
    s_waitcnt lgkmcnt(5)
    v_mfma_f32_32x32x16_bf16 v[44:59], a[108:111], v[24:27], v[44:59]
    ds_read_b128 v[16:19], v8 offset:33792
    s_waitcnt lgkmcnt(5)
    v_mfma_f32_32x32x16_bf16 v[60:75], a[0:3], v[28:31], 0
    ds_read_b128 v[20:23], v8 offset:34816
    s_waitcnt lgkmcnt(5)
    v_mfma_f32_32x32x16_bf16 v[60:75], a[4:7], v[32:35], v[60:75]
    ds_read_b128 v[24:27], v8 offset:35840
    s_waitcnt lgkmcnt(5)
    v_mfma_f32_32x32x16_bf16 v[60:75], a[8:11], v[36:39], v[60:75]
    ds_read_b128 v[28:31], v8 offset:36864
    s_waitcnt lgkmcnt(5)
    v_mfma_f32_32x32x16_bf16 v[60:75], a[12:15], v[40:43], v[60:75]
    ds_read_b128 v[32:35], v8 offset:37888
    s_waitcnt lgkmcnt(5)
    v_mfma_f32_32x32x16_bf16 v[60:75], a[16:19], v[12:15], v[60:75]
    ds_read_b128 v[36:39], v8 offset:38912
    v_cvt_pk_bf16_f32 v76, v44, v45
    v_cvt_pk_bf16_f32 v77, v46, v47
    s_waitcnt lgkmcnt(5)
    v_mfma_f32_32x32x16_bf16 v[60:75], a[20:23], v[16:19], v[60:75]
    ds_read_b128 v[40:43], v8 offset:39936
    v_cvt_pk_bf16_f32 v78, v48, v49
    v_cvt_pk_bf16_f32 v79, v50, v51
    s_waitcnt lgkmcnt(5)
    v_mfma_f32_32x32x16_bf16 v[60:75], a[24:27], v[20:23], v[60:75]
    ds_read_b128 v[12:15], v8 offset:40960
    v_cvt_pk_bf16_f32 v80, v52, v53
    v_cvt_pk_bf16_f32 v81, v54, v55
    s_waitcnt lgkmcnt(5)
    v_mfma_f32_32x32x16_bf16 v[60:75], a[28:31], v[24:27], v[60:75]
    ds_read_b128 v[16:19], v8 offset:41984
    v_cvt_pk_bf16_f32 v82, v56, v57
    v_cvt_pk_bf16_f32 v83, v58, v59
    s_waitcnt lgkmcnt(5)
    v_mfma_f32_32x32x16_bf16 v[60:75], a[32:35], v[28:31], v[60:75]
    ds_read_b128 v[20:23], v8 offset:43008
    buffer_store_dwordx4 v[76:79], v2, s[8:11], s29 offen offset:0 sc1
    s_waitcnt lgkmcnt(5)
    v_mfma_f32_32x32x16_bf16 v[60:75], a[36:39], v[32:35], v[60:75]
    ds_read_b128 v[24:27], v8 offset:44032
    buffer_store_dwordx4 v[80:83], v2, s[8:11], s29 offen offset:1024 sc1
    s_waitcnt lgkmcnt(5)
    v_mfma_f32_32x32x16_bf16 v[60:75], a[40:43], v[36:39], v[60:75]
    ds_read_b128 v[28:31], v8 offset:45056
    s_add_u32 s29, s29, 32768
    s_cmp_ge_u32 s29, s37
    s_cselect_b32 s29, s36, s29
    s_waitcnt lgkmcnt(5)
    v_mfma_f32_32x32x16_bf16 v[60:75], a[44:47], v[40:43], v[60:75]
    ds_read_b128 v[32:35], v8 offset:46080
    s_waitcnt lgkmcnt(5)
    v_mfma_f32_32x32x16_bf16 v[60:75], a[48:51], v[12:15], v[60:75]
    ds_read_b128 v[36:39], v8 offset:47104
    s_waitcnt lgkmcnt(5)
    v_mfma_f32_32x32x16_bf16 v[60:75], a[52:55], v[16:19], v[60:75]
    ds_read_b128 v[40:43], v8 offset:48128
    s_waitcnt lgkmcnt(5)
    v_mfma_f32_32x32x16_bf16 v[60:75], a[56:59], v[20:23], v[60:75]
    ds_read_b128 v[12:15], v8 offset:49152
    s_waitcnt lgkmcnt(5)
    v_mfma_f32_32x32x16_bf16 v[60:75], a[60:63], v[24:27], v[60:75]
    ds_read_b128 v[16:19], v8 offset:50176
    s_waitcnt lgkmcnt(5)
    v_mfma_f32_32x32x16_bf16 v[60:75], a[64:67], v[28:31], v[60:75]
    ds_read_b128 v[20:23], v8 offset:51200
    s_waitcnt lgkmcnt(5)
    v_mfma_f32_32x32x16_bf16 v[60:75], a[68:71], v[32:35], v[60:75]
    ds_read_b128 v[24:27], v8 offset:52224
    s_waitcnt lgkmcnt(5)
    v_mfma_f32_32x32x16_bf16 v[60:75], a[72:75], v[36:39], v[60:75]
    ds_read_b128 v[28:31], v8 offset:53248
    s_waitcnt lgkmcnt(5)
    v_mfma_f32_32x32x16_bf16 v[60:75], a[76:79], v[40:43], v[60:75]
    ds_read_b128 v[32:35], v8 offset:54272
    s_waitcnt lgkmcnt(5)
    v_mfma_f32_32x32x16_bf16 v[60:75], a[80:83], v[12:15], v[60:75]
    ds_read_b128 v[36:39], v8 offset:55296
    s_waitcnt lgkmcnt(5)
    v_mfma_f32_32x32x16_bf16 v[60:75], a[84:87], v[16:19], v[60:75]
    ds_read_b128 v[40:43], v8 offset:56320
    s_waitcnt lgkmcnt(5)
    v_mfma_f32_32x32x16_bf16 v[60:75], a[88:91], v[20:23], v[60:75]
    s_waitcnt lgkmcnt(4)
    v_mfma_f32_32x32x16_bf16 v[60:75], a[92:95], v[24:27], v[60:75]
    s_waitcnt lgkmcnt(3)
    v_mfma_f32_32x32x16_bf16 v[60:75], a[96:99], v[28:31], v[60:75]
    s_waitcnt lgkmcnt(2)
    v_mfma_f32_32x32x16_bf16 v[60:75], a[100:103], v[32:35], v[60:75]
    s_waitcnt lgkmcnt(1)
    v_mfma_f32_32x32x16_bf16 v[60:75], a[104:107], v[36:39], v[60:75]
    s_waitcnt lgkmcnt(0)
    v_mfma_f32_32x32x16_bf16 v[60:75], a[108:111], v[40:43], v[60:75]
    s_nop 11
    v_cvt_pk_bf16_f32 v76, v60, v61
    v_cvt_pk_bf16_f32 v77, v62, v63
    s_nop 0
    v_cvt_pk_bf16_f32 v78, v64, v65
    v_cvt_pk_bf16_f32 v79, v66, v67
    s_nop 0
    v_cvt_pk_bf16_f32 v80, v68, v69
    v_cvt_pk_bf16_f32 v81, v70, v71
    s_nop 0
    v_cvt_pk_bf16_f32 v82, v72, v73
    v_cvt_pk_bf16_f32 v83, v74, v75
    s_nop 0
    buffer_store_dwordx4 v[76:79], v5, s[8:11], s29 offen offset:0 sc1
    s_nop 0
    buffer_store_dwordx4 v[80:83], v5, s[8:11], s29 offen offset:1024 sc1
    s_nop 0
    s_add_u32 s29, s29, 32768
    s_cmp_ge_u32 s29, s37
    s_cselect_b32 s29, s36, s29
    s_nop 0
    s_lshl_b32 s30, s25, 7
    s_add_u32 s30, s30, 18616320
    s_waitcnt vmcnt(0)
    s_barrier
    s_cmp_lg_u32 s21, 0
    s_cbranch_scc1 sig_55
    v_mov_b32 v3, 1
    s_mov_b64 exec, 1
    buffer_atomic_add v3, off, s[8:11], s30 sc1
    s_mov_b64 exec, -1
sig_55:
    s_branch main_next
job_2:
    s_lshl_b32 s33, s25, 2
    s_add_u32 s33, s33, s21
    s_mul_i32 s26, s24, 344064
    s_add_u32 s26, s26, 56623104
    s_lshl_b32 s29, s24, 8
    s_add_u32 s29, s29, s33
    s_lshl_b32 s30, s29, 12
    s_lshl_b32 s29, s29, 11
    s_add_u32 s29, s29, 59768832
    s_add_u32 s30, s30, 61865984
    s_mov_b32 s31, 0x3e8b97f6
    s_mov_b32 s34, 0x10000000
    s_mov_b32 s35, 0x10000000
    v_mov_b32 v84, 0x3f803f80
    s_mov_b32 s28, 18620928
    v_mov_b32 v7, v2
    s_mul_i32 s32, s21, 7168
    v_add_u32 v4, s32, v2
    v_add_u32 v8, 57344, v7
    s_mul_i32 s27, s33, 28672
    s_add_u32 s27, s27, 15728640
    s_lshr_b32 s3, s33, 2
    s_lshl_b32 s3, s3, 7
    s_add_u32 s3, s3, 18614272
    v_mov_b32 v6, s28
    v_writelane_b32 v6, s3, 0
    v_mov_b32 v12, 62
    v_writelane_b32 v12, 2, 0
gw_56:
    buffer_load_dword v3, v6, s[8:11], 0 offen sc1
    s_waitcnt vmcnt(0)
    v_cmp_gt_u32 vcc, v12, v3
    s_cbranch_vccz gw_56k
    s_sleep 2
    s_sub_u32 s23, s23, 1
    s_cbranch_scc0 gw_56
    s_mov_b32 s23, 0
gw_56k:
    s_add_u32 m0, s32, 0
    s_add_u32 s28, s26, 0
    buffer_load_dwordx4 v4, s[8:11], s28 offen offset:0 sc1 lds
    buffer_load_dwordx4 v4, s[8:11], s28 offen offset:1024 sc1 lds
    buffer_load_dwordx4 v4, s[8:11], s28 offen offset:2048 sc1 lds
    buffer_load_dwordx4 v4, s[8:11], s28 offen offset:3072 sc1 lds
    s_add_u32 m0, s32, 4096
    s_add_u32 s28, s26, 4096
    buffer_load_dwordx4 v4, s[8:11], s28 offen offset:0 sc1 lds
    buffer_load_dwordx4 v4, s[8:11], s28 offen offset:1024 sc1 lds
    buffer_load_dwordx4 v4, s[8:11], s28 offen offset:2048 sc1 lds
    buffer_load_dwordx4 a[0:3], v2, s[8:11], s27 offen offset:0 sc1
    buffer_load_dwordx4 a[4:7], v2, s[8:11], s27 offen offset:1024 sc1
    buffer_load_dwordx4 a[8:11], v2, s[8:11], s27 offen offset:2048 sc1
    buffer_load_dwordx4 a[12:15], v2, s[8:11], s27 offen offset:3072 sc1
    s_add_u32 s27, s27, 4096
    buffer_load_dwordx4 a[16:19], v2, s[8:11], s27 offen offset:0 sc1
    buffer_load_dwordx4 a[20:23], v2, s[8:11], s27 offen offset:1024 sc1
    buffer_load_dwordx4 a[24:27], v2, s[8:11], s27 offen offset:2048 sc1
    buffer_load_dwordx4 a[28:31], v2, s[8:11], s27 offen offset:3072 sc1
    s_add_u32 s27, s27, 4096
    buffer_load_dwordx4 a[32:35], v2, s[8:11], s27 offen offset:0 sc1
    buffer_load_dwordx4 a[36:39], v2, s[8:11], s27 offen offset:1024 sc1
    buffer_load_dwordx4 a[40:43], v2, s[8:11], s27 offen offset:2048 sc1
    buffer_load_dwordx4 a[44:47], v2, s[8:11], s27 offen offset:3072 sc1
    s_add_u32 s27, s27, 4096
    buffer_load_dwordx4 a[48:51], v2, s[8:11], s27 offen offset:0 sc1
    buffer_load_dwordx4 a[52:55], v2, s[8:11], s27 offen offset:1024 sc1
    buffer_load_dwordx4 a[56:59], v2, s[8:11], s27 offen offset:2048 sc1
    buffer_load_dwordx4 a[60:63], v2, s[8:11], s27 offen offset:3072 sc1
    s_add_u32 s27, s27, 4096
    buffer_load_dwordx4 a[64:67], v2, s[8:11], s27 offen offset:0 sc1
    buffer_load_dwordx4 a[68:71], v2, s[8:11], s27 offen offset:1024 sc1
    buffer_load_dwordx4 a[72:75], v2, s[8:11], s27 offen offset:2048 sc1
    buffer_load_dwordx4 a[76:79], v2, s[8:11], s27 offen offset:3072 sc1
    s_add_u32 s27, s27, 4096
    buffer_load_dwordx4 a[80:83], v2, s[8:11], s27 offen offset:0 sc1
    buffer_load_dwordx4 a[84:87], v2, s[8:11], s27 offen offset:1024 sc1
    buffer_load_dwordx4 a[88:91], v2, s[8:11], s27 offen offset:2048 sc1
    buffer_load_dwordx4 a[92:95], v2, s[8:11], s27 offen offset:3072 sc1
    s_add_u32 s27, s27, 4096
    buffer_load_dwordx4 a[96:99], v2, s[8:11], s27 offen offset:0 sc1
    buffer_load_dwordx4 a[100:103], v2, s[8:11], s27 offen offset:1024 sc1
    buffer_load_dwordx4 a[104:107], v2, s[8:11], s27 offen offset:2048 sc1
    buffer_load_dwordx4 a[108:111], v2, s[8:11], s27 offen offset:3072 sc1
    s_add_u32 m0, s32, 28672
    s_add_u32 s28, s26, 28672
    buffer_load_dwordx4 v4, s[8:11], s28 offen offset:0 sc1 lds
    buffer_load_dwordx4 v4, s[8:11], s28 offen offset:1024 sc1 lds
    buffer_load_dwordx4 v4, s[8:11], s28 offen offset:2048 sc1 lds
    buffer_load_dwordx4 v4, s[8:11], s28 offen offset:3072 sc1 lds
    s_add_u32 m0, s32, 32768
    s_add_u32 s28, s26, 32768
    buffer_load_dwordx4 v4, s[8:11], s28 offen offset:0 sc1 lds
    buffer_load_dwordx4 v4, s[8:11], s28 offen offset:1024 sc1 lds
    buffer_load_dwordx4 v4, s[8:11], s28 offen offset:2048 sc1 lds
    s_waitcnt vmcnt(7)
    s_barrier
    ds_read_b128 v[12:15], v7 offset:0
    ds_read_b128 v[16:19], v7 offset:1024
    ds_read_b128 v[20:23], v7 offset:2048
    ds_read_b128 v[24:27], v7 offset:3072
    ds_read_b128 v[28:31], v7 offset:4096
    ds_read_b128 v[32:35], v7 offset:5120
    s_waitcnt lgkmcnt(5)
    v_mfma_f32_32x32x16_bf16 v[44:59], v[12:15], a[0:3], 0
    ds_read_b128 v[36:39], v7 offset:6144
    s_add_u32 m0, s32, 57344
    s_add_u32 s28, s26, 57344
    buffer_load_dwordx4 v4, s[8:11], s28 offen offset:0 sc1 lds
    s_waitcnt lgkmcnt(5)
    v_mfma_f32_32x32x16_bf16 v[44:59], v[16:19], a[4:7], v[44:59]
    ds_read_b128 v[40:43], v7 offset:7168
    s_waitcnt lgkmcnt(5)
    v_mfma_f32_32x32x16_bf16 v[44:59], v[20:23], a[8:11], v[44:59]
    ds_read_b128 v[12:15], v7 offset:8192
    buffer_load_dwordx4 v4, s[8:11], s28 offen offset:1024 sc1 lds
    s_waitcnt lgkmcnt(5)
    v_mfma_f32_32x32x16_bf16 v[44:59], v[24:27], a[12:15], v[44:59]
    ds_read_b128 v[16:19], v7 offset:9216
    s_waitcnt lgkmcnt(5)
    v_mfma_f32_32x32x16_bf16 v[44:59], v[28:31], a[16:19], v[44:59]
    ds_read_b128 v[20:23], v7 offset:10240
    buffer_load_dwordx4 v4, s[8:11], s28 offen offset:2048 sc1 lds
    s_waitcnt lgkmcnt(5)
    v_mfma_f32_32x32x16_bf16 v[44:59], v[32:35], a[20:23], v[44:59]
    ds_read_b128 v[24:27], v7 offset:11264
    s_waitcnt lgkmcnt(5)
    v_mfma_f32_32x32x16_bf16 v[44:59], v[36:39], a[24:27], v[44:59]
    ds_read_b128 v[28:31], v7 offset:12288
    buffer_load_dwordx4 v4, s[8:11], s28 offen offset:3072 sc1 lds
    s_waitcnt lgkmcnt(5)
    v_mfma_f32_32x32x16_bf16 v[44:59], v[40:43], a[28:31], v[44:59]
    ds_read_b128 v[32:35], v7 offset:13312
    s_waitcnt lgkmcnt(5)
    v_mfma_f32_32x32x16_bf16 v[44:59], v[12:15], a[32:35], v[44:59]
    ds_read_b128 v[36:39], v7 offset:14336
    s_add_u32 m0, s32, 61440
    s_add_u32 s28, s26, 61440
    buffer_load_dwordx4 v4, s[8:11], s28 offen offset:0 sc1 lds
    s_waitcnt lgkmcnt(5)
    v_mfma_f32_32x32x16_bf16 v[44:59], v[16:19], a[36:39], v[44:59]
    ds_read_b128 v[40:43], v7 offset:15360
    s_waitcnt lgkmcnt(5)
    v_mfma_f32_32x32x16_bf16 v[44:59], v[20:23], a[40:43], v[44:59]
    ds_read_b128 v[12:15], v7 offset:16384
    buffer_load_dwordx4 v4, s[8:11], s28 offen offset:1024 sc1 lds
    s_waitcnt lgkmcnt(5)
    v_mfma_f32_32x32x16_bf16 v[44:59], v[24:27], a[44:47], v[44:59]
    ds_read_b128 v[16:19], v7 offset:17408
    s_waitcnt lgkmcnt(5)
    v_mfma_f32_32x32x16_bf16 v[44:59], v[28:31], a[48:51], v[44:59]
    ds_read_b128 v[20:23], v7 offset:18432
    buffer_load_dwordx4 v4, s[8:11], s28 offen offset:2048 sc1 lds
    s_waitcnt lgkmcnt(5)
    v_mfma_f32_32x32x16_bf16 v[44:59], v[32:35], a[52:55], v[44:59]
    ds_read_b128 v[24:27], v7 offset:19456
    s_waitcnt lgkmcnt(5)
    v_mfma_f32_32x32x16_bf16 v[44:59], v[36:39], a[56:59], v[44:59]
    ds_read_b128 v[28:31], v7 offset:20480
    s_waitcnt lgkmcnt(5)
    v_mfma_f32_32x32x16_bf16 v[44:59], v[40:43], a[60:63], v[44:59]
    ds_read_b128 v[32:35], v7 offset:21504
    s_waitcnt lgkmcnt(5)
    v_mfma_f32_32x32x16_bf16 v[44:59], v[12:15], a[64:67], v[44:59]
    ds_read_b128 v[36:39], v7 offset:22528
    s_waitcnt lgkmcnt(5)
    v_mfma_f32_32x32x16_bf16 v[44:59], v[16:19], a[68:71], v[44:59]
    ds_read_b128 v[40:43], v7 offset:23552
    s_waitcnt lgkmcnt(5)
    v_mfma_f32_32x32x16_bf16 v[44:59], v[20:23], a[72:75], v[44:59]
    ds_read_b128 v[12:15], v7 offset:24576
    s_waitcnt lgkmcnt(5)
    v_mfma_f32_32x32x16_bf16 v[44:59], v[24:27], a[76:79], v[44:59]
    ds_read_b128 v[16:19], v7 offset:25600
    s_waitcnt lgkmcnt(5)
    v_mfma_f32_32x32x16_bf16 v[44:59], v[28:31], a[80:83], v[44:59]
    ds_read_b128 v[20:23], v7 offset:26624
    s_waitcnt vmcnt(7)
    s_barrier
    s_waitcnt lgkmcnt(5)
    v_mfma_f32_32x32x16_bf16 v[44:59], v[32:35], a[84:87], v[44:59]
    ds_read_b128 v[24:27], v7 offset:27648
    s_add_u32 m0, s32, 86016
    s_add_u32 s28, s26, 86016
    buffer_load_dwordx4 v4, s[8:11], s28 offen offset:0 sc1 lds
    s_waitcnt lgkmcnt(5)
    v_mfma_f32_32x32x16_bf16 v[44:59], v[36:39], a[88:91], v[44:59]
    ds_read_b128 v[28:31], v7 offset:28672
    s_waitcnt lgkmcnt(5)
    v_mfma_f32_32x32x16_bf16 v[44:59], v[40:43], a[92:95], v[44:59]
    ds_read_b128 v[32:35], v7 offset:29696
    buffer_load_dwordx4 v4, s[8:11], s28 offen offset:1024 sc1 lds
    s_waitcnt lgkmcnt(5)
    v_mfma_f32_32x32x16_bf16 v[44:59], v[12:15], a[96:99], v[44:59]
    ds_read_b128 v[36:39], v7 offset:30720
    s_waitcnt lgkmcnt(5)
    v_mfma_f32_32x32x16_bf16 v[44:59], v[16:19], a[100:103], v[44:59]
    ds_read_b128 v[40:43], v7 offset:31744
    buffer_load_dwordx4 v4, s[8:11], s28 offen offset:2048 sc1 lds
    s_waitcnt lgkmcnt(5)
    v_mfma_f32_32x32x16_bf16 v[44:59], v[20:23], a[104:107], v[44:59]
    ds_read_b128 v[12:15], v7 offset:32768
    s_waitcnt lgkmcnt(5)
    v_mfma_f32_32x32x16_bf16 v[44:59], v[24:27], a[108:111], v[44:59]
    ds_read_b128 v[16:19], v7 offset:33792
    buffer_load_dwordx4 v4, s[8:11], s28 offen offset:3072 sc1 lds
    s_waitcnt lgkmcnt(5)
    v_mfma_f32_32x32x16_bf16 v[60:75], v[28:31], a[0:3], 0
    ds_read_b128 v[20:23], v7 offset:34816
    s_waitcnt lgkmcnt(5)
    v_mfma_f32_32x32x16_bf16 v[60:75], v[32:35], a[4:7], v[60:75]
    ds_read_b128 v[24:27], v7 offset:35840
    s_add_u32 m0, s32, 90112
    s_add_u32 s28, s26, 90112
    buffer_load_dwordx4 v4, s[8:11], s28 offen offset:0 sc1 lds
    s_waitcnt lgkmcnt(5)
    v_mfma_f32_32x32x16_bf16 v[60:75], v[36:39], a[8:11], v[60:75]
    ds_read_b128 v[28:31], v7 offset:36864
    s_waitcnt lgkmcnt(5)
    v_mfma_f32_32x32x16_bf16 v[60:75], v[40:43], a[12:15], v[60:75]
    ds_read_b128 v[32:35], v7 offset:37888
    buffer_load_dwordx4 v4, s[8:11], s28 offen offset:1024 sc1 lds
    s_waitcnt lgkmcnt(5)
    v_mfma_f32_32x32x16_bf16 v[60:75], v[12:15], a[16:19], v[60:75]
    ds_read_b128 v[36:39], v7 offset:38912
    v_mul_f32 v44, s31, v44
    v_mul_f32 v45, s31, v45
    v_mul_f32 v46, s31, v46
    v_mul_f32 v47, s31, v47
    s_waitcnt lgkmcnt(5)
    v_mfma_f32_32x32x16_bf16 v[60:75], v[16:19], a[20:23], v[60:75]
    ds_read_b128 v[40:43], v7 offset:39936
    buffer_load_dwordx4 v4, s[8:11], s28 offen offset:2048 sc1 lds
    v_mul_f32 v48, s31, v48
    v_mul_f32 v49, s31, v49
    v_mul_f32 v50, s31, v50
    v_mul_f32 v51, s31, v51
    s_waitcnt lgkmcnt(5)
    v_mfma_f32_32x32x16_bf16 v[60:75], v[20:23], a[24:27], v[60:75]
    ds_read_b128 v[12:15], v7 offset:40960
    v_mul_f32 v52, s31, v52
    v_mul_f32 v53, s31, v53
    v_mul_f32 v54, s31, v54
    v_mul_f32 v55, s31, v55
    s_waitcnt lgkmcnt(5)
    v_mfma_f32_32x32x16_bf16 v[60:75], v[24:27], a[28:31], v[60:75]
    ds_read_b128 v[16:19], v7 offset:41984
    v_mul_f32 v56, s31, v56
    v_mul_f32 v57, s31, v57
    v_mul_f32 v58, s31, v58
    v_mul_f32 v59, s31, v59
    s_waitcnt lgkmcnt(5)
    v_mfma_f32_32x32x16_bf16 v[60:75], v[28:31], a[32:35], v[60:75]
    ds_read_b128 v[20:23], v7 offset:43008
    v_cvt_pk_bf16_f32 v76, v44, v45
    v_cvt_pk_bf16_f32 v77, v46, v47
    s_waitcnt lgkmcnt(5)
    v_mfma_f32_32x32x16_bf16 v[60:75], v[32:35], a[36:39], v[60:75]
    ds_read_b128 v[24:27], v7 offset:44032
    v_cvt_pk_bf16_f32 v78, v48, v49
    v_cvt_pk_bf16_f32 v79, v50, v51
    s_waitcnt lgkmcnt(5)
    v_mfma_f32_32x32x16_bf16 v[60:75], v[36:39], a[40:43], v[60:75]
    ds_read_b128 v[28:31], v7 offset:45056
    v_cvt_pk_bf16_f32 v80, v52, v53
    v_cvt_pk_bf16_f32 v81, v54, v55
    s_waitcnt lgkmcnt(5)
    v_mfma_f32_32x32x16_bf16 v[60:75], v[40:43], a[44:47], v[60:75]
    ds_read_b128 v[32:35], v7 offset:46080
    v_cvt_pk_bf16_f32 v82, v56, v57
    v_cvt_pk_bf16_f32 v83, v58, v59
    s_waitcnt lgkmcnt(5)
    v_mfma_f32_32x32x16_bf16 v[60:75], v[12:15], a[48:51], v[60:75]
    ds_read_b128 v[36:39], v7 offset:47104
    buffer_store_dwordx4 v[76:79], v2, s[8:11], s29 offen offset:0 sc1
    s_waitcnt lgkmcnt(5)
    v_mfma_f32_32x32x16_bf16 v[60:75], v[16:19], a[52:55], v[60:75]
    ds_read_b128 v[40:43], v7 offset:48128
    buffer_store_dwordx4 v[80:83], v2, s[8:11], s29 offen offset:1024 sc1
    s_waitcnt lgkmcnt(5)
    v_mfma_f32_32x32x16_bf16 v[60:75], v[20:23], a[56:59], v[60:75]
    ds_read_b128 v[12:15], v7 offset:49152
    s_add_u32 s29, s29, 131072
    s_waitcnt lgkmcnt(5)
    v_mfma_f32_32x32x16_bf16 v[60:75], v[24:27], a[60:63], v[60:75]
    ds_read_b128 v[16:19], v7 offset:50176
    s_waitcnt lgkmcnt(5)
    v_mfma_f32_32x32x16_bf16 v[60:75], v[28:31], a[64:67], v[60:75]
    ds_read_b128 v[20:23], v7 offset:51200
    s_waitcnt lgkmcnt(5)
    v_mfma_f32_32x32x16_bf16 v[60:75], v[32:35], a[68:71], v[60:75]
    ds_read_b128 v[24:27], v7 offset:52224
    s_waitcnt lgkmcnt(5)
    v_mfma_f32_32x32x16_bf16 v[60:75], v[36:39], a[72:75], v[60:75]
    ds_read_b128 v[28:31], v7 offset:53248
    s_waitcnt lgkmcnt(5)
    v_mfma_f32_32x32x16_bf16 v[60:75], v[40:43], a[76:79], v[60:75]
    ds_read_b128 v[32:35], v7 offset:54272
    s_waitcnt lgkmcnt(5)
    v_mfma_f32_32x32x16_bf16 v[60:75], v[12:15], a[80:83], v[60:75]
    ds_read_b128 v[36:39], v7 offset:55296
    s_waitcnt vmcnt(9)
    s_barrier
    s_waitcnt lgkmcnt(5)
    v_mfma_f32_32x32x16_bf16 v[60:75], v[16:19], a[84:87], v[60:75]
    ds_read_b128 v[40:43], v7 offset:56320
    s_add_u32 m0, s32, 0
    s_add_u32 s28, s26, 114688
    buffer_load_dwordx4 v4, s[8:11], s28 offen offset:0 sc1 lds
    s_waitcnt lgkmcnt(5)
    v_mfma_f32_32x32x16_bf16 v[60:75], v[20:23], a[88:91], v[60:75]
    ds_read_b128 v[12:15], v8 offset:0
    s_waitcnt lgkmcnt(5)
    v_mfma_f32_32x32x16_bf16 v[60:75], v[24:27], a[92:95], v[60:75]
    ds_read_b128 v[16:19], v8 offset:1024
    buffer_load_dwordx4 v4, s[8:11], s28 offen offset:1024 sc1 lds
    s_waitcnt lgkmcnt(5)
    v_mfma_f32_32x32x16_bf16 v[60:75], v[28:31], a[96:99], v[60:75]
    ds_read_b128 v[20:23], v8 offset:2048
    s_waitcnt lgkmcnt(5)
    v_mfma_f32_32x32x16_bf16 v[60:75], v[32:35], a[100:103], v[60:75]
    ds_read_b128 v[24:27], v8 offset:3072
    buffer_load_dwordx4 v4, s[8:11], s28 offen offset:2048 sc1 lds
    s_waitcnt lgkmcnt(5)
    v_mfma_f32_32x32x16_bf16 v[60:75], v[36:39], a[104:107], v[60:75]
    ds_read_b128 v[28:31], v8 offset:4096
    s_waitcnt lgkmcnt(5)
    v_mfma_f32_32x32x16_bf16 v[60:75], v[40:43], a[108:111], v[60:75]
    ds_read_b128 v[32:35], v8 offset:5120
    buffer_load_dwordx4 v4, s[8:11], s28 offen offset:3072 sc1 lds
    s_waitcnt lgkmcnt(5)
    v_mfma_f32_32x32x16_bf16 v[44:59], a[0:3], v[12:15], 0
    ds_read_b128 v[36:39], v8 offset:6144
    s_waitcnt lgkmcnt(5)
    v_mfma_f32_32x32x16_bf16 v[44:59], a[4:7], v[16:19], v[44:59]
    ds_read_b128 v[40:43], v8 offset:7168
    s_add_u32 m0, s32, 4096
    s_add_u32 s28, s26, 118784
    buffer_load_dwordx4 v4, s[8:11], s28 offen offset:0 sc1 lds
    s_waitcnt lgkmcnt(5)
    v_mfma_f32_32x32x16_bf16 v[44:59], a[8:11], v[20:23], v[44:59]
    ds_read_b128 v[12:15], v8 offset:8192
    s_waitcnt lgkmcnt(5)
    v_mfma_f32_32x32x16_bf16 v[44:59], a[12:15], v[24:27], v[44:59]
    ds_read_b128 v[16:19], v8 offset:9216
    buffer_load_dwordx4 v4, s[8:11], s28 offen offset:1024 sc1 lds
    s_waitcnt lgkmcnt(5)
    v_mfma_f32_32x32x16_bf16 v[44:59], a[16:19], v[28:31], v[44:59]
    ds_read_b128 v[20:23], v8 offset:10240
    v_cvt_pk_bf16_f32 v76, v60, v61
    v_cvt_pk_bf16_f32 v77, v62, v63
    s_waitcnt lgkmcnt(5)
    v_mfma_f32_32x32x16_bf16 v[44:59], a[20:23], v[32:35], v[44:59]
    ds_read_b128 v[24:27], v8 offset:11264
    buffer_load_dwordx4 v4, s[8:11], s28 offen offset:2048 sc1 lds
    v_cvt_pk_bf16_f32 v78, v64, v65
    v_cvt_pk_bf16_f32 v79, v66, v67
    s_waitcnt lgkmcnt(5)
    v_mfma_f32_32x32x16_bf16 v[44:59], a[24:27], v[36:39], v[44:59]
    ds_read_b128 v[28:31], v8 offset:12288
    v_cvt_pk_bf16_f32 v80, v68, v69
    v_cvt_pk_bf16_f32 v81, v70, v71
    s_waitcnt lgkmcnt(5)
    v_mfma_f32_32x32x16_bf16 v[44:59], a[28:31], v[40:43], v[44:59]
    ds_read_b128 v[32:35], v8 offset:13312
    v_cvt_pk_bf16_f32 v82, v72, v73
    v_cvt_pk_bf16_f32 v83, v74, v75
    s_waitcnt lgkmcnt(5)
    v_mfma_f32_32x32x16_bf16 v[44:59], a[32:35], v[12:15], v[44:59]
    ds_read_b128 v[36:39], v8 offset:14336
    buffer_store_dwordx4 v[76:79], v2, s[8:11], s30 offen offset:0 sc1
    s_waitcnt lgkmcnt(5)
    v_mfma_f32_32x32x16_bf16 v[44:59], a[36:39], v[16:19], v[44:59]
    ds_read_b128 v[40:43], v8 offset:15360
    buffer_store_dwordx4 v[80:83], v2, s[8:11], s30 offen offset:1024 sc1
    s_waitcnt lgkmcnt(5)
    v_mfma_f32_32x32x16_bf16 v[44:59], a[40:43], v[20:23], v[44:59]
    ds_read_b128 v[12:15], v8 offset:16384
    s_waitcnt lgkmcnt(5)
    v_mfma_f32_32x32x16_bf16 v[44:59], a[44:47], v[24:27], v[44:59]
    ds_read_b128 v[16:19], v8 offset:17408
    s_waitcnt lgkmcnt(5)
    v_mfma_f32_32x32x16_bf16 v[44:59], a[48:51], v[28:31], v[44:59]
    ds_read_b128 v[20:23], v8 offset:18432
    s_waitcnt lgkmcnt(5)
    v_mfma_f32_32x32x16_bf16 v[44:59], a[52:55], v[32:35], v[44:59]
    ds_read_b128 v[24:27], v8 offset:19456
    s_waitcnt lgkmcnt(5)
    v_mfma_f32_32x32x16_bf16 v[44:59], a[56:59], v[36:39], v[44:59]
    ds_read_b128 v[28:31], v8 offset:20480
    s_waitcnt lgkmcnt(5)
    v_mfma_f32_32x32x16_bf16 v[44:59], a[60:63], v[40:43], v[44:59]
    ds_read_b128 v[32:35], v8 offset:21504
    s_waitcnt lgkmcnt(5)
    v_mfma_f32_32x32x16_bf16 v[44:59], a[64:67], v[12:15], v[44:59]
    ds_read_b128 v[36:39], v8 offset:22528
    s_waitcnt lgkmcnt(5)
    v_mfma_f32_32x32x16_bf16 v[44:59], a[68:71], v[16:19], v[44:59]
    ds_read_b128 v[40:43], v8 offset:23552
    s_waitcnt lgkmcnt(5)
    v_mfma_f32_32x32x16_bf16 v[44:59], a[72:75], v[20:23], v[44:59]
    ds_read_b128 v[12:15], v8 offset:24576
    s_waitcnt lgkmcnt(5)
    v_mfma_f32_32x32x16_bf16 v[44:59], a[76:79], v[24:27], v[44:59]
    ds_read_b128 v[16:19], v8 offset:25600
    s_waitcnt lgkmcnt(5)
    v_mfma_f32_32x32x16_bf16 v[44:59], a[80:83], v[28:31], v[44:59]
    ds_read_b128 v[20:23], v8 offset:26624
    s_waitcnt vmcnt(11)
    s_barrier
    s_waitcnt lgkmcnt(5)
    v_mfma_f32_32x32x16_bf16 v[44:59], a[84:87], v[32:35], v[44:59]
    ds_read_b128 v[24:27], v8 offset:27648
    s_add_u32 m0, s32, 28672
    s_add_u32 s28, s26, 143360
    buffer_load_dwordx4 v4, s[8:11], s28 offen offset:0 sc1 lds
    s_waitcnt lgkmcnt(5)
    v_mfma_f32_32x32x16_bf16 v[44:59], a[88:91], v[36:39], v[44:59]
    ds_read_b128 v[28:31], v8 offset:28672
    s_waitcnt lgkmcnt(5)
    v_mfma_f32_32x32x16_bf16 v[44:59], a[92:95], v[40:43], v[44:59]
    ds_read_b128 v[32:35], v8 offset:29696
    buffer_load_dwordx4 v4, s[8:11], s28 offen offset:1024 sc1 lds
    s_waitcnt lgkmcnt(5)
    v_mfma_f32_32x32x16_bf16 v[44:59], a[96:99], v[12:15], v[44:59]
    ds_read_b128 v[36:39], v8 offset:30720
    s_waitcnt lgkmcnt(5)
    v_mfma_f32_32x32x16_bf16 v[44:59], a[100:103], v[16:19], v[44:59]
    ds_read_b128 v[40:43], v8 offset:31744
    buffer_load_dwordx4 v4, s[8:11], s28 offen offset:2048 sc1 lds
    s_waitcnt lgkmcnt(5)
    v_mfma_f32_32x32x16_bf16 v[44:59], a[104:107], v[20:23], v[44:59]
    ds_read_b128 v[12:15], v8 offset:32768
    s_waitcnt lgkmcnt(5)
    v_mfma_f32_32x32x16_bf16 v[44:59], a[108:111], v[24:27], v[44:59]
    ds_read_b128 v[16:19], v8 offset:33792
    buffer_load_dwordx4 v4, s[8:11], s28 offen offset:3072 sc1 lds
    s_waitcnt lgkmcnt(5)
    v_mfma_f32_32x32x16_bf16 v[60:75], v[28:31], a[0:3], 0
    ds_read_b128 v[20:23], v8 offset:34816
    s_waitcnt lgkmcnt(5)
    v_mfma_f32_32x32x16_bf16 v[60:75], v[32:35], a[4:7], v[60:75]
    ds_read_b128 v[24:27], v8 offset:35840
    s_add_u32 m0, s32, 32768
    s_add_u32 s28, s26, 147456
    buffer_load_dwordx4 v4, s[8:11], s28 offen offset:0 sc1 lds
    s_waitcnt lgkmcnt(5)
    v_mfma_f32_32x32x16_bf16 v[60:75], v[36:39], a[8:11], v[60:75]
    ds_read_b128 v[28:31], v8 offset:36864
    s_waitcnt lgkmcnt(5)
    v_mfma_f32_32x32x16_bf16 v[60:75], v[40:43], a[12:15], v[60:75]
    ds_read_b128 v[32:35], v8 offset:37888
    buffer_load_dwordx4 v4, s[8:11], s28 offen offset:1024 sc1 lds
    s_waitcnt lgkmcnt(5)
    v_mfma_f32_32x32x16_bf16 v[60:75], v[12:15], a[16:19], v[60:75]
    ds_read_b128 v[36:39], v8 offset:38912
    v_cvt_pk_bf16_f32 v76, v44, v45
    v_cvt_pk_bf16_f32 v77, v46, v47
    s_waitcnt lgkmcnt(5)
    v_mfma_f32_32x32x16_bf16 v[60:75], v[16:19], a[20:23], v[60:75]
    ds_read_b128 v[40:43], v8 offset:39936
    buffer_load_dwordx4 v4, s[8:11], s28 offen offset:2048 sc1 lds
    v_cvt_pk_bf16_f32 v78, v48, v49
    v_cvt_pk_bf16_f32 v79, v50, v51
    s_waitcnt lgkmcnt(5)
    v_mfma_f32_32x32x16_bf16 v[60:75], v[20:23], a[24:27], v[60:75]
    ds_read_b128 v[12:15], v8 offset:40960
    v_cvt_pk_bf16_f32 v80, v52, v53
    v_cvt_pk_bf16_f32 v81, v54, v55
    s_waitcnt lgkmcnt(5)
    v_mfma_f32_32x32x16_bf16 v[60:75], v[24:27], a[28:31], v[60:75]
    ds_read_b128 v[16:19], v8 offset:41984
    v_cvt_pk_bf16_f32 v82, v56, v57
    v_cvt_pk_bf16_f32 v83, v58, v59
    s_waitcnt lgkmcnt(5)
    v_mfma_f32_32x32x16_bf16 v[60:75], v[28:31], a[32:35], v[60:75]
    ds_read_b128 v[20:23], v8 offset:43008
    v_cndmask_b32 v76, v76, v84, s[34:35]
    v_cndmask_b32 v77, v77, v84, s[34:35]
    v_cndmask_b32 v78, v78, v84, s[34:35]
    v_cndmask_b32 v79, v79, v84, s[34:35]
    s_waitcnt lgkmcnt(5)
    v_mfma_f32_32x32x16_bf16 v[60:75], v[32:35], a[36:39], v[60:75]
    ds_read_b128 v[24:27], v8 offset:44032
    v_cndmask_b32 v80, v80, v84, s[34:35]
    v_cndmask_b32 v81, v81, v84, s[34:35]
    v_cndmask_b32 v82, v82, v84, s[34:35]
    v_cndmask_b32 v83, v83, v84, s[34:35]
    s_waitcnt lgkmcnt(5)
    v_mfma_f32_32x32x16_bf16 v[60:75], v[36:39], a[40:43], v[60:75]
    ds_read_b128 v[28:31], v8 offset:45056
    buffer_store_dwordx4 v[76:79], v2, s[8:11], s30 offen offset:2048 sc1
    s_waitcnt lgkmcnt(5)
    v_mfma_f32_32x32x16_bf16 v[60:75], v[40:43], a[44:47], v[60:75]
    ds_read_b128 v[32:35], v8 offset:46080
    buffer_store_dwordx4 v[80:83], v2, s[8:11], s30 offen offset:3072 sc1
    s_waitcnt lgkmcnt(5)
    v_mfma_f32_32x32x16_bf16 v[60:75], v[12:15], a[48:51], v[60:75]
    ds_read_b128 v[36:39], v8 offset:47104
    s_add_u32 s30, s30, 262144
    s_waitcnt lgkmcnt(5)
    v_mfma_f32_32x32x16_bf16 v[60:75], v[16:19], a[52:55], v[60:75]
    ds_read_b128 v[40:43], v8 offset:48128
    s_waitcnt lgkmcnt(5)
    v_mfma_f32_32x32x16_bf16 v[60:75], v[20:23], a[56:59], v[60:75]
    ds_read_b128 v[12:15], v8 offset:49152
    s_waitcnt lgkmcnt(5)
    v_mfma_f32_32x32x16_bf16 v[60:75], v[24:27], a[60:63], v[60:75]
    ds_read_b128 v[16:19], v8 offset:50176
    s_waitcnt lgkmcnt(5)
    v_mfma_f32_32x32x16_bf16 v[60:75], v[28:31], a[64:67], v[60:75]
    ds_read_b128 v[20:23], v8 offset:51200
    s_waitcnt lgkmcnt(5)
    v_mfma_f32_32x32x16_bf16 v[60:75], v[32:35], a[68:71], v[60:75]
    ds_read_b128 v[24:27], v8 offset:52224
    s_waitcnt lgkmcnt(5)
    v_mfma_f32_32x32x16_bf16 v[60:75], v[36:39], a[72:75], v[60:75]
    ds_read_b128 v[28:31], v8 offset:53248
    s_waitcnt lgkmcnt(5)
    v_mfma_f32_32x32x16_bf16 v[60:75], v[40:43], a[76:79], v[60:75]
    ds_read_b128 v[32:35], v8 offset:54272
    s_waitcnt lgkmcnt(5)
    v_mfma_f32_32x32x16_bf16 v[60:75], v[12:15], a[80:83], v[60:75]
    ds_read_b128 v[36:39], v8 offset:55296
    s_waitcnt vmcnt(11)
    s_barrier
    s_waitcnt lgkmcnt(5)
    v_mfma_f32_32x32x16_bf16 v[60:75], v[16:19], a[84:87], v[60:75]
    ds_read_b128 v[40:43], v8 offset:56320
    s_add_u32 m0, s32, 57344
    s_add_u32 s28, s26, 172032
    buffer_load_dwordx4 v4, s[8:11], s28 offen offset:0 sc1 lds
    s_waitcnt lgkmcnt(5)
    v_mfma_f32_32x32x16_bf16 v[60:75], v[20:23], a[88:91], v[60:75]
    ds_read_b128 v[12:15], v7 offset:0
    s_waitcnt lgkmcnt(5)
    v_mfma_f32_32x32x16_bf16 v[60:75], v[24:27], a[92:95], v[60:75]
    ds_read_b128 v[16:19], v7 offset:1024
    buffer_load_dwordx4 v4, s[8:11], s28 offen offset:1024 sc1 lds
    s_waitcnt lgkmcnt(5)
    v_mfma_f32_32x32x16_bf16 v[60:75], v[28:31], a[96:99], v[60:75]
    ds_read_b128 v[20:23], v7 offset:2048
    s_waitcnt lgkmcnt(5)
    v_mfma_f32_32x32x16_bf16 v[60:75], v[32:35], a[100:103], v[60:75]
    ds_read_b128 v[24:27], v7 offset:3072
    buffer_load_dwordx4 v4, s[8:11], s28 offen offset:2048 sc1 lds
    s_waitcnt lgkmcnt(5)
    v_mfma_f32_32x32x16_bf16 v[60:75], v[36:39], a[104:107], v[60:75]
    ds_read_b128 v[28:31], v7 offset:4096
    s_waitcnt lgkmcnt(5)
    v_mfma_f32_32x32x16_bf16 v[60:75], v[40:43], a[108:111], v[60:75]
    ds_read_b128 v[32:35], v7 offset:5120
    buffer_load_dwordx4 v4, s[8:11], s28 offen offset:3072 sc1 lds
    s_waitcnt lgkmcnt(5)
    v_mfma_f32_32x32x16_bf16 v[44:59], v[12:15], a[0:3], 0
    ds_read_b128 v[36:39], v7 offset:6144
    s_waitcnt lgkmcnt(5)
    v_mfma_f32_32x32x16_bf16 v[44:59], v[16:19], a[4:7], v[44:59]
    ds_read_b128 v[40:43], v7 offset:7168
    s_add_u32 m0, s32, 61440
    s_add_u32 s28, s26, 176128
    buffer_load_dwordx4 v4, s[8:11], s28 offen offset:0 sc1 lds
    s_waitcnt lgkmcnt(5)
    v_mfma_f32_32x32x16_bf16 v[44:59], v[20:23], a[8:11], v[44:59]
    ds_read_b128 v[12:15], v7 offset:8192
    s_waitcnt lgkmcnt(5)
    v_mfma_f32_32x32x16_bf16 v[44:59], v[24:27], a[12:15], v[44:59]
    ds_read_b128 v[16:19], v7 offset:9216
    buffer_load_dwordx4 v4, s[8:11], s28 offen offset:1024 sc1 lds
    s_waitcnt lgkmcnt(5)
    v_mfma_f32_32x32x16_bf16 v[44:59], v[28:31], a[16:19], v[44:59]
    ds_read_b128 v[20:23], v7 offset:10240
    v_mul_f32 v60, s31, v60
    v_mul_f32 v61, s31, v61
    v_mul_f32 v62, s31, v62
    v_mul_f32 v63, s31, v63
    s_waitcnt lgkmcnt(5)
    v_mfma_f32_32x32x16_bf16 v[44:59], v[32:35], a[20:23], v[44:59]
    ds_read_b128 v[24:27], v7 offset:11264
    buffer_load_dwordx4 v4, s[8:11], s28 offen offset:2048 sc1 lds
    v_mul_f32 v64, s31, v64
    v_mul_f32 v65, s31, v65
    v_mul_f32 v66, s31, v66
    v_mul_f32 v67, s31, v67
    s_waitcnt lgkmcnt(5)
    v_mfma_f32_32x32x16_bf16 v[44:59], v[36:39], a[24:27], v[44:59]
    ds_read_b128 v[28:31], v7 offset:12288
    v_mul_f32 v68, s31, v68
    v_mul_f32 v69, s31, v69
    v_mul_f32 v70, s31, v70
    v_mul_f32 v71, s31, v71
    s_waitcnt lgkmcnt(5)
    v_mfma_f32_32x32x16_bf16 v[44:59], v[40:43], a[28:31], v[44:59]
    ds_read_b128 v[32:35], v7 offset:13312
    v_mul_f32 v72, s31, v72
    v_mul_f32 v73, s31, v73
    v_mul_f32 v74, s31, v74
    v_mul_f32 v75, s31, v75
    s_waitcnt lgkmcnt(5)
    v_mfma_f32_32x32x16_bf16 v[44:59], v[12:15], a[32:35], v[44:59]
    ds_read_b128 v[36:39], v7 offset:14336
    v_cvt_pk_bf16_f32 v76, v60, v61
    v_cvt_pk_bf16_f32 v77, v62, v63
    s_waitcnt lgkmcnt(5)
    v_mfma_f32_32x32x16_bf16 v[44:59], v[16:19], a[36:39], v[44:59]
    ds_read_b128 v[40:43], v7 offset:15360
    v_cvt_pk_bf16_f32 v78, v64, v65
    v_cvt_pk_bf16_f32 v79, v66, v67
    s_waitcnt lgkmcnt(5)
    v_mfma_f32_32x32x16_bf16 v[44:59], v[20:23], a[40:43], v[44:59]
    ds_read_b128 v[12:15], v7 offset:16384
    v_cvt_pk_bf16_f32 v80, v68, v69
    v_cvt_pk_bf16_f32 v81, v70, v71
    s_waitcnt lgkmcnt(5)
    v_mfma_f32_32x32x16_bf16 v[44:59], v[24:27], a[44:47], v[44:59]
    ds_read_b128 v[16:19], v7 offset:17408
    v_cvt_pk_bf16_f32 v82, v72, v73
    v_cvt_pk_bf16_f32 v83, v74, v75
    s_waitcnt lgkmcnt(5)
    v_mfma_f32_32x32x16_bf16 v[44:59], v[28:31], a[48:51], v[44:59]
    ds_read_b128 v[20:23], v7 offset:18432
    buffer_store_dwordx4 v[76:79], v2, s[8:11], s29 offen offset:0 sc1
    s_waitcnt lgkmcnt(5)
    v_mfma_f32_32x32x16_bf16 v[44:59], v[32:35], a[52:55], v[44:59]
    ds_read_b128 v[24:27], v7 offset:19456
    buffer_store_dwordx4 v[80:83], v2, s[8:11], s29 offen offset:1024 sc1
    s_waitcnt lgkmcnt(5)
    v_mfma_f32_32x32x16_bf16 v[44:59], v[36:39], a[56:59], v[44:59]
    ds_read_b128 v[28:31], v7 offset:20480
    s_add_u32 s29, s29, 131072
    s_waitcnt lgkmcnt(5)
    v_mfma_f32_32x32x16_bf16 v[44:59], v[40:43], a[60:63], v[44:59]
    ds_read_b128 v[32:35], v7 offset:21504
    s_waitcnt lgkmcnt(5)
    v_mfma_f32_32x32x16_bf16 v[44:59], v[12:15], a[64:67], v[44:59]
    ds_read_b128 v[36:39], v7 offset:22528
    s_waitcnt lgkmcnt(5)
    v_mfma_f32_32x32x16_bf16 v[44:59], v[16:19], a[68:71], v[44:59]
    ds_read_b128 v[40:43], v7 offset:23552
    s_waitcnt lgkmcnt(5)
    v_mfma_f32_32x32x16_bf16 v[44:59], v[20:23], a[72:75], v[44:59]
    ds_read_b128 v[12:15], v7 offset:24576
    s_waitcnt lgkmcnt(5)
    v_mfma_f32_32x32x16_bf16 v[44:59], v[24:27], a[76:79], v[44:59]
    ds_read_b128 v[16:19], v7 offset:25600
    s_waitcnt lgkmcnt(5)
    v_mfma_f32_32x32x16_bf16 v[44:59], v[28:31], a[80:83], v[44:59]
    ds_read_b128 v[20:23], v7 offset:26624
    s_waitcnt vmcnt(11)
    s_barrier
    s_waitcnt lgkmcnt(5)
    v_mfma_f32_32x32x16_bf16 v[44:59], v[32:35], a[84:87], v[44:59]
    ds_read_b128 v[24:27], v7 offset:27648
    s_add_u32 m0, s32, 86016
    s_add_u32 s28, s26, 200704
    buffer_load_dwordx4 v4, s[8:11], s28 offen offset:0 sc1 lds
    s_waitcnt lgkmcnt(5)
    v_mfma_f32_32x32x16_bf16 v[44:59], v[36:39], a[88:91], v[44:59]
    ds_read_b128 v[28:31], v7 offset:28672
    s_waitcnt lgkmcnt(5)
    v_mfma_f32_32x32x16_bf16 v[44:59], v[40:43], a[92:95], v[44:59]
    ds_read_b128 v[32:35], v7 offset:29696
    buffer_load_dwordx4 v4, s[8:11], s28 offen offset:1024 sc1 lds
    s_waitcnt lgkmcnt(5)
    v_mfma_f32_32x32x16_bf16 v[44:59], v[12:15], a[96:99], v[44:59]
    ds_read_b128 v[36:39], v7 offset:30720
    s_waitcnt lgkmcnt(5)
    v_mfma_f32_32x32x16_bf16 v[44:59], v[16:19], a[100:103], v[44:59]
    ds_read_b128 v[40:43], v7 offset:31744
    buffer_load_dwordx4 v4, s[8:11], s28 offen offset:2048 sc1 lds
    s_waitcnt lgkmcnt(5)
    v_mfma_f32_32x32x16_bf16 v[44:59], v[20:23], a[104:107], v[44:59]
    ds_read_b128 v[12:15], v7 offset:32768
    s_waitcnt lgkmcnt(5)
    v_mfma_f32_32x32x16_bf16 v[44:59], v[24:27], a[108:111], v[44:59]
    ds_read_b128 v[16:19], v7 offset:33792
    buffer_load_dwordx4 v4, s[8:11], s28 offen offset:3072 sc1 lds
    s_waitcnt lgkmcnt(5)
    v_mfma_f32_32x32x16_bf16 v[60:75], a[0:3], v[28:31], 0
    ds_read_b128 v[20:23], v7 offset:34816
    s_waitcnt lgkmcnt(5)
    v_mfma_f32_32x32x16_bf16 v[60:75], a[4:7], v[32:35], v[60:75]
    ds_read_b128 v[24:27], v7 offset:35840
    s_add_u32 m0, s32, 90112
    s_add_u32 s28, s26, 204800
    buffer_load_dwordx4 v4, s[8:11], s28 offen offset:0 sc1 lds
    s_waitcnt lgkmcnt(5)
    v_mfma_f32_32x32x16_bf16 v[60:75], a[8:11], v[36:39], v[60:75]
    ds_read_b128 v[28:31], v7 offset:36864
    s_waitcnt lgkmcnt(5)
    v_mfma_f32_32x32x16_bf16 v[60:75], a[12:15], v[40:43], v[60:75]
    ds_read_b128 v[32:35], v7 offset:37888
    buffer_load_dwordx4 v4, s[8:11], s28 offen offset:1024 sc1 lds
    s_waitcnt lgkmcnt(5)
    v_mfma_f32_32x32x16_bf16 v[60:75], a[16:19], v[12:15], v[60:75]
    ds_read_b128 v[36:39], v7 offset:38912
    v_cvt_pk_bf16_f32 v76, v44, v45
    v_cvt_pk_bf16_f32 v77, v46, v47
    s_waitcnt lgkmcnt(5)
    v_mfma_f32_32x32x16_bf16 v[60:75], a[20:23], v[16:19], v[60:75]
    ds_read_b128 v[40:43], v7 offset:39936
    buffer_load_dwordx4 v4, s[8:11], s28 offen offset:2048 sc1 lds
    v_cvt_pk_bf16_f32 v78, v48, v49
    v_cvt_pk_bf16_f32 v79, v50, v51
    s_waitcnt lgkmcnt(5)
    v_mfma_f32_32x32x16_bf16 v[60:75], a[24:27], v[20:23], v[60:75]
    ds_read_b128 v[12:15], v7 offset:40960
    v_cvt_pk_bf16_f32 v80, v52, v53
    v_cvt_pk_bf16_f32 v81, v54, v55
    s_waitcnt lgkmcnt(5)
    v_mfma_f32_32x32x16_bf16 v[60:75], a[28:31], v[24:27], v[60:75]
    ds_read_b128 v[16:19], v7 offset:41984
    v_cvt_pk_bf16_f32 v82, v56, v57
    v_cvt_pk_bf16_f32 v83, v58, v59
    s_waitcnt lgkmcnt(5)
    v_mfma_f32_32x32x16_bf16 v[60:75], a[32:35], v[28:31], v[60:75]
    ds_read_b128 v[20:23], v7 offset:43008
    buffer_store_dwordx4 v[76:79], v2, s[8:11], s30 offen offset:0 sc1
    s_waitcnt lgkmcnt(5)
    v_mfma_f32_32x32x16_bf16 v[60:75], a[36:39], v[32:35], v[60:75]
    ds_read_b128 v[24:27], v7 offset:44032
    buffer_store_dwordx4 v[80:83], v2, s[8:11], s30 offen offset:1024 sc1
    s_waitcnt lgkmcnt(5)
    v_mfma_f32_32x32x16_bf16 v[60:75], a[40:43], v[36:39], v[60:75]
    ds_read_b128 v[28:31], v7 offset:45056
    s_waitcnt lgkmcnt(5)
    v_mfma_f32_32x32x16_bf16 v[60:75], a[44:47], v[40:43], v[60:75]
    ds_read_b128 v[32:35], v7 offset:46080
    s_waitcnt lgkmcnt(5)
    v_mfma_f32_32x32x16_bf16 v[60:75], a[48:51], v[12:15], v[60:75]
    ds_read_b128 v[36:39], v7 offset:47104
    s_waitcnt lgkmcnt(5)
    v_mfma_f32_32x32x16_bf16 v[60:75], a[52:55], v[16:19], v[60:75]
    ds_read_b128 v[40:43], v7 offset:48128
    s_waitcnt lgkmcnt(5)
    v_mfma_f32_32x32x16_bf16 v[60:75], a[56:59], v[20:23], v[60:75]
    ds_read_b128 v[12:15], v7 offset:49152
    s_waitcnt lgkmcnt(5)
    v_mfma_f32_32x32x16_bf16 v[60:75], a[60:63], v[24:27], v[60:75]
    ds_read_b128 v[16:19], v7 offset:50176
    s_waitcnt lgkmcnt(5)
    v_mfma_f32_32x32x16_bf16 v[60:75], a[64:67], v[28:31], v[60:75]
    ds_read_b128 v[20:23], v7 offset:51200
    s_waitcnt lgkmcnt(5)
    v_mfma_f32_32x32x16_bf16 v[60:75], a[68:71], v[32:35], v[60:75]
    ds_read_b128 v[24:27], v7 offset:52224
    s_waitcnt lgkmcnt(5)
    v_mfma_f32_32x32x16_bf16 v[60:75], a[72:75], v[36:39], v[60:75]
    ds_read_b128 v[28:31], v7 offset:53248
    s_waitcnt lgkmcnt(5)
    v_mfma_f32_32x32x16_bf16 v[60:75], a[76:79], v[40:43], v[60:75]
    ds_read_b128 v[32:35], v7 offset:54272
    s_waitcnt lgkmcnt(5)
    v_mfma_f32_32x32x16_bf16 v[60:75], a[80:83], v[12:15], v[60:75]
    ds_read_b128 v[36:39], v7 offset:55296
    s_waitcnt vmcnt(11)
    s_barrier
    s_waitcnt lgkmcnt(5)
    v_mfma_f32_32x32x16_bf16 v[60:75], a[84:87], v[16:19], v[60:75]
    ds_read_b128 v[40:43], v7 offset:56320
    s_add_u32 m0, s32, 0
    s_add_u32 s28, s26, 229376
    buffer_load_dwordx4 v4, s[8:11], s28 offen offset:0 sc1 lds
    s_waitcnt lgkmcnt(5)
    v_mfma_f32_32x32x16_bf16 v[60:75], a[88:91], v[20:23], v[60:75]
    ds_read_b128 v[12:15], v8 offset:0
    s_waitcnt lgkmcnt(5)
    v_mfma_f32_32x32x16_bf16 v[60:75], a[92:95], v[24:27], v[60:75]
    ds_read_b128 v[16:19], v8 offset:1024
    buffer_load_dwordx4 v4, s[8:11], s28 offen offset:1024 sc1 lds
    s_waitcnt lgkmcnt(5)
    v_mfma_f32_32x32x16_bf16 v[60:75], a[96:99], v[28:31], v[60:75]
    ds_read_b128 v[20:23], v8 offset:2048
    s_waitcnt lgkmcnt(5)
    v_mfma_f32_32x32x16_bf16 v[60:75], a[100:103], v[32:35], v[60:75]
    ds_read_b128 v[24:27], v8 offset:3072
    buffer_load_dwordx4 v4, s[8:11], s28 offen offset:2048 sc1 lds
    s_waitcnt lgkmcnt(5)
    v_mfma_f32_32x32x16_bf16 v[60:75], a[104:107], v[36:39], v[60:75]
    ds_read_b128 v[28:31], v8 offset:4096
    s_waitcnt lgkmcnt(5)
    v_mfma_f32_32x32x16_bf16 v[60:75], a[108:111], v[40:43], v[60:75]
    ds_read_b128 v[32:35], v8 offset:5120
    buffer_load_dwordx4 v4, s[8:11], s28 offen offset:3072 sc1 lds
    s_waitcnt lgkmcnt(5)
    v_mfma_f32_32x32x16_bf16 v[44:59], v[12:15], a[0:3], 0
    ds_read_b128 v[36:39], v8 offset:6144
    s_waitcnt lgkmcnt(5)
    v_mfma_f32_32x32x16_bf16 v[44:59], v[16:19], a[4:7], v[44:59]
    ds_read_b128 v[40:43], v8 offset:7168
    s_add_u32 m0, s32, 4096
    s_add_u32 s28, s26, 233472
    buffer_load_dwordx4 v4, s[8:11], s28 offen offset:0 sc1 lds
    s_waitcnt lgkmcnt(5)
    v_mfma_f32_32x32x16_bf16 v[44:59], v[20:23], a[8:11], v[44:59]
    ds_read_b128 v[12:15], v8 offset:8192
    s_waitcnt lgkmcnt(5)
    v_mfma_f32_32x32x16_bf16 v[44:59], v[24:27], a[12:15], v[44:59]
    ds_read_b128 v[16:19], v8 offset:9216
    buffer_load_dwordx4 v4, s[8:11], s28 offen offset:1024 sc1 lds
    s_waitcnt lgkmcnt(5)
    v_mfma_f32_32x32x16_bf16 v[44:59], v[28:31], a[16:19], v[44:59]
    ds_read_b128 v[20:23], v8 offset:10240
    v_cvt_pk_bf16_f32 v76, v60, v61
    v_cvt_pk_bf16_f32 v77, v62, v63
    s_waitcnt lgkmcnt(5)
    v_mfma_f32_32x32x16_bf16 v[44:59], v[32:35], a[20:23], v[44:59]
    ds_read_b128 v[24:27], v8 offset:11264
    buffer_load_dwordx4 v4, s[8:11], s28 offen offset:2048 sc1 lds
    v_cvt_pk_bf16_f32 v78, v64, v65
    v_cvt_pk_bf16_f32 v79, v66, v67
    s_waitcnt lgkmcnt(5)
    v_mfma_f32_32x32x16_bf16 v[44:59], v[36:39], a[24:27], v[44:59]
    ds_read_b128 v[28:31], v8 offset:12288
    v_cvt_pk_bf16_f32 v80, v68, v69
    v_cvt_pk_bf16_f32 v81, v70, v71
    s_waitcnt lgkmcnt(5)
    v_mfma_f32_32x32x16_bf16 v[44:59], v[40:43], a[28:31], v[44:59]
    ds_read_b128 v[32:35], v8 offset:13312
    v_cvt_pk_bf16_f32 v82, v72, v73
    v_cvt_pk_bf16_f32 v83, v74, v75
    s_waitcnt lgkmcnt(5)
    v_mfma_f32_32x32x16_bf16 v[44:59], v[12:15], a[32:35], v[44:59]
    ds_read_b128 v[36:39], v8 offset:14336
    v_cndmask_b32 v76, v76, v84, s[34:35]
    v_cndmask_b32 v77, v77, v84, s[34:35]
    v_cndmask_b32 v78, v78, v84, s[34:35]
    v_cndmask_b32 v79, v79, v84, s[34:35]
    s_waitcnt lgkmcnt(5)
    v_mfma_f32_32x32x16_bf16 v[44:59], v[16:19], a[36:39], v[44:59]
    ds_read_b128 v[40:43], v8 offset:15360
    v_cndmask_b32 v80, v80, v84, s[34:35]
    v_cndmask_b32 v81, v81, v84, s[34:35]
    v_cndmask_b32 v82, v82, v84, s[34:35]
    v_cndmask_b32 v83, v83, v84, s[34:35]
    s_waitcnt lgkmcnt(5)
    v_mfma_f32_32x32x16_bf16 v[44:59], v[20:23], a[40:43], v[44:59]
    ds_read_b128 v[12:15], v8 offset:16384
    buffer_store_dwordx4 v[76:79], v2, s[8:11], s30 offen offset:2048 sc1
    s_waitcnt lgkmcnt(5)
    v_mfma_f32_32x32x16_bf16 v[44:59], v[24:27], a[44:47], v[44:59]
    ds_read_b128 v[16:19], v8 offset:17408
    buffer_store_dwordx4 v[80:83], v2, s[8:11], s30 offen offset:3072 sc1
    s_waitcnt lgkmcnt(5)
    v_mfma_f32_32x32x16_bf16 v[44:59], v[28:31], a[48:51], v[44:59]
    ds_read_b128 v[20:23], v8 offset:18432
    s_add_u32 s30, s30, 262144
    s_waitcnt lgkmcnt(5)
    v_mfma_f32_32x32x16_bf16 v[44:59], v[32:35], a[52:55], v[44:59]
    ds_read_b128 v[24:27], v8 offset:19456
    s_waitcnt lgkmcnt(5)
    v_mfma_f32_32x32x16_bf16 v[44:59], v[36:39], a[56:59], v[44:59]
    ds_read_b128 v[28:31], v8 offset:20480
    s_waitcnt lgkmcnt(5)
    v_mfma_f32_32x32x16_bf16 v[44:59], v[40:43], a[60:63], v[44:59]
    ds_read_b128 v[32:35], v8 offset:21504
    s_waitcnt lgkmcnt(5)
    v_mfma_f32_32x32x16_bf16 v[44:59], v[12:15], a[64:67], v[44:59]
    ds_read_b128 v[36:39], v8 offset:22528
    s_waitcnt lgkmcnt(5)
    v_mfma_f32_32x32x16_bf16 v[44:59], v[16:19], a[68:71], v[44:59]
    ds_read_b128 v[40:43], v8 offset:23552
    s_waitcnt lgkmcnt(5)
    v_mfma_f32_32x32x16_bf16 v[44:59], v[20:23], a[72:75], v[44:59]
    ds_read_b128 v[12:15], v8 offset:24576
    s_waitcnt lgkmcnt(5)
    v_mfma_f32_32x32x16_bf16 v[44:59], v[24:27], a[76:79], v[44:59]
    ds_read_b128 v[16:19], v8 offset:25600
    s_waitcnt lgkmcnt(5)
    v_mfma_f32_32x32x16_bf16 v[44:59], v[28:31], a[80:83], v[44:59]
    ds_read_b128 v[20:23], v8 offset:26624
    s_waitcnt vmcnt(11)
    s_barrier
    s_waitcnt lgkmcnt(5)
    v_mfma_f32_32x32x16_bf16 v[44:59], v[32:35], a[84:87], v[44:59]
    ds_read_b128 v[24:27], v8 offset:27648
    s_add_u32 m0, s32, 28672
    s_add_u32 s28, s26, 258048
    buffer_load_dwordx4 v4, s[8:11], s28 offen offset:0 sc1 lds
    s_waitcnt lgkmcnt(5)
    v_mfma_f32_32x32x16_bf16 v[44:59], v[36:39], a[88:91], v[44:59]
    ds_read_b128 v[28:31], v8 offset:28672
    s_waitcnt lgkmcnt(5)
    v_mfma_f32_32x32x16_bf16 v[44:59], v[40:43], a[92:95], v[44:59]
    ds_read_b128 v[32:35], v8 offset:29696
    buffer_load_dwordx4 v4, s[8:11], s28 offen offset:1024 sc1 lds
    s_waitcnt lgkmcnt(5)
    v_mfma_f32_32x32x16_bf16 v[44:59], v[12:15], a[96:99], v[44:59]
    ds_read_b128 v[36:39], v8 offset:30720
    s_waitcnt lgkmcnt(5)
    v_mfma_f32_32x32x16_bf16 v[44:59], v[16:19], a[100:103], v[44:59]
    ds_read_b128 v[40:43], v8 offset:31744
    buffer_load_dwordx4 v4, s[8:11], s28 offen offset:2048 sc1 lds
    s_waitcnt lgkmcnt(5)
    v_mfma_f32_32x32x16_bf16 v[44:59], v[20:23], a[104:107], v[44:59]
    ds_read_b128 v[12:15], v8 offset:32768
    s_waitcnt lgkmcnt(5)
    v_mfma_f32_32x32x16_bf16 v[44:59], v[24:27], a[108:111], v[44:59]
    ds_read_b128 v[16:19], v8 offset:33792
    buffer_load_dwordx4 v4, s[8:11], s28 offen offset:3072 sc1 lds
    s_waitcnt lgkmcnt(5)
    v_mfma_f32_32x32x16_bf16 v[60:75], v[28:31], a[0:3], 0
    ds_read_b128 v[20:23], v8 offset:34816
    s_waitcnt lgkmcnt(5)
    v_mfma_f32_32x32x16_bf16 v[60:75], v[32:35], a[4:7], v[60:75]
    ds_read_b128 v[24:27], v8 offset:35840
    s_add_u32 m0, s32, 32768
    s_add_u32 s28, s26, 262144
    buffer_load_dwordx4 v4, s[8:11], s28 offen offset:0 sc1 lds
    s_waitcnt lgkmcnt(5)
    v_mfma_f32_32x32x16_bf16 v[60:75], v[36:39], a[8:11], v[60:75]
    ds_read_b128 v[28:31], v8 offset:36864
    s_waitcnt lgkmcnt(5)
    v_mfma_f32_32x32x16_bf16 v[60:75], v[40:43], a[12:15], v[60:75]
    ds_read_b128 v[32:35], v8 offset:37888
    buffer_load_dwordx4 v4, s[8:11], s28 offen offset:1024 sc1 lds
    s_waitcnt lgkmcnt(5)
    v_mfma_f32_32x32x16_bf16 v[60:75], v[12:15], a[16:19], v[60:75]
    ds_read_b128 v[36:39], v8 offset:38912
    v_mul_f32 v44, s31, v44
    v_mul_f32 v45, s31, v45
    v_mul_f32 v46, s31, v46
    v_mul_f32 v47, s31, v47
    s_waitcnt lgkmcnt(5)
    v_mfma_f32_32x32x16_bf16 v[60:75], v[16:19], a[20:23], v[60:75]
    ds_read_b128 v[40:43], v8 offset:39936
    buffer_load_dwordx4 v4, s[8:11], s28 offen offset:2048 sc1 lds
    v_mul_f32 v48, s31, v48
    v_mul_f32 v49, s31, v49
    v_mul_f32 v50, s31, v50
    v_mul_f32 v51, s31, v51
    s_waitcnt lgkmcnt(5)
    v_mfma_f32_32x32x16_bf16 v[60:75], v[20:23], a[24:27], v[60:75]
    ds_read_b128 v[12:15], v8 offset:40960
    v_mul_f32 v52, s31, v52
    v_mul_f32 v53, s31, v53
    v_mul_f32 v54, s31, v54
    v_mul_f32 v55, s31, v55
    s_waitcnt lgkmcnt(5)
    v_mfma_f32_32x32x16_bf16 v[60:75], v[24:27], a[28:31], v[60:75]
    ds_read_b128 v[16:19], v8 offset:41984
    v_mul_f32 v56, s31, v56
    v_mul_f32 v57, s31, v57
    v_mul_f32 v58, s31, v58
    v_mul_f32 v59, s31, v59
    s_waitcnt lgkmcnt(5)
    v_mfma_f32_32x32x16_bf16 v[60:75], v[28:31], a[32:35], v[60:75]
    ds_read_b128 v[20:23], v8 offset:43008
    v_cvt_pk_bf16_f32 v76, v44, v45
    v_cvt_pk_bf16_f32 v77, v46, v47
    s_waitcnt lgkmcnt(5)
    v_mfma_f32_32x32x16_bf16 v[60:75], v[32:35], a[36:39], v[60:75]
    ds_read_b128 v[24:27], v8 offset:44032
    v_cvt_pk_bf16_f32 v78, v48, v49
    v_cvt_pk_bf16_f32 v79, v50, v51
    s_waitcnt lgkmcnt(5)
    v_mfma_f32_32x32x16_bf16 v[60:75], v[36:39], a[40:43], v[60:75]
    ds_read_b128 v[28:31], v8 offset:45056
    v_cvt_pk_bf16_f32 v80, v52, v53
    v_cvt_pk_bf16_f32 v81, v54, v55
    s_waitcnt lgkmcnt(5)
    v_mfma_f32_32x32x16_bf16 v[60:75], v[40:43], a[44:47], v[60:75]
    ds_read_b128 v[32:35], v8 offset:46080
    v_cvt_pk_bf16_f32 v82, v56, v57
    v_cvt_pk_bf16_f32 v83, v58, v59
    s_waitcnt lgkmcnt(5)
    v_mfma_f32_32x32x16_bf16 v[60:75], v[12:15], a[48:51], v[60:75]
    ds_read_b128 v[36:39], v8 offset:47104
    buffer_store_dwordx4 v[76:79], v2, s[8:11], s29 offen offset:0 sc1
    s_waitcnt lgkmcnt(5)
    v_mfma_f32_32x32x16_bf16 v[60:75], v[16:19], a[52:55], v[60:75]
    ds_read_b128 v[40:43], v8 offset:48128
    buffer_store_dwordx4 v[80:83], v2, s[8:11], s29 offen offset:1024 sc1
    s_waitcnt lgkmcnt(5)
    v_mfma_f32_32x32x16_bf16 v[60:75], v[20:23], a[56:59], v[60:75]
    ds_read_b128 v[12:15], v8 offset:49152
    s_add_u32 s29, s29, 131072
    s_waitcnt lgkmcnt(5)
    v_mfma_f32_32x32x16_bf16 v[60:75], v[24:27], a[60:63], v[60:75]
    ds_read_b128 v[16:19], v8 offset:50176
    s_waitcnt lgkmcnt(5)
    v_mfma_f32_32x32x16_bf16 v[60:75], v[28:31], a[64:67], v[60:75]
    ds_read_b128 v[20:23], v8 offset:51200
    s_waitcnt lgkmcnt(5)
    v_mfma_f32_32x32x16_bf16 v[60:75], v[32:35], a[68:71], v[60:75]
    ds_read_b128 v[24:27], v8 offset:52224
    s_waitcnt lgkmcnt(5)
    v_mfma_f32_32x32x16_bf16 v[60:75], v[36:39], a[72:75], v[60:75]
    ds_read_b128 v[28:31], v8 offset:53248
    s_waitcnt lgkmcnt(5)
    v_mfma_f32_32x32x16_bf16 v[60:75], v[40:43], a[76:79], v[60:75]
    ds_read_b128 v[32:35], v8 offset:54272
    s_waitcnt lgkmcnt(5)
    v_mfma_f32_32x32x16_bf16 v[60:75], v[12:15], a[80:83], v[60:75]
    ds_read_b128 v[36:39], v8 offset:55296
    s_waitcnt vmcnt(11)
    s_barrier
    s_waitcnt lgkmcnt(5)
    v_mfma_f32_32x32x16_bf16 v[60:75], v[16:19], a[84:87], v[60:75]
    ds_read_b128 v[40:43], v8 offset:56320
    s_add_u32 m0, s32, 57344
    s_add_u32 s28, s26, 286720
    buffer_load_dwordx4 v4, s[8:11], s28 offen offset:0 sc1 lds
    s_waitcnt lgkmcnt(5)
    v_mfma_f32_32x32x16_bf16 v[60:75], v[20:23], a[88:91], v[60:75]
    ds_read_b128 v[12:15], v7 offset:0
    s_waitcnt lgkmcnt(5)
    v_mfma_f32_32x32x16_bf16 v[60:75], v[24:27], a[92:95], v[60:75]
    ds_read_b128 v[16:19], v7 offset:1024
    buffer_load_dwordx4 v4, s[8:11], s28 offen offset:1024 sc1 lds
    s_waitcnt lgkmcnt(5)
    v_mfma_f32_32x32x16_bf16 v[60:75], v[28:31], a[96:99], v[60:75]
    ds_read_b128 v[20:23], v7 offset:2048
    s_waitcnt lgkmcnt(5)
    v_mfma_f32_32x32x16_bf16 v[60:75], v[32:35], a[100:103], v[60:75]
    ds_read_b128 v[24:27], v7 offset:3072
    buffer_load_dwordx4 v4, s[8:11], s28 offen offset:2048 sc1 lds
    s_waitcnt lgkmcnt(5)
    v_mfma_f32_32x32x16_bf16 v[60:75], v[36:39], a[104:107], v[60:75]
    ds_read_b128 v[28:31], v7 offset:4096
    s_waitcnt lgkmcnt(5)
    v_mfma_f32_32x32x16_bf16 v[60:75], v[40:43], a[108:111], v[60:75]
    ds_read_b128 v[32:35], v7 offset:5120
    buffer_load_dwordx4 v4, s[8:11], s28 offen offset:3072 sc1 lds
    s_waitcnt lgkmcnt(5)
    v_mfma_f32_32x32x16_bf16 v[44:59], a[0:3], v[12:15], 0
    ds_read_b128 v[36:39], v7 offset:6144
    s_waitcnt lgkmcnt(5)
    v_mfma_f32_32x32x16_bf16 v[44:59], a[4:7], v[16:19], v[44:59]
    ds_read_b128 v[40:43], v7 offset:7168
    s_add_u32 m0, s32, 61440
    s_add_u32 s28, s26, 290816
    buffer_load_dwordx4 v4, s[8:11], s28 offen offset:0 sc1 lds
    s_waitcnt lgkmcnt(5)
    v_mfma_f32_32x32x16_bf16 v[44:59], a[8:11], v[20:23], v[44:59]
    ds_read_b128 v[12:15], v7 offset:8192
    s_waitcnt lgkmcnt(5)
    v_mfma_f32_32x32x16_bf16 v[44:59], a[12:15], v[24:27], v[44:59]
    ds_read_b128 v[16:19], v7 offset:9216
    buffer_load_dwordx4 v4, s[8:11], s28 offen offset:1024 sc1 lds
    s_waitcnt lgkmcnt(5)
    v_mfma_f32_32x32x16_bf16 v[44:59], a[16:19], v[28:31], v[44:59]
    ds_read_b128 v[20:23], v7 offset:10240
    v_cvt_pk_bf16_f32 v76, v60, v61
    v_cvt_pk_bf16_f32 v77, v62, v63
    s_waitcnt lgkmcnt(5)
    v_mfma_f32_32x32x16_bf16 v[44:59], a[20:23], v[32:35], v[44:59]
    ds_read_b128 v[24:27], v7 offset:11264
    buffer_load_dwordx4 v4, s[8:11], s28 offen offset:2048 sc1 lds
    v_cvt_pk_bf16_f32 v78, v64, v65
    v_cvt_pk_bf16_f32 v79, v66, v67
    s_waitcnt lgkmcnt(5)
    v_mfma_f32_32x32x16_bf16 v[44:59], a[24:27], v[36:39], v[44:59]
    ds_read_b128 v[28:31], v7 offset:12288
    v_cvt_pk_bf16_f32 v80, v68, v69
    v_cvt_pk_bf16_f32 v81, v70, v71
    s_waitcnt lgkmcnt(5)
    v_mfma_f32_32x32x16_bf16 v[44:59], a[28:31], v[40:43], v[44:59]
    ds_read_b128 v[32:35], v7 offset:13312
    v_cvt_pk_bf16_f32 v82, v72, v73
    v_cvt_pk_bf16_f32 v83, v74, v75
    s_waitcnt lgkmcnt(5)
    v_mfma_f32_32x32x16_bf16 v[44:59], a[32:35], v[12:15], v[44:59]
    ds_read_b128 v[36:39], v7 offset:14336
    buffer_store_dwordx4 v[76:79], v2, s[8:11], s30 offen offset:0 sc1
    s_waitcnt lgkmcnt(5)
    v_mfma_f32_32x32x16_bf16 v[44:59], a[36:39], v[16:19], v[44:59]
    ds_read_b128 v[40:43], v7 offset:15360
    buffer_store_dwordx4 v[80:83], v2, s[8:11], s30 offen offset:1024 sc1
    s_waitcnt lgkmcnt(5)
    v_mfma_f32_32x32x16_bf16 v[44:59], a[40:43], v[20:23], v[44:59]
    ds_read_b128 v[12:15], v7 offset:16384
    s_waitcnt lgkmcnt(5)
    v_mfma_f32_32x32x16_bf16 v[44:59], a[44:47], v[24:27], v[44:59]
    ds_read_b128 v[16:19], v7 offset:17408
    s_waitcnt lgkmcnt(5)
    v_mfma_f32_32x32x16_bf16 v[44:59], a[48:51], v[28:31], v[44:59]
    ds_read_b128 v[20:23], v7 offset:18432
    s_waitcnt lgkmcnt(5)
    v_mfma_f32_32x32x16_bf16 v[44:59], a[52:55], v[32:35], v[44:59]
    ds_read_b128 v[24:27], v7 offset:19456
    s_waitcnt lgkmcnt(5)
    v_mfma_f32_32x32x16_bf16 v[44:59], a[56:59], v[36:39], v[44:59]
    ds_read_b128 v[28:31], v7 offset:20480
    s_waitcnt lgkmcnt(5)
    v_mfma_f32_32x32x16_bf16 v[44:59], a[60:63], v[40:43], v[44:59]
    ds_read_b128 v[32:35], v7 offset:21504
    s_waitcnt lgkmcnt(5)
    v_mfma_f32_32x32x16_bf16 v[44:59], a[64:67], v[12:15], v[44:59]
    ds_read_b128 v[36:39], v7 offset:22528
    s_waitcnt lgkmcnt(5)
    v_mfma_f32_32x32x16_bf16 v[44:59], a[68:71], v[16:19], v[44:59]
    ds_read_b128 v[40:43], v7 offset:23552
    s_waitcnt lgkmcnt(5)
    v_mfma_f32_32x32x16_bf16 v[44:59], a[72:75], v[20:23], v[44:59]
    ds_read_b128 v[12:15], v7 offset:24576
    s_waitcnt lgkmcnt(5)
    v_mfma_f32_32x32x16_bf16 v[44:59], a[76:79], v[24:27], v[44:59]
    ds_read_b128 v[16:19], v7 offset:25600
    s_waitcnt lgkmcnt(5)
    v_mfma_f32_32x32x16_bf16 v[44:59], a[80:83], v[28:31], v[44:59]
    ds_read_b128 v[20:23], v7 offset:26624
    s_waitcnt vmcnt(11)
    s_barrier
    s_waitcnt lgkmcnt(5)
    v_mfma_f32_32x32x16_bf16 v[44:59], a[84:87], v[32:35], v[44:59]
    ds_read_b128 v[24:27], v7 offset:27648
    s_add_u32 m0, s32, 86016
    s_add_u32 s28, s26, 315392
    buffer_load_dwordx4 v4, s[8:11], s28 offen offset:0 sc1 lds
    s_waitcnt lgkmcnt(5)
    v_mfma_f32_32x32x16_bf16 v[44:59], a[88:91], v[36:39], v[44:59]
    ds_read_b128 v[28:31], v7 offset:28672
    s_waitcnt lgkmcnt(5)
    v_mfma_f32_32x32x16_bf16 v[44:59], a[92:95], v[40:43], v[44:59]
    ds_read_b128 v[32:35], v7 offset:29696
    buffer_load_dwordx4 v4, s[8:11], s28 offen offset:1024 sc1 lds
    s_waitcnt lgkmcnt(5)
    v_mfma_f32_32x32x16_bf16 v[44:59], a[96:99], v[12:15], v[44:59]
    ds_read_b128 v[36:39], v7 offset:30720
    s_waitcnt lgkmcnt(5)
    v_mfma_f32_32x32x16_bf16 v[44:59], a[100:103], v[16:19], v[44:59]
    ds_read_b128 v[40:43], v7 offset:31744
    buffer_load_dwordx4 v4, s[8:11], s28 offen offset:2048 sc1 lds
    s_waitcnt lgkmcnt(5)
    v_mfma_f32_32x32x16_bf16 v[44:59], a[104:107], v[20:23], v[44:59]
    ds_read_b128 v[12:15], v7 offset:32768
    s_waitcnt lgkmcnt(5)
    v_mfma_f32_32x32x16_bf16 v[44:59], a[108:111], v[24:27], v[44:59]
    ds_read_b128 v[16:19], v7 offset:33792
    buffer_load_dwordx4 v4, s[8:11], s28 offen offset:3072 sc1 lds
    s_waitcnt lgkmcnt(5)
    v_mfma_f32_32x32x16_bf16 v[60:75], v[28:31], a[0:3], 0
    ds_read_b128 v[20:23], v7 offset:34816
    s_waitcnt lgkmcnt(5)
    v_mfma_f32_32x32x16_bf16 v[60:75], v[32:35], a[4:7], v[60:75]
    ds_read_b128 v[24:27], v7 offset:35840
    s_add_u32 m0, s32, 90112
    s_add_u32 s28, s26, 319488
    buffer_load_dwordx4 v4, s[8:11], s28 offen offset:0 sc1 lds
    s_waitcnt lgkmcnt(5)
    v_mfma_f32_32x32x16_bf16 v[60:75], v[36:39], a[8:11], v[60:75]
    ds_read_b128 v[28:31], v7 offset:36864
    s_waitcnt lgkmcnt(5)
    v_mfma_f32_32x32x16_bf16 v[60:75], v[40:43], a[12:15], v[60:75]
    ds_read_b128 v[32:35], v7 offset:37888
    buffer_load_dwordx4 v4, s[8:11], s28 offen offset:1024 sc1 lds
    s_waitcnt lgkmcnt(5)
    v_mfma_f32_32x32x16_bf16 v[60:75], v[12:15], a[16:19], v[60:75]
    ds_read_b128 v[36:39], v7 offset:38912
    v_cvt_pk_bf16_f32 v76, v44, v45
    v_cvt_pk_bf16_f32 v77, v46, v47
    s_waitcnt lgkmcnt(5)
    v_mfma_f32_32x32x16_bf16 v[60:75], v[16:19], a[20:23], v[60:75]
    ds_read_b128 v[40:43], v7 offset:39936
    buffer_load_dwordx4 v4, s[8:11], s28 offen offset:2048 sc1 lds
    v_cvt_pk_bf16_f32 v78, v48, v49
    v_cvt_pk_bf16_f32 v79, v50, v51
    s_waitcnt lgkmcnt(5)
    v_mfma_f32_32x32x16_bf16 v[60:75], v[20:23], a[24:27], v[60:75]
    ds_read_b128 v[12:15], v7 offset:40960
    v_cvt_pk_bf16_f32 v80, v52, v53
    v_cvt_pk_bf16_f32 v81, v54, v55
    s_waitcnt lgkmcnt(5)
    v_mfma_f32_32x32x16_bf16 v[60:75], v[24:27], a[28:31], v[60:75]
    ds_read_b128 v[16:19], v7 offset:41984
    v_cvt_pk_bf16_f32 v82, v56, v57
    v_cvt_pk_bf16_f32 v83, v58, v59
    s_waitcnt lgkmcnt(5)
    v_mfma_f32_32x32x16_bf16 v[60:75], v[28:31], a[32:35], v[60:75]
    ds_read_b128 v[20:23], v7 offset:43008
    v_cndmask_b32 v76, v76, v84, s[34:35]
    v_cndmask_b32 v77, v77, v84, s[34:35]
    v_cndmask_b32 v78, v78, v84, s[34:35]
    v_cndmask_b32 v79, v79, v84, s[34:35]
    s_waitcnt lgkmcnt(5)
    v_mfma_f32_32x32x16_bf16 v[60:75], v[32:35], a[36:39], v[60:75]
    ds_read_b128 v[24:27], v7 offset:44032
    v_cndmask_b32 v80, v80, v84, s[34:35]
    v_cndmask_b32 v81, v81, v84, s[34:35]
    v_cndmask_b32 v82, v82, v84, s[34:35]
    v_cndmask_b32 v83, v83, v84, s[34:35]
    s_waitcnt lgkmcnt(5)
    v_mfma_f32_32x32x16_bf16 v[60:75], v[36:39], a[40:43], v[60:75]
    ds_read_b128 v[28:31], v7 offset:45056
    buffer_store_dwordx4 v[76:79], v2, s[8:11], s30 offen offset:2048 sc1
    s_waitcnt lgkmcnt(5)
    v_mfma_f32_32x32x16_bf16 v[60:75], v[40:43], a[44:47], v[60:75]
    ds_read_b128 v[32:35], v7 offset:46080
    buffer_store_dwordx4 v[80:83], v2, s[8:11], s30 offen offset:3072 sc1
    s_waitcnt lgkmcnt(5)
    v_mfma_f32_32x32x16_bf16 v[60:75], v[12:15], a[48:51], v[60:75]
    ds_read_b128 v[36:39], v7 offset:47104
    s_add_u32 s30, s30, 262144
    s_waitcnt lgkmcnt(5)
    v_mfma_f32_32x32x16_bf16 v[60:75], v[16:19], a[52:55], v[60:75]
    ds_read_b128 v[40:43], v7 offset:48128
    s_waitcnt lgkmcnt(5)
    v_mfma_f32_32x32x16_bf16 v[60:75], v[20:23], a[56:59], v[60:75]
    ds_read_b128 v[12:15], v7 offset:49152
    s_waitcnt lgkmcnt(5)
    v_mfma_f32_32x32x16_bf16 v[60:75], v[24:27], a[60:63], v[60:75]
    ds_read_b128 v[16:19], v7 offset:50176
    s_waitcnt lgkmcnt(5)
    v_mfma_f32_32x32x16_bf16 v[60:75], v[28:31], a[64:67], v[60:75]
    ds_read_b128 v[20:23], v7 offset:51200
    s_waitcnt lgkmcnt(5)
    v_mfma_f32_32x32x16_bf16 v[60:75], v[32:35], a[68:71], v[60:75]
    ds_read_b128 v[24:27], v7 offset:52224
    s_waitcnt lgkmcnt(5)
    v_mfma_f32_32x32x16_bf16 v[60:75], v[36:39], a[72:75], v[60:75]
    ds_read_b128 v[28:31], v7 offset:53248
    s_waitcnt lgkmcnt(5)
    v_mfma_f32_32x32x16_bf16 v[60:75], v[40:43], a[76:79], v[60:75]
    ds_read_b128 v[32:35], v7 offset:54272
    s_waitcnt lgkmcnt(5)
    v_mfma_f32_32x32x16_bf16 v[60:75], v[12:15], a[80:83], v[60:75]
    ds_read_b128 v[36:39], v7 offset:55296
    s_waitcnt vmcnt(11)
    s_barrier
    s_waitcnt lgkmcnt(5)
    v_mfma_f32_32x32x16_bf16 v[60:75], v[16:19], a[84:87], v[60:75]
    ds_read_b128 v[40:43], v7 offset:56320
    s_waitcnt lgkmcnt(5)
    v_mfma_f32_32x32x16_bf16 v[60:75], v[20:23], a[88:91], v[60:75]
    ds_read_b128 v[12:15], v8 offset:0
    s_waitcnt lgkmcnt(5)
    v_mfma_f32_32x32x16_bf16 v[60:75], v[24:27], a[92:95], v[60:75]
    ds_read_b128 v[16:19], v8 offset:1024
    s_waitcnt lgkmcnt(5)
    v_mfma_f32_32x32x16_bf16 v[60:75], v[28:31], a[96:99], v[60:75]
    ds_read_b128 v[20:23], v8 offset:2048
    s_waitcnt lgkmcnt(5)
    v_mfma_f32_32x32x16_bf16 v[60:75], v[32:35], a[100:103], v[60:75]
    ds_read_b128 v[24:27], v8 offset:3072
    s_waitcnt lgkmcnt(5)
    v_mfma_f32_32x32x16_bf16 v[60:75], v[36:39], a[104:107], v[60:75]
    ds_read_b128 v[28:31], v8 offset:4096
    s_waitcnt lgkmcnt(5)
    v_mfma_f32_32x32x16_bf16 v[60:75], v[40:43], a[108:111], v[60:75]
    ds_read_b128 v[32:35], v8 offset:5120
    s_waitcnt lgkmcnt(5)
    v_mfma_f32_32x32x16_bf16 v[44:59], v[12:15], a[0:3], 0
    ds_read_b128 v[36:39], v8 offset:6144
    s_waitcnt lgkmcnt(5)
    v_mfma_f32_32x32x16_bf16 v[44:59], v[16:19], a[4:7], v[44:59]
    ds_read_b128 v[40:43], v8 offset:7168
    s_waitcnt lgkmcnt(5)
    v_mfma_f32_32x32x16_bf16 v[44:59], v[20:23], a[8:11], v[44:59]
    ds_read_b128 v[12:15], v8 offset:8192
    s_waitcnt lgkmcnt(5)
    v_mfma_f32_32x32x16_bf16 v[44:59], v[24:27], a[12:15], v[44:59]
    ds_read_b128 v[16:19], v8 offset:9216
    s_waitcnt lgkmcnt(5)
    v_mfma_f32_32x32x16_bf16 v[44:59], v[28:31], a[16:19], v[44:59]
    ds_read_b128 v[20:23], v8 offset:10240
    v_mul_f32 v60, s31, v60
    v_mul_f32 v61, s31, v61
    v_mul_f32 v62, s31, v62
    v_mul_f32 v63, s31, v63
    s_waitcnt lgkmcnt(5)
    v_mfma_f32_32x32x16_bf16 v[44:59], v[32:35], a[20:23], v[44:59]
    ds_read_b128 v[24:27], v8 offset:11264
    v_mul_f32 v64, s31, v64
    v_mul_f32 v65, s31, v65
    v_mul_f32 v66, s31, v66
    v_mul_f32 v67, s31, v67
    s_waitcnt lgkmcnt(5)
    v_mfma_f32_32x32x16_bf16 v[44:59], v[36:39], a[24:27], v[44:59]
    ds_read_b128 v[28:31], v8 offset:12288
    v_mul_f32 v68, s31, v68
    v_mul_f32 v69, s31, v69
    v_mul_f32 v70, s31, v70
    v_mul_f32 v71, s31, v71
    s_waitcnt lgkmcnt(5)
    v_mfma_f32_32x32x16_bf16 v[44:59], v[40:43], a[28:31], v[44:59]
    ds_read_b128 v[32:35], v8 offset:13312
    v_mul_f32 v72, s31, v72
    v_mul_f32 v73, s31, v73
    v_mul_f32 v74, s31, v74
    v_mul_f32 v75, s31, v75
    s_waitcnt lgkmcnt(5)
    v_mfma_f32_32x32x16_bf16 v[44:59], v[12:15], a[32:35], v[44:59]
    ds_read_b128 v[36:39], v8 offset:14336
    v_cvt_pk_bf16_f32 v76, v60, v61
    v_cvt_pk_bf16_f32 v77, v62, v63
    s_waitcnt lgkmcnt(5)
    v_mfma_f32_32x32x16_bf16 v[44:59], v[16:19], a[36:39], v[44:59]
    ds_read_b128 v[40:43], v8 offset:15360
    v_cvt_pk_bf16_f32 v78, v64, v65
    v_cvt_pk_bf16_f32 v79, v66, v67
    s_waitcnt lgkmcnt(5)
    v_mfma_f32_32x32x16_bf16 v[44:59], v[20:23], a[40:43], v[44:59]
    ds_read_b128 v[12:15], v8 offset:16384
    v_cvt_pk_bf16_f32 v80, v68, v69
    v_cvt_pk_bf16_f32 v81, v70, v71
    s_waitcnt lgkmcnt(5)
    v_mfma_f32_32x32x16_bf16 v[44:59], v[24:27], a[44:47], v[44:59]
    ds_read_b128 v[16:19], v8 offset:17408
    v_cvt_pk_bf16_f32 v82, v72, v73
    v_cvt_pk_bf16_f32 v83, v74, v75
    s_waitcnt lgkmcnt(5)
    v_mfma_f32_32x32x16_bf16 v[44:59], v[28:31], a[48:51], v[44:59]
    ds_read_b128 v[20:23], v8 offset:18432
    buffer_store_dwordx4 v[76:79], v2, s[8:11], s29 offen offset:0 sc1
    s_waitcnt lgkmcnt(5)
    v_mfma_f32_32x32x16_bf16 v[44:59], v[32:35], a[52:55], v[44:59]
    ds_read_b128 v[24:27], v8 offset:19456
    buffer_store_dwordx4 v[80:83], v2, s[8:11], s29 offen offset:1024 sc1
    s_waitcnt lgkmcnt(5)
    v_mfma_f32_32x32x16_bf16 v[44:59], v[36:39], a[56:59], v[44:59]
    ds_read_b128 v[28:31], v8 offset:20480
    s_add_u32 s29, s29, 131072
    s_waitcnt lgkmcnt(5)
    v_mfma_f32_32x32x16_bf16 v[44:59], v[40:43], a[60:63], v[44:59]
    ds_read_b128 v[32:35], v8 offset:21504
    s_waitcnt lgkmcnt(5)
    v_mfma_f32_32x32x16_bf16 v[44:59], v[12:15], a[64:67], v[44:59]
    ds_read_b128 v[36:39], v8 offset:22528
    s_waitcnt lgkmcnt(5)
    v_mfma_f32_32x32x16_bf16 v[44:59], v[16:19], a[68:71], v[44:59]
    ds_read_b128 v[40:43], v8 offset:23552
    s_waitcnt lgkmcnt(5)
    v_mfma_f32_32x32x16_bf16 v[44:59], v[20:23], a[72:75], v[44:59]
    ds_read_b128 v[12:15], v8 offset:24576
    s_waitcnt lgkmcnt(5)
    v_mfma_f32_32x32x16_bf16 v[44:59], v[24:27], a[76:79], v[44:59]
    ds_read_b128 v[16:19], v8 offset:25600
    s_waitcnt lgkmcnt(5)
    v_mfma_f32_32x32x16_bf16 v[44:59], v[28:31], a[80:83], v[44:59]
    ds_read_b128 v[20:23], v8 offset:26624
    s_waitcnt vmcnt(4)
    s_barrier
    s_waitcnt lgkmcnt(5)
    v_mfma_f32_32x32x16_bf16 v[44:59], v[32:35], a[84:87], v[44:59]
    ds_read_b128 v[24:27], v8 offset:27648
    s_waitcnt lgkmcnt(5)
    v_mfma_f32_32x32x16_bf16 v[44:59], v[36:39], a[88:91], v[44:59]
    ds_read_b128 v[28:31], v8 offset:28672
    s_waitcnt lgkmcnt(5)
    v_mfma_f32_32x32x16_bf16 v[44:59], v[40:43], a[92:95], v[44:59]
    ds_read_b128 v[32:35], v8 offset:29696
    s_waitcnt lgkmcnt(5)
    v_mfma_f32_32x32x16_bf16 v[44:59], v[12:15], a[96:99], v[44:59]
    ds_read_b128 v[36:39], v8 offset:30720
    s_waitcnt lgkmcnt(5)
    v_mfma_f32_32x32x16_bf16 v[44:59], v[16:19], a[100:103], v[44:59]
    ds_read_b128 v[40:43], v8 offset:31744
    s_waitcnt lgkmcnt(5)
    v_mfma_f32_32x32x16_bf16 v[44:59], v[20:23], a[104:107], v[44:59]
    ds_read_b128 v[12:15], v8 offset:32768
    s_waitcnt lgkmcnt(5)
    v_mfma_f32_32x32x16_bf16 v[44:59], v[24:27], a[108:111], v[44:59]
    ds_read_b128 v[16:19], v8 offset:33792
    s_waitcnt lgkmcnt(5)
    v_mfma_f32_32x32x16_bf16 v[60:75], a[0:3], v[28:31], 0
    ds_read_b128 v[20:23], v8 offset:34816
    s_waitcnt lgkmcnt(5)
    v_mfma_f32_32x32x16_bf16 v[60:75], a[4:7], v[32:35], v[60:75]
    ds_read_b128 v[24:27], v8 offset:35840
    s_waitcnt lgkmcnt(5)
    v_mfma_f32_32x32x16_bf16 v[60:75], a[8:11], v[36:39], v[60:75]
    ds_read_b128 v[28:31], v8 offset:36864
    s_waitcnt lgkmcnt(5)
    v_mfma_f32_32x32x16_bf16 v[60:75], a[12:15], v[40:43], v[60:75]
    ds_read_b128 v[32:35], v8 offset:37888
    s_waitcnt lgkmcnt(5)
    v_mfma_f32_32x32x16_bf16 v[60:75], a[16:19], v[12:15], v[60:75]
    ds_read_b128 v[36:39], v8 offset:38912
    v_cvt_pk_bf16_f32 v76, v44, v45
    v_cvt_pk_bf16_f32 v77, v46, v47
    s_waitcnt lgkmcnt(5)
    v_mfma_f32_32x32x16_bf16 v[60:75], a[20:23], v[16:19], v[60:75]
    ds_read_b128 v[40:43], v8 offset:39936
    v_cvt_pk_bf16_f32 v78, v48, v49
    v_cvt_pk_bf16_f32 v79, v50, v51
    s_waitcnt lgkmcnt(5)
    v_mfma_f32_32x32x16_bf16 v[60:75], a[24:27], v[20:23], v[60:75]
    ds_read_b128 v[12:15], v8 offset:40960
    v_cvt_pk_bf16_f32 v80, v52, v53
    v_cvt_pk_bf16_f32 v81, v54, v55
    s_waitcnt lgkmcnt(5)
    v_mfma_f32_32x32x16_bf16 v[60:75], a[28:31], v[24:27], v[60:75]
    ds_read_b128 v[16:19], v8 offset:41984
    v_cvt_pk_bf16_f32 v82, v56, v57
    v_cvt_pk_bf16_f32 v83, v58, v59
    s_waitcnt lgkmcnt(5)
    v_mfma_f32_32x32x16_bf16 v[60:75], a[32:35], v[28:31], v[60:75]
    ds_read_b128 v[20:23], v8 offset:43008
    buffer_store_dwordx4 v[76:79], v2, s[8:11], s30 offen offset:0 sc1
    s_waitcnt lgkmcnt(5)
    v_mfma_f32_32x32x16_bf16 v[60:75], a[36:39], v[32:35], v[60:75]
    ds_read_b128 v[24:27], v8 offset:44032
    buffer_store_dwordx4 v[80:83], v2, s[8:11], s30 offen offset:1024 sc1
    s_waitcnt lgkmcnt(5)
    v_mfma_f32_32x32x16_bf16 v[60:75], a[40:43], v[36:39], v[60:75]
    ds_read_b128 v[28:31], v8 offset:45056
    s_waitcnt lgkmcnt(5)
    v_mfma_f32_32x32x16_bf16 v[60:75], a[44:47], v[40:43], v[60:75]
    ds_read_b128 v[32:35], v8 offset:46080
    s_waitcnt lgkmcnt(5)
    v_mfma_f32_32x32x16_bf16 v[60:75], a[48:51], v[12:15], v[60:75]
    ds_read_b128 v[36:39], v8 offset:47104
    s_waitcnt lgkmcnt(5)
    v_mfma_f32_32x32x16_bf16 v[60:75], a[52:55], v[16:19], v[60:75]
    ds_read_b128 v[40:43], v8 offset:48128
    s_waitcnt lgkmcnt(5)
    v_mfma_f32_32x32x16_bf16 v[60:75], a[56:59], v[20:23], v[60:75]
    ds_read_b128 v[12:15], v8 offset:49152
    s_waitcnt lgkmcnt(5)
    v_mfma_f32_32x32x16_bf16 v[60:75], a[60:63], v[24:27], v[60:75]
    ds_read_b128 v[16:19], v8 offset:50176
    s_waitcnt lgkmcnt(5)
    v_mfma_f32_32x32x16_bf16 v[60:75], a[64:67], v[28:31], v[60:75]
    ds_read_b128 v[20:23], v8 offset:51200
    s_waitcnt lgkmcnt(5)
    v_mfma_f32_32x32x16_bf16 v[60:75], a[68:71], v[32:35], v[60:75]
    ds_read_b128 v[24:27], v8 offset:52224
    s_waitcnt lgkmcnt(5)
    v_mfma_f32_32x32x16_bf16 v[60:75], a[72:75], v[36:39], v[60:75]
    ds_read_b128 v[28:31], v8 offset:53248
    s_waitcnt lgkmcnt(5)
    v_mfma_f32_32x32x16_bf16 v[60:75], a[76:79], v[40:43], v[60:75]
    ds_read_b128 v[32:35], v8 offset:54272
    s_waitcnt lgkmcnt(5)
    v_mfma_f32_32x32x16_bf16 v[60:75], a[80:83], v[12:15], v[60:75]
    ds_read_b128 v[36:39], v8 offset:55296
    s_waitcnt lgkmcnt(5)
    v_mfma_f32_32x32x16_bf16 v[60:75], a[84:87], v[16:19], v[60:75]
    ds_read_b128 v[40:43], v8 offset:56320
    s_waitcnt lgkmcnt(5)
    v_mfma_f32_32x32x16_bf16 v[60:75], a[88:91], v[20:23], v[60:75]
    s_waitcnt lgkmcnt(4)
    v_mfma_f32_32x32x16_bf16 v[60:75], a[92:95], v[24:27], v[60:75]
    s_waitcnt lgkmcnt(3)
    v_mfma_f32_32x32x16_bf16 v[60:75], a[96:99], v[28:31], v[60:75]
    s_waitcnt lgkmcnt(2)
    v_mfma_f32_32x32x16_bf16 v[60:75], a[100:103], v[32:35], v[60:75]
    s_waitcnt lgkmcnt(1)
    v_mfma_f32_32x32x16_bf16 v[60:75], a[104:107], v[36:39], v[60:75]
    s_waitcnt lgkmcnt(0)
    v_mfma_f32_32x32x16_bf16 v[60:75], a[108:111], v[40:43], v[60:75]
    s_nop 11
    v_cvt_pk_bf16_f32 v76, v60, v61
    v_cvt_pk_bf16_f32 v77, v62, v63
    s_nop 0
    v_cvt_pk_bf16_f32 v78, v64, v65
    v_cvt_pk_bf16_f32 v79, v66, v67
    s_nop 0
    v_cvt_pk_bf16_f32 v80, v68, v69
    v_cvt_pk_bf16_f32 v81, v70, v71
    s_nop 0
    v_cvt_pk_bf16_f32 v82, v72, v73
    v_cvt_pk_bf16_f32 v83, v74, v75
    s_nop 0
    v_cndmask_b32 v76, v76, v84, s[34:35]
    v_cndmask_b32 v77, v77, v84, s[34:35]
    v_cndmask_b32 v78, v78, v84, s[34:35]
    v_cndmask_b32 v79, v79, v84, s[34:35]
    s_nop 0
    v_cndmask_b32 v80, v80, v84, s[34:35]
    v_cndmask_b32 v81, v81, v84, s[34:35]
    v_cndmask_b32 v82, v82, v84, s[34:35]
    v_cndmask_b32 v83, v83, v84, s[34:35]
    s_nop 0
    buffer_store_dwordx4 v[76:79], v2, s[8:11], s30 offen offset:2048 sc1
    s_nop 0
    buffer_store_dwordx4 v[80:83], v2, s[8:11], s30 offen offset:3072 sc1
    s_nop 0
    s_add_u32 s30, s30, 262144
    s_nop 0
    s_lshl_b32 s30, s24, 7
    s_add_u32 s30, s30, 18620416
    s_waitcnt vmcnt(0)
    s_barrier
    s_cmp_lg_u32 s21, 0
    s_cbranch_scc1 sig_57
    v_mov_b32 v3, 1
    s_mov_b64 exec, 1
    buffer_atomic_add v3, off, s[8:11], s30 sc1
    s_mov_b64 exec, -1
sig_57:
    s_branch main_next
job_3:
    s_lshl_b32 s33, s25, 2
    s_add_u32 s33, s33, s21
    s_lshr_b32 s36, s24, 4
    s_and_b32 s36, s36, s90
    s_and_b32 s24, s24, 15
    s_mul_i32 s26, s24, 401408
    s_add_u32 s26, s26, 0
    s_lshl_b32 s30, s33, 7
    s_add_u32 s31, s30, 18626560
    s_add_u32 s30, s30, 17629184
    v_and_b32 v117, 31, v0
    v_lshlrev_b32 v116, 2, v117
    s_mul_i32 s34, s33, 40960
    s_add_u32 s34, s34, 68157440
    s_lshl_b32 s35, s24, 9
    s_add_u32 s35, s35, s34
    s_add_u32 s35, s35, 32768
    s_lshl_b32 s29, s24, 11
    s_add_u32 s34, s34, s29
    v_lshrrev_b32 v120, 2, v2
    v_mov_b64 v[76:77], -1
    v_mov_b64 v[78:79], -1
    v_mov_b64 v[80:81], -1
    v_mov_b64 v[82:83], -1
    s_cmp_eq_u32 s36, 0
    s_cbranch_scc1 sp_58
    buffer_store_dwordx4 v[76:79], v2, s[8:11], s34 offen offset:0
    buffer_store_dwordx4 v[80:83], v2, s[8:11], s34 offen offset:1024
    buffer_store_dword v76, v120, s[8:11], s35 offen offset:0
    buffer_store_dword v76, v120, s[8:11], s35 offen offset:256
    s_branch sp_58e
sp_58:
    buffer_store_dwordx4 v[76:79], v2, s[8:11], s34 offen offset:0 sc1
    buffer_store_dwordx4 v[80:83], v2, s[8:11], s34 offen offset:1024 sc1
    buffer_store_dword v76, v120, s[8:11], s35 offen offset:0 sc1
    buffer_store_dword v76, v120, s[8:11], s35 offen offset:256 sc1
sp_58e:
    s_lshl_b32 s28, s24, 7
    s_add_u32 s28, s28, 18634752
    v_bfe_u32 v3, v0, 3, 3
    v_lshlrev_b32 v7, 7, v3
    v_bfe_u32 v3, v0, 1, 1
    v_lshl_add_u32 v7, v3, 6, v7
    v_bfe_u32 v3, v0, 2, 1
    v_lshl_add_u32 v7, v3, 5, v7
    v_bfe_u32 v3, v0, 0, 1
    v_lshl_add_u32 v7, v3, 4, v7
    s_mul_i32 s32, s21, 7168
    v_add_u32 v4, s32, v2
    v_add_u32 v8, 57344, v7
    s_mul_i32 s27, s33, 28672
    s_add_u32 s27, s27, 15728640
    s_lshr_b32 s3, s33, 2
    s_lshl_b32 s3, s3, 7
    s_add_u32 s3, s3, 18614272
    v_mov_b32 v6, s28
    v_writelane_b32 v6, s3, 0
    v_mov_b32 v12, 10922
    v_writelane_b32 v12, 2, 0
gw_59:
    buffer_load_dword v3, v6, s[8:11], 0 offen sc1
    s_waitcnt vmcnt(0)
    v_cmp_gt_u32 vcc, v12, v3
    s_cbranch_vccz gw_59k
    s_sleep 2
    s_sub_u32 s23, s23, 1
    s_cbranch_scc0 gw_59
    s_mov_b32 s23, 0
gw_59k:
    s_waitcnt vmcnt(0)
    v_mov_b32 v3, 1
    s_mov_b64 exec, 1
    buffer_atomic_add v3, off, s[8:11], s31 sc1
    s_mov_b64 exec, -1
sig_60:
    buffer_load_dword v116, v116, s[8:11], s30 offen sc1
    s_add_u32 m0, s32, 0
    s_add_u32 s28, s26, 0
    buffer_load_dwordx4 v4, s[8:11], s28 offen offset:0 sc1 lds
    buffer_load_dwordx4 v4, s[8:11], s28 offen offset:1024 sc1 lds
    buffer_load_dwordx4 v4, s[8:11], s28 offen offset:2048 sc1 lds
    buffer_load_dwordx4 v4, s[8:11], s28 offen offset:3072 sc1 lds
    s_add_u32 m0, s32, 4096
    s_add_u32 s28, s26, 4096
    buffer_load_dwordx4 v4, s[8:11], s28 offen offset:0 sc1 lds
    buffer_load_dwordx4 v4, s[8:11], s28 offen offset:1024 sc1 lds
    buffer_load_dwordx4 v4, s[8:11], s28 offen offset:2048 sc1 lds
    buffer_load_dwordx4 a[0:3], v2, s[8:11], s27 offen offset:0 sc1
    buffer_load_dwordx4 a[4:7], v2, s[8:11], s27 offen offset:1024 sc1
    buffer_load_dwordx4 a[8:11], v2, s[8:11], s27 offen offset:2048 sc1
    buffer_load_dwordx4 a[12:15], v2, s[8:11], s27 offen offset:3072 sc1
    s_add_u32 s27, s27, 4096
    buffer_load_dwordx4 a[16:19], v2, s[8:11], s27 offen offset:0 sc1
    buffer_load_dwordx4 a[20:23], v2, s[8:11], s27 offen offset:1024 sc1
    buffer_load_dwordx4 a[24:27], v2, s[8:11], s27 offen offset:2048 sc1
    buffer_load_dwordx4 a[28:31], v2, s[8:11], s27 offen offset:3072 sc1
    s_add_u32 s27, s27, 4096
    buffer_load_dwordx4 a[32:35], v2, s[8:11], s27 offen offset:0 sc1
    buffer_load_dwordx4 a[36:39], v2, s[8:11], s27 offen offset:1024 sc1
    buffer_load_dwordx4 a[40:43], v2, s[8:11], s27 offen offset:2048 sc1
    buffer_load_dwordx4 a[44:47], v2, s[8:11], s27 offen offset:3072 sc1
    s_add_u32 s27, s27, 4096
    buffer_load_dwordx4 a[48:51], v2, s[8:11], s27 offen offset:0 sc1
    buffer_load_dwordx4 a[52:55], v2, s[8:11], s27 offen offset:1024 sc1
    buffer_load_dwordx4 a[56:59], v2, s[8:11], s27 offen offset:2048 sc1
    buffer_load_dwordx4 a[60:63], v2, s[8:11], s27 offen offset:3072 sc1
    s_add_u32 s27, s27, 4096
    buffer_load_dwordx4 a[64:67], v2, s[8:11], s27 offen offset:0 sc1
    buffer_load_dwordx4 a[68:71], v2, s[8:11], s27 offen offset:1024 sc1
    buffer_load_dwordx4 a[72:75], v2, s[8:11], s27 offen offset:2048 sc1
    buffer_load_dwordx4 a[76:79], v2, s[8:11], s27 offen offset:3072 sc1
    s_add_u32 s27, s27, 4096
    buffer_load_dwordx4 a[80:83], v2, s[8:11], s27 offen offset:0 sc1
    buffer_load_dwordx4 a[84:87], v2, s[8:11], s27 offen offset:1024 sc1
    buffer_load_dwordx4 a[88:91], v2, s[8:11], s27 offen offset:2048 sc1
    buffer_load_dwordx4 a[92:95], v2, s[8:11], s27 offen offset:3072 sc1
    s_add_u32 s27, s27, 4096
    buffer_load_dwordx4 a[96:99], v2, s[8:11], s27 offen offset:0 sc1
    buffer_load_dwordx4 a[100:103], v2, s[8:11], s27 offen offset:1024 sc1
    buffer_load_dwordx4 a[104:107], v2, s[8:11], s27 offen offset:2048 sc1
    buffer_load_dwordx4 a[108:111], v2, s[8:11], s27 offen offset:3072 sc1
    s_add_u32 m0, s32, 28672
    s_add_u32 s28, s26, 28672
    buffer_load_dwordx4 v4, s[8:11], s28 offen offset:0 sc1 lds
    buffer_load_dwordx4 v4, s[8:11], s28 offen offset:1024 sc1 lds
    buffer_load_dwordx4 v4, s[8:11], s28 offen offset:2048 sc1 lds
    buffer_load_dwordx4 v4, s[8:11], s28 offen offset:3072 sc1 lds
    s_add_u32 m0, s32, 32768
    s_add_u32 s28, s26, 32768
    buffer_load_dwordx4 v4, s[8:11], s28 offen offset:0 sc1 lds
    buffer_load_dwordx4 v4, s[8:11], s28 offen offset:1024 sc1 lds
    buffer_load_dwordx4 v4, s[8:11], s28 offen offset:2048 sc1 lds
    s_waitcnt vmcnt(7)
    s_barrier
    ds_read_b128 v[12:15], v7 offset:0
    ds_read_b128 v[16:19], v7 offset:1024
    ds_read_b128 v[20:23], v7 offset:2048
    ds_read_b128 v[24:27], v7 offset:3072
    ds_read_b128 v[28:31], v7 offset:4096
    ds_read_b128 v[32:35], v7 offset:5120
    s_waitcnt lgkmcnt(5)
    v_mfma_f32_32x32x16_bf16 v[44:59], v[12:15], a[0:3], 0
    ds_read_b128 v[36:39], v7 offset:6144
    s_add_u32 m0, s32, 57344
    s_add_u32 s28, s26, 57344
    buffer_load_dwordx4 v4, s[8:11], s28 offen offset:0 sc1 lds
    s_waitcnt lgkmcnt(5)
    v_mfma_f32_32x32x16_bf16 v[44:59], v[16:19], a[4:7], v[44:59]
    ds_read_b128 v[40:43], v7 offset:7168
    s_waitcnt lgkmcnt(5)
    v_mfma_f32_32x32x16_bf16 v[44:59], v[20:23], a[8:11], v[44:59]
    ds_read_b128 v[12:15], v7 offset:8192
    buffer_load_dwordx4 v4, s[8:11], s28 offen offset:1024 sc1 lds
    s_waitcnt lgkmcnt(5)
    v_mfma_f32_32x32x16_bf16 v[44:59], v[24:27], a[12:15], v[44:59]
    ds_read_b128 v[16:19], v7 offset:9216
    s_waitcnt lgkmcnt(5)
    v_mfma_f32_32x32x16_bf16 v[44:59], v[28:31], a[16:19], v[44:59]
    ds_read_b128 v[20:23], v7 offset:10240
    buffer_load_dwordx4 v4, s[8:11], s28 offen offset:2048 sc1 lds
    s_waitcnt lgkmcnt(5)
    v_mfma_f32_32x32x16_bf16 v[44:59], v[32:35], a[20:23], v[44:59]
    ds_read_b128 v[24:27], v7 offset:11264
    s_waitcnt lgkmcnt(5)
    v_mfma_f32_32x32x16_bf16 v[44:59], v[36:39], a[24:27], v[44:59]
    ds_read_b128 v[28:31], v7 offset:12288
    buffer_load_dwordx4 v4, s[8:11], s28 offen offset:3072 sc1 lds
    s_waitcnt lgkmcnt(5)
    v_mfma_f32_32x32x16_bf16 v[44:59], v[40:43], a[28:31], v[44:59]
    ds_read_b128 v[32:35], v7 offset:13312
    s_waitcnt lgkmcnt(5)
    v_mfma_f32_32x32x16_bf16 v[44:59], v[12:15], a[32:35], v[44:59]
    ds_read_b128 v[36:39], v7 offset:14336
    s_add_u32 m0, s32, 61440
    s_add_u32 s28, s26, 61440
    buffer_load_dwordx4 v4, s[8:11], s28 offen offset:0 sc1 lds
    s_waitcnt lgkmcnt(5)
    v_mfma_f32_32x32x16_bf16 v[44:59], v[16:19], a[36:39], v[44:59]
    ds_read_b128 v[40:43], v7 offset:15360
    s_waitcnt lgkmcnt(5)
    v_mfma_f32_32x32x16_bf16 v[44:59], v[20:23], a[40:43], v[44:59]
    ds_read_b128 v[12:15], v7 offset:16384
    buffer_load_dwordx4 v4, s[8:11], s28 offen offset:1024 sc1 lds
    s_waitcnt lgkmcnt(5)
    v_mfma_f32_32x32x16_bf16 v[44:59], v[24:27], a[44:47], v[44:59]
    ds_read_b128 v[16:19], v7 offset:17408
    s_waitcnt lgkmcnt(5)
    v_mfma_f32_32x32x16_bf16 v[44:59], v[28:31], a[48:51], v[44:59]
    ds_read_b128 v[20:23], v7 offset:18432
    buffer_load_dwordx4 v4, s[8:11], s28 offen offset:2048 sc1 lds
    s_waitcnt lgkmcnt(5)
    v_mfma_f32_32x32x16_bf16 v[44:59], v[32:35], a[52:55], v[44:59]
    ds_read_b128 v[24:27], v7 offset:19456
    s_waitcnt lgkmcnt(5)
    v_mfma_f32_32x32x16_bf16 v[44:59], v[36:39], a[56:59], v[44:59]
    ds_read_b128 v[28:31], v7 offset:20480
    s_waitcnt lgkmcnt(5)
    v_mfma_f32_32x32x16_bf16 v[44:59], v[40:43], a[60:63], v[44:59]
    ds_read_b128 v[32:35], v7 offset:21504
    s_waitcnt lgkmcnt(5)
    v_mfma_f32_32x32x16_bf16 v[44:59], v[12:15], a[64:67], v[44:59]
    ds_read_b128 v[36:39], v7 offset:22528
    s_waitcnt lgkmcnt(5)
    v_mfma_f32_32x32x16_bf16 v[44:59], v[16:19], a[68:71], v[44:59]
    ds_read_b128 v[40:43], v7 offset:23552
    s_waitcnt lgkmcnt(5)
    v_mfma_f32_32x32x16_bf16 v[44:59], v[20:23], a[72:75], v[44:59]
    ds_read_b128 v[12:15], v7 offset:24576
    s_waitcnt lgkmcnt(5)
    v_mfma_f32_32x32x16_bf16 v[44:59], v[24:27], a[76:79], v[44:59]
    ds_read_b128 v[16:19], v7 offset:25600
    s_waitcnt lgkmcnt(5)
    v_mfma_f32_32x32x16_bf16 v[44:59], v[28:31], a[80:83], v[44:59]
    ds_read_b128 v[20:23], v7 offset:26624
    s_waitcnt vmcnt(7)
    s_barrier
    s_waitcnt lgkmcnt(5)
    v_mfma_f32_32x32x16_bf16 v[44:59], v[32:35], a[84:87], v[44:59]
    ds_read_b128 v[24:27], v7 offset:27648
    s_add_u32 m0, s32, 86016
    s_add_u32 s28, s26, 86016
    buffer_load_dwordx4 v4, s[8:11], s28 offen offset:0 sc1 lds
    s_waitcnt lgkmcnt(5)
    v_mfma_f32_32x32x16_bf16 v[44:59], v[36:39], a[88:91], v[44:59]
    ds_read_b128 v[28:31], v7 offset:28672
    s_waitcnt lgkmcnt(5)
    v_mfma_f32_32x32x16_bf16 v[44:59], v[40:43], a[92:95], v[44:59]
    ds_read_b128 v[32:35], v7 offset:29696
    buffer_load_dwordx4 v4, s[8:11], s28 offen offset:1024 sc1 lds
    s_waitcnt lgkmcnt(5)
    v_mfma_f32_32x32x16_bf16 v[44:59], v[12:15], a[96:99], v[44:59]
    ds_read_b128 v[36:39], v7 offset:30720
    s_waitcnt lgkmcnt(5)
    v_mfma_f32_32x32x16_bf16 v[44:59], v[16:19], a[100:103], v[44:59]
    ds_read_b128 v[40:43], v7 offset:31744
    buffer_load_dwordx4 v4, s[8:11], s28 offen offset:2048 sc1 lds
    s_waitcnt lgkmcnt(5)
    v_mfma_f32_32x32x16_bf16 v[44:59], v[20:23], a[104:107], v[44:59]
    ds_read_b128 v[12:15], v7 offset:32768
    s_waitcnt lgkmcnt(5)
    v_mfma_f32_32x32x16_bf16 v[44:59], v[24:27], a[108:111], v[44:59]
    ds_read_b128 v[16:19], v7 offset:33792
    buffer_load_dwordx4 v4, s[8:11], s28 offen offset:3072 sc1 lds
    s_waitcnt lgkmcnt(5)
    v_mfma_f32_32x32x16_bf16 v[60:75], v[28:31], a[0:3], 0
    ds_read_b128 v[20:23], v7 offset:34816
    s_waitcnt lgkmcnt(5)
    v_mfma_f32_32x32x16_bf16 v[60:75], v[32:35], a[4:7], v[60:75]
    ds_read_b128 v[24:27], v7 offset:35840
    s_add_u32 m0, s32, 90112
    s_add_u32 s28, s26, 90112
    buffer_load_dwordx4 v4, s[8:11], s28 offen offset:0 sc1 lds
    s_waitcnt lgkmcnt(5)
    v_mfma_f32_32x32x16_bf16 v[60:75], v[36:39], a[8:11], v[60:75]
    ds_read_b128 v[28:31], v7 offset:36864
    s_waitcnt lgkmcnt(5)
    v_mfma_f32_32x32x16_bf16 v[60:75], v[40:43], a[12:15], v[60:75]
    ds_read_b128 v[32:35], v7 offset:37888
    buffer_load_dwordx4 v4, s[8:11], s28 offen offset:1024 sc1 lds
    s_waitcnt lgkmcnt(5)
    v_mfma_f32_32x32x16_bf16 v[60:75], v[12:15], a[16:19], v[60:75]
    ds_read_b128 v[36:39], v7 offset:38912
    v_cvt_pk_bf16_f32 v144, v44, v45
    v_cvt_pk_bf16_f32 v145, v46, v47
    s_waitcnt lgkmcnt(5)
    v_mfma_f32_32x32x16_bf16 v[60:75], v[16:19], a[20:23], v[60:75]
    ds_read_b128 v[40:43], v7 offset:39936
    buffer_load_dwordx4 v4, s[8:11], s28 offen offset:2048 sc1 lds
    v_cvt_pk_bf16_f32 v146, v48, v49
    v_cvt_pk_bf16_f32 v147, v50, v51
    s_waitcnt lgkmcnt(5)
    v_mfma_f32_32x32x16_bf16 v[60:75], v[20:23], a[24:27], v[60:75]
    ds_read_b128 v[12:15], v7 offset:40960
    v_cvt_pk_bf16_f32 v148, v52, v53
    v_cvt_pk_bf16_f32 v149, v54, v55
    s_waitcnt lgkmcnt(5)
    v_mfma_f32_32x32x16_bf16 v[60:75], v[24:27], a[28:31], v[60:75]
    ds_read_b128 v[16:19], v7 offset:41984
    v_cvt_pk_bf16_f32 v150, v56, v57
    v_cvt_pk_bf16_f32 v151, v58, v59
    s_waitcnt lgkmcnt(5)
    v_mfma_f32_32x32x16_bf16 v[60:75], v[28:31], a[32:35], v[60:75]
    ds_read_b128 v[20:23], v7 offset:43008
    s_nop 0
    s_waitcnt lgkmcnt(5)
    v_mfma_f32_32x32x16_bf16 v[60:75], v[32:35], a[36:39], v[60:75]
    ds_read_b128 v[24:27], v7 offset:44032
    v_mfma_f32_32x32x16_bf16 v[84:99], a[0:3], v[144:147], 0
    s_waitcnt lgkmcnt(5)
    v_mfma_f32_32x32x16_bf16 v[60:75], v[36:39], a[40:43], v[60:75]
    ds_read_b128 v[28:31], v7 offset:45056
    v_mfma_f32_32x32x16_bf16 v[84:99], a[4:7], v[148:151], v[84:99]
    s_waitcnt lgkmcnt(5)
    v_mfma_f32_32x32x16_bf16 v[60:75], v[40:43], a[44:47], v[60:75]
    ds_read_b128 v[32:35], v7 offset:46080
    s_waitcnt lgkmcnt(5)
    v_mfma_f32_32x32x16_bf16 v[60:75], v[12:15], a[48:51], v[60:75]
    ds_read_b128 v[36:39], v7 offset:47104
    s_waitcnt lgkmcnt(5)
    v_mfma_f32_32x32x16_bf16 v[60:75], v[16:19], a[52:55], v[60:75]
    ds_read_b128 v[40:43], v7 offset:48128
    s_waitcnt lgkmcnt(5)
    v_mfma_f32_32x32x16_bf16 v[60:75], v[20:23], a[56:59], v[60:75]
    ds_read_b128 v[12:15], v7 offset:49152
    s_waitcnt lgkmcnt(5)
    v_mfma_f32_32x32x16_bf16 v[60:75], v[24:27], a[60:63], v[60:75]
    ds_read_b128 v[16:19], v7 offset:50176
    s_waitcnt lgkmcnt(5)
    v_mfma_f32_32x32x16_bf16 v[60:75], v[28:31], a[64:67], v[60:75]
    ds_read_b128 v[20:23], v7 offset:51200
    s_waitcnt lgkmcnt(5)
    v_mfma_f32_32x32x16_bf16 v[60:75], v[32:35], a[68:71], v[60:75]
    ds_read_b128 v[24:27], v7 offset:52224
    s_waitcnt lgkmcnt(5)
    v_mfma_f32_32x32x16_bf16 v[60:75], v[36:39], a[72:75], v[60:75]
    ds_read_b128 v[28:31], v7 offset:53248
    s_waitcnt lgkmcnt(5)
    v_mfma_f32_32x32x16_bf16 v[60:75], v[40:43], a[76:79], v[60:75]
    ds_read_b128 v[32:35], v7 offset:54272
    s_waitcnt lgkmcnt(5)
    v_mfma_f32_32x32x16_bf16 v[60:75], v[12:15], a[80:83], v[60:75]
    ds_read_b128 v[36:39], v7 offset:55296
    s_waitcnt vmcnt(7)
    s_barrier
    s_waitcnt lgkmcnt(5)
    v_mfma_f32_32x32x16_bf16 v[60:75], v[16:19], a[84:87], v[60:75]
    ds_read_b128 v[40:43], v7 offset:56320
    s_add_u32 m0, s32, 0
    s_add_u32 s28, s26, 114688
    buffer_load_dwordx4 v4, s[8:11], s28 offen offset:0 sc1 lds
    s_waitcnt lgkmcnt(5)
    v_mfma_f32_32x32x16_bf16 v[60:75], v[20:23], a[88:91], v[60:75]
    ds_read_b128 v[12:15], v8 offset:0
    s_waitcnt lgkmcnt(5)
    v_mfma_f32_32x32x16_bf16 v[60:75], v[24:27], a[92:95], v[60:75]
    ds_read_b128 v[16:19], v8 offset:1024
    buffer_load_dwordx4 v4, s[8:11], s28 offen offset:1024 sc1 lds
    s_waitcnt lgkmcnt(5)
    v_mfma_f32_32x32x16_bf16 v[60:75], v[28:31], a[96:99], v[60:75]
    ds_read_b128 v[20:23], v8 offset:2048
    s_waitcnt lgkmcnt(5)
    v_mfma_f32_32x32x16_bf16 v[60:75], v[32:35], a[100:103], v[60:75]
    ds_read_b128 v[24:27], v8 offset:3072
    buffer_load_dwordx4 v4, s[8:11], s28 offen offset:2048 sc1 lds
    s_waitcnt lgkmcnt(5)
    v_mfma_f32_32x32x16_bf16 v[60:75], v[36:39], a[104:107], v[60:75]
    ds_read_b128 v[28:31], v8 offset:4096
    s_waitcnt lgkmcnt(5)
    v_mfma_f32_32x32x16_bf16 v[60:75], v[40:43], a[108:111], v[60:75]
    ds_read_b128 v[32:35], v8 offset:5120
    buffer_load_dwordx4 v4, s[8:11], s28 offen offset:3072 sc1 lds
    s_waitcnt lgkmcnt(5)
    v_mfma_f32_32x32x16_bf16 v[44:59], v[12:15], a[0:3], 0
    ds_read_b128 v[36:39], v8 offset:6144
    s_waitcnt lgkmcnt(5)
    v_mfma_f32_32x32x16_bf16 v[44:59], v[16:19], a[4:7], v[44:59]
    ds_read_b128 v[40:43], v8 offset:7168
    s_add_u32 m0, s32, 4096
    s_add_u32 s28, s26, 118784
    buffer_load_dwordx4 v4, s[8:11], s28 offen offset:0 sc1 lds
    s_waitcnt lgkmcnt(5)
    v_mfma_f32_32x32x16_bf16 v[44:59], v[20:23], a[8:11], v[44:59]
    ds_read_b128 v[12:15], v8 offset:8192
    s_waitcnt lgkmcnt(5)
    v_mfma_f32_32x32x16_bf16 v[44:59], v[24:27], a[12:15], v[44:59]
    ds_read_b128 v[16:19], v8 offset:9216
    buffer_load_dwordx4 v4, s[8:11], s28 offen offset:1024 sc1 lds
    s_waitcnt lgkmcnt(5)
    v_mfma_f32_32x32x16_bf16 v[44:59], v[28:31], a[16:19], v[44:59]
    ds_read_b128 v[20:23], v8 offset:10240
    v_cvt_pk_bf16_f32 v152, v60, v61
    v_cvt_pk_bf16_f32 v153, v62, v63
    s_waitcnt lgkmcnt(5)
    v_mfma_f32_32x32x16_bf16 v[44:59], v[32:35], a[20:23], v[44:59]
    ds_read_b128 v[24:27], v8 offset:11264
    buffer_load_dwordx4 v4, s[8:11], s28 offen offset:2048 sc1 lds
    v_cvt_pk_bf16_f32 v154, v64, v65
    v_cvt_pk_bf16_f32 v155, v66, v67
    s_waitcnt lgkmcnt(5)
    v_mfma_f32_32x32x16_bf16 v[44:59], v[36:39], a[24:27], v[44:59]
    ds_read_b128 v[28:31], v8 offset:12288
    v_cvt_pk_bf16_f32 v156, v68, v69
    v_cvt_pk_bf16_f32 v157, v70, v71
    s_waitcnt lgkmcnt(5)
    v_mfma_f32_32x32x16_bf16 v[44:59], v[40:43], a[28:31], v[44:59]
    ds_read_b128 v[32:35], v8 offset:13312
    v_cvt_pk_bf16_f32 v158, v72, v73
    v_cvt_pk_bf16_f32 v159, v74, v75
    s_waitcnt lgkmcnt(5)
    v_mfma_f32_32x32x16_bf16 v[44:59], v[12:15], a[32:35], v[44:59]
    ds_read_b128 v[36:39], v8 offset:14336
    s_nop 0
    s_waitcnt lgkmcnt(5)
    v_mfma_f32_32x32x16_bf16 v[44:59], v[16:19], a[36:39], v[44:59]
    ds_read_b128 v[40:43], v8 offset:15360
    v_mfma_f32_32x32x16_bf16 v[84:99], a[8:11], v[152:155], v[84:99]
    s_waitcnt lgkmcnt(5)
    v_mfma_f32_32x32x16_bf16 v[44:59], v[20:23], a[40:43], v[44:59]
    ds_read_b128 v[12:15], v8 offset:16384
    v_mfma_f32_32x32x16_bf16 v[84:99], a[12:15], v[156:159], v[84:99]
    s_waitcnt lgkmcnt(5)
    v_mfma_f32_32x32x16_bf16 v[44:59], v[24:27], a[44:47], v[44:59]
    ds_read_b128 v[16:19], v8 offset:17408
    s_waitcnt lgkmcnt(5)
    v_mfma_f32_32x32x16_bf16 v[44:59], v[28:31], a[48:51], v[44:59]
    ds_read_b128 v[20:23], v8 offset:18432
    s_waitcnt lgkmcnt(5)
    v_mfma_f32_32x32x16_bf16 v[44:59], v[32:35], a[52:55], v[44:59]
    ds_read_b128 v[24:27], v8 offset:19456
    s_waitcnt lgkmcnt(5)
    v_mfma_f32_32x32x16_bf16 v[44:59], v[36:39], a[56:59], v[44:59]
    ds_read_b128 v[28:31], v8 offset:20480
    s_waitcnt lgkmcnt(5)
    v_mfma_f32_32x32x16_bf16 v[44:59], v[40:43], a[60:63], v[44:59]
    ds_read_b128 v[32:35], v8 offset:21504
    s_waitcnt lgkmcnt(5)
    v_mfma_f32_32x32x16_bf16 v[44:59], v[12:15], a[64:67], v[44:59]
    ds_read_b128 v[36:39], v8 offset:22528
    s_waitcnt lgkmcnt(5)
    v_mfma_f32_32x32x16_bf16 v[44:59], v[16:19], a[68:71], v[44:59]
    ds_read_b128 v[40:43], v8 offset:23552
    s_waitcnt lgkmcnt(5)
    v_mfma_f32_32x32x16_bf16 v[44:59], v[20:23], a[72:75], v[44:59]
    ds_read_b128 v[12:15], v8 offset:24576
    s_waitcnt lgkmcnt(5)
    v_mfma_f32_32x32x16_bf16 v[44:59], v[24:27], a[76:79], v[44:59]
    ds_read_b128 v[16:19], v8 offset:25600
    s_waitcnt lgkmcnt(5)
    v_mfma_f32_32x32x16_bf16 v[44:59], v[28:31], a[80:83], v[44:59]
    ds_read_b128 v[20:23], v8 offset:26624
    s_waitcnt vmcnt(7)
    s_barrier
    s_waitcnt lgkmcnt(5)
    v_mfma_f32_32x32x16_bf16 v[44:59], v[32:35], a[84:87], v[44:59]
    ds_read_b128 v[24:27], v8 offset:27648
    s_add_u32 m0, s32, 28672
    s_add_u32 s28, s26, 143360
    buffer_load_dwordx4 v4, s[8:11], s28 offen offset:0 sc1 lds
    s_waitcnt lgkmcnt(5)
    v_mfma_f32_32x32x16_bf16 v[44:59], v[36:39], a[88:91], v[44:59]
    ds_read_b128 v[28:31], v8 offset:28672
    s_waitcnt lgkmcnt(5)
    v_mfma_f32_32x32x16_bf16 v[44:59], v[40:43], a[92:95], v[44:59]
    ds_read_b128 v[32:35], v8 offset:29696
    buffer_load_dwordx4 v4, s[8:11], s28 offen offset:1024 sc1 lds
    s_waitcnt lgkmcnt(5)
    v_mfma_f32_32x32x16_bf16 v[44:59], v[12:15], a[96:99], v[44:59]
    ds_read_b128 v[36:39], v8 offset:30720
    s_waitcnt lgkmcnt(5)
    v_mfma_f32_32x32x16_bf16 v[44:59], v[16:19], a[100:103], v[44:59]
    ds_read_b128 v[40:43], v8 offset:31744
    buffer_load_dwordx4 v4, s[8:11], s28 offen offset:2048 sc1 lds
    s_waitcnt lgkmcnt(5)
    v_mfma_f32_32x32x16_bf16 v[44:59], v[20:23], a[104:107], v[44:59]
    ds_read_b128 v[12:15], v8 offset:32768
    s_waitcnt lgkmcnt(5)
    v_mfma_f32_32x32x16_bf16 v[44:59], v[24:27], a[108:111], v[44:59]
    ds_read_b128 v[16:19], v8 offset:33792
    buffer_load_dwordx4 v4, s[8:11], s28 offen offset:3072 sc1 lds
    s_waitcnt lgkmcnt(5)
    v_mfma_f32_32x32x16_bf16 v[60:75], v[28:31], a[0:3], 0
    ds_read_b128 v[20:23], v8 offset:34816
    s_waitcnt lgkmcnt(5)
    v_mfma_f32_32x32x16_bf16 v[60:75], v[32:35], a[4:7], v[60:75]
    ds_read_b128 v[24:27], v8 offset:35840
    s_add_u32 m0, s32, 32768
    s_add_u32 s28, s26, 147456
    buffer_load_dwordx4 v4, s[8:11], s28 offen offset:0 sc1 lds
    s_waitcnt lgkmcnt(5)
    v_mfma_f32_32x32x16_bf16 v[60:75], v[36:39], a[8:11], v[60:75]
    ds_read_b128 v[28:31], v8 offset:36864
    s_waitcnt lgkmcnt(5)
    v_mfma_f32_32x32x16_bf16 v[60:75], v[40:43], a[12:15], v[60:75]
    ds_read_b128 v[32:35], v8 offset:37888
    buffer_load_dwordx4 v4, s[8:11], s28 offen offset:1024 sc1 lds
    s_waitcnt lgkmcnt(5)
    v_mfma_f32_32x32x16_bf16 v[60:75], v[12:15], a[16:19], v[60:75]
    ds_read_b128 v[36:39], v8 offset:38912
    v_cvt_pk_bf16_f32 v160, v44, v45
    v_cvt_pk_bf16_f32 v161, v46, v47
    s_waitcnt lgkmcnt(5)
    v_mfma_f32_32x32x16_bf16 v[60:75], v[16:19], a[20:23], v[60:75]
    ds_read_b128 v[40:43], v8 offset:39936
    buffer_load_dwordx4 v4, s[8:11], s28 offen offset:2048 sc1 lds
    v_cvt_pk_bf16_f32 v162, v48, v49
    v_cvt_pk_bf16_f32 v163, v50, v51
    s_waitcnt lgkmcnt(5)
    v_mfma_f32_32x32x16_bf16 v[60:75], v[20:23], a[24:27], v[60:75]
    ds_read_b128 v[12:15], v8 offset:40960
    v_cvt_pk_bf16_f32 v164, v52, v53
    v_cvt_pk_bf16_f32 v165, v54, v55
    s_waitcnt lgkmcnt(5)
    v_mfma_f32_32x32x16_bf16 v[60:75], v[24:27], a[28:31], v[60:75]
    ds_read_b128 v[16:19], v8 offset:41984
    v_cvt_pk_bf16_f32 v166, v56, v57
    v_cvt_pk_bf16_f32 v167, v58, v59
    s_waitcnt lgkmcnt(5)
    v_mfma_f32_32x32x16_bf16 v[60:75], v[28:31], a[32:35], v[60:75]
    ds_read_b128 v[20:23], v8 offset:43008
    s_nop 0
    s_waitcnt lgkmcnt(5)
    v_mfma_f32_32x32x16_bf16 v[60:75], v[32:35], a[36:39], v[60:75]
    ds_read_b128 v[24:27], v8 offset:44032
    v_mfma_f32_32x32x16_bf16 v[84:99], a[16:19], v[160:163], v[84:99]
    s_waitcnt lgkmcnt(5)
    v_mfma_f32_32x32x16_bf16 v[60:75], v[36:39], a[40:43], v[60:75]
    ds_read_b128 v[28:31], v8 offset:45056
    v_mfma_f32_32x32x16_bf16 v[84:99], a[20:23], v[164:167], v[84:99]
    s_waitcnt lgkmcnt(5)
    v_mfma_f32_32x32x16_bf16 v[60:75], v[40:43], a[44:47], v[60:75]
    ds_read_b128 v[32:35], v8 offset:46080
    s_waitcnt lgkmcnt(5)
    v_mfma_f32_32x32x16_bf16 v[60:75], v[12:15], a[48:51], v[60:75]
    ds_read_b128 v[36:39], v8 offset:47104
    s_waitcnt lgkmcnt(5)
    v_mfma_f32_32x32x16_bf16 v[60:75], v[16:19], a[52:55], v[60:75]
    ds_read_b128 v[40:43], v8 offset:48128
    s_waitcnt lgkmcnt(5)
    v_mfma_f32_32x32x16_bf16 v[60:75], v[20:23], a[56:59], v[60:75]
    ds_read_b128 v[12:15], v8 offset:49152
    s_waitcnt lgkmcnt(5)
    v_mfma_f32_32x32x16_bf16 v[60:75], v[24:27], a[60:63], v[60:75]
    ds_read_b128 v[16:19], v8 offset:50176
    s_waitcnt lgkmcnt(5)
    v_mfma_f32_32x32x16_bf16 v[60:75], v[28:31], a[64:67], v[60:75]
    ds_read_b128 v[20:23], v8 offset:51200
    s_waitcnt lgkmcnt(5)
    v_mfma_f32_32x32x16_bf16 v[60:75], v[32:35], a[68:71], v[60:75]
    ds_read_b128 v[24:27], v8 offset:52224
    s_waitcnt lgkmcnt(5)
    v_mfma_f32_32x32x16_bf16 v[60:75], v[36:39], a[72:75], v[60:75]
    ds_read_b128 v[28:31], v8 offset:53248
    s_waitcnt lgkmcnt(5)
    v_mfma_f32_32x32x16_bf16 v[60:75], v[40:43], a[76:79], v[60:75]
    ds_read_b128 v[32:35], v8 offset:54272
    s_waitcnt lgkmcnt(5)
    v_mfma_f32_32x32x16_bf16 v[60:75], v[12:15], a[80:83], v[60:75]
    ds_read_b128 v[36:39], v8 offset:55296
    s_waitcnt vmcnt(7)
    s_barrier
    s_waitcnt lgkmcnt(5)
    v_mfma_f32_32x32x16_bf16 v[60:75], v[16:19], a[84:87], v[60:75]
    ds_read_b128 v[40:43], v8 offset:56320
    s_add_u32 m0, s32, 57344
    s_add_u32 s28, s26, 172032
    buffer_load_dwordx4 v4, s[8:11], s28 offen offset:0 sc1 lds
    s_waitcnt lgkmcnt(5)
    v_mfma_f32_32x32x16_bf16 v[60:75], v[20:23], a[88:91], v[60:75]
    ds_read_b128 v[12:15], v7 offset:0
    s_waitcnt lgkmcnt(5)
    v_mfma_f32_32x32x16_bf16 v[60:75], v[24:27], a[92:95], v[60:75]
    ds_read_b128 v[16:19], v7 offset:1024
    buffer_load_dwordx4 v4, s[8:11], s28 offen offset:1024 sc1 lds
    s_waitcnt lgkmcnt(5)
    v_mfma_f32_32x32x16_bf16 v[60:75], v[28:31], a[96:99], v[60:75]
    ds_read_b128 v[20:23], v7 offset:2048
    s_waitcnt lgkmcnt(5)
    v_mfma_f32_32x32x16_bf16 v[60:75], v[32:35], a[100:103], v[60:75]
    ds_read_b128 v[24:27], v7 offset:3072
    buffer_load_dwordx4 v4, s[8:11], s28 offen offset:2048 sc1 lds
    s_waitcnt lgkmcnt(5)
    v_mfma_f32_32x32x16_bf16 v[60:75], v[36:39], a[104:107], v[60:75]
    ds_read_b128 v[28:31], v7 offset:4096
    s_waitcnt lgkmcnt(5)
    v_mfma_f32_32x32x16_bf16 v[60:75], v[40:43], a[108:111], v[60:75]
    ds_read_b128 v[32:35], v7 offset:5120
    buffer_load_dwordx4 v4, s[8:11], s28 offen offset:3072 sc1 lds
    s_waitcnt lgkmcnt(5)
    v_mfma_f32_32x32x16_bf16 v[44:59], v[12:15], a[0:3], 0
    ds_read_b128 v[36:39], v7 offset:6144
    s_waitcnt lgkmcnt(5)
    v_mfma_f32_32x32x16_bf16 v[44:59], v[16:19], a[4:7], v[44:59]
    ds_read_b128 v[40:43], v7 offset:7168
    s_add_u32 m0, s32, 61440
    s_add_u32 s28, s26, 176128
    buffer_load_dwordx4 v4, s[8:11], s28 offen offset:0 sc1 lds
    s_waitcnt lgkmcnt(5)
    v_mfma_f32_32x32x16_bf16 v[44:59], v[20:23], a[8:11], v[44:59]
    ds_read_b128 v[12:15], v7 offset:8192
    s_waitcnt lgkmcnt(5)
    v_mfma_f32_32x32x16_bf16 v[44:59], v[24:27], a[12:15], v[44:59]
    ds_read_b128 v[16:19], v7 offset:9216
    buffer_load_dwordx4 v4, s[8:11], s28 offen offset:1024 sc1 lds
    s_waitcnt lgkmcnt(5)
    v_mfma_f32_32x32x16_bf16 v[44:59], v[28:31], a[16:19], v[44:59]
    ds_read_b128 v[20:23], v7 offset:10240
    v_cvt_pk_bf16_f32 v168, v60, v61
    v_cvt_pk_bf16_f32 v169, v62, v63
    s_waitcnt lgkmcnt(5)
    v_mfma_f32_32x32x16_bf16 v[44:59], v[32:35], a[20:23], v[44:59]
    ds_read_b128 v[24:27], v7 offset:11264
    buffer_load_dwordx4 v4, s[8:11], s28 offen offset:2048 sc1 lds
    v_cvt_pk_bf16_f32 v170, v64, v65
    v_cvt_pk_bf16_f32 v171, v66, v67
    s_waitcnt lgkmcnt(5)
    v_mfma_f32_32x32x16_bf16 v[44:59], v[36:39], a[24:27], v[44:59]
    ds_read_b128 v[28:31], v7 offset:12288
    v_cvt_pk_bf16_f32 v172, v68, v69
    v_cvt_pk_bf16_f32 v173, v70, v71
    s_waitcnt lgkmcnt(5)
    v_mfma_f32_32x32x16_bf16 v[44:59], v[40:43], a[28:31], v[44:59]
    ds_read_b128 v[32:35], v7 offset:13312
    v_cvt_pk_bf16_f32 v174, v72, v73
    v_cvt_pk_bf16_f32 v175, v74, v75
    s_waitcnt lgkmcnt(5)
    v_mfma_f32_32x32x16_bf16 v[44:59], v[12:15], a[32:35], v[44:59]
    ds_read_b128 v[36:39], v7 offset:14336
    s_nop 0
    s_waitcnt lgkmcnt(5)
    v_mfma_f32_32x32x16_bf16 v[44:59], v[16:19], a[36:39], v[44:59]
    ds_read_b128 v[40:43], v7 offset:15360
    v_mfma_f32_32x32x16_bf16 v[84:99], a[24:27], v[168:171], v[84:99]
    s_waitcnt lgkmcnt(5)
    v_mfma_f32_32x32x16_bf16 v[44:59], v[20:23], a[40:43], v[44:59]
    ds_read_b128 v[12:15], v7 offset:16384
    v_mfma_f32_32x32x16_bf16 v[84:99], a[28:31], v[172:175], v[84:99]
    s_waitcnt lgkmcnt(5)
    v_mfma_f32_32x32x16_bf16 v[44:59], v[24:27], a[44:47], v[44:59]
    ds_read_b128 v[16:19], v7 offset:17408
    s_waitcnt lgkmcnt(5)
    v_mfma_f32_32x32x16_bf16 v[44:59], v[28:31], a[48:51], v[44:59]
    ds_read_b128 v[20:23], v7 offset:18432
    s_waitcnt lgkmcnt(5)
    v_mfma_f32_32x32x16_bf16 v[44:59], v[32:35], a[52:55], v[44:59]
    ds_read_b128 v[24:27], v7 offset:19456
    s_waitcnt lgkmcnt(5)
    v_mfma_f32_32x32x16_bf16 v[44:59], v[36:39], a[56:59], v[44:59]
    ds_read_b128 v[28:31], v7 offset:20480
    s_waitcnt lgkmcnt(5)
    v_mfma_f32_32x32x16_bf16 v[44:59], v[40:43], a[60:63], v[44:59]
    ds_read_b128 v[32:35], v7 offset:21504
    s_waitcnt lgkmcnt(5)
    v_mfma_f32_32x32x16_bf16 v[44:59], v[12:15], a[64:67], v[44:59]
    ds_read_b128 v[36:39], v7 offset:22528
    s_waitcnt lgkmcnt(5)
    v_mfma_f32_32x32x16_bf16 v[44:59], v[16:19], a[68:71], v[44:59]
    ds_read_b128 v[40:43], v7 offset:23552
    s_waitcnt lgkmcnt(5)
    v_mfma_f32_32x32x16_bf16 v[44:59], v[20:23], a[72:75], v[44:59]
    ds_read_b128 v[12:15], v7 offset:24576
    s_waitcnt lgkmcnt(5)
    v_mfma_f32_32x32x16_bf16 v[44:59], v[24:27], a[76:79], v[44:59]
    ds_read_b128 v[16:19], v7 offset:25600
    s_waitcnt lgkmcnt(5)
    v_mfma_f32_32x32x16_bf16 v[44:59], v[28:31], a[80:83], v[44:59]
    ds_read_b128 v[20:23], v7 offset:26624
    s_waitcnt vmcnt(7)
    s_barrier
    s_waitcnt lgkmcnt(5)
    v_mfma_f32_32x32x16_bf16 v[44:59], v[32:35], a[84:87], v[44:59]
    ds_read_b128 v[24:27], v7 offset:27648
    s_add_u32 m0, s32, 86016
    s_add_u32 s28, s26, 200704
    buffer_load_dwordx4 v4, s[8:11], s28 offen offset:0 sc1 lds
    s_waitcnt lgkmcnt(5)
    v_mfma_f32_32x32x16_bf16 v[44:59], v[36:39], a[88:91], v[44:59]
    ds_read_b128 v[28:31], v7 offset:28672
    s_waitcnt lgkmcnt(5)
    v_mfma_f32_32x32x16_bf16 v[44:59], v[40:43], a[92:95], v[44:59]
    ds_read_b128 v[32:35], v7 offset:29696
    buffer_load_dwordx4 v4, s[8:11], s28 offen offset:1024 sc1 lds
    s_waitcnt lgkmcnt(5)
    v_mfma_f32_32x32x16_bf16 v[44:59], v[12:15], a[96:99], v[44:59]
    ds_read_b128 v[36:39], v7 offset:30720
    s_waitcnt lgkmcnt(5)
    v_mfma_f32_32x32x16_bf16 v[44:59], v[16:19], a[100:103], v[44:59]
    ds_read_b128 v[40:43], v7 offset:31744
    buffer_load_dwordx4 v4, s[8:11], s28 offen offset:2048 sc1 lds
    s_waitcnt lgkmcnt(5)
    v_mfma_f32_32x32x16_bf16 v[44:59], v[20:23], a[104:107], v[44:59]
    ds_read_b128 v[12:15], v7 offset:32768
    s_waitcnt lgkmcnt(5)
    v_mfma_f32_32x32x16_bf16 v[44:59], v[24:27], a[108:111], v[44:59]
    ds_read_b128 v[16:19], v7 offset:33792
    buffer_load_dwordx4 v4, s[8:11], s28 offen offset:3072 sc1 lds
    s_waitcnt lgkmcnt(5)
    v_mfma_f32_32x32x16_bf16 v[60:75], v[28:31], a[0:3], 0
    ds_read_b128 v[20:23], v7 offset:34816
    s_waitcnt lgkmcnt(5)
    v_mfma_f32_32x32x16_bf16 v[60:75], v[32:35], a[4:7], v[60:75]
    ds_read_b128 v[24:27], v7 offset:35840
    s_add_u32 m0, s32, 90112
    s_add_u32 s28, s26, 204800
    buffer_load_dwordx4 v4, s[8:11], s28 offen offset:0 sc1 lds
    s_waitcnt lgkmcnt(5)
    v_mfma_f32_32x32x16_bf16 v[60:75], v[36:39], a[8:11], v[60:75]
    ds_read_b128 v[28:31], v7 offset:36864
    s_waitcnt lgkmcnt(5)
    v_mfma_f32_32x32x16_bf16 v[60:75], v[40:43], a[12:15], v[60:75]
    ds_read_b128 v[32:35], v7 offset:37888
    buffer_load_dwordx4 v4, s[8:11], s28 offen offset:1024 sc1 lds
    s_waitcnt lgkmcnt(5)
    v_mfma_f32_32x32x16_bf16 v[60:75], v[12:15], a[16:19], v[60:75]
    ds_read_b128 v[36:39], v7 offset:38912
    v_cvt_pk_bf16_f32 v176, v44, v45
    v_cvt_pk_bf16_f32 v177, v46, v47
    s_waitcnt lgkmcnt(5)
    v_mfma_f32_32x32x16_bf16 v[60:75], v[16:19], a[20:23], v[60:75]
    ds_read_b128 v[40:43], v7 offset:39936
    buffer_load_dwordx4 v4, s[8:11], s28 offen offset:2048 sc1 lds
    v_cvt_pk_bf16_f32 v178, v48, v49
    v_cvt_pk_bf16_f32 v179, v50, v51
    s_waitcnt lgkmcnt(5)
    v_mfma_f32_32x32x16_bf16 v[60:75], v[20:23], a[24:27], v[60:75]
    ds_read_b128 v[12:15], v7 offset:40960
    v_cvt_pk_bf16_f32 v180, v52, v53
    v_cvt_pk_bf16_f32 v181, v54, v55
    s_waitcnt lgkmcnt(5)
    v_mfma_f32_32x32x16_bf16 v[60:75], v[24:27], a[28:31], v[60:75]
    ds_read_b128 v[16:19], v7 offset:41984
    v_cvt_pk_bf16_f32 v182, v56, v57
    v_cvt_pk_bf16_f32 v183, v58, v59
    s_waitcnt lgkmcnt(5)
    v_mfma_f32_32x32x16_bf16 v[60:75], v[28:31], a[32:35], v[60:75]
    ds_read_b128 v[20:23], v7 offset:43008
    s_nop 0
    s_waitcnt lgkmcnt(5)
    v_mfma_f32_32x32x16_bf16 v[60:75], v[32:35], a[36:39], v[60:75]
    ds_read_b128 v[24:27], v7 offset:44032
    v_mfma_f32_32x32x16_bf16 v[84:99], a[32:35], v[176:179], v[84:99]
    s_waitcnt lgkmcnt(5)
    v_mfma_f32_32x32x16_bf16 v[60:75], v[36:39], a[40:43], v[60:75]
    ds_read_b128 v[28:31], v7 offset:45056
    v_mfma_f32_32x32x16_bf16 v[84:99], a[36:39], v[180:183], v[84:99]
    s_waitcnt lgkmcnt(5)
    v_mfma_f32_32x32x16_bf16 v[60:75], v[40:43], a[44:47], v[60:75]
    ds_read_b128 v[32:35], v7 offset:46080
    s_waitcnt lgkmcnt(5)
    v_mfma_f32_32x32x16_bf16 v[60:75], v[12:15], a[48:51], v[60:75]
    ds_read_b128 v[36:39], v7 offset:47104
    s_waitcnt lgkmcnt(5)
    v_mfma_f32_32x32x16_bf16 v[60:75], v[16:19], a[52:55], v[60:75]
    ds_read_b128 v[40:43], v7 offset:48128
    s_waitcnt lgkmcnt(5)
    v_mfma_f32_32x32x16_bf16 v[60:75], v[20:23], a[56:59], v[60:75]
    ds_read_b128 v[12:15], v7 offset:49152
    s_waitcnt lgkmcnt(5)
    v_mfma_f32_32x32x16_bf16 v[60:75], v[24:27], a[60:63], v[60:75]
    ds_read_b128 v[16:19], v7 offset:50176
    s_waitcnt lgkmcnt(5)
    v_mfma_f32_32x32x16_bf16 v[60:75], v[28:31], a[64:67], v[60:75]
    ds_read_b128 v[20:23], v7 offset:51200
    s_waitcnt lgkmcnt(5)
    v_mfma_f32_32x32x16_bf16 v[60:75], v[32:35], a[68:71], v[60:75]
    ds_read_b128 v[24:27], v7 offset:52224
    s_waitcnt lgkmcnt(5)
    v_mfma_f32_32x32x16_bf16 v[60:75], v[36:39], a[72:75], v[60:75]
    ds_read_b128 v[28:31], v7 offset:53248
    s_waitcnt lgkmcnt(5)
    v_mfma_f32_32x32x16_bf16 v[60:75], v[40:43], a[76:79], v[60:75]
    ds_read_b128 v[32:35], v7 offset:54272
    s_waitcnt lgkmcnt(5)
    v_mfma_f32_32x32x16_bf16 v[60:75], v[12:15], a[80:83], v[60:75]
    ds_read_b128 v[36:39], v7 offset:55296
    s_waitcnt vmcnt(7)
    s_barrier
    s_waitcnt lgkmcnt(5)
    v_mfma_f32_32x32x16_bf16 v[60:75], v[16:19], a[84:87], v[60:75]
    ds_read_b128 v[40:43], v7 offset:56320
    s_add_u32 m0, s32, 0
    s_add_u32 s28, s26, 229376
    buffer_load_dwordx4 v4, s[8:11], s28 offen offset:0 sc1 lds
    s_waitcnt lgkmcnt(5)
    v_mfma_f32_32x32x16_bf16 v[60:75], v[20:23], a[88:91], v[60:75]
    ds_read_b128 v[12:15], v8 offset:0
    s_waitcnt lgkmcnt(5)
    v_mfma_f32_32x32x16_bf16 v[60:75], v[24:27], a[92:95], v[60:75]
    ds_read_b128 v[16:19], v8 offset:1024
    buffer_load_dwordx4 v4, s[8:11], s28 offen offset:1024 sc1 lds
    s_waitcnt lgkmcnt(5)
    v_mfma_f32_32x32x16_bf16 v[60:75], v[28:31], a[96:99], v[60:75]
    ds_read_b128 v[20:23], v8 offset:2048
    s_waitcnt lgkmcnt(5)
    v_mfma_f32_32x32x16_bf16 v[60:75], v[32:35], a[100:103], v[60:75]
    ds_read_b128 v[24:27], v8 offset:3072
    buffer_load_dwordx4 v4, s[8:11], s28 offen offset:2048 sc1 lds
    s_waitcnt lgkmcnt(5)
    v_mfma_f32_32x32x16_bf16 v[60:75], v[36:39], a[104:107], v[60:75]
    ds_read_b128 v[28:31], v8 offset:4096
    s_waitcnt lgkmcnt(5)
    v_mfma_f32_32x32x16_bf16 v[60:75], v[40:43], a[108:111], v[60:75]
    ds_read_b128 v[32:35], v8 offset:5120
    buffer_load_dwordx4 v4, s[8:11], s28 offen offset:3072 sc1 lds
    s_waitcnt lgkmcnt(5)
    v_mfma_f32_32x32x16_bf16 v[44:59], v[12:15], a[0:3], 0
    ds_read_b128 v[36:39], v8 offset:6144
    s_waitcnt lgkmcnt(5)
    v_mfma_f32_32x32x16_bf16 v[44:59], v[16:19], a[4:7], v[44:59]
    ds_read_b128 v[40:43], v8 offset:7168
    s_add_u32 m0, s32, 4096
    s_add_u32 s28, s26, 233472
    buffer_load_dwordx4 v4, s[8:11], s28 offen offset:0 sc1 lds
    s_waitcnt lgkmcnt(5)
    v_mfma_f32_32x32x16_bf16 v[44:59], v[20:23], a[8:11], v[44:59]
    ds_read_b128 v[12:15], v8 offset:8192
    s_waitcnt lgkmcnt(5)
    v_mfma_f32_32x32x16_bf16 v[44:59], v[24:27], a[12:15], v[44:59]
    ds_read_b128 v[16:19], v8 offset:9216
    buffer_load_dwordx4 v4, s[8:11], s28 offen offset:1024 sc1 lds
    s_waitcnt lgkmcnt(5)
    v_mfma_f32_32x32x16_bf16 v[44:59], v[28:31], a[16:19], v[44:59]
    ds_read_b128 v[20:23], v8 offset:10240
    v_cvt_pk_bf16_f32 v184, v60, v61
    v_cvt_pk_bf16_f32 v185, v62, v63
    s_waitcnt lgkmcnt(5)
    v_mfma_f32_32x32x16_bf16 v[44:59], v[32:35], a[20:23], v[44:59]
    ds_read_b128 v[24:27], v8 offset:11264
    buffer_load_dwordx4 v4, s[8:11], s28 offen offset:2048 sc1 lds
    v_cvt_pk_bf16_f32 v186, v64, v65
    v_cvt_pk_bf16_f32 v187, v66, v67
    s_waitcnt lgkmcnt(5)
    v_mfma_f32_32x32x16_bf16 v[44:59], v[36:39], a[24:27], v[44:59]
    ds_read_b128 v[28:31], v8 offset:12288
    v_cvt_pk_bf16_f32 v188, v68, v69
    v_cvt_pk_bf16_f32 v189, v70, v71
    s_waitcnt lgkmcnt(5)
    v_mfma_f32_32x32x16_bf16 v[44:59], v[40:43], a[28:31], v[44:59]
    ds_read_b128 v[32:35], v8 offset:13312
    v_cvt_pk_bf16_f32 v190, v72, v73
    v_cvt_pk_bf16_f32 v191, v74, v75
    s_waitcnt lgkmcnt(5)
    v_mfma_f32_32x32x16_bf16 v[44:59], v[12:15], a[32:35], v[44:59]
    ds_read_b128 v[36:39], v8 offset:14336
    s_nop 0
    s_waitcnt lgkmcnt(5)
    v_mfma_f32_32x32x16_bf16 v[44:59], v[16:19], a[36:39], v[44:59]
    ds_read_b128 v[40:43], v8 offset:15360
    v_mfma_f32_32x32x16_bf16 v[84:99], a[40:43], v[184:187], v[84:99]
    s_waitcnt lgkmcnt(5)
    v_mfma_f32_32x32x16_bf16 v[44:59], v[20:23], a[40:43], v[44:59]
    ds_read_b128 v[12:15], v8 offset:16384
    v_mfma_f32_32x32x16_bf16 v[84:99], a[44:47], v[188:191], v[84:99]
    s_waitcnt lgkmcnt(5)
    v_mfma_f32_32x32x16_bf16 v[44:59], v[24:27], a[44:47], v[44:59]
    ds_read_b128 v[16:19], v8 offset:17408
    s_waitcnt lgkmcnt(5)
    v_mfma_f32_32x32x16_bf16 v[44:59], v[28:31], a[48:51], v[44:59]
    ds_read_b128 v[20:23], v8 offset:18432
    s_waitcnt lgkmcnt(5)
    v_mfma_f32_32x32x16_bf16 v[44:59], v[32:35], a[52:55], v[44:59]
    ds_read_b128 v[24:27], v8 offset:19456
    s_waitcnt lgkmcnt(5)
    v_mfma_f32_32x32x16_bf16 v[44:59], v[36:39], a[56:59], v[44:59]
    ds_read_b128 v[28:31], v8 offset:20480
    s_waitcnt lgkmcnt(5)
    v_mfma_f32_32x32x16_bf16 v[44:59], v[40:43], a[60:63], v[44:59]
    ds_read_b128 v[32:35], v8 offset:21504
    s_waitcnt lgkmcnt(5)
    v_mfma_f32_32x32x16_bf16 v[44:59], v[12:15], a[64:67], v[44:59]
    ds_read_b128 v[36:39], v8 offset:22528
    s_waitcnt lgkmcnt(5)
    v_mfma_f32_32x32x16_bf16 v[44:59], v[16:19], a[68:71], v[44:59]
    ds_read_b128 v[40:43], v8 offset:23552
    s_waitcnt lgkmcnt(5)
    v_mfma_f32_32x32x16_bf16 v[44:59], v[20:23], a[72:75], v[44:59]
    ds_read_b128 v[12:15], v8 offset:24576
    s_waitcnt lgkmcnt(5)
    v_mfma_f32_32x32x16_bf16 v[44:59], v[24:27], a[76:79], v[44:59]
    ds_read_b128 v[16:19], v8 offset:25600
    s_waitcnt lgkmcnt(5)
    v_mfma_f32_32x32x16_bf16 v[44:59], v[28:31], a[80:83], v[44:59]
    ds_read_b128 v[20:23], v8 offset:26624
    s_waitcnt vmcnt(7)
    s_barrier
    s_waitcnt lgkmcnt(5)
    v_mfma_f32_32x32x16_bf16 v[44:59], v[32:35], a[84:87], v[44:59]
    ds_read_b128 v[24:27], v8 offset:27648
    s_add_u32 m0, s32, 28672
    s_add_u32 s28, s26, 258048
    buffer_load_dwordx4 v4, s[8:11], s28 offen offset:0 sc1 lds
    s_waitcnt lgkmcnt(5)
    v_mfma_f32_32x32x16_bf16 v[44:59], v[36:39], a[88:91], v[44:59]
    ds_read_b128 v[28:31], v8 offset:28672
    s_waitcnt lgkmcnt(5)
    v_mfma_f32_32x32x16_bf16 v[44:59], v[40:43], a[92:95], v[44:59]
    ds_read_b128 v[32:35], v8 offset:29696
    buffer_load_dwordx4 v4, s[8:11], s28 offen offset:1024 sc1 lds
    s_waitcnt lgkmcnt(5)
    v_mfma_f32_32x32x16_bf16 v[44:59], v[12:15], a[96:99], v[44:59]
    ds_read_b128 v[36:39], v8 offset:30720
    s_waitcnt lgkmcnt(5)
    v_mfma_f32_32x32x16_bf16 v[44:59], v[16:19], a[100:103], v[44:59]
    ds_read_b128 v[40:43], v8 offset:31744
    buffer_load_dwordx4 v4, s[8:11], s28 offen offset:2048 sc1 lds
    s_waitcnt lgkmcnt(5)
    v_mfma_f32_32x32x16_bf16 v[44:59], v[20:23], a[104:107], v[44:59]
    ds_read_b128 v[12:15], v8 offset:32768
    s_waitcnt lgkmcnt(5)
    v_mfma_f32_32x32x16_bf16 v[44:59], v[24:27], a[108:111], v[44:59]
    ds_read_b128 v[16:19], v8 offset:33792
    buffer_load_dwordx4 v4, s[8:11], s28 offen offset:3072 sc1 lds
    s_waitcnt lgkmcnt(5)
    v_mfma_f32_32x32x16_bf16 v[60:75], v[28:31], a[0:3], 0
    ds_read_b128 v[20:23], v8 offset:34816
    s_waitcnt lgkmcnt(5)
    v_mfma_f32_32x32x16_bf16 v[60:75], v[32:35], a[4:7], v[60:75]
    ds_read_b128 v[24:27], v8 offset:35840
    s_add_u32 m0, s32, 32768
    s_add_u32 s28, s26, 262144
    buffer_load_dwordx4 v4, s[8:11], s28 offen offset:0 sc1 lds
    s_waitcnt lgkmcnt(5)
    v_mfma_f32_32x32x16_bf16 v[60:75], v[36:39], a[8:11], v[60:75]
    ds_read_b128 v[28:31], v8 offset:36864
    s_waitcnt lgkmcnt(5)
    v_mfma_f32_32x32x16_bf16 v[60:75], v[40:43], a[12:15], v[60:75]
    ds_read_b128 v[32:35], v8 offset:37888
    buffer_load_dwordx4 v4, s[8:11], s28 offen offset:1024 sc1 lds
    s_waitcnt lgkmcnt(5)
    v_mfma_f32_32x32x16_bf16 v[60:75], v[12:15], a[16:19], v[60:75]
    ds_read_b128 v[36:39], v8 offset:38912
    v_cvt_pk_bf16_f32 v192, v44, v45
    v_cvt_pk_bf16_f32 v193, v46, v47
    s_waitcnt lgkmcnt(5)
    v_mfma_f32_32x32x16_bf16 v[60:75], v[16:19], a[20:23], v[60:75]
    ds_read_b128 v[40:43], v8 offset:39936
    buffer_load_dwordx4 v4, s[8:11], s28 offen offset:2048 sc1 lds
    v_cvt_pk_bf16_f32 v194, v48, v49
    v_cvt_pk_bf16_f32 v195, v50, v51
    s_waitcnt lgkmcnt(5)
    v_mfma_f32_32x32x16_bf16 v[60:75], v[20:23], a[24:27], v[60:75]
    ds_read_b128 v[12:15], v8 offset:40960
    v_cvt_pk_bf16_f32 v196, v52, v53
    v_cvt_pk_bf16_f32 v197, v54, v55
    s_waitcnt lgkmcnt(5)
    v_mfma_f32_32x32x16_bf16 v[60:75], v[24:27], a[28:31], v[60:75]
    ds_read_b128 v[16:19], v8 offset:41984
    v_cvt_pk_bf16_f32 v198, v56, v57
    v_cvt_pk_bf16_f32 v199, v58, v59
    s_waitcnt lgkmcnt(5)
    v_mfma_f32_32x32x16_bf16 v[60:75], v[28:31], a[32:35], v[60:75]
    ds_read_b128 v[20:23], v8 offset:43008
    s_nop 0
    s_waitcnt lgkmcnt(5)
    v_mfma_f32_32x32x16_bf16 v[60:75], v[32:35], a[36:39], v[60:75]
    ds_read_b128 v[24:27], v8 offset:44032
    v_mfma_f32_32x32x16_bf16 v[84:99], a[48:51], v[192:195], v[84:99]
    s_waitcnt lgkmcnt(5)
    v_mfma_f32_32x32x16_bf16 v[60:75], v[36:39], a[40:43], v[60:75]
    ds_read_b128 v[28:31], v8 offset:45056
    v_mfma_f32_32x32x16_bf16 v[84:99], a[52:55], v[196:199], v[84:99]
    s_waitcnt lgkmcnt(5)
    v_mfma_f32_32x32x16_bf16 v[60:75], v[40:43], a[44:47], v[60:75]
    ds_read_b128 v[32:35], v8 offset:46080
    s_waitcnt lgkmcnt(5)
    v_mfma_f32_32x32x16_bf16 v[60:75], v[12:15], a[48:51], v[60:75]
    ds_read_b128 v[36:39], v8 offset:47104
    s_waitcnt lgkmcnt(5)
    v_mfma_f32_32x32x16_bf16 v[60:75], v[16:19], a[52:55], v[60:75]
    ds_read_b128 v[40:43], v8 offset:48128
    s_waitcnt lgkmcnt(5)
    v_mfma_f32_32x32x16_bf16 v[60:75], v[20:23], a[56:59], v[60:75]
    ds_read_b128 v[12:15], v8 offset:49152
    s_waitcnt lgkmcnt(5)
    v_mfma_f32_32x32x16_bf16 v[60:75], v[24:27], a[60:63], v[60:75]
    ds_read_b128 v[16:19], v8 offset:50176
    s_waitcnt lgkmcnt(5)
    v_mfma_f32_32x32x16_bf16 v[60:75], v[28:31], a[64:67], v[60:75]
    ds_read_b128 v[20:23], v8 offset:51200
    s_waitcnt lgkmcnt(5)
    v_mfma_f32_32x32x16_bf16 v[60:75], v[32:35], a[68:71], v[60:75]
    ds_read_b128 v[24:27], v8 offset:52224
    s_waitcnt lgkmcnt(5)
    v_mfma_f32_32x32x16_bf16 v[60:75], v[36:39], a[72:75], v[60:75]
    ds_read_b128 v[28:31], v8 offset:53248
    s_waitcnt lgkmcnt(5)
    v_mfma_f32_32x32x16_bf16 v[60:75], v[40:43], a[76:79], v[60:75]
    ds_read_b128 v[32:35], v8 offset:54272
    s_waitcnt lgkmcnt(5)
    v_mfma_f32_32x32x16_bf16 v[60:75], v[12:15], a[80:83], v[60:75]
    ds_read_b128 v[36:39], v8 offset:55296
    s_waitcnt vmcnt(7)
    s_barrier
    s_waitcnt lgkmcnt(5)
    v_mfma_f32_32x32x16_bf16 v[60:75], v[16:19], a[84:87], v[60:75]
    ds_read_b128 v[40:43], v8 offset:56320
    s_add_u32 m0, s32, 57344
    s_add_u32 s28, s26, 286720
    buffer_load_dwordx4 v4, s[8:11], s28 offen offset:0 sc1 lds
    s_waitcnt lgkmcnt(5)
    v_mfma_f32_32x32x16_bf16 v[60:75], v[20:23], a[88:91], v[60:75]
    ds_read_b128 v[12:15], v7 offset:0
    s_waitcnt lgkmcnt(5)
    v_mfma_f32_32x32x16_bf16 v[60:75], v[24:27], a[92:95], v[60:75]
    ds_read_b128 v[16:19], v7 offset:1024
    buffer_load_dwordx4 v4, s[8:11], s28 offen offset:1024 sc1 lds
    s_waitcnt lgkmcnt(5)
    v_mfma_f32_32x32x16_bf16 v[60:75], v[28:31], a[96:99], v[60:75]
    ds_read_b128 v[20:23], v7 offset:2048
    s_waitcnt lgkmcnt(5)
    v_mfma_f32_32x32x16_bf16 v[60:75], v[32:35], a[100:103], v[60:75]
    ds_read_b128 v[24:27], v7 offset:3072
    buffer_load_dwordx4 v4, s[8:11], s28 offen offset:2048 sc1 lds
    s_waitcnt lgkmcnt(5)
    v_mfma_f32_32x32x16_bf16 v[60:75], v[36:39], a[104:107], v[60:75]
    ds_read_b128 v[28:31], v7 offset:4096
    s_waitcnt lgkmcnt(5)
    v_mfma_f32_32x32x16_bf16 v[60:75], v[40:43], a[108:111], v[60:75]
    ds_read_b128 v[32:35], v7 offset:5120
    buffer_load_dwordx4 v4, s[8:11], s28 offen offset:3072 sc1 lds
    s_waitcnt lgkmcnt(5)
    v_mfma_f32_32x32x16_bf16 v[44:59], v[12:15], a[0:3], 0
    ds_read_b128 v[36:39], v7 offset:6144
    s_waitcnt lgkmcnt(5)
    v_mfma_f32_32x32x16_bf16 v[44:59], v[16:19], a[4:7], v[44:59]
    ds_read_b128 v[40:43], v7 offset:7168
    s_add_u32 m0, s32, 61440
    s_add_u32 s28, s26, 290816
    buffer_load_dwordx4 v4, s[8:11], s28 offen offset:0 sc1 lds
    s_waitcnt lgkmcnt(5)
    v_mfma_f32_32x32x16_bf16 v[44:59], v[20:23], a[8:11], v[44:59]
    ds_read_b128 v[12:15], v7 offset:8192
    s_waitcnt lgkmcnt(5)
    v_mfma_f32_32x32x16_bf16 v[44:59], v[24:27], a[12:15], v[44:59]
    ds_read_b128 v[16:19], v7 offset:9216
    buffer_load_dwordx4 v4, s[8:11], s28 offen offset:1024 sc1 lds
    s_waitcnt lgkmcnt(5)
    v_mfma_f32_32x32x16_bf16 v[44:59], v[28:31], a[16:19], v[44:59]
    ds_read_b128 v[20:23], v7 offset:10240
    v_cvt_pk_bf16_f32 v200, v60, v61
    v_cvt_pk_bf16_f32 v201, v62, v63
    s_waitcnt lgkmcnt(5)
    v_mfma_f32_32x32x16_bf16 v[44:59], v[32:35], a[20:23], v[44:59]
    ds_read_b128 v[24:27], v7 offset:11264
    buffer_load_dwordx4 v4, s[8:11], s28 offen offset:2048 sc1 lds
    v_cvt_pk_bf16_f32 v202, v64, v65
    v_cvt_pk_bf16_f32 v203, v66, v67
    s_waitcnt lgkmcnt(5)
    v_mfma_f32_32x32x16_bf16 v[44:59], v[36:39], a[24:27], v[44:59]
    ds_read_b128 v[28:31], v7 offset:12288
    v_cvt_pk_bf16_f32 v204, v68, v69
    v_cvt_pk_bf16_f32 v205, v70, v71
    s_waitcnt lgkmcnt(5)
    v_mfma_f32_32x32x16_bf16 v[44:59], v[40:43], a[28:31], v[44:59]
    ds_read_b128 v[32:35], v7 offset:13312
    v_cvt_pk_bf16_f32 v206, v72, v73
    v_cvt_pk_bf16_f32 v207, v74, v75
    s_waitcnt lgkmcnt(5)
    v_mfma_f32_32x32x16_bf16 v[44:59], v[12:15], a[32:35], v[44:59]
    ds_read_b128 v[36:39], v7 offset:14336
    s_nop 0
    s_waitcnt lgkmcnt(5)
    v_mfma_f32_32x32x16_bf16 v[44:59], v[16:19], a[36:39], v[44:59]
    ds_read_b128 v[40:43], v7 offset:15360
    v_mfma_f32_32x32x16_bf16 v[84:99], a[56:59], v[200:203], v[84:99]
    s_waitcnt lgkmcnt(5)
    v_mfma_f32_32x32x16_bf16 v[44:59], v[20:23], a[40:43], v[44:59]
    ds_read_b128 v[12:15], v7 offset:16384
    v_mfma_f32_32x32x16_bf16 v[84:99], a[60:63], v[204:207], v[84:99]
    s_waitcnt lgkmcnt(5)
    v_mfma_f32_32x32x16_bf16 v[44:59], v[24:27], a[44:47], v[44:59]
    ds_read_b128 v[16:19], v7 offset:17408
    s_waitcnt lgkmcnt(5)
    v_mfma_f32_32x32x16_bf16 v[44:59], v[28:31], a[48:51], v[44:59]
    ds_read_b128 v[20:23], v7 offset:18432
    s_waitcnt lgkmcnt(5)
    v_mfma_f32_32x32x16_bf16 v[44:59], v[32:35], a[52:55], v[44:59]
    ds_read_b128 v[24:27], v7 offset:19456
    s_waitcnt lgkmcnt(5)
    v_mfma_f32_32x32x16_bf16 v[44:59], v[36:39], a[56:59], v[44:59]
    ds_read_b128 v[28:31], v7 offset:20480
    s_waitcnt lgkmcnt(5)
    v_mfma_f32_32x32x16_bf16 v[44:59], v[40:43], a[60:63], v[44:59]
    ds_read_b128 v[32:35], v7 offset:21504
    s_waitcnt lgkmcnt(5)
    v_mfma_f32_32x32x16_bf16 v[44:59], v[12:15], a[64:67], v[44:59]
    ds_read_b128 v[36:39], v7 offset:22528
    s_waitcnt lgkmcnt(5)
    v_mfma_f32_32x32x16_bf16 v[44:59], v[16:19], a[68:71], v[44:59]
    ds_read_b128 v[40:43], v7 offset:23552
    s_waitcnt lgkmcnt(5)
    v_mfma_f32_32x32x16_bf16 v[44:59], v[20:23], a[72:75], v[44:59]
    ds_read_b128 v[12:15], v7 offset:24576
    s_waitcnt lgkmcnt(5)
    v_mfma_f32_32x32x16_bf16 v[44:59], v[24:27], a[76:79], v[44:59]
    ds_read_b128 v[16:19], v7 offset:25600
    s_waitcnt lgkmcnt(5)
    v_mfma_f32_32x32x16_bf16 v[44:59], v[28:31], a[80:83], v[44:59]
    ds_read_b128 v[20:23], v7 offset:26624
    s_waitcnt vmcnt(7)
    s_barrier
    s_waitcnt lgkmcnt(5)
    v_mfma_f32_32x32x16_bf16 v[44:59], v[32:35], a[84:87], v[44:59]
    ds_read_b128 v[24:27], v7 offset:27648
    s_add_u32 m0, s32, 86016
    s_add_u32 s28, s26, 315392
    buffer_load_dwordx4 v4, s[8:11], s28 offen offset:0 sc1 lds
    s_waitcnt lgkmcnt(5)
    v_mfma_f32_32x32x16_bf16 v[44:59], v[36:39], a[88:91], v[44:59]
    ds_read_b128 v[28:31], v7 offset:28672
    s_waitcnt lgkmcnt(5)
    v_mfma_f32_32x32x16_bf16 v[44:59], v[40:43], a[92:95], v[44:59]
    ds_read_b128 v[32:35], v7 offset:29696
    buffer_load_dwordx4 v4, s[8:11], s28 offen offset:1024 sc1 lds
    s_waitcnt lgkmcnt(5)
    v_mfma_f32_32x32x16_bf16 v[44:59], v[12:15], a[96:99], v[44:59]
    ds_read_b128 v[36:39], v7 offset:30720
    s_waitcnt lgkmcnt(5)
    v_mfma_f32_32x32x16_bf16 v[44:59], v[16:19], a[100:103], v[44:59]
    ds_read_b128 v[40:43], v7 offset:31744
    buffer_load_dwordx4 v4, s[8:11], s28 offen offset:2048 sc1 lds
    s_waitcnt lgkmcnt(5)
    v_mfma_f32_32x32x16_bf16 v[44:59], v[20:23], a[104:107], v[44:59]
    ds_read_b128 v[12:15], v7 offset:32768
    s_waitcnt lgkmcnt(5)
    v_mfma_f32_32x32x16_bf16 v[44:59], v[24:27], a[108:111], v[44:59]
    ds_read_b128 v[16:19], v7 offset:33792
    buffer_load_dwordx4 v4, s[8:11], s28 offen offset:3072 sc1 lds
    s_waitcnt lgkmcnt(5)
    v_mfma_f32_32x32x16_bf16 v[60:75], v[28:31], a[0:3], 0
    ds_read_b128 v[20:23], v7 offset:34816
    s_waitcnt lgkmcnt(5)
    v_mfma_f32_32x32x16_bf16 v[60:75], v[32:35], a[4:7], v[60:75]
    ds_read_b128 v[24:27], v7 offset:35840
    s_add_u32 m0, s32, 90112
    s_add_u32 s28, s26, 319488
    buffer_load_dwordx4 v4, s[8:11], s28 offen offset:0 sc1 lds
    s_waitcnt lgkmcnt(5)
    v_mfma_f32_32x32x16_bf16 v[60:75], v[36:39], a[8:11], v[60:75]
    ds_read_b128 v[28:31], v7 offset:36864
    s_waitcnt lgkmcnt(5)
    v_mfma_f32_32x32x16_bf16 v[60:75], v[40:43], a[12:15], v[60:75]
    ds_read_b128 v[32:35], v7 offset:37888
    buffer_load_dwordx4 v4, s[8:11], s28 offen offset:1024 sc1 lds
    s_waitcnt lgkmcnt(5)
    v_mfma_f32_32x32x16_bf16 v[60:75], v[12:15], a[16:19], v[60:75]
    ds_read_b128 v[36:39], v7 offset:38912
    v_cvt_pk_bf16_f32 v208, v44, v45
    v_cvt_pk_bf16_f32 v209, v46, v47
    s_waitcnt lgkmcnt(5)
    v_mfma_f32_32x32x16_bf16 v[60:75], v[16:19], a[20:23], v[60:75]
    ds_read_b128 v[40:43], v7 offset:39936
    buffer_load_dwordx4 v4, s[8:11], s28 offen offset:2048 sc1 lds
    v_cvt_pk_bf16_f32 v210, v48, v49
    v_cvt_pk_bf16_f32 v211, v50, v51
    s_waitcnt lgkmcnt(5)
    v_mfma_f32_32x32x16_bf16 v[60:75], v[20:23], a[24:27], v[60:75]
    ds_read_b128 v[12:15], v7 offset:40960
    v_cvt_pk_bf16_f32 v212, v52, v53
    v_cvt_pk_bf16_f32 v213, v54, v55
    s_waitcnt lgkmcnt(5)
    v_mfma_f32_32x32x16_bf16 v[60:75], v[24:27], a[28:31], v[60:75]
    ds_read_b128 v[16:19], v7 offset:41984
    v_cvt_pk_bf16_f32 v214, v56, v57
    v_cvt_pk_bf16_f32 v215, v58, v59
    s_waitcnt lgkmcnt(5)
    v_mfma_f32_32x32x16_bf16 v[60:75], v[28:31], a[32:35], v[60:75]
    ds_read_b128 v[20:23], v7 offset:43008
    s_nop 0
    s_waitcnt lgkmcnt(5)
    v_mfma_f32_32x32x16_bf16 v[60:75], v[32:35], a[36:39], v[60:75]
    ds_read_b128 v[24:27], v7 offset:44032
    v_mfma_f32_32x32x16_bf16 v[84:99], a[64:67], v[208:211], v[84:99]
    s_waitcnt lgkmcnt(5)
    v_mfma_f32_32x32x16_bf16 v[60:75], v[36:39], a[40:43], v[60:75]
    ds_read_b128 v[28:31], v7 offset:45056
    v_mfma_f32_32x32x16_bf16 v[84:99], a[68:71], v[212:215], v[84:99]
    s_waitcnt lgkmcnt(5)
    v_mfma_f32_32x32x16_bf16 v[60:75], v[40:43], a[44:47], v[60:75]
    ds_read_b128 v[32:35], v7 offset:46080
    s_waitcnt lgkmcnt(5)
    v_mfma_f32_32x32x16_bf16 v[60:75], v[12:15], a[48:51], v[60:75]
    ds_read_b128 v[36:39], v7 offset:47104
    s_waitcnt lgkmcnt(5)
    v_mfma_f32_32x32x16_bf16 v[60:75], v[16:19], a[52:55], v[60:75]
    ds_read_b128 v[40:43], v7 offset:48128
    s_waitcnt lgkmcnt(5)
    v_mfma_f32_32x32x16_bf16 v[60:75], v[20:23], a[56:59], v[60:75]
    ds_read_b128 v[12:15], v7 offset:49152
    s_waitcnt lgkmcnt(5)
    v_mfma_f32_32x32x16_bf16 v[60:75], v[24:27], a[60:63], v[60:75]
    ds_read_b128 v[16:19], v7 offset:50176
    s_waitcnt lgkmcnt(5)
    v_mfma_f32_32x32x16_bf16 v[60:75], v[28:31], a[64:67], v[60:75]
    ds_read_b128 v[20:23], v7 offset:51200
    s_waitcnt lgkmcnt(5)
    v_mfma_f32_32x32x16_bf16 v[60:75], v[32:35], a[68:71], v[60:75]
    ds_read_b128 v[24:27], v7 offset:52224
    s_waitcnt lgkmcnt(5)
    v_mfma_f32_32x32x16_bf16 v[60:75], v[36:39], a[72:75], v[60:75]
    ds_read_b128 v[28:31], v7 offset:53248
    s_waitcnt lgkmcnt(5)
    v_mfma_f32_32x32x16_bf16 v[60:75], v[40:43], a[76:79], v[60:75]
    ds_read_b128 v[32:35], v7 offset:54272
    s_waitcnt lgkmcnt(5)
    v_mfma_f32_32x32x16_bf16 v[60:75], v[12:15], a[80:83], v[60:75]
    ds_read_b128 v[36:39], v7 offset:55296
    s_waitcnt vmcnt(7)
    s_barrier
    s_waitcnt lgkmcnt(5)
    v_mfma_f32_32x32x16_bf16 v[60:75], v[16:19], a[84:87], v[60:75]
    ds_read_b128 v[40:43], v7 offset:56320
    s_add_u32 m0, s32, 0
    s_add_u32 s28, s26, 344064
    buffer_load_dwordx4 v4, s[8:11], s28 offen offset:0 sc1 lds
    s_waitcnt lgkmcnt(5)
    v_mfma_f32_32x32x16_bf16 v[60:75], v[20:23], a[88:91], v[60:75]
    ds_read_b128 v[12:15], v8 offset:0
    s_waitcnt lgkmcnt(5)
    v_mfma_f32_32x32x16_bf16 v[60:75], v[24:27], a[92:95], v[60:75]
    ds_read_b128 v[16:19], v8 offset:1024
    buffer_load_dwordx4 v4, s[8:11], s28 offen offset:1024 sc1 lds
    s_waitcnt lgkmcnt(5)
    v_mfma_f32_32x32x16_bf16 v[60:75], v[28:31], a[96:99], v[60:75]
    ds_read_b128 v[20:23], v8 offset:2048
    s_waitcnt lgkmcnt(5)
    v_mfma_f32_32x32x16_bf16 v[60:75], v[32:35], a[100:103], v[60:75]
    ds_read_b128 v[24:27], v8 offset:3072
    buffer_load_dwordx4 v4, s[8:11], s28 offen offset:2048 sc1 lds
    s_waitcnt lgkmcnt(5)
    v_mfma_f32_32x32x16_bf16 v[60:75], v[36:39], a[104:107], v[60:75]
    ds_read_b128 v[28:31], v8 offset:4096
    s_waitcnt lgkmcnt(5)
    v_mfma_f32_32x32x16_bf16 v[60:75], v[40:43], a[108:111], v[60:75]
    ds_read_b128 v[32:35], v8 offset:5120
    buffer_load_dwordx4 v4, s[8:11], s28 offen offset:3072 sc1 lds
    s_waitcnt lgkmcnt(5)
    v_mfma_f32_32x32x16_bf16 v[44:59], v[12:15], a[0:3], 0
    ds_read_b128 v[36:39], v8 offset:6144
    s_waitcnt lgkmcnt(5)
    v_mfma_f32_32x32x16_bf16 v[44:59], v[16:19], a[4:7], v[44:59]
    ds_read_b128 v[40:43], v8 offset:7168
    s_add_u32 m0, s32, 4096
    s_add_u32 s28, s26, 348160
    buffer_load_dwordx4 v4, s[8:11], s28 offen offset:0 sc1 lds
    s_waitcnt lgkmcnt(5)
    v_mfma_f32_32x32x16_bf16 v[44:59], v[20:23], a[8:11], v[44:59]
    ds_read_b128 v[12:15], v8 offset:8192
    s_waitcnt lgkmcnt(5)
    v_mfma_f32_32x32x16_bf16 v[44:59], v[24:27], a[12:15], v[44:59]
    ds_read_b128 v[16:19], v8 offset:9216
    buffer_load_dwordx4 v4, s[8:11], s28 offen offset:1024 sc1 lds
    s_waitcnt lgkmcnt(5)
    v_mfma_f32_32x32x16_bf16 v[44:59], v[28:31], a[16:19], v[44:59]
    ds_read_b128 v[20:23], v8 offset:10240
    v_cvt_pk_bf16_f32 v216, v60, v61
    v_cvt_pk_bf16_f32 v217, v62, v63
    s_waitcnt lgkmcnt(5)
    v_mfma_f32_32x32x16_bf16 v[44:59], v[32:35], a[20:23], v[44:59]
    ds_read_b128 v[24:27], v8 offset:11264
    buffer_load_dwordx4 v4, s[8:11], s28 offen offset:2048 sc1 lds
    v_cvt_pk_bf16_f32 v218, v64, v65
    v_cvt_pk_bf16_f32 v219, v66, v67
    s_waitcnt lgkmcnt(5)
    v_mfma_f32_32x32x16_bf16 v[44:59], v[36:39], a[24:27], v[44:59]
    ds_read_b128 v[28:31], v8 offset:12288
    v_cvt_pk_bf16_f32 v220, v68, v69
    v_cvt_pk_bf16_f32 v221, v70, v71
    s_waitcnt lgkmcnt(5)
    v_mfma_f32_32x32x16_bf16 v[44:59], v[40:43], a[28:31], v[44:59]
    ds_read_b128 v[32:35], v8 offset:13312
    v_cvt_pk_bf16_f32 v222, v72, v73
    v_cvt_pk_bf16_f32 v223, v74, v75
    s_waitcnt lgkmcnt(5)
    v_mfma_f32_32x32x16_bf16 v[44:59], v[12:15], a[32:35], v[44:59]
    ds_read_b128 v[36:39], v8 offset:14336
    s_nop 0
    s_waitcnt lgkmcnt(5)
    v_mfma_f32_32x32x16_bf16 v[44:59], v[16:19], a[36:39], v[44:59]
    ds_read_b128 v[40:43], v8 offset:15360
    v_mfma_f32_32x32x16_bf16 v[84:99], a[72:75], v[216:219], v[84:99]
    s_waitcnt lgkmcnt(5)
    v_mfma_f32_32x32x16_bf16 v[44:59], v[20:23], a[40:43], v[44:59]
    ds_read_b128 v[12:15], v8 offset:16384
    v_mfma_f32_32x32x16_bf16 v[84:99], a[76:79], v[220:223], v[84:99]
    s_waitcnt lgkmcnt(5)
    v_mfma_f32_32x32x16_bf16 v[44:59], v[24:27], a[44:47], v[44:59]
    ds_read_b128 v[16:19], v8 offset:17408
    s_waitcnt lgkmcnt(5)
    v_mfma_f32_32x32x16_bf16 v[44:59], v[28:31], a[48:51], v[44:59]
    ds_read_b128 v[20:23], v8 offset:18432
    s_waitcnt lgkmcnt(5)
    v_mfma_f32_32x32x16_bf16 v[44:59], v[32:35], a[52:55], v[44:59]
    ds_read_b128 v[24:27], v8 offset:19456
    s_waitcnt lgkmcnt(5)
    v_mfma_f32_32x32x16_bf16 v[44:59], v[36:39], a[56:59], v[44:59]
    ds_read_b128 v[28:31], v8 offset:20480
    s_waitcnt lgkmcnt(5)
    v_mfma_f32_32x32x16_bf16 v[44:59], v[40:43], a[60:63], v[44:59]
    ds_read_b128 v[32:35], v8 offset:21504
    s_waitcnt lgkmcnt(5)
    v_mfma_f32_32x32x16_bf16 v[44:59], v[12:15], a[64:67], v[44:59]
    ds_read_b128 v[36:39], v8 offset:22528
    s_waitcnt lgkmcnt(5)
    v_mfma_f32_32x32x16_bf16 v[44:59], v[16:19], a[68:71], v[44:59]
    ds_read_b128 v[40:43], v8 offset:23552
    s_waitcnt lgkmcnt(5)
    v_mfma_f32_32x32x16_bf16 v[44:59], v[20:23], a[72:75], v[44:59]
    ds_read_b128 v[12:15], v8 offset:24576
    s_waitcnt lgkmcnt(5)
    v_mfma_f32_32x32x16_bf16 v[44:59], v[24:27], a[76:79], v[44:59]
    ds_read_b128 v[16:19], v8 offset:25600
    s_waitcnt lgkmcnt(5)
    v_mfma_f32_32x32x16_bf16 v[44:59], v[28:31], a[80:83], v[44:59]
    ds_read_b128 v[20:23], v8 offset:26624
    s_waitcnt vmcnt(7)
    s_barrier
    s_waitcnt lgkmcnt(5)
    v_mfma_f32_32x32x16_bf16 v[44:59], v[32:35], a[84:87], v[44:59]
    ds_read_b128 v[24:27], v8 offset:27648
    s_add_u32 m0, s32, 28672
    s_add_u32 s28, s26, 372736
    buffer_load_dwordx4 v4, s[8:11], s28 offen offset:0 sc1 lds
    s_waitcnt lgkmcnt(5)
    v_mfma_f32_32x32x16_bf16 v[44:59], v[36:39], a[88:91], v[44:59]
    ds_read_b128 v[28:31], v8 offset:28672
    s_waitcnt lgkmcnt(5)
    v_mfma_f32_32x32x16_bf16 v[44:59], v[40:43], a[92:95], v[44:59]
    ds_read_b128 v[32:35], v8 offset:29696
    buffer_load_dwordx4 v4, s[8:11], s28 offen offset:1024 sc1 lds
    s_waitcnt lgkmcnt(5)
    v_mfma_f32_32x32x16_bf16 v[44:59], v[12:15], a[96:99], v[44:59]
    ds_read_b128 v[36:39], v8 offset:30720
    s_waitcnt lgkmcnt(5)
    v_mfma_f32_32x32x16_bf16 v[44:59], v[16:19], a[100:103], v[44:59]
    ds_read_b128 v[40:43], v8 offset:31744
    buffer_load_dwordx4 v4, s[8:11], s28 offen offset:2048 sc1 lds
    s_waitcnt lgkmcnt(5)
    v_mfma_f32_32x32x16_bf16 v[44:59], v[20:23], a[104:107], v[44:59]
    ds_read_b128 v[12:15], v8 offset:32768
    s_waitcnt lgkmcnt(5)
    v_mfma_f32_32x32x16_bf16 v[44:59], v[24:27], a[108:111], v[44:59]
    ds_read_b128 v[16:19], v8 offset:33792
    buffer_load_dwordx4 v4, s[8:11], s28 offen offset:3072 sc1 lds
    s_waitcnt lgkmcnt(5)
    v_mfma_f32_32x32x16_bf16 v[60:75], v[28:31], a[0:3], 0
    ds_read_b128 v[20:23], v8 offset:34816
    s_waitcnt lgkmcnt(5)
    v_mfma_f32_32x32x16_bf16 v[60:75], v[32:35], a[4:7], v[60:75]
    ds_read_b128 v[24:27], v8 offset:35840
    s_add_u32 m0, s32, 32768
    s_add_u32 s28, s26, 376832
    buffer_load_dwordx4 v4, s[8:11], s28 offen offset:0 sc1 lds
    s_waitcnt lgkmcnt(5)
    v_mfma_f32_32x32x16_bf16 v[60:75], v[36:39], a[8:11], v[60:75]
    ds_read_b128 v[28:31], v8 offset:36864
    s_waitcnt lgkmcnt(5)
    v_mfma_f32_32x32x16_bf16 v[60:75], v[40:43], a[12:15], v[60:75]
    ds_read_b128 v[32:35], v8 offset:37888
    buffer_load_dwordx4 v4, s[8:11], s28 offen offset:1024 sc1 lds
    s_waitcnt lgkmcnt(5)
    v_mfma_f32_32x32x16_bf16 v[60:75], v[12:15], a[16:19], v[60:75]
    ds_read_b128 v[36:39], v8 offset:38912
    v_cvt_pk_bf16_f32 v224, v44, v45
    v_cvt_pk_bf16_f32 v225, v46, v47
    s_waitcnt lgkmcnt(5)
    v_mfma_f32_32x32x16_bf16 v[60:75], v[16:19], a[20:23], v[60:75]
    ds_read_b128 v[40:43], v8 offset:39936
    buffer_load_dwordx4 v4, s[8:11], s28 offen offset:2048 sc1 lds
    v_cvt_pk_bf16_f32 v226, v48, v49
    v_cvt_pk_bf16_f32 v227, v50, v51
    s_waitcnt lgkmcnt(5)
    v_mfma_f32_32x32x16_bf16 v[60:75], v[20:23], a[24:27], v[60:75]
    ds_read_b128 v[12:15], v8 offset:40960
    v_cvt_pk_bf16_f32 v228, v52, v53
    v_cvt_pk_bf16_f32 v229, v54, v55
    s_waitcnt lgkmcnt(5)
    v_mfma_f32_32x32x16_bf16 v[60:75], v[24:27], a[28:31], v[60:75]
    ds_read_b128 v[16:19], v8 offset:41984
    v_cvt_pk_bf16_f32 v230, v56, v57
    v_cvt_pk_bf16_f32 v231, v58, v59
    s_waitcnt lgkmcnt(5)
    v_mfma_f32_32x32x16_bf16 v[60:75], v[28:31], a[32:35], v[60:75]
    ds_read_b128 v[20:23], v8 offset:43008
    s_nop 0
    s_waitcnt lgkmcnt(5)
    v_mfma_f32_32x32x16_bf16 v[60:75], v[32:35], a[36:39], v[60:75]
    ds_read_b128 v[24:27], v8 offset:44032
    v_mfma_f32_32x32x16_bf16 v[84:99], a[80:83], v[224:227], v[84:99]
    s_waitcnt lgkmcnt(5)
    v_mfma_f32_32x32x16_bf16 v[60:75], v[36:39], a[40:43], v[60:75]
    ds_read_b128 v[28:31], v8 offset:45056
    v_mfma_f32_32x32x16_bf16 v[84:99], a[84:87], v[228:231], v[84:99]
    s_waitcnt lgkmcnt(5)
    v_mfma_f32_32x32x16_bf16 v[60:75], v[40:43], a[44:47], v[60:75]
    ds_read_b128 v[32:35], v8 offset:46080
    s_waitcnt lgkmcnt(5)
    v_mfma_f32_32x32x16_bf16 v[60:75], v[12:15], a[48:51], v[60:75]
    ds_read_b128 v[36:39], v8 offset:47104
    s_waitcnt lgkmcnt(5)
    v_mfma_f32_32x32x16_bf16 v[60:75], v[16:19], a[52:55], v[60:75]
    ds_read_b128 v[40:43], v8 offset:48128
    s_waitcnt lgkmcnt(5)
    v_mfma_f32_32x32x16_bf16 v[60:75], v[20:23], a[56:59], v[60:75]
    ds_read_b128 v[12:15], v8 offset:49152
    s_waitcnt lgkmcnt(5)
    v_mfma_f32_32x32x16_bf16 v[60:75], v[24:27], a[60:63], v[60:75]
    ds_read_b128 v[16:19], v8 offset:50176
    s_waitcnt lgkmcnt(5)
    v_mfma_f32_32x32x16_bf16 v[60:75], v[28:31], a[64:67], v[60:75]
    ds_read_b128 v[20:23], v8 offset:51200
    s_waitcnt lgkmcnt(5)
    v_mfma_f32_32x32x16_bf16 v[60:75], v[32:35], a[68:71], v[60:75]
    ds_read_b128 v[24:27], v8 offset:52224
    s_waitcnt lgkmcnt(5)
    v_mfma_f32_32x32x16_bf16 v[60:75], v[36:39], a[72:75], v[60:75]
    ds_read_b128 v[28:31], v8 offset:53248
    s_waitcnt lgkmcnt(5)
    v_mfma_f32_32x32x16_bf16 v[60:75], v[40:43], a[76:79], v[60:75]
    ds_read_b128 v[32:35], v8 offset:54272
    s_waitcnt lgkmcnt(5)
    v_mfma_f32_32x32x16_bf16 v[60:75], v[12:15], a[80:83], v[60:75]
    ds_read_b128 v[36:39], v8 offset:55296
    s_waitcnt vmcnt(7)
    s_barrier
    s_waitcnt lgkmcnt(5)
    v_mfma_f32_32x32x16_bf16 v[60:75], v[16:19], a[84:87], v[60:75]
    ds_read_b128 v[40:43], v8 offset:56320
    s_waitcnt lgkmcnt(5)
    v_mfma_f32_32x32x16_bf16 v[60:75], v[20:23], a[88:91], v[60:75]
    ds_read_b128 v[12:15], v7 offset:0
    s_waitcnt lgkmcnt(5)
    v_mfma_f32_32x32x16_bf16 v[60:75], v[24:27], a[92:95], v[60:75]
    ds_read_b128 v[16:19], v7 offset:1024
    s_waitcnt lgkmcnt(5)
    v_mfma_f32_32x32x16_bf16 v[60:75], v[28:31], a[96:99], v[60:75]
    ds_read_b128 v[20:23], v7 offset:2048
    s_waitcnt lgkmcnt(5)
    v_mfma_f32_32x32x16_bf16 v[60:75], v[32:35], a[100:103], v[60:75]
    ds_read_b128 v[24:27], v7 offset:3072
    s_waitcnt lgkmcnt(5)
    v_mfma_f32_32x32x16_bf16 v[60:75], v[36:39], a[104:107], v[60:75]
    ds_read_b128 v[28:31], v7 offset:4096
    s_waitcnt lgkmcnt(5)
    v_mfma_f32_32x32x16_bf16 v[60:75], v[40:43], a[108:111], v[60:75]
    ds_read_b128 v[32:35], v7 offset:5120
    s_waitcnt lgkmcnt(5)
    v_mfma_f32_32x32x16_bf16 v[44:59], v[12:15], a[0:3], 0
    ds_read_b128 v[36:39], v7 offset:6144
    s_waitcnt lgkmcnt(5)
    v_mfma_f32_32x32x16_bf16 v[44:59], v[16:19], a[4:7], v[44:59]
    ds_read_b128 v[40:43], v7 offset:7168
    s_waitcnt lgkmcnt(5)
    v_mfma_f32_32x32x16_bf16 v[44:59], v[20:23], a[8:11], v[44:59]
    ds_read_b128 v[12:15], v7 offset:8192
    s_waitcnt lgkmcnt(5)
    v_mfma_f32_32x32x16_bf16 v[44:59], v[24:27], a[12:15], v[44:59]
    ds_read_b128 v[16:19], v7 offset:9216
    s_waitcnt lgkmcnt(5)
    v_mfma_f32_32x32x16_bf16 v[44:59], v[28:31], a[16:19], v[44:59]
    ds_read_b128 v[20:23], v7 offset:10240
    v_cvt_pk_bf16_f32 v232, v60, v61
    v_cvt_pk_bf16_f32 v233, v62, v63
    s_waitcnt lgkmcnt(5)
    v_mfma_f32_32x32x16_bf16 v[44:59], v[32:35], a[20:23], v[44:59]
    ds_read_b128 v[24:27], v7 offset:11264
    v_cvt_pk_bf16_f32 v234, v64, v65
    v_cvt_pk_bf16_f32 v235, v66, v67
    s_waitcnt lgkmcnt(5)
    v_mfma_f32_32x32x16_bf16 v[44:59], v[36:39], a[24:27], v[44:59]
    ds_read_b128 v[28:31], v7 offset:12288
    v_cvt_pk_bf16_f32 v236, v68, v69
    v_cvt_pk_bf16_f32 v237, v70, v71
    s_waitcnt lgkmcnt(5)
    v_mfma_f32_32x32x16_bf16 v[44:59], v[40:43], a[28:31], v[44:59]
    ds_read_b128 v[32:35], v7 offset:13312
    v_cvt_pk_bf16_f32 v238, v72, v73
    v_cvt_pk_bf16_f32 v239, v74, v75
    s_waitcnt lgkmcnt(5)
    v_mfma_f32_32x32x16_bf16 v[44:59], v[12:15], a[32:35], v[44:59]
    ds_read_b128 v[36:39], v7 offset:14336
    s_nop 0
    s_waitcnt lgkmcnt(5)
    v_mfma_f32_32x32x16_bf16 v[44:59], v[16:19], a[36:39], v[44:59]
    ds_read_b128 v[40:43], v7 offset:15360
    v_mfma_f32_32x32x16_bf16 v[84:99], a[88:91], v[232:235], v[84:99]
    s_waitcnt lgkmcnt(5)
    v_mfma_f32_32x32x16_bf16 v[44:59], v[20:23], a[40:43], v[44:59]
    ds_read_b128 v[12:15], v7 offset:16384
    v_mfma_f32_32x32x16_bf16 v[84:99], a[92:95], v[236:239], v[84:99]
    s_waitcnt lgkmcnt(5)
    v_mfma_f32_32x32x16_bf16 v[44:59], v[24:27], a[44:47], v[44:59]
    ds_read_b128 v[16:19], v7 offset:17408
    s_waitcnt lgkmcnt(5)
    v_mfma_f32_32x32x16_bf16 v[44:59], v[28:31], a[48:51], v[44:59]
    ds_read_b128 v[20:23], v7 offset:18432
    s_waitcnt lgkmcnt(5)
    v_mfma_f32_32x32x16_bf16 v[44:59], v[32:35], a[52:55], v[44:59]
    ds_read_b128 v[24:27], v7 offset:19456
    s_waitcnt lgkmcnt(5)
    v_mfma_f32_32x32x16_bf16 v[44:59], v[36:39], a[56:59], v[44:59]
    ds_read_b128 v[28:31], v7 offset:20480
    s_waitcnt lgkmcnt(5)
    v_mfma_f32_32x32x16_bf16 v[44:59], v[40:43], a[60:63], v[44:59]
    ds_read_b128 v[32:35], v7 offset:21504
    s_waitcnt lgkmcnt(5)
    v_mfma_f32_32x32x16_bf16 v[44:59], v[12:15], a[64:67], v[44:59]
    ds_read_b128 v[36:39], v7 offset:22528
    s_waitcnt lgkmcnt(5)
    v_mfma_f32_32x32x16_bf16 v[44:59], v[16:19], a[68:71], v[44:59]
    ds_read_b128 v[40:43], v7 offset:23552
    s_waitcnt lgkmcnt(5)
    v_mfma_f32_32x32x16_bf16 v[44:59], v[20:23], a[72:75], v[44:59]
    ds_read_b128 v[12:15], v7 offset:24576
    s_waitcnt lgkmcnt(5)
    v_mfma_f32_32x32x16_bf16 v[44:59], v[24:27], a[76:79], v[44:59]
    ds_read_b128 v[16:19], v7 offset:25600
    s_waitcnt lgkmcnt(5)
    v_mfma_f32_32x32x16_bf16 v[44:59], v[28:31], a[80:83], v[44:59]
    ds_read_b128 v[20:23], v7 offset:26624
    s_waitcnt vmcnt(0)
    s_barrier
    s_waitcnt lgkmcnt(5)
    v_mfma_f32_32x32x16_bf16 v[44:59], v[32:35], a[84:87], v[44:59]
    ds_read_b128 v[24:27], v7 offset:27648
    s_waitcnt lgkmcnt(5)
    v_mfma_f32_32x32x16_bf16 v[44:59], v[36:39], a[88:91], v[44:59]
    ds_read_b128 v[28:31], v7 offset:28672
    s_waitcnt lgkmcnt(5)
    v_mfma_f32_32x32x16_bf16 v[44:59], v[40:43], a[92:95], v[44:59]
    ds_read_b128 v[32:35], v7 offset:29696
    s_waitcnt lgkmcnt(5)
    v_mfma_f32_32x32x16_bf16 v[44:59], v[12:15], a[96:99], v[44:59]
    ds_read_b128 v[36:39], v7 offset:30720
    s_waitcnt lgkmcnt(5)
    v_mfma_f32_32x32x16_bf16 v[44:59], v[16:19], a[100:103], v[44:59]
    ds_read_b128 v[40:43], v7 offset:31744
    s_waitcnt lgkmcnt(5)
    v_mfma_f32_32x32x16_bf16 v[44:59], v[20:23], a[104:107], v[44:59]
    ds_read_b128 v[12:15], v7 offset:32768
    s_waitcnt lgkmcnt(5)
    v_mfma_f32_32x32x16_bf16 v[44:59], v[24:27], a[108:111], v[44:59]
    ds_read_b128 v[16:19], v7 offset:33792
    s_waitcnt lgkmcnt(5)
    v_mfma_f32_32x32x16_bf16 v[60:75], v[28:31], a[0:3], 0
    ds_read_b128 v[20:23], v7 offset:34816
    s_waitcnt lgkmcnt(5)
    v_mfma_f32_32x32x16_bf16 v[60:75], v[32:35], a[4:7], v[60:75]
    ds_read_b128 v[24:27], v7 offset:35840
    s_waitcnt lgkmcnt(5)
    v_mfma_f32_32x32x16_bf16 v[60:75], v[36:39], a[8:11], v[60:75]
    ds_read_b128 v[28:31], v7 offset:36864
    s_waitcnt lgkmcnt(5)
    v_mfma_f32_32x32x16_bf16 v[60:75], v[40:43], a[12:15], v[60:75]
    ds_read_b128 v[32:35], v7 offset:37888
    s_waitcnt lgkmcnt(5)
    v_mfma_f32_32x32x16_bf16 v[60:75], v[12:15], a[16:19], v[60:75]
    ds_read_b128 v[36:39], v7 offset:38912
    v_cvt_pk_bf16_f32 v240, v44, v45
    v_cvt_pk_bf16_f32 v241, v46, v47
    s_waitcnt lgkmcnt(5)
    v_mfma_f32_32x32x16_bf16 v[60:75], v[16:19], a[20:23], v[60:75]
    ds_read_b128 v[40:43], v7 offset:39936
    v_cvt_pk_bf16_f32 v242, v48, v49
    v_cvt_pk_bf16_f32 v243, v50, v51
    s_waitcnt lgkmcnt(5)
    v_mfma_f32_32x32x16_bf16 v[60:75], v[20:23], a[24:27], v[60:75]
    ds_read_b128 v[12:15], v7 offset:40960
    v_cvt_pk_bf16_f32 v244, v52, v53
    v_cvt_pk_bf16_f32 v245, v54, v55
    s_waitcnt lgkmcnt(5)
    v_mfma_f32_32x32x16_bf16 v[60:75], v[24:27], a[28:31], v[60:75]
    ds_read_b128 v[16:19], v7 offset:41984
    v_cvt_pk_bf16_f32 v246, v56, v57
    v_cvt_pk_bf16_f32 v247, v58, v59
    s_waitcnt lgkmcnt(5)
    v_mfma_f32_32x32x16_bf16 v[60:75], v[28:31], a[32:35], v[60:75]
    ds_read_b128 v[20:23], v7 offset:43008
    s_nop 0
    s_waitcnt lgkmcnt(5)
    v_mfma_f32_32x32x16_bf16 v[60:75], v[32:35], a[36:39], v[60:75]
    ds_read_b128 v[24:27], v7 offset:44032
    v_mfma_f32_32x32x16_bf16 v[84:99], a[96:99], v[240:243], v[84:99]
    s_waitcnt lgkmcnt(5)
    v_mfma_f32_32x32x16_bf16 v[60:75], v[36:39], a[40:43], v[60:75]
    ds_read_b128 v[28:31], v7 offset:45056
    v_mfma_f32_32x32x16_bf16 v[84:99], a[100:103], v[244:247], v[84:99]
    s_waitcnt lgkmcnt(5)
    v_mfma_f32_32x32x16_bf16 v[60:75], v[40:43], a[44:47], v[60:75]
    ds_read_b128 v[32:35], v7 offset:46080
    s_waitcnt lgkmcnt(5)
    v_mfma_f32_32x32x16_bf16 v[60:75], v[12:15], a[48:51], v[60:75]
    ds_read_b128 v[36:39], v7 offset:47104
    s_waitcnt lgkmcnt(5)
    v_mfma_f32_32x32x16_bf16 v[60:75], v[16:19], a[52:55], v[60:75]
    ds_read_b128 v[40:43], v7 offset:48128
    s_waitcnt lgkmcnt(5)
    v_mfma_f32_32x32x16_bf16 v[60:75], v[20:23], a[56:59], v[60:75]
    ds_read_b128 v[12:15], v7 offset:49152
    s_waitcnt lgkmcnt(5)
    v_mfma_f32_32x32x16_bf16 v[60:75], v[24:27], a[60:63], v[60:75]
    ds_read_b128 v[16:19], v7 offset:50176
    s_waitcnt lgkmcnt(5)
    v_mfma_f32_32x32x16_bf16 v[60:75], v[28:31], a[64:67], v[60:75]
    ds_read_b128 v[20:23], v7 offset:51200
    s_waitcnt lgkmcnt(5)
    v_mfma_f32_32x32x16_bf16 v[60:75], v[32:35], a[68:71], v[60:75]
    ds_read_b128 v[24:27], v7 offset:52224
    s_waitcnt lgkmcnt(5)
    v_mfma_f32_32x32x16_bf16 v[60:75], v[36:39], a[72:75], v[60:75]
    ds_read_b128 v[28:31], v7 offset:53248
    s_waitcnt lgkmcnt(5)
    v_mfma_f32_32x32x16_bf16 v[60:75], v[40:43], a[76:79], v[60:75]
    ds_read_b128 v[32:35], v7 offset:54272
    s_waitcnt lgkmcnt(5)
    v_mfma_f32_32x32x16_bf16 v[60:75], v[12:15], a[80:83], v[60:75]
    ds_read_b128 v[36:39], v7 offset:55296
    s_waitcnt lgkmcnt(5)
    v_mfma_f32_32x32x16_bf16 v[60:75], v[16:19], a[84:87], v[60:75]
    ds_read_b128 v[40:43], v7 offset:56320
    s_waitcnt lgkmcnt(5)
    v_mfma_f32_32x32x16_bf16 v[60:75], v[20:23], a[88:91], v[60:75]
    s_waitcnt lgkmcnt(4)
    v_mfma_f32_32x32x16_bf16 v[60:75], v[24:27], a[92:95], v[60:75]
    s_waitcnt lgkmcnt(3)
    v_mfma_f32_32x32x16_bf16 v[60:75], v[28:31], a[96:99], v[60:75]
    s_waitcnt lgkmcnt(2)
    v_mfma_f32_32x32x16_bf16 v[60:75], v[32:35], a[100:103], v[60:75]
    s_waitcnt lgkmcnt(1)
    v_mfma_f32_32x32x16_bf16 v[60:75], v[36:39], a[104:107], v[60:75]
    s_waitcnt lgkmcnt(0)
    v_mfma_f32_32x32x16_bf16 v[60:75], v[40:43], a[108:111], v[60:75]
    s_nop 11
    v_cvt_pk_bf16_f32 v248, v60, v61
    v_cvt_pk_bf16_f32 v249, v62, v63
    s_nop 0
    v_cvt_pk_bf16_f32 v250, v64, v65
    v_cvt_pk_bf16_f32 v251, v66, v67
    s_nop 0
    v_cvt_pk_bf16_f32 v252, v68, v69
    v_cvt_pk_bf16_f32 v253, v70, v71
    s_nop 0
    v_cvt_pk_bf16_f32 v254, v72, v73
    v_cvt_pk_bf16_f32 v255, v74, v75
    s_nop 0
    s_nop 0
    s_nop 0
    v_mfma_f32_32x32x16_bf16 v[84:99], a[104:107], v[248:251], v[84:99]
    s_nop 0
    v_mfma_f32_32x32x16_bf16 v[84:99], a[108:111], v[252:255], v[84:99]
    s_nop 0
    v_bfe_u32 v3, v0, 5, 1
    v_lshlrev_b32 v3, 2, v3
    v_sub_u32 v4, v117, v3
    v_mov_b32 v5, 0xff800000
    v_sub_f32 v116, 1.0, v116
    v_mov_b64 v[44:45], 0
    v_mov_b64 v[46:47], 0
    v_mov_b64 v[48:49], 0
    v_mov_b64 v[50:51], 0
    v_mov_b64 v[52:53], 0
    v_mov_b64 v[54:55], 0
    v_mov_b64 v[56:57], 0
    v_mov_b64 v[58:59], 0
    v_mov_b64 v[60:61], 0
    v_mov_b64 v[62:63], 0
    v_mov_b64 v[64:65], 0
    v_mov_b64 v[66:67], 0
    v_mov_b64 v[68:69], 0
    v_mov_b64 v[70:71], 0
    v_mov_b64 v[72:73], 0
    v_mov_b64 v[74:75], 0
    v_bfe_u32 v3, v0, 4, 1
    v_lshlrev_b32 v7, 9, v3
    v_bfe_u32 v3, v0, 5, 1
    v_lshl_add_u32 v7, v3, 8, v7
    v_bfe_u32 v3, v0, 0, 4
    v_lshl_add_u32 v7, v3, 4, v7
    v_and_b32 v121, 63, v0
    v_min_u32 v121, 55, v121
    v_lshlrev_b32 v121, 7, v121
    v_and_b32 v122, 1, v0
    v_mul_u32_u24 v122, 0xaaaa, v122
    v_add_u32 v122, 0x4444, v122
    v_cmp_le_i32 vcc, 0, v4
    s_nop 1
    v_cndmask_b32 v84, v5, v84, vcc
    v_cmp_le_i32 vcc, 1, v4
    s_nop 1
    v_cndmask_b32 v85, v5, v85, vcc
    v_cmp_le_i32 vcc, 2, v4
    s_nop 1
    v_cndmask_b32 v86, v5, v86, vcc
    v_cmp_le_i32 vcc, 3, v4
    s_nop 1
    v_cndmask_b32 v87, v5, v87, vcc
    v_cmp_le_i32 vcc, 8, v4
    s_nop 1
    v_cndmask_b32 v88, v5, v88, vcc
    v_cmp_le_i32 vcc, 9, v4
    s_nop 1
    v_cndmask_b32 v89, v5, v89, vcc
    v_cmp_le_i32 vcc, 10, v4
    s_nop 1
    v_cndmask_b32 v90, v5, v90, vcc
    v_cmp_le_i32 vcc, 11, v4
    s_nop 1
    v_cndmask_b32 v91, v5, v91, vcc
    v_cmp_le_i32 vcc, 16, v4
    s_nop 1
    v_cndmask_b32 v92, v5, v92, vcc
    v_cmp_le_i32 vcc, 17, v4
    s_nop 1
    v_cndmask_b32 v93, v5, v93, vcc
    v_cmp_le_i32 vcc, 18, v4
    s_nop 1
    v_cndmask_b32 v94, v5, v94, vcc
    v_cmp_le_i32 vcc, 19, v4
    s_nop 1
    v_cndmask_b32 v95, v5, v95, vcc
    v_cmp_le_i32 vcc, 24, v4
    s_nop 1
    v_cndmask_b32 v96, v5, v96, vcc
    v_cmp_le_i32 vcc, 25, v4
    s_nop 1
    v_cndmask_b32 v97, v5, v97, vcc
    v_cmp_le_i32 vcc, 26, v4
    s_nop 1
    v_cndmask_b32 v98, v5, v98, vcc
    v_cmp_le_i32 vcc, 27, v4
    s_nop 1
    v_cndmask_b32 v99, v5, v99, vcc
    v_max3_f32 v118, v84, v85, v86
    v_max3_f32 v118, v87, v88, v118
    v_max3_f32 v118, v89, v90, v118
    v_max3_f32 v118, v91, v92, v118
    v_max3_f32 v118, v93, v94, v118
    v_max3_f32 v118, v95, v96, v118
    v_max3_f32 v118, v97, v98, v118
    v_max_f32 v118, v99, v118
    v_mov_b32 v3, v118
    s_nop 1
    v_permlane32_swap_b32 v118, v3
    v_max_f32 v118, v118, v3
    v_sub_f32 v84, v84, v118
    v_sub_f32 v85, v85, v118
    v_sub_f32 v86, v86, v118
    v_sub_f32 v87, v87, v118
    v_sub_f32 v88, v88, v118
    v_sub_f32 v89, v89, v118
    v_sub_f32 v90, v90, v118
    v_sub_f32 v91, v91, v118
    v_sub_f32 v92, v92, v118
    v_sub_f32 v93, v93, v118
    v_sub_f32 v94, v94, v118
    v_sub_f32 v95, v95, v118
    v_sub_f32 v96, v96, v118
    v_sub_f32 v97, v97, v118
    v_sub_f32 v98, v98, v118
    v_sub_f32 v99, v99, v118
    v_exp_f32 v84, v84
    v_exp_f32 v85, v85
    v_exp_f32 v86, v86
    v_exp_f32 v87, v87
    v_exp_f32 v88, v88
    v_exp_f32 v89, v89
    v_exp_f32 v90, v90
    v_exp_f32 v91, v91
    v_exp_f32 v92, v92
    v_exp_f32 v93, v93
    v_exp_f32 v94, v94
    v_exp_f32 v95, v95
    v_exp_f32 v96, v96
    v_exp_f32 v97, v97
    v_exp_f32 v98, v98
    v_exp_f32 v99, v99
    v_add_f32 v119, v84, v85
    v_add_f32 v119, v86, v119
    v_add_f32 v119, v87, v119
    v_add_f32 v119, v88, v119
    v_add_f32 v119, v89, v119
    v_add_f32 v119, v90, v119
    v_add_f32 v119, v91, v119
    v_add_f32 v119, v92, v119
    v_add_f32 v119, v93, v119
    v_add_f32 v119, v94, v119
    v_add_f32 v119, v95, v119
    v_add_f32 v119, v96, v119
    v_add_f32 v119, v97, v119
    v_add_f32 v119, v98, v119
    v_add_f32 v119, v99, v119
    s_mul_i32 s26, s33, 7168
    s_add_u32 s26, s26, 17825792
    s_add_u32 s27, s26, 4096
    s_sub_u32 s29, s26, 7168
    s_max_u32 s29, s29, 17825792
pm_61:
    s_sub_u32 s23, s23, 1
    s_cbranch_scc1 pm_61x
    buffer_load_dword v3, v121, s[8:11], s29 offen sc1
    s_waitcnt vmcnt(0)
    v_cmp_eq_u32 vcc, -1, v3
    s_cbranch_vccz pm_61f
    s_sleep 6
    s_branch pm_61
pm_61f:
    buffer_load_dwordx4 v[12:15], v7, s[8:11], s26 offen offset:0 sc1
    buffer_load_dwordx4 v[16:19], v7, s[8:11], s26 offen offset:1024 sc1
    buffer_load_dwordx4 v[20:23], v7, s[8:11], s26 offen offset:2048 sc1
    buffer_load_dwordx4 v[24:27], v7, s[8:11], s26 offen offset:3072 sc1
    buffer_load_dwordx4 v[28:31], v7, s[8:11], s27 offen offset:0 sc1
    buffer_load_dwordx4 v[32:35], v7, s[8:11], s27 offen offset:1024 sc1
    buffer_load_dwordx4 v[36:39], v7, s[8:11], s27 offen offset:2048 sc1
    v_mov_b32 v3, 0
    s_waitcnt vmcnt(6)
    v_max3_u32 v3, v12, v13, v3
    v_max3_u32 v3, v14, v15, v3
    s_waitcnt vmcnt(5)
    v_max3_u32 v3, v16, v17, v3
    v_max3_u32 v3, v18, v19, v3
    s_waitcnt vmcnt(4)
    v_max3_u32 v3, v20, v21, v3
    v_max3_u32 v3, v22, v23, v3
    s_waitcnt vmcnt(3)
    v_max3_u32 v3, v24, v25, v3
    v_max3_u32 v3, v26, v27, v3
    s_waitcnt vmcnt(2)
    v_max3_u32 v3, v28, v29, v3
    v_max3_u32 v3, v30, v31, v3
    s_waitcnt vmcnt(1)
    v_max3_u32 v3, v32, v33, v3
    v_max3_u32 v3, v34, v35, v3
    s_waitcnt vmcnt(0)
    v_max3_u32 v3, v36, v37, v3
    v_max3_u32 v3, v38, v39, v3
    v_cmp_eq_u32 vcc, -1, v3
    s_cbranch_vccz pm_61g
    s_sub_u32 s23, s23, 1
    s_cbranch_scc0 pm_61f
pm_61x:
    s_mov_b32 s23, 0
pm_61g:
    v_smfmac_f32_32x32x32_bf16 v[44:59], v[12:15], v[144:151], v122
    v_smfmac_f32_32x32x32_bf16 v[60:75], v[12:15], v[152:159], v122
    v_smfmac_f32_32x32x32_bf16 v[44:59], v[16:19], v[160:167], v122
    v_smfmac_f32_32x32x32_bf16 v[60:75], v[16:19], v[168:175], v122
    v_smfmac_f32_32x32x32_bf16 v[44:59], v[20:23], v[176:183], v122
    v_smfmac_f32_32x32x32_bf16 v[60:75], v[20:23], v[184:191], v122
    v_smfmac_f32_32x32x32_bf16 v[44:59], v[24:27], v[192:199], v122
    v_smfmac_f32_32x32x32_bf16 v[60:75], v[24:27], v[200:207], v122
    v_smfmac_f32_32x32x32_bf16 v[44:59], v[28:31], v[208:215], v122
    v_smfmac_f32_32x32x32_bf16 v[60:75], v[28:31], v[216:223], v122
    v_smfmac_f32_32x32x32_bf16 v[44:59], v[32:35], v[224:231], v122
    v_smfmac_f32_32x32x32_bf16 v[60:75], v[32:35], v[232:239], v122
    v_smfmac_f32_32x32x32_bf16 v[44:59], v[36:39], v[240:247], v122
    v_smfmac_f32_32x32x32_bf16 v[60:75], v[36:39], v[248:255], v122
    s_nop 10
    v_add_f32 v100, v44, v45
    v_add_f32 v101, v46, v47
    v_add_f32 v102, v48, v49
    v_add_f32 v103, v50, v51
    v_add_f32 v100, v100, v68
    v_add_f32 v101, v101, v70
    v_add_f32 v102, v102, v72
    v_add_f32 v103, v103, v74
    v_add_f32 v100, v100, v69
    v_add_f32 v101, v101, v71
    v_add_f32 v102, v102, v73
    v_add_f32 v103, v103, v75
    v_max3_f32 v4, v100, v101, v118
    v_max3_f32 v4, v102, v103, v4
    v_mov_b32 v3, v4
    s_nop 1
    v_permlane32_swap_b32 v4, v3
    v_max_f32 v4, v4, v3
    v_sub_f32 v118, v118, v4
    v_sub_f32 v100, v100, v4
    v_sub_f32 v101, v101, v4
    v_sub_f32 v102, v102, v4
    v_sub_f32 v103, v103, v4
    v_exp_f32 v118, v118
    v_exp_f32 v100, v100
    v_exp_f32 v101, v101
    v_exp_f32 v102, v102
    v_exp_f32 v103, v103
    v_fma_f32 v119, v119, v118, v100
    v_add_f32 v119, v101, v119
    v_add_f32 v119, v102, v119
    v_add_f32 v119, v103, v119
    v_mov_b32 v3, v119
    s_nop 1
    v_permlane32_swap_b32 v119, v3
    v_add_f32 v119, v119, v3
    v_rcp_f32 v119, v119
    s_nop 0
    v_mul_f32 v119, v119, v116
    v_mul_f32 v118, v118, v119
    v_mul_f32 v84, v84, v118
    v_mul_f32 v85, v85, v118
    v_mul_f32 v86, v86, v118
    v_mul_f32 v87, v87, v118
    v_mul_f32 v88, v88, v118
    v_mul_f32 v89, v89, v118
    v_mul_f32 v90, v90, v118
    v_mul_f32 v91, v91, v118
    v_mul_f32 v92, v92, v118
    v_mul_f32 v93, v93, v118
    v_mul_f32 v94, v94, v118
    v_mul_f32 v95, v95, v118
    v_mul_f32 v96, v96, v118
    v_mul_f32 v97, v97, v118
    v_mul_f32 v98, v98, v118
    v_mul_f32 v99, v99, v118
    v_cvt_pk_bf16_f32 v76, v84, v85
    v_cvt_pk_bf16_f32 v77, v86, v87
    v_cvt_pk_bf16_f32 v78, v88, v89
    v_cvt_pk_bf16_f32 v79, v90, v91
    v_cvt_pk_bf16_f32 v80, v92, v93
    v_cvt_pk_bf16_f32 v81, v94, v95
    v_cvt_pk_bf16_f32 v82, v96, v97
    v_cvt_pk_bf16_f32 v83, v98, v99
    v_mul_f32 v100, v100, v119
    v_mul_f32 v101, v101, v119
    v_mul_f32 v102, v102, v119
    v_mul_f32 v103, v103, v119
    v_cvt_pk_bf16_f32 v3, v100, v101
    v_cvt_pk_bf16_f32 v4, v102, v103
    s_cmp_eq_u32 s36, 0
    s_cbranch_scc1 sp_62
    buffer_store_dwordx4 v[76:79], v2, s[8:11], s34 offen offset:0
    buffer_store_dwordx4 v[80:83], v2, s[8:11], s34 offen offset:1024
    buffer_store_dword v3, v120, s[8:11], s35 offen offset:0
    buffer_store_dword v4, v120, s[8:11], s35 offen offset:256
    s_branch sp_62e
sp_62:
    buffer_store_dwordx4 v[76:79], v2, s[8:11], s34 offen offset:0 sc1
    buffer_store_dwordx4 v[80:83], v2, s[8:11], s34 offen offset:1024 sc1
    buffer_store_dword v3, v120, s[8:11], s35 offen offset:0 sc1
    buffer_store_dword v4, v120, s[8:11], s35 offen offset:256 sc1
sp_62e:
    s_barrier
    s_branch main_next
job_4:
    s_lshl_b32 s33, s25, 2
    s_add_u32 s33, s33, s21
    s_lshr_b32 s28, s24, 2
    s_lshl_b32 s28, s28, 7
    s_add_u32 s28, s28, 18620416
wc_64:
    buffer_load_dword v3, off, s[8:11], s28 sc1
    s_waitcnt vmcnt(0)
    v_cmp_gt_u32 vcc, 16, v3
    s_cbranch_vccz wc_64k
    s_sleep 12
    s_sub_u32 s23, s23, 1
    s_cbranch_scc0 wc_64
    s_mov_b32 s23, 0
wc_64k:
    s_lshl_b32 s26, s24, 18
    s_add_u32 s26, s26, 61865984
    s_lshl_b32 s27, s24, 6
    s_add_u32 s27, s27, s33
    s_lshl_b32 s27, s27, 11
    s_add_u32 s27, s27, 59768832
    s_lshl_b32 s32, s21, 13
    v_add_u32 v4, s32, v2
    s_mov_b32 s35, 0
    buffer_load_dwordx4 v[116:119], v2, s[8:11], s27 offen offset:0 sc1
    buffer_load_dwordx4 v[120:123], v2, s[8:11], s27 offen offset:1024 sc1
att_63_start:
    s_add_u32 s29, s32, 0
    s_add_u32 s30, s26, 0
    s_add_u32 m0, s29, 0
    s_add_u32 s28, s30, 0
    buffer_load_dwordx4 v4, s[8:11], s28 offen offset:0 sc1 lds
    buffer_load_dwordx4 v4, s[8:11], s28 offen offset:1024 sc1 lds
    buffer_load_dwordx4 v4, s[8:11], s28 offen offset:2048 sc1 lds
    buffer_load_dwordx4 v4, s[8:11], s28 offen offset:3072 sc1 lds
    s_add_u32 m0, s29, 4096
    s_add_u32 s28, s30, 4096
    buffer_load_dwordx4 v4, s[8:11], s28 offen offset:0 sc1 lds
    buffer_load_dwordx4 v4, s[8:11], s28 offen offset:1024 sc1 lds
    buffer_load_dwordx4 v4, s[8:11], s28 offen offset:2048 sc1 lds
    buffer_load_dwordx4 v4, s[8:11], s28 offen offset:3072 sc1 lds
    s_add_u32 s29, s32, 32768
    s_add_u32 s30, s26, 32768
    s_add_u32 m0, s29, 0
    s_add_u32 s28, s30, 0
    buffer_load_dwordx4 v4, s[8:11], s28 offen offset:0 sc1 lds
    buffer_load_dwordx4 v4, s[8:11], s28 offen offset:1024 sc1 lds
    buffer_load_dwordx4 v4, s[8:11], s28 offen offset:2048 sc1 lds
    buffer_load_dwordx4 v4, s[8:11], s28 offen offset:3072 sc1 lds
    s_add_u32 m0, s29, 4096
    s_add_u32 s28, s30, 4096
    buffer_load_dwordx4 v4, s[8:11], s28 offen offset:0 sc1 lds
    buffer_load_dwordx4 v4, s[8:11], s28 offen offset:1024 sc1 lds
    buffer_load_dwordx4 v4, s[8:11], s28 offen offset:2048 sc1 lds
    buffer_load_dwordx4 v4, s[8:11], s28 offen offset:3072 sc1 lds
    s_add_u32 s29, s32, 65536
    s_add_u32 s30, s26, 65536
    s_add_u32 m0, s29, 0
    s_add_u32 s28, s30, 0
    buffer_load_dwordx4 v4, s[8:11], s28 offen offset:0 sc1 lds
    buffer_load_dwordx4 v4, s[8:11], s28 offen offset:1024 sc1 lds
    buffer_load_dwordx4 v4, s[8:11], s28 offen offset:2048 sc1 lds
    buffer_load_dwordx4 v4, s[8:11], s28 offen offset:3072 sc1 lds
    s_add_u32 m0, s29, 4096
    s_add_u32 s28, s30, 4096
    buffer_load_dwordx4 v4, s[8:11], s28 offen offset:0 sc1 lds
    buffer_load_dwordx4 v4, s[8:11], s28 offen offset:1024 sc1 lds
    buffer_load_dwordx4 v4, s[8:11], s28 offen offset:2048 sc1 lds
    buffer_load_dwordx4 v4, s[8:11], s28 offen offset:3072 sc1 lds
    v_mov_b32 v7, v2
    v_add_u32 v8, 32768, v2
    v_mov_b64 v[84:85], 0
    v_mov_b64 v[86:87], 0
    v_mov_b64 v[88:89], 0
    v_mov_b64 v[90:91], 0
    v_mov_b64 v[92:93], 0
    v_mov_b64 v[94:95], 0
    v_mov_b64 v[96:97], 0
    v_mov_b64 v[98:99], 0
    v_mov_b64 v[80:81], 0
    v_mov_b64 v[82:83], 0
    v_mov_b64 v[40:41], 0
    v_mov_b64 v[42:43], 0
    s_mov_b32 s34, 0
    s_waitcnt vmcnt(16)
    s_barrier
    ds_read_b128 v[12:15], v7 offset:0
    ds_read_b128 v[16:19], v7 offset:1024
    ds_read_b128 v[20:23], v7 offset:4096
    ds_read_b128 v[28:31], v7 offset:2048
    ds_read_b128 v[24:27], v7 offset:5120
    ds_read_b128 v[32:35], v7 offset:3072
    s_waitcnt lgkmcnt(4)
    s_cmp_lg_u32 s35, 0
    s_cbranch_scc1 att_63_shift
    v_mfma_f32_32x32x16_bf16 v[44:59], v[12:15], v[116:119], 0
    v_mfma_f32_32x32x16_bf16 v[44:59], v[16:19], v[120:123], v[44:59]
    v_mov_b32 v124, 0xff800000
    s_nop 10
    v_max3_f32 v3, v44, v45, v46
    v_max3_f32 v3, v47, v48, v3
    v_max3_f32 v3, v49, v50, v3
    v_max3_f32 v3, v51, v52, v3
    v_max3_f32 v3, v53, v54, v3
    v_max3_f32 v3, v55, v56, v3
    v_max3_f32 v3, v57, v58, v3
    v_max3_f32 v124, v59, v3, v124
    v_mov_b32 v3, v124
    s_nop 1
    v_permlane32_swap_b32 v124, v3
    v_max_f32 v124, v124, v3
    v_sub_f32 v100, 0, v124
    v_sub_f32 v101, 0, v124
    v_sub_f32 v102, 0, v124
    v_sub_f32 v103, 0, v124
    v_sub_f32 v104, 0, v124
    v_sub_f32 v105, 0, v124
    v_sub_f32 v106, 0, v124
    v_sub_f32 v107, 0, v124
    v_sub_f32 v108, 0, v124
    v_sub_f32 v109, 0, v124
    v_sub_f32 v110, 0, v124
    v_sub_f32 v111, 0, v124
    v_sub_f32 v112, 0, v124
    v_sub_f32 v113, 0, v124
    v_sub_f32 v114, 0, v124
    v_sub_f32 v115, 0, v124
att_63_shift:
    s_nop 1
    v_mfma_f32_32x32x16_bf16 v[44:59], v[12:15], v[116:119], v[100:115]
    v_mfma_f32_32x32x16_bf16 v[44:59], v[16:19], v[120:123], v[44:59]
    s_nop 9
.p2align 6
att_63_loop:
    s_add_u32 s30, s34, 3
    s_and_b32 s36, s30, 3
    s_lshl_b32 s36, s36, 15
    s_add_u32 s29, s36, s32
    s_and_b32 s30, s30, 7
    s_lshl_b32 s30, s30, 15
    s_add_u32 s30, s30, s26
    s_waitcnt lgkmcnt(3)
    v_mfma_f32_32x32x16_bf16 v[60:75], v[20:23], v[116:119], v[100:115]
    ds_read_b128 v[12:15], v7 offset:8192
    v_exp_f32 v44, v44
    v_exp_f32 v45, v45
    v_exp_f32 v46, v46
    v_exp_f32 v47, v47
    v_cvt_pk_bf16_f32 v76, v44, v45
    v_cvt_pk_bf16_f32 v77, v46, v47
    v_mfma_f32_32x32x16_bf16 v[84:99], v[40:43], v[80:83], v[84:99]
    ds_read_b128 v[36:39], v7 offset:6144
    v_exp_f32 v48, v48
    v_exp_f32 v49, v49
    v_exp_f32 v50, v50
    v_exp_f32 v51, v51
    v_cvt_pk_bf16_f32 v78, v48, v49
    v_cvt_pk_bf16_f32 v79, v50, v51
    s_waitcnt lgkmcnt(3)
    v_mfma_f32_32x32x16_bf16 v[60:75], v[24:27], v[120:123], v[60:75]
    ds_read_b128 v[16:19], v7 offset:9216
    v_exp_f32 v52, v52
    v_exp_f32 v53, v53
    v_exp_f32 v54, v54
    v_exp_f32 v55, v55
    v_cvt_pk_bf16_f32 v80, v52, v53
    v_cvt_pk_bf16_f32 v81, v54, v55
    v_mfma_f32_32x32x16_bf16 v[84:99], v[28:31], v[76:79], v[84:99]
    ds_read_b128 v[40:43], v7 offset:7168
    v_exp_f32 v56, v56
    v_exp_f32 v57, v57
    v_exp_f32 v58, v58
    v_exp_f32 v59, v59
    v_cvt_pk_bf16_f32 v82, v56, v57
    v_cvt_pk_bf16_f32 v83, v58, v59
    s_waitcnt lgkmcnt(3)
    v_mfma_f32_32x32x16_bf16 v[44:59], v[12:15], v[116:119], v[100:115]
    ds_read_b128 v[20:23], v7 offset:12288
    v_exp_f32 v60, v60
    v_exp_f32 v61, v61
    v_exp_f32 v62, v62
    v_exp_f32 v63, v63
    v_cvt_pk_bf16_f32 v76, v60, v61
    v_cvt_pk_bf16_f32 v77, v62, v63
    v_mfma_f32_32x32x16_bf16 v[84:99], v[32:35], v[80:83], v[84:99]
    ds_read_b128 v[28:31], v7 offset:10240
    v_exp_f32 v64, v64
    v_exp_f32 v65, v65
    v_exp_f32 v66, v66
    v_exp_f32 v67, v67
    v_cvt_pk_bf16_f32 v78, v64, v65
    v_cvt_pk_bf16_f32 v79, v66, v67
    s_waitcnt lgkmcnt(3)
    v_mfma_f32_32x32x16_bf16 v[44:59], v[16:19], v[120:123], v[44:59]
    ds_read_b128 v[24:27], v7 offset:13312
    v_exp_f32 v68, v68
    v_exp_f32 v69, v69
    v_exp_f32 v70, v70
    v_exp_f32 v71, v71
    v_cvt_pk_bf16_f32 v80, v68, v69
    v_cvt_pk_bf16_f32 v81, v70, v71
    v_mfma_f32_32x32x16_bf16 v[84:99], v[36:39], v[76:79], v[84:99]
    ds_read_b128 v[32:35], v7 offset:11264
    v_exp_f32 v72, v72
    v_exp_f32 v73, v73
    v_exp_f32 v74, v74
    v_exp_f32 v75, v75
    v_cvt_pk_bf16_f32 v82, v72, v73
    v_cvt_pk_bf16_f32 v83, v74, v75
    s_waitcnt lgkmcnt(3)
    v_mfma_f32_32x32x16_bf16 v[60:75], v[20:23], v[116:119], v[100:115]
    ds_read_b128 v[12:15], v7 offset:16384
    v_exp_f32 v44, v44
    v_exp_f32 v45, v45
    v_exp_f32 v46, v46
    v_exp_f32 v47, v47
    v_cvt_pk_bf16_f32 v76, v44, v45
    v_cvt_pk_bf16_f32 v77, v46, v47
    v_mfma_f32_32x32x16_bf16 v[84:99], v[40:43], v[80:83], v[84:99]
    ds_read_b128 v[36:39], v7 offset:14336
    v_exp_f32 v48, v48
    v_exp_f32 v49, v49
    v_exp_f32 v50, v50
    v_exp_f32 v51, v51
    v_cvt_pk_bf16_f32 v78, v48, v49
    v_cvt_pk_bf16_f32 v79, v50, v51
    s_waitcnt lgkmcnt(3)
    v_mfma_f32_32x32x16_bf16 v[60:75], v[24:27], v[120:123], v[60:75]
    ds_read_b128 v[16:19], v7 offset:17408
    v_exp_f32 v52, v52
    v_exp_f32 v53, v53
    v_exp_f32 v54, v54
    v_exp_f32 v55, v55
    v_cvt_pk_bf16_f32 v80, v52, v53
    v_cvt_pk_bf16_f32 v81, v54, v55
    v_mfma_f32_32x32x16_bf16 v[84:99], v[28:31], v[76:79], v[84:99]
    ds_read_b128 v[40:43], v7 offset:15360
    v_exp_f32 v56, v56
    v_exp_f32 v57, v57
    v_exp_f32 v58, v58
    v_exp_f32 v59, v59
    v_cvt_pk_bf16_f32 v82, v56, v57
    v_cvt_pk_bf16_f32 v83, v58, v59
    s_waitcnt lgkmcnt(3)
    v_mfma_f32_32x32x16_bf16 v[44:59], v[12:15], v[116:119], v[100:115]
    ds_read_b128 v[20:23], v7 offset:20480
    v_exp_f32 v60, v60
    v_exp_f32 v61, v61
    v_exp_f32 v62, v62
    v_exp_f32 v63, v63
    v_cvt_pk_bf16_f32 v76, v60, v61
    v_cvt_pk_bf16_f32 v77, v62, v63
    v_mfma_f32_32x32x16_bf16 v[84:99], v[32:35], v[80:83], v[84:99]
    ds_read_b128 v[28:31], v7 offset:18432
    v_exp_f32 v64, v64
    v_exp_f32 v65, v65
    v_exp_f32 v66, v66
    v_exp_f32 v67, v67
    v_cvt_pk_bf16_f32 v78, v64, v65
    v_cvt_pk_bf16_f32 v79, v66, v67
    s_waitcnt lgkmcnt(3)
    v_mfma_f32_32x32x16_bf16 v[44:59], v[16:19], v[120:123], v[44:59]
    ds_read_b128 v[24:27], v7 offset:21504
    v_exp_f32 v68, v68
    v_exp_f32 v69, v69
    v_exp_f32 v70, v70
    v_exp_f32 v71, v71
    v_cvt_pk_bf16_f32 v80, v68, v69
    v_cvt_pk_bf16_f32 v81, v70, v71
    v_mfma_f32_32x32x16_bf16 v[84:99], v[36:39], v[76:79], v[84:99]
    ds_read_b128 v[32:35], v7 offset:19456
    v_exp_f32 v72, v72
    v_exp_f32 v73, v73
    v_exp_f32 v74, v74
    v_exp_f32 v75, v75
    v_cvt_pk_bf16_f32 v82, v72, v73
    v_cvt_pk_bf16_f32 v83, v74, v75
    s_waitcnt vmcnt(8)
    s_barrier
    s_waitcnt lgkmcnt(3)
    v_mfma_f32_32x32x16_bf16 v[60:75], v[20:23], v[116:119], v[100:115]
    ds_read_b128 v[12:15], v7 offset:24576
    v_exp_f32 v44, v44
    v_exp_f32 v45, v45
    v_exp_f32 v46, v46
    v_exp_f32 v47, v47
    v_cvt_pk_bf16_f32 v76, v44, v45
    v_cvt_pk_bf16_f32 v77, v46, v47
    v_mfma_f32_32x32x16_bf16 v[84:99], v[40:43], v[80:83], v[84:99]
    ds_read_b128 v[36:39], v7 offset:22528
    s_add_u32 m0, s29, 0
    s_add_u32 s28, s30, 0
    buffer_load_dwordx4 v4, s[8:11], s28 offen offset:0 sc1 lds
    v_exp_f32 v48, v48
    v_exp_f32 v49, v49
    v_exp_f32 v50, v50
    v_exp_f32 v51, v51
    v_cvt_pk_bf16_f32 v78, v48, v49
    v_cvt_pk_bf16_f32 v79, v50, v51
    s_waitcnt lgkmcnt(3)
    v_mfma_f32_32x32x16_bf16 v[60:75], v[24:27], v[120:123], v[60:75]
    ds_read_b128 v[16:19], v7 offset:25600
    v_exp_f32 v52, v52
    v_exp_f32 v53, v53
    v_exp_f32 v54, v54
    v_exp_f32 v55, v55
    v_cvt_pk_bf16_f32 v80, v52, v53
    v_cvt_pk_bf16_f32 v81, v54, v55
    v_mfma_f32_32x32x16_bf16 v[84:99], v[28:31], v[76:79], v[84:99]
    ds_read_b128 v[40:43], v7 offset:23552
    buffer_load_dwordx4 v4, s[8:11], s28 offen offset:1024 sc1 lds
    v_exp_f32 v56, v56
    v_exp_f32 v57, v57
    v_exp_f32 v58, v58
    v_exp_f32 v59, v59
    v_cvt_pk_bf16_f32 v82, v56, v57
    v_cvt_pk_bf16_f32 v83, v58, v59
    s_waitcnt lgkmcnt(3)
    v_mfma_f32_32x32x16_bf16 v[44:59], v[12:15], v[116:119], v[100:115]
    ds_read_b128 v[20:23], v7 offset:28672
    v_exp_f32 v60, v60
    v_exp_f32 v61, v61
    v_exp_f32 v62, v62
    v_exp_f32 v63, v63
    v_cvt_pk_bf16_f32 v76, v60, v61
    v_cvt_pk_bf16_f32 v77, v62, v63
    v_mfma_f32_32x32x16_bf16 v[84:99], v[32:35], v[80:83], v[84:99]
    ds_read_b128 v[28:31], v7 offset:26624
    buffer_load_dwordx4 v4, s[8:11], s28 offen offset:2048 sc1 lds
    v_exp_f32 v64, v64
    v_exp_f32 v65, v65
    v_exp_f32 v66, v66
    v_exp_f32 v67, v67
    v_cvt_pk_bf16_f32 v78, v64, v65
    v_cvt_pk_bf16_f32 v79, v66, v67
    s_waitcnt lgkmcnt(3)
    v_mfma_f32_32x32x16_bf16 v[44:59], v[16:19], v[120:123], v[44:59]
    ds_read_b128 v[24:27], v7 offset:29696
    v_exp_f32 v68, v68
    v_exp_f32 v69, v69
    v_exp_f32 v70, v70
    v_exp_f32 v71, v71
    v_cvt_pk_bf16_f32 v80, v68, v69
    v_cvt_pk_bf16_f32 v81, v70, v71
    v_mfma_f32_32x32x16_bf16 v[84:99], v[36:39], v[76:79], v[84:99]
    ds_read_b128 v[32:35], v7 offset:27648
    buffer_load_dwordx4 v4, s[8:11], s28 offen offset:3072 sc1 lds
    v_exp_f32 v72, v72
    v_exp_f32 v73, v73
    v_exp_f32 v74, v74
    v_exp_f32 v75, v75
    v_cvt_pk_bf16_f32 v82, v72, v73
    v_cvt_pk_bf16_f32 v83, v74, v75
    s_waitcnt lgkmcnt(3)
    v_mfma_f32_32x32x16_bf16 v[60:75], v[20:23], v[116:119], v[100:115]
    ds_read_b128 v[12:15], v8 offset:0
    v_exp_f32 v44, v44
    v_exp_f32 v45, v45
    v_exp_f32 v46, v46
    v_exp_f32 v47, v47
    v_cvt_pk_bf16_f32 v76, v44, v45
    v_cvt_pk_bf16_f32 v77, v46, v47
    v_mfma_f32_32x32x16_bf16 v[84:99], v[40:43], v[80:83], v[84:99]
    ds_read_b128 v[36:39], v7 offset:30720
    s_add_u32 m0, s29, 4096
    s_add_u32 s28, s30, 4096
    buffer_load_dwordx4 v4, s[8:11], s28 offen offset:0 sc1 lds
    v_exp_f32 v48, v48
    v_exp_f32 v49, v49
    v_exp_f32 v50, v50
    v_exp_f32 v51, v51
    v_cvt_pk_bf16_f32 v78, v48, v49
    v_cvt_pk_bf16_f32 v79, v50, v51
    s_waitcnt lgkmcnt(3)
    v_mfma_f32_32x32x16_bf16 v[60:75], v[24:27], v[120:123], v[60:75]
    ds_read_b128 v[16:19], v8 offset:1024
    v_exp_f32 v52, v52
    v_exp_f32 v53, v53
    v_exp_f32 v54, v54
    v_exp_f32 v55, v55
    v_cvt_pk_bf16_f32 v80, v52, v53
    v_cvt_pk_bf16_f32 v81, v54, v55
    v_mfma_f32_32x32x16_bf16 v[84:99], v[28:31], v[76:79], v[84:99]
    ds_read_b128 v[40:43], v7 offset:31744
    buffer_load_dwordx4 v4, s[8:11], s28 offen offset:1024 sc1 lds
    v_exp_f32 v56, v56
    v_exp_f32 v57, v57
    v_exp_f32 v58, v58
    v_exp_f32 v59, v59
    v_cvt_pk_bf16_f32 v82, v56, v57
    v_cvt_pk_bf16_f32 v83, v58, v59
    s_waitcnt lgkmcnt(3)
    v_mfma_f32_32x32x16_bf16 v[44:59], v[12:15], v[116:119], v[100:115]
    ds_read_b128 v[20:23], v8 offset:4096
    v_exp_f32 v60, v60
    v_exp_f32 v61, v61
    v_exp_f32 v62, v62
    v_exp_f32 v63, v63
    v_cvt_pk_bf16_f32 v76, v60, v61
    v_cvt_pk_bf16_f32 v77, v62, v63
    v_mfma_f32_32x32x16_bf16 v[84:99], v[32:35], v[80:83], v[84:99]
    ds_read_b128 v[28:31], v8 offset:2048
    buffer_load_dwordx4 v4, s[8:11], s28 offen offset:2048 sc1 lds
    v_exp_f32 v64, v64
    v_exp_f32 v65, v65
    v_exp_f32 v66, v66
    v_exp_f32 v67, v67
    v_cvt_pk_bf16_f32 v78, v64, v65
    v_cvt_pk_bf16_f32 v79, v66, v67
    s_waitcnt lgkmcnt(3)
    v_mfma_f32_32x32x16_bf16 v[44:59], v[16:19], v[120:123], v[44:59]
    ds_read_b128 v[24:27], v8 offset:5120
    v_exp_f32 v68, v68
    v_exp_f32 v69, v69
    v_exp_f32 v70, v70
    v_exp_f32 v71, v71
    v_cvt_pk_bf16_f32 v80, v68, v69
    v_cvt_pk_bf16_f32 v81, v70, v71
    v_mfma_f32_32x32x16_bf16 v[84:99], v[36:39], v[76:79], v[84:99]
    ds_read_b128 v[32:35], v8 offset:3072
    buffer_load_dwordx4 v4, s[8:11], s28 offen offset:3072 sc1 lds
    v_exp_f32 v72, v72
    v_exp_f32 v73, v73
    v_exp_f32 v74, v74
    v_exp_f32 v75, v75
    v_cvt_pk_bf16_f32 v82, v72, v73
    v_cvt_pk_bf16_f32 v83, v74, v75
    s_add_u32 s34, s34, 1
    s_add_u32 s30, s34, 1
    s_and_b32 s30, s30, 3
    s_lshl_b32 s30, s30, 15
    v_mov_b32 v7, v8
    v_add_u32 v8, s30, v2
    s_cmp_lt_u32 s34, 8
    s_cbranch_scc1 att_63_loop
    v_mfma_f32_32x32x16_bf16 v[84:99], v[40:43], v[80:83], v[84:99]
    s_nop 11
    v_mov_b32 v3, v96
    v_mov_b32 v5, v96
    s_mov_b32 s28, 0x53800000
    s_lshl_b32 s30, s21, 2
    v_permlane32_swap_b32 v3, v5
    s_add_u32 s30, s30, 131072
    v_cmp_nge_f32 vcc, s28, v5
    v_mov_b32 v6, s30
    s_cmp_lg_u64 vcc, 0
    s_cselect_b32 s28, 1, 0
    v_mov_b32 v3, s28
    ds_write_b32 v6, v3
    v_mov_b32 v6, 131072
    s_waitcnt vmcnt(0) lgkmcnt(0)
    s_barrier
    ds_read_b128 v[76:79], v6
    v_rcp_f32 v5, v5
    s_waitcnt lgkmcnt(0)
    v_or3_b32 v3, v76, v77, v78
    v_or_b32 v3, v3, v79
    s_nop 0
    v_readfirstlane_b32 s28, v3
    s_nop 0
    s_andn2_b32 s28, s28, s35
    s_cbranch_scc1 att_63_redo
    v_mul_f32 v84, v84, v5
    v_mul_f32 v85, v85, v5
    v_mul_f32 v86, v86, v5
    v_mul_f32 v87, v87, v5
    v_mul_f32 v88, v88, v5
    v_mul_f32 v89, v89, v5
    v_mul_f32 v90, v90, v5
    v_mul_f32 v91, v91, v5
    v_mul_f32 v92, v92, v5
    v_mul_f32 v93, v93, v5
    v_mul_f32 v94, v94, v5
    v_mul_f32 v95, v95, v5
    v_mul_f32 v96, v96, v5
    v_mul_f32 v97, v97, v5
    v_mul_f32 v98, v98, v5
    v_mul_f32 v99, v99, v5
    v_cvt_pk_bf16_f32 v76, v84, v85
    v_cvt_pk_bf16_f32 v77, v86, v87
    v_cvt_pk_bf16_f32 v78, v88, v89
    v_cvt_pk_bf16_f32 v79, v90, v91
    v_cvt_pk_bf16_f32 v80, v92, v93
    v_cvt_pk_bf16_f32 v81, v94, v95
    v_cvt_pk_bf16_f32 v82, v96, v97
    v_cvt_pk_bf16_f32 v83, v98, v99
    s_lshl_b32 s29, s33, 4
    s_add_u32 s29, s29, s24
    s_lshl_b32 s29, s29, 11
    s_add_u32 s29, s29, 66060288
    buffer_store_dwordx4 v[76:79], v2, s[8:11], s29 offen offset:0 sc1
    buffer_store_dwordx4 v[80:83], v2, s[8:11], s29 offen offset:1024 sc1
    s_lshl_b32 s30, s25, 7
    s_add_u32 s30, s30, 18618368
    s_waitcnt vmcnt(0)
    s_barrier
    s_cmp_lg_u32 s21, 0
    s_cbranch_scc1 sig_65
    v_mov_b32 v3, 1
    s_mov_b64 exec, 1
    buffer_atomic_add v3, off, s[8:11], s30 sc1
    s_mov_b64 exec, -1
sig_65:
    s_branch att_63_end
att_63_redo:
    s_mov_b32 s35, 1
    s_mov_b32 s34, 0
    s_mov_b32 s30, s26
    v_mov_b32 v124, 0xff800000
att_63_mx:
    buffer_load_dwordx4 v[12:15], v2, s[8:11], s30 offen offset:0 sc1
    buffer_load_dwordx4 v[16:19], v2, s[8:11], s30 offen offset:1024 sc1
    s_waitcnt vmcnt(0)
    v_mfma_f32_32x32x16_bf16 v[44:59], v[12:15], v[116:119], 0
    v_mfma_f32_32x32x16_bf16 v[44:59], v[16:19], v[120:123], v[44:59]
    s_nop 11
    v_max3_f32 v3, v44, v45, v46
    v_max3_f32 v3, v47, v48, v3
    v_max3_f32 v3, v49, v50, v3
    v_max3_f32 v3, v51, v52, v3
    v_max3_f32 v3, v53, v54, v3
    v_max3_f32 v3, v55, v56, v3
    v_max3_f32 v3, v57, v58, v3
    v_max3_f32 v124, v59, v3, v124
    s_add_u32 s30, s30, 4096
    s_add_u32 s34, s34, 1
    s_cmp_lt_u32 s34, 64
    s_cbranch_scc1 att_63_mx
    v_mov_b32 v3, v124
    s_nop 1
    v_permlane32_swap_b32 v124, v3
    v_max_f32 v124, v124, v3
    v_sub_f32 v100, 0, v124
    v_sub_f32 v101, 0, v124
    v_sub_f32 v102, 0, v124
    v_sub_f32 v103, 0, v124
    v_sub_f32 v104, 0, v124
    v_sub_f32 v105, 0, v124
    v_sub_f32 v106, 0, v124
    v_sub_f32 v107, 0, v124
    v_sub_f32 v108, 0, v124
    v_sub_f32 v109, 0, v124
    v_sub_f32 v110, 0, v124
    v_sub_f32 v111, 0, v124
    v_sub_f32 v112, 0, v124
    v_sub_f32 v113, 0, v124
    v_sub_f32 v114, 0, v124
    v_sub_f32 v115, 0, v124
    s_branch att_63_start
att_63_end:
    s_branch main_next
job_5:
    s_mov_b32 s35, 0
    s_load_dwordx2 s[12:13], s[0:1], 88
    s_mov_b32 s14, 1835008
    s_mov_b32 s15, 0x20000
    s_lshl_b32 s34, s25, 2
    s_add_u32 s34, s34, s21
    v_bfe_u32 v3, v0, 0, 5
    v_mul_u32_u24 v117, 896, v3
    v_bfe_u32 v3, v0, 5, 1
    v_lshl_add_u32 v117, v3, 4, v117
    s_cmp_lt_u32 s34, 14
    s_cselect_b32 s28, 0, 2147483632
    v_or_b32 v117, s28, v117
    s_min_u32 s34, s34, 13
    v_bfe_u32 v3, v0, 5, 1
    v_lshlrev_b32 v118, 7, v3
    v_bfe_u32 v3, v0, 0, 5
    v_lshl_add_u32 v118, v3, 2, v118
    v_add_u32 v118, 65536, v118
    s_lshl_b32 s30, s24, 7
    s_add_u32 s30, s30, 17629184
    v_and_b32 v116, 31, v0
    v_lshlrev_b32 v116, 2, v116
    s_lshr_b32 s29, s24, 2
    s_lshl_b32 s29, s29, 7
    s_add_u32 s28, s29, 18618368
wc_66:
    buffer_load_dword v3, off, s[8:11], s28 sc1
    s_waitcnt vmcnt(0)
    v_cmp_gt_u32 vcc, 16, v3
    s_cbranch_vccz wc_66k
    s_sleep 12
    s_sub_u32 s23, s23, 1
    s_cbranch_scc0 wc_66
    s_mov_b32 s23, 0
wc_66k:
    buffer_load_dword v116, v116, s[8:11], s30 offen sc1
    s_add_u32 s28, s29, 18616320
    s_waitcnt lgkmcnt(0)
wc_67:
    buffer_load_dword v3, off, s[8:11], s28 sc1
    s_waitcnt vmcnt(0)
    v_cmp_gt_u32 vcc, 66, v3
    s_cbranch_vccz wc_67k
    s_sleep 12
    s_sub_u32 s23, s23, 1
    s_cbranch_scc0 wc_67
    s_mov_b32 s23, 0
wc_67k:
    s_lshl_b32 s26, s24, 15
    s_add_u32 s26, s26, 66060288
    s_lshl_b32 s27, s34, 15
    s_mul_i32 s29, s24, 458752
    s_add_u32 s29, s29, s27
    s_add_u32 s29, s29, 27262976
    s_add_u32 s27, s27, 58720256
    s_mul_i32 s32, s21, 8192
    v_add_u32 v4, s32, v2
    s_add_u32 m0, s32, 0
    s_add_u32 s28, s26, 0
    buffer_load_dwordx4 v4, s[8:11], s28 offen offset:0 sc1 lds
    buffer_load_dwordx4 v4, s[8:11], s28 offen offset:1024 sc1 lds
    buffer_load_dwordx4 v4, s[8:11], s28 offen offset:2048 sc1 lds
    buffer_load_dwordx4 v4, s[8:11], s28 offen offset:3072 sc1 lds
    s_add_u32 m0, s32, 4096
    s_add_u32 s28, s26, 4096
    buffer_load_dwordx4 v4, s[8:11], s28 offen offset:0 sc1 lds
    buffer_load_dwordx4 v4, s[8:11], s28 offen offset:1024 sc1 lds
    buffer_load_dwordx4 v4, s[8:11], s28 offen offset:2048 sc1 lds
    buffer_load_dwordx4 v4, s[8:11], s28 offen offset:3072 sc1 lds
    buffer_load_dwordx4 a[0:3], v2, s[8:11], s27 offen offset:0 sc1
    buffer_load_dwordx4 a[4:7], v2, s[8:11], s27 offen offset:1024 sc1
    buffer_load_dwordx4 a[8:11], v2, s[8:11], s27 offen offset:2048 sc1
    buffer_load_dwordx4 a[12:15], v2, s[8:11], s27 offen offset:3072 sc1
    s_add_u32 s27, s27, 4096
    buffer_load_dwordx4 a[16:19], v2, s[8:11], s27 offen offset:0 sc1
    buffer_load_dwordx4 a[20:23], v2, s[8:11], s27 offen offset:1024 sc1
    buffer_load_dwordx4 a[24:27], v2, s[8:11], s27 offen offset:2048 sc1
    buffer_load_dwordx4 a[28:31], v2, s[8:11], s27 offen offset:3072 sc1
    s_add_u32 s27, s27, 4096
    buffer_load_dwordx4 a[32:35], v2, s[8:11], s27 offen offset:0 sc1
    buffer_load_dwordx4 a[36:39], v2, s[8:11], s27 offen offset:1024 sc1
    buffer_load_dwordx4 a[40:43], v2, s[8:11], s27 offen offset:2048 sc1
    buffer_load_dwordx4 a[44:47], v2, s[8:11], s27 offen offset:3072 sc1
    s_add_u32 s27, s27, 4096
    buffer_load_dwordx4 a[48:51], v2, s[8:11], s27 offen offset:0 sc1
    buffer_load_dwordx4 a[52:55], v2, s[8:11], s27 offen offset:1024 sc1
    buffer_load_dwordx4 a[56:59], v2, s[8:11], s27 offen offset:2048 sc1
    buffer_load_dwordx4 a[60:63], v2, s[8:11], s27 offen offset:3072 sc1
    s_add_u32 s27, s27, 4096
    buffer_load_dwordx4 a[64:67], v2, s[8:11], s27 offen offset:0 sc1
    buffer_load_dwordx4 a[68:71], v2, s[8:11], s27 offen offset:1024 sc1
    buffer_load_dwordx4 a[72:75], v2, s[8:11], s27 offen offset:2048 sc1
    buffer_load_dwordx4 a[76:79], v2, s[8:11], s27 offen offset:3072 sc1
    s_add_u32 s27, s27, 4096
    buffer_load_dwordx4 a[80:83], v2, s[8:11], s27 offen offset:0 sc1
    buffer_load_dwordx4 a[84:87], v2, s[8:11], s27 offen offset:1024 sc1
    buffer_load_dwordx4 a[88:91], v2, s[8:11], s27 offen offset:2048 sc1
    buffer_load_dwordx4 a[92:95], v2, s[8:11], s27 offen offset:3072 sc1
    s_add_u32 s27, s27, 4096
    buffer_load_dwordx4 a[96:99], v2, s[8:11], s27 offen offset:0 sc1
    buffer_load_dwordx4 a[100:103], v2, s[8:11], s27 offen offset:1024 sc1
    buffer_load_dwordx4 a[104:107], v2, s[8:11], s27 offen offset:2048 sc1
    buffer_load_dwordx4 a[108:111], v2, s[8:11], s27 offen offset:3072 sc1
    s_add_u32 s27, s27, 4096
    buffer_load_dwordx4 a[112:115], v2, s[8:11], s27 offen offset:0 sc1
    buffer_load_dwordx4 a[116:119], v2, s[8:11], s27 offen offset:1024 sc1
    buffer_load_dwordx4 a[120:123], v2, s[8:11], s27 offen offset:2048 sc1
    buffer_load_dwordx4 a[124:127], v2, s[8:11], s27 offen offset:3072 sc1
    s_waitcnt vmcnt(32)
    s_barrier
    ds_read_b128 v[12:15], v2 offset:0
    ds_read_b128 v[16:19], v2 offset:1024
    ds_read_b128 v[20:23], v2 offset:2048
    ds_read_b128 v[24:27], v2 offset:3072
    ds_read_b128 v[28:31], v2 offset:4096
    ds_read_b128 v[32:35], v2 offset:5120
    s_waitcnt vmcnt(31)
    s_waitcnt lgkmcnt(5)
    v_mfma_f32_32x32x16_bf16 v[44:59], a[0:3], v[12:15], 0
    ds_read_b128 v[36:39], v2 offset:6144
    buffer_load_dwordx4 a[128:131], v2, s[8:11], s29 offen offset:0 sc1
    s_waitcnt vmcnt(31)
    s_waitcnt lgkmcnt(5)
    v_mfma_f32_32x32x16_bf16 v[44:59], a[4:7], v[16:19], v[44:59]
    ds_read_b128 v[40:43], v2 offset:7168
    buffer_load_dwordx4 a[132:135], v2, s[8:11], s29 offen offset:1024 sc1
    s_waitcnt vmcnt(31)
    s_waitcnt lgkmcnt(5)
    v_mfma_f32_32x32x16_bf16 v[44:59], a[8:11], v[20:23], v[44:59]
    ds_read_b128 v[12:15], v2 offset:8192
    buffer_load_dwordx4 a[136:139], v2, s[8:11], s29 offen offset:2048 sc1
    s_waitcnt vmcnt(31)
    s_waitcnt lgkmcnt(5)
    v_mfma_f32_32x32x16_bf16 v[44:59], a[12:15], v[24:27], v[44:59]
    ds_read_b128 v[16:19], v2 offset:9216
    buffer_load_dwordx4 a[140:143], v2, s[8:11], s29 offen offset:3072 sc1
    s_waitcnt vmcnt(31)
    s_waitcnt lgkmcnt(5)
    v_mfma_f32_32x32x16_bf16 v[44:59], a[16:19], v[28:31], v[44:59]
    ds_read_b128 v[20:23], v2 offset:10240
    s_add_u32 s29, s29, 4096
    buffer_load_dwordx4 a[144:147], v2, s[8:11], s29 offen offset:0 sc1
    s_waitcnt vmcnt(31)
    s_waitcnt lgkmcnt(5)
    v_mfma_f32_32x32x16_bf16 v[44:59], a[20:23], v[32:35], v[44:59]
    ds_read_b128 v[24:27], v2 offset:11264
    buffer_load_dwordx4 a[148:151], v2, s[8:11], s29 offen offset:1024 sc1
    s_waitcnt vmcnt(31)
    s_waitcnt lgkmcnt(5)
    v_mfma_f32_32x32x16_bf16 v[44:59], a[24:27], v[36:39], v[44:59]
    ds_read_b128 v[28:31], v2 offset:12288
    buffer_load_dwordx4 a[152:155], v2, s[8:11], s29 offen offset:2048 sc1
    s_waitcnt vmcnt(31)
    s_waitcnt lgkmcnt(5)
    v_mfma_f32_32x32x16_bf16 v[44:59], a[28:31], v[40:43], v[44:59]
    ds_read_b128 v[32:35], v2 offset:13312
    buffer_load_dwordx4 a[156:159], v2, s[8:11], s29 offen offset:3072 sc1
    s_waitcnt vmcnt(31)
    s_waitcnt lgkmcnt(5)
    v_mfma_f32_32x32x16_bf16 v[44:59], a[32:35], v[12:15], v[44:59]
    ds_read_b128 v[36:39], v2 offset:14336
    s_add_u32 s29, s29, 4096
    buffer_load_dwordx4 a[160:163], v2, s[8:11], s29 offen offset:0 sc1
    s_waitcnt vmcnt(31)
    s_waitcnt lgkmcnt(5)
    v_mfma_f32_32x32x16_bf16 v[44:59], a[36:39], v[16:19], v[44:59]
    ds_read_b128 v[40:43], v2 offset:15360
    buffer_load_dwordx4 a[164:167], v2, s[8:11], s29 offen offset:1024 sc1
    s_waitcnt vmcnt(31)
    s_waitcnt lgkmcnt(5)
    v_mfma_f32_32x32x16_bf16 v[44:59], a[40:43], v[20:23], v[44:59]
    ds_read_b128 v[12:15], v2 offset:16384
    buffer_load_dwordx4 a[168:171], v2, s[8:11], s29 offen offset:2048 sc1
    s_waitcnt vmcnt(31)
    s_waitcnt lgkmcnt(5)
    v_mfma_f32_32x32x16_bf16 v[44:59], a[44:47], v[24:27], v[44:59]
    ds_read_b128 v[16:19], v2 offset:17408
    buffer_load_dwordx4 a[172:175], v2, s[8:11], s29 offen offset:3072 sc1
    s_waitcnt vmcnt(31)
    s_waitcnt lgkmcnt(5)
    v_mfma_f32_32x32x16_bf16 v[44:59], a[48:51], v[28:31], v[44:59]
    ds_read_b128 v[20:23], v2 offset:18432
    s_add_u32 s29, s29, 4096
    buffer_load_dwordx4 a[176:179], v2, s[8:11], s29 offen offset:0 sc1
    s_waitcnt vmcnt(31)
    s_waitcnt lgkmcnt(5)
    v_mfma_f32_32x32x16_bf16 v[44:59], a[52:55], v[32:35], v[44:59]
    ds_read_b128 v[24:27], v2 offset:19456
    buffer_load_dwordx4 a[180:183], v2, s[8:11], s29 offen offset:1024 sc1
    s_waitcnt vmcnt(31)
    s_waitcnt lgkmcnt(5)
    v_mfma_f32_32x32x16_bf16 v[44:59], a[56:59], v[36:39], v[44:59]
    ds_read_b128 v[28:31], v2 offset:20480
    buffer_load_dwordx4 a[184:187], v2, s[8:11], s29 offen offset:2048 sc1
    s_waitcnt vmcnt(31)
    s_waitcnt lgkmcnt(5)
    v_mfma_f32_32x32x16_bf16 v[44:59], a[60:63], v[40:43], v[44:59]
    ds_read_b128 v[32:35], v2 offset:21504
    buffer_load_dwordx4 a[188:191], v2, s[8:11], s29 offen offset:3072 sc1
    s_waitcnt vmcnt(31)
    s_waitcnt lgkmcnt(5)
    v_mfma_f32_32x32x16_bf16 v[44:59], a[64:67], v[12:15], v[44:59]
    ds_read_b128 v[36:39], v2 offset:22528
    s_add_u32 s29, s29, 4096
    buffer_load_dwordx4 a[192:195], v2, s[8:11], s29 offen offset:0 sc1
    s_waitcnt vmcnt(31)
    s_waitcnt lgkmcnt(5)
    v_mfma_f32_32x32x16_bf16 v[44:59], a[68:71], v[16:19], v[44:59]
    ds_read_b128 v[40:43], v2 offset:23552
    buffer_load_dwordx4 a[196:199], v2, s[8:11], s29 offen offset:1024 sc1
    s_waitcnt vmcnt(31)
    s_waitcnt lgkmcnt(5)
    v_mfma_f32_32x32x16_bf16 v[44:59], a[72:75], v[20:23], v[44:59]
    ds_read_b128 v[12:15], v2 offset:24576
    buffer_load_dwordx4 a[200:203], v2, s[8:11], s29 offen offset:2048 sc1
    s_waitcnt vmcnt(31)
    s_waitcnt lgkmcnt(5)
    v_mfma_f32_32x32x16_bf16 v[44:59], a[76:79], v[24:27], v[44:59]
    ds_read_b128 v[16:19], v2 offset:25600
    buffer_load_dwordx4 a[204:207], v2, s[8:11], s29 offen offset:3072 sc1
    s_waitcnt vmcnt(31)
    s_waitcnt lgkmcnt(5)
    v_mfma_f32_32x32x16_bf16 v[44:59], a[80:83], v[28:31], v[44:59]
    ds_read_b128 v[20:23], v2 offset:26624
    s_add_u32 s29, s29, 4096
    buffer_load_dwordx4 a[208:211], v2, s[8:11], s29 offen offset:0 sc1
    s_waitcnt vmcnt(31)
    s_waitcnt lgkmcnt(5)
    v_mfma_f32_32x32x16_bf16 v[44:59], a[84:87], v[32:35], v[44:59]
    ds_read_b128 v[24:27], v2 offset:27648
    buffer_load_dwordx4 a[212:215], v2, s[8:11], s29 offen offset:1024 sc1
    s_waitcnt vmcnt(31)
    s_waitcnt lgkmcnt(5)
    v_mfma_f32_32x32x16_bf16 v[44:59], a[88:91], v[36:39], v[44:59]
    ds_read_b128 v[28:31], v2 offset:28672
    buffer_load_dwordx4 a[216:219], v2, s[8:11], s29 offen offset:2048 sc1
    s_waitcnt vmcnt(31)
    s_waitcnt lgkmcnt(5)
    v_mfma_f32_32x32x16_bf16 v[44:59], a[92:95], v[40:43], v[44:59]
    ds_read_b128 v[32:35], v2 offset:29696
    buffer_load_dwordx4 a[220:223], v2, s[8:11], s29 offen offset:3072 sc1
    s_waitcnt vmcnt(31)
    s_waitcnt lgkmcnt(5)
    v_mfma_f32_32x32x16_bf16 v[44:59], a[96:99], v[12:15], v[44:59]
    ds_read_b128 v[36:39], v2 offset:30720
    s_add_u32 s29, s29, 4096
    buffer_load_dwordx4 a[224:227], v2, s[8:11], s29 offen offset:0 sc1
    s_waitcnt vmcnt(31)
    s_waitcnt lgkmcnt(5)
    v_mfma_f32_32x32x16_bf16 v[44:59], a[100:103], v[16:19], v[44:59]
    ds_read_b128 v[40:43], v2 offset:31744
    buffer_load_dwordx4 a[228:231], v2, s[8:11], s29 offen offset:1024 sc1
    s_waitcnt vmcnt(31)
    s_waitcnt lgkmcnt(5)
    v_mfma_f32_32x32x16_bf16 v[44:59], a[104:107], v[20:23], v[44:59]
    buffer_load_dwordx4 a[232:235], v2, s[8:11], s29 offen offset:2048 sc1
    s_waitcnt vmcnt(31)
    s_waitcnt lgkmcnt(4)
    v_mfma_f32_32x32x16_bf16 v[44:59], a[108:111], v[24:27], v[44:59]
    buffer_load_dwordx4 a[236:239], v2, s[8:11], s29 offen offset:3072 sc1
    s_waitcnt vmcnt(31)
    s_waitcnt lgkmcnt(3)
    v_mfma_f32_32x32x16_bf16 v[44:59], a[112:115], v[28:31], v[44:59]
    s_add_u32 s29, s29, 4096
    buffer_load_dwordx4 a[240:243], v2, s[8:11], s29 offen offset:0 sc1
    s_waitcnt vmcnt(31)
    s_waitcnt lgkmcnt(2)
    v_mfma_f32_32x32x16_bf16 v[44:59], a[116:119], v[32:35], v[44:59]
    buffer_load_dwordx4 a[244:247], v2, s[8:11], s29 offen offset:1024 sc1
    s_waitcnt vmcnt(31)
    s_waitcnt lgkmcnt(1)
    v_mfma_f32_32x32x16_bf16 v[44:59], a[120:123], v[36:39], v[44:59]
    buffer_load_dwordx4 a[248:251], v2, s[8:11], s29 offen offset:2048 sc1
    s_waitcnt vmcnt(31)
    s_waitcnt lgkmcnt(0)
    v_mfma_f32_32x32x16_bf16 v[44:59], a[124:127], v[40:43], v[44:59]
    buffer_load_dwordx4 a[252:255], v2, s[8:11], s29 offen offset:3072 sc1
    s_lshl_b32 s28, s24, 7
    s_add_u32 s28, s28, 18626560
    s_mul_i32 s26, s24, 40960
    s_add_u32 s26, s26, 68157440
    s_mul_i32 s27, s24, 114688
    s_lshl_b32 s30, s34, 13
    s_add_u32 s27, s27, s30
    s_add_u32 s27, s27, 18874368
    s_cmp_ge_u32 s24, 62
    s_cselect_b32 s3, 7602176, 0
    s_sub_u32 s27, s27, s3
    s_lshl_b32 s30, s34, 9
    s_add_u32 s30, s30, 18638848
    s_add_u32 s31, s24, 1
    s_cmp_ge_u32 s24, 62
    s_cselect_b32 s31, 0, s31
    s_mul_i32 s29, s24, 28672
    s_lshl_b32 s34, s34, 6
    s_add_u32 s29, s29, s34
    v_mul_f32 v44, v44, v116
    v_mul_f32 v45, v45, v116
    v_mul_f32 v46, v46, v116
    v_mul_f32 v47, v47, v116
    v_mul_f32 v48, v48, v116
    v_mul_f32 v49, v49, v116
    v_mul_f32 v50, v50, v116
    v_mul_f32 v51, v51, v116
    v_mul_f32 v52, v52, v116
    v_mul_f32 v53, v53, v116
    v_mul_f32 v54, v54, v116
    v_mul_f32 v55, v55, v116
    v_mul_f32 v56, v56, v116
    v_mul_f32 v57, v57, v116
    v_mul_f32 v58, v58, v116
    v_mul_f32 v59, v59, v116
    v_bfe_u32 v3, v0, 2, 4
    v_lshlrev_b32 v119, 11, v3
    v_bfe_u32 v3, v0, 0, 1
    v_lshl_add_u32 v119, v3, 10, v119
    v_add_u32 v119, 1020, v119
    v_bfe_u32 v3, v0, 2, 4
    v_lshlrev_b32 v5, 9, v3
    v_bfe_u32 v3, v0, 0, 1
    v_lshl_add_u32 v5, v3, 8, v5
    v_add_u32 v5, 33020, v5
    v_bfe_u32 v3, v0, 0, 2
    v_lshlrev_b32 v120, 7, v3
    v_and_b32 v3, 2, v0
    v_cmp_eq_u32 vcc, 0, v3
    v_lshlrev_b32 v4, 4, v0
    s_lshl_b32 s32, s21, 10
    v_cndmask_b32 v119, v5, v119, vcc
wc_68:
    buffer_load_dword v3, off, s[8:11], s28 sc1
    s_waitcnt vmcnt(0)
    v_cmp_gt_u32 vcc, 16, v3
    s_cbranch_vccz wc_68k
    s_sleep 12
    s_sub_u32 s23, s23, 1
    s_cbranch_scc0 wc_68
    s_mov_b32 s23, 0
wc_68k:
op_69:
    buffer_load_dword v3, v119, s[8:11], s26 offen sc1
    s_waitcnt vmcnt(0)
    v_cmp_eq_u32 vcc, -1, v3
    s_cbranch_vccz op_69f
    s_sleep 1
    s_sub_u32 s23, s23, 1
    s_cbranch_scc0 op_69
    s_mov_b32 s23, 0
op_69f:
    s_add_u32 m0, s32, 32768
    s_add_u32 s3, s26, 0
    buffer_load_dwordx4 v4, s[8:11], s3 offen sc1 lds
    s_add_u32 m0, s32, 36864
    s_add_u32 s3, s26, 4096
    buffer_load_dwordx4 v4, s[8:11], s3 offen sc1 lds
    s_add_u32 m0, s32, 40960
    s_add_u32 s3, s26, 8192
    buffer_load_dwordx4 v4, s[8:11], s3 offen sc1 lds
    s_add_u32 m0, s32, 45056
    s_add_u32 s3, s26, 12288
    buffer_load_dwordx4 v4, s[8:11], s3 offen sc1 lds
    s_add_u32 m0, s32, 49152
    s_add_u32 s3, s26, 16384
    buffer_load_dwordx4 v4, s[8:11], s3 offen sc1 lds
    v_mov_b32 v122, 0
    s_add_u32 s28, s27, 4096
    s_waitcnt vmcnt(3)
    s_barrier
    ds_read_b128 v[12:15], v2 offset:32768
    ds_read_b128 v[16:19], v2 offset:33792
    ds_read_b128 v[20:23], v2 offset:34816
    ds_read_b128 v[24:27], v2 offset:35840
    s_waitcnt lgkmcnt(3)
    v_mfma_f32_32x32x16_bf16 v[60:75], a[128:131], v[12:15], v[44:59]
    ds_read_b128 v[28:31], v2 offset:36864
    s_add_u32 m0, s32, 53248
    s_add_u32 s3, s26, 20480
    buffer_load_dwordx4 v4, s[8:11], s3 offen sc1 lds
    v_max3_u32 v122, v12, v13, v122
    v_max3_u32 v122, v14, v15, v122
    s_waitcnt lgkmcnt(3)
    v_mfma_f32_32x32x16_bf16 v[60:75], a[132:135], v[16:19], v[60:75]
    ds_read_b128 v[32:35], v2 offset:37888
    s_add_u32 m0, s32, 57344
    s_add_u32 s3, s26, 24576
    buffer_load_dwordx4 v4, s[8:11], s3 offen sc1 lds
    v_max3_u32 v122, v16, v17, v122
    v_max3_u32 v122, v18, v19, v122
    s_waitcnt lgkmcnt(3)
    v_mfma_f32_32x32x16_bf16 v[60:75], a[136:139], v[20:23], v[60:75]
    ds_read_b128 v[36:39], v2 offset:38912
    s_add_u32 m0, s32, 61440
    s_add_u32 s3, s26, 28672
    buffer_load_dwordx4 v4, s[8:11], s3 offen sc1 lds
    v_max3_u32 v122, v20, v21, v122
    v_max3_u32 v122, v22, v23, v122
    s_waitcnt lgkmcnt(3)
    v_mfma_f32_32x32x16_bf16 v[60:75], a[140:143], v[24:27], v[60:75]
    ds_read_b128 v[40:43], v2 offset:39936
    s_add_u32 m0, s32, 65536
    s_add_u32 s3, s26, 32768
    buffer_load_dwordx4 v4, s[8:11], s3 offen sc1 lds
    v_max3_u32 v122, v24, v25, v122
    v_max3_u32 v122, v26, v27, v122
    s_waitcnt lgkmcnt(3)
    v_mfma_f32_32x32x16_bf16 v[60:75], a[144:147], v[28:31], v[60:75]
    s_waitcnt vmcnt(5)
    s_barrier
    ds_read_b128 v[12:15], v2 offset:40960
    s_add_u32 m0, s32, 69632
    s_add_u32 s3, s26, 36864
    buffer_load_dwordx4 v4, s[8:11], s3 offen sc1 lds
    v_max3_u32 v122, v28, v29, v122
    v_max3_u32 v122, v30, v31, v122
    s_waitcnt lgkmcnt(3)
    v_mfma_f32_32x32x16_bf16 v[60:75], a[148:151], v[32:35], v[60:75]
    ds_read_b128 v[16:19], v2 offset:41984
    buffer_load_dword v121, v120, s[8:11], s30 offen sc1
    v_max3_u32 v122, v32, v33, v122
    v_max3_u32 v122, v34, v35, v122
    s_waitcnt lgkmcnt(3)
    v_mfma_f32_32x32x16_bf16 v[60:75], a[152:155], v[36:39], v[60:75]
    ds_read_b128 v[20:23], v2 offset:43008
    v_max3_u32 v122, v36, v37, v122
    v_max3_u32 v122, v38, v39, v122
    buffer_load_dwordx4 v[84:87], v2, s[8:11], s27 offen offset:0 sc1
    s_waitcnt lgkmcnt(3)
    v_mfma_f32_32x32x16_bf16 v[60:75], a[156:159], v[40:43], v[60:75]
    ds_read_b128 v[24:27], v2 offset:44032
    v_max3_u32 v122, v40, v41, v122
    v_max3_u32 v122, v42, v43, v122
    buffer_load_dwordx4 v[88:91], v2, s[8:11], s27 offen offset:1024 sc1
    s_waitcnt lgkmcnt(3)
    v_mfma_f32_32x32x16_bf16 v[60:75], a[160:163], v[12:15], v[60:75]
    ds_read_b128 v[28:31], v2 offset:45056
    v_max3_u32 v122, v12, v13, v122
    v_max3_u32 v122, v14, v15, v122
    buffer_load_dwordx4 v[92:95], v2, s[8:11], s27 offen offset:2048 sc1
    s_waitcnt lgkmcnt(3)
    v_mfma_f32_32x32x16_bf16 v[60:75], a[164:167], v[16:19], v[60:75]
    ds_read_b128 v[32:35], v2 offset:46080
    v_max3_u32 v122, v16, v17, v122
    v_max3_u32 v122, v18, v19, v122
    buffer_load_dwordx4 v[96:99], v2, s[8:11], s27 offen offset:3072 sc1
    s_waitcnt lgkmcnt(3)
    v_mfma_f32_32x32x16_bf16 v[60:75], a[168:171], v[20:23], v[60:75]
    ds_read_b128 v[36:39], v2 offset:47104
    v_max3_u32 v122, v20, v21, v122
    v_max3_u32 v122, v22, v23, v122
    buffer_load_dwordx4 v[100:103], v2, s[8:11], s28 offen offset:0 sc1
    s_waitcnt lgkmcnt(3)
    v_mfma_f32_32x32x16_bf16 v[60:75], a[172:175], v[24:27], v[60:75]
    ds_read_b128 v[40:43], v2 offset:48128
    v_max3_u32 v122, v24, v25, v122
    v_max3_u32 v122, v26, v27, v122
    buffer_load_dwordx4 v[104:107], v2, s[8:11], s28 offen offset:1024 sc1
    s_waitcnt lgkmcnt(3)
    v_mfma_f32_32x32x16_bf16 v[60:75], a[176:179], v[28:31], v[60:75]
    s_waitcnt vmcnt(11)
    s_barrier
    ds_read_b128 v[12:15], v2 offset:49152
    v_max3_u32 v122, v28, v29, v122
    v_max3_u32 v122, v30, v31, v122
    buffer_load_dwordx4 v[108:111], v2, s[8:11], s28 offen offset:2048 sc1
    s_waitcnt lgkmcnt(3)
    v_mfma_f32_32x32x16_bf16 v[60:75], a[180:183], v[32:35], v[60:75]
    ds_read_b128 v[16:19], v2 offset:50176
    v_max3_u32 v122, v32, v33, v122
    v_max3_u32 v122, v34, v35, v122
    buffer_load_dwordx4 v[112:115], v2, s[8:11], s28 offen offset:3072 sc1
    s_waitcnt lgkmcnt(3)
    v_mfma_f32_32x32x16_bf16 v[60:75], a[184:187], v[36:39], v[60:75]
    ds_read_b128 v[20:23], v2 offset:51200
    v_max3_u32 v122, v36, v37, v122
    v_max3_u32 v122, v38, v39, v122
    s_waitcnt lgkmcnt(3)
    v_mfma_f32_32x32x16_bf16 v[60:75], a[188:191], v[40:43], v[60:75]
    ds_read_b128 v[24:27], v2 offset:52224
    v_max3_u32 v122, v40, v41, v122
    v_max3_u32 v122, v42, v43, v122
    s_waitcnt lgkmcnt(3)
    v_mfma_f32_32x32x16_bf16 v[60:75], a[192:195], v[12:15], v[60:75]
    ds_read_b128 v[28:31], v2 offset:53248
    v_max3_u32 v122, v12, v13, v122
    v_max3_u32 v122, v14, v15, v122
    s_waitcnt lgkmcnt(3)
    v_mfma_f32_32x32x16_bf16 v[60:75], a[196:199], v[16:19], v[60:75]
    ds_read_b128 v[32:35], v2 offset:54272
    v_max3_u32 v122, v16, v17, v122
    v_max3_u32 v122, v18, v19, v122
    s_waitcnt lgkmcnt(3)
    v_mfma_f32_32x32x16_bf16 v[60:75], a[200:203], v[20:23], v[60:75]
    ds_read_b128 v[36:39], v2 offset:55296
    v_max3_u32 v122, v20, v21, v122
    v_max3_u32 v122, v22, v23, v122
    s_waitcnt lgkmcnt(3)
    v_mfma_f32_32x32x16_bf16 v[60:75], a[204:207], v[24:27], v[60:75]
    ds_read_b128 v[40:43], v2 offset:56320
    v_max3_u32 v122, v24, v25, v122
    v_max3_u32 v122, v26, v27, v122
    s_waitcnt lgkmcnt(3)
    v_mfma_f32_32x32x16_bf16 v[60:75], a[208:211], v[28:31], v[60:75]
    s_waitcnt vmcnt(9)
    s_barrier
    ds_read_b128 v[12:15], v2 offset:57344
    v_max3_u32 v122, v28, v29, v122
    v_max3_u32 v122, v30, v31, v122
    s_waitcnt lgkmcnt(3)
    v_mfma_f32_32x32x16_bf16 v[60:75], a[212:215], v[32:35], v[60:75]
    ds_read_b128 v[16:19], v2 offset:58368
    v_max3_u32 v122, v32, v33, v122
    v_max3_u32 v122, v34, v35, v122
    s_waitcnt lgkmcnt(3)
    v_mfma_f32_32x32x16_bf16 v[60:75], a[216:219], v[36:39], v[60:75]
    ds_read_b128 v[20:23], v2 offset:59392
    v_max3_u32 v122, v36, v37, v122
    v_max3_u32 v122, v38, v39, v122
    s_waitcnt lgkmcnt(3)
    v_mfma_f32_32x32x16_bf16 v[60:75], a[220:223], v[40:43], v[60:75]
    ds_read_b128 v[24:27], v2 offset:60416
    v_max3_u32 v122, v40, v41, v122
    v_max3_u32 v122, v42, v43, v122
    s_waitcnt lgkmcnt(3)
    v_mfma_f32_32x32x16_bf16 v[60:75], a[224:227], v[12:15], v[60:75]
    ds_read_b128 v[28:31], v2 offset:61440
    v_max3_u32 v122, v12, v13, v122
    v_max3_u32 v122, v14, v15, v122
    s_waitcnt lgkmcnt(3)
    v_mfma_f32_32x32x16_bf16 v[60:75], a[228:231], v[16:19], v[60:75]
    ds_read_b128 v[32:35], v2 offset:62464
    v_max3_u32 v122, v16, v17, v122
    v_max3_u32 v122, v18, v19, v122
    s_waitcnt lgkmcnt(3)
    v_mfma_f32_32x32x16_bf16 v[60:75], a[232:235], v[20:23], v[60:75]
    ds_read_b128 v[36:39], v2 offset:63488
    v_max3_u32 v122, v20, v21, v122
    v_max3_u32 v122, v22, v23, v122
    s_waitcnt lgkmcnt(3)
    v_mfma_f32_32x32x16_bf16 v[60:75], a[236:239], v[24:27], v[60:75]
    ds_read_b128 v[40:43], v2 offset:64512
    v_max3_u32 v122, v24, v25, v122
    v_max3_u32 v122, v26, v27, v122
    s_waitcnt lgkmcnt(3)
    v_mfma_f32_32x32x16_bf16 v[60:75], a[240:243], v[28:31], v[60:75]
    ds_read2st64_b32 v[12:13], v118 offset0:0 offset1:2
    ds_read2st64_b32 v[14:15], v118 offset0:4 offset1:6
    v_max3_u32 v122, v28, v29, v122
    v_max3_u32 v122, v30, v31, v122
    s_waitcnt lgkmcnt(4)
    v_mfma_f32_32x32x16_bf16 v[60:75], a[244:247], v[32:35], v[60:75]
    ds_read2st64_b32 v[16:17], v118 offset0:1 offset1:3
    ds_read2st64_b32 v[18:19], v118 offset0:5 offset1:7
    v_max3_u32 v122, v32, v33, v122
    v_max3_u32 v122, v34, v35, v122
    s_waitcnt lgkmcnt(5)
    v_mfma_f32_32x32x16_bf16 v[60:75], a[248:251], v[36:39], v[60:75]
    ds_read2st64_b32 v[20:21], v118 offset0:8 offset1:10
    ds_read2st64_b32 v[22:23], v118 offset0:12 offset1:14
    v_max3_u32 v122, v36, v37, v122
    v_max3_u32 v122, v38, v39, v122
    s_waitcnt lgkmcnt(6)
    v_mfma_f32_32x32x16_bf16 v[60:75], a[252:255], v[40:43], v[60:75]
    ds_read2st64_b32 v[24:25], v118 offset0:9 offset1:11
    ds_read2st64_b32 v[26:27], v118 offset0:13 offset1:15
    v_max3_u32 v122, v40, v41, v122
    v_max3_u32 v122, v42, v43, v122
    s_waitcnt vmcnt(8)
    v_cmp_gt_u32 vcc, s31, v121
    s_cbranch_vccnz op_69v
op_69c:
    s_waitcnt vmcnt(0)
    v_max_u32 v3, v84, v85
    v_max3_u32 v3, v86, v87, v3
    v_max3_u32 v3, v88, v89, v3
    v_max3_u32 v3, v90, v91, v3
    v_max3_u32 v3, v92, v93, v3
    v_max3_u32 v3, v94, v95, v3
    v_max3_u32 v3, v96, v97, v3
    v_max3_u32 v3, v98, v99, v3
    v_max3_u32 v3, v100, v101, v3
    v_max3_u32 v3, v102, v103, v3
    v_max3_u32 v3, v104, v105, v3
    v_max3_u32 v3, v106, v107, v3
    v_max3_u32 v3, v108, v109, v3
    v_max3_u32 v3, v110, v111, v3
    v_max3_u32 v3, v112, v113, v3
    v_max3_u32 v3, v114, v115, v3
    v_cmp_eq_u32 vcc, -1, v3
    s_cbranch_vccz op_69w
    s_cmp_eq_u32 s31, 0
    s_cbranch_scc1 op_69l
op_69v:
    buffer_load_dword v121, v120, s[8:11], s30 offen sc1
    s_sub_u32 s23, s23, 1
    s_cbranch_scc1 op_69x
    s_waitcnt vmcnt(0)
    v_cmp_gt_u32 vcc, s31, v121
    s_cbranch_vccnz op_69v
op_69l:
    buffer_load_dwordx4 v[84:87], v2, s[8:11], s27 offen offset:0 sc1
    buffer_load_dwordx4 v[88:91], v2, s[8:11], s27 offen offset:1024 sc1
    buffer_load_dwordx4 v[92:95], v2, s[8:11], s27 offen offset:2048 sc1
    buffer_load_dwordx4 v[96:99], v2, s[8:11], s27 offen offset:3072 sc1
    buffer_load_dwordx4 v[100:103], v2, s[8:11], s28 offen offset:0 sc1
    buffer_load_dwordx4 v[104:107], v2, s[8:11], s28 offen offset:1024 sc1
    buffer_load_dwordx4 v[108:111], v2, s[8:11], s28 offen offset:2048 sc1
    buffer_load_dwordx4 v[112:115], v2, s[8:11], s28 offen offset:3072 sc1
    s_sub_u32 s23, s23, 1
    s_cbranch_scc0 op_69c
op_69x:
    s_mov_b32 s23, 0
    s_waitcnt vmcnt(0)
op_69w:
    s_waitcnt lgkmcnt(6)
    v_mfma_f32_32x32x16_bf16 v[60:75], v[84:87], v[12:15], v[60:75]
    ds_read2st64_b32 v[28:29], v118 offset0:16 offset1:18
    ds_read2st64_b32 v[30:31], v118 offset0:20 offset1:22
    v_max3_u32 v122, v12, v13, v122
    v_max3_u32 v122, v14, v15, v122
    s_waitcnt lgkmcnt(6)
    v_mfma_f32_32x32x16_bf16 v[60:75], v[88:91], v[16:19], v[60:75]
    ds_read2st64_b32 v[32:33], v118 offset0:17 offset1:19
    ds_read2st64_b32 v[34:35], v118 offset0:21 offset1:23
    v_max3_u32 v122, v16, v17, v122
    v_max3_u32 v122, v18, v19, v122
    s_waitcnt lgkmcnt(6)
    v_mfma_f32_32x32x16_bf16 v[60:75], v[92:95], v[20:23], v[60:75]
    ds_read2st64_b32 v[36:37], v118 offset0:24 offset1:26
    ds_read2st64_b32 v[38:39], v118 offset0:28 offset1:30
    v_max3_u32 v122, v20, v21, v122
    v_max3_u32 v122, v22, v23, v122
    s_waitcnt lgkmcnt(6)
    v_mfma_f32_32x32x16_bf16 v[60:75], v[96:99], v[24:27], v[60:75]
    ds_read2st64_b32 v[40:41], v118 offset0:25 offset1:27
    ds_read2st64_b32 v[42:43], v118 offset0:29 offset1:31
    v_max3_u32 v122, v24, v25, v122
    v_max3_u32 v122, v26, v27, v122
    s_waitcnt lgkmcnt(6)
    v_mfma_f32_32x32x16_bf16 v[60:75], v[100:103], v[28:31], v[60:75]
    v_max3_u32 v122, v28, v29, v122
    v_max3_u32 v122, v30, v31, v122
    s_waitcnt lgkmcnt(4)
    v_mfma_f32_32x32x16_bf16 v[60:75], v[104:107], v[32:35], v[60:75]
    v_max3_u32 v122, v32, v33, v122
    v_max3_u32 v122, v34, v35, v122
    s_waitcnt lgkmcnt(2)
    v_mfma_f32_32x32x16_bf16 v[60:75], v[108:111], v[36:39], v[60:75]
    v_max3_u32 v122, v36, v37, v122
    v_max3_u32 v122, v38, v39, v122
    s_waitcnt lgkmcnt(0)
    v_mfma_f32_32x32x16_bf16 v[60:75], v[112:115], v[40:43], v[60:75]
    v_max3_u32 v122, v40, v41, v122
    v_max3_u32 v122, v42, v43, v122
    v_cmp_eq_u32 vcc, -1, v122
    s_cbranch_vccz op_69k
    s_barrier
    s_add_u32 s35, s35, 1
    s_cmp_lt_u32 s35, 4000
    s_cbranch_scc1 op_69f
op_69k:
    s_nop 7
    v_cvt_pk_bf16_f32 v76, v60, v68
    v_cvt_pk_bf16_f32 v77, v61, v69
    v_cvt_pk_bf16_f32 v78, v62, v70
    v_cvt_pk_bf16_f32 v79, v63, v71
    v_cvt_pk_bf16_f32 v80, v64, v72
    v_cvt_pk_bf16_f32 v81, v65, v73
    v_cvt_pk_bf16_f32 v82, v66, v74
    v_cvt_pk_bf16_f32 v83, v67, v75
    buffer_store_dwordx4 v[76:79], v117, s[12:15], s29 offen offset:0
    buffer_store_dwordx4 v[80:83], v117, s[12:15], s29 offen offset:32
    s_barrier
    s_branch main_next
job_6:
    s_mov_b32 s26, s24
    s_cmp_ge_u32 s24, 48
    s_cbranch_scc1 wq_70_o
    s_load_dwordx2 s[12:13], s[0:1], 8
    s_mov_b32 s14, 1204224
    s_mov_b32 s15, 0x20000
    s_mul_i32 s27, s26, 43
    s_lshr_b32 s27, s27, 7
    s_mul_i32 s28, s27, 3
    s_sub_u32 s28, s26, s28
    s_mul_i32 s27, s27, 56
    s_mul_i32 s28, s28, 896
    s_add_u32 s27, s27, s28
    s_mul_i32 s28, s21, 301056
    s_add_u32 s27, s27, s28
    s_lshl2_add_u32 s29, s26, s21
    s_mul_i32 s29, s29, 7168
    s_add_u32 s29, s29, 56623104
    v_bfe_u32 v3, v0, 5, 1
    v_mul_u32_u24 v4, 10752, v3
    v_bfe_u32 v3, v0, 0, 5
    v_lshl_add_u32 v4, v3, 1, v4
    v_and_b32 v3, 31, v0
    v_cmp_gt_u32 vcc, 28, v3
    v_mov_b32 v3, 2147483632
    s_waitcnt lgkmcnt(0)
    v_cndmask_b32 v4, v3, v4, vcc
    s_mov_b32 s34, 1
wq_70_71:
    s_add_u32 s28, s27, 0
    buffer_load_ushort v12, v4, s[12:15], s28 offen offset:0
    buffer_load_ushort v13, v4, s[12:15], s28 offen offset:2688
    s_add_u32 s28, s27, 21504
    buffer_load_ushort v14, v4, s[12:15], s28 offen offset:0
    buffer_load_ushort v15, v4, s[12:15], s28 offen offset:2688
    s_add_u32 s28, s27, 5376
    buffer_load_ushort v16, v4, s[12:15], s28 offen offset:0
    buffer_load_ushort v17, v4, s[12:15], s28 offen offset:2688
    s_add_u32 s28, s27, 26880
    buffer_load_ushort v18, v4, s[12:15], s28 offen offset:0
    buffer_load_ushort v19, v4, s[12:15], s28 offen offset:2688
    s_add_u32 s27, s27, 43008
    s_add_u32 s28, s27, 0
    buffer_load_ushort v20, v4, s[12:15], s28 offen offset:0
    buffer_load_ushort v21, v4, s[12:15], s28 offen offset:2688
    s_add_u32 s28, s27, 21504
    buffer_load_ushort v22, v4, s[12:15], s28 offen offset:0
    buffer_load_ushort v23, v4, s[12:15], s28 offen offset:2688
    s_add_u32 s28, s27, 5376
    buffer_load_ushort v24, v4, s[12:15], s28 offen offset:0
    buffer_load_ushort v25, v4, s[12:15], s28 offen offset:2688
    s_add_u32 s28, s27, 26880
    buffer_load_ushort v26, v4, s[12:15], s28 offen offset:0
    buffer_load_ushort v27, v4, s[12:15], s28 offen offset:2688
    s_add_u32 s27, s27, 43008
    s_add_u32 s28, s27, 0
    buffer_load_ushort v28, v4, s[12:15], s28 offen offset:0
    buffer_load_ushort v29, v4, s[12:15], s28 offen offset:2688
    s_add_u32 s28, s27, 21504
    buffer_load_ushort v30, v4, s[12:15], s28 offen offset:0
    buffer_load_ushort v31, v4, s[12:15], s28 offen offset:2688
    s_add_u32 s28, s27, 5376
    buffer_load_ushort v32, v4, s[12:15], s28 offen offset:0
    buffer_load_ushort v33, v4, s[12:15], s28 offen offset:2688
    s_add_u32 s28, s27, 26880
    buffer_load_ushort v34, v4, s[12:15], s28 offen offset:0
    buffer_load_ushort v35, v4, s[12:15], s28 offen offset:2688
    s_add_u32 s27, s27, 43008
    s_add_u32 s28, s27, 0
    buffer_load_ushort v36, v4, s[12:15], s28 offen offset:0
    buffer_load_ushort v37, v4, s[12:15], s28 offen offset:2688
    s_add_u32 s28, s27, 21504
    buffer_load_ushort v38, v4, s[12:15], s28 offen offset:0
    buffer_load_ushort v39, v4, s[12:15], s28 offen offset:2688
    s_add_u32 s28, s27, 5376
    buffer_load_ushort v40, v4, s[12:15], s28 offen offset:0
    buffer_load_ushort v41, v4, s[12:15], s28 offen offset:2688
    s_add_u32 s28, s27, 26880
    buffer_load_ushort v42, v4, s[12:15], s28 offen offset:0
    buffer_load_ushort v43, v4, s[12:15], s28 offen offset:2688
    s_add_u32 s27, s27, 43008
    s_add_u32 s28, s27, 0
    buffer_load_ushort v44, v4, s[12:15], s28 offen offset:0
    buffer_load_ushort v45, v4, s[12:15], s28 offen offset:2688
    s_add_u32 s28, s27, 21504
    buffer_load_ushort v46, v4, s[12:15], s28 offen offset:0
    buffer_load_ushort v47, v4, s[12:15], s28 offen offset:2688
    s_add_u32 s28, s27, 5376
    buffer_load_ushort v48, v4, s[12:15], s28 offen offset:0
    buffer_load_ushort v49, v4, s[12:15], s28 offen offset:2688
    s_add_u32 s28, s27, 26880
    buffer_load_ushort v50, v4, s[12:15], s28 offen offset:0
    buffer_load_ushort v51, v4, s[12:15], s28 offen offset:2688
    s_add_u32 s27, s27, 43008
    s_add_u32 s28, s27, 0
    buffer_load_ushort v52, v4, s[12:15], s28 offen offset:0
    buffer_load_ushort v53, v4, s[12:15], s28 offen offset:2688
    s_add_u32 s28, s27, 21504
    buffer_load_ushort v54, v4, s[12:15], s28 offen offset:0
    buffer_load_ushort v55, v4, s[12:15], s28 offen offset:2688
    s_add_u32 s28, s27, 5376
    buffer_load_ushort v56, v4, s[12:15], s28 offen offset:0
    buffer_load_ushort v57, v4, s[12:15], s28 offen offset:2688
    s_add_u32 s28, s27, 26880
    buffer_load_ushort v58, v4, s[12:15], s28 offen offset:0
    buffer_load_ushort v59, v4, s[12:15], s28 offen offset:2688
    s_add_u32 s27, s27, 43008
    s_add_u32 s28, s27, 0
    buffer_load_ushort v60, v4, s[12:15], s28 offen offset:0
    buffer_load_ushort v61, v4, s[12:15], s28 offen offset:2688
    s_add_u32 s28, s27, 21504
    buffer_load_ushort v62, v4, s[12:15], s28 offen offset:0
    buffer_load_ushort v63, v4, s[12:15], s28 offen offset:2688
    s_add_u32 s28, s27, 5376
    buffer_load_ushort v64, v4, s[12:15], s28 offen offset:0
    buffer_load_ushort v65, v4, s[12:15], s28 offen offset:2688
    s_add_u32 s28, s27, 26880
    buffer_load_ushort v66, v4, s[12:15], s28 offen offset:0
    buffer_load_ushort v67, v4, s[12:15], s28 offen offset:2688
    s_add_u32 s27, s27, 43008
    s_waitcnt vmcnt(48)
    v_lshl_or_b32 v72, v13, 16, v12
    v_lshl_or_b32 v73, v15, 16, v14
    v_lshl_or_b32 v74, v17, 16, v16
    v_lshl_or_b32 v75, v19, 16, v18
    buffer_store_dwordx4 v[72:75], v2, s[8:11], s29 offen offset:0 sc1
    s_waitcnt vmcnt(41)
    v_lshl_or_b32 v76, v21, 16, v20
    v_lshl_or_b32 v77, v23, 16, v22
    v_lshl_or_b32 v78, v25, 16, v24
    v_lshl_or_b32 v79, v27, 16, v26
    buffer_store_dwordx4 v[76:79], v2, s[8:11], s29 offen offset:1024 sc1
    s_waitcnt vmcnt(34)
    v_lshl_or_b32 v80, v29, 16, v28
    v_lshl_or_b32 v81, v31, 16, v30
    v_lshl_or_b32 v82, v33, 16, v32
    v_lshl_or_b32 v83, v35, 16, v34
    buffer_store_dwordx4 v[80:83], v2, s[8:11], s29 offen offset:2048 sc1
    s_waitcnt vmcnt(27)
    v_lshl_or_b32 v84, v37, 16, v36
    v_lshl_or_b32 v85, v39, 16, v38
    v_lshl_or_b32 v86, v41, 16, v40
    v_lshl_or_b32 v87, v43, 16, v42
    buffer_store_dwordx4 v[84:87], v2, s[8:11], s29 offen offset:3072 sc1
    s_add_u32 s29, s29, 4096
    s_waitcnt vmcnt(20)
    v_lshl_or_b32 v88, v45, 16, v44
    v_lshl_or_b32 v89, v47, 16, v46
    v_lshl_or_b32 v90, v49, 16, v48
    v_lshl_or_b32 v91, v51, 16, v50
    buffer_store_dwordx4 v[88:91], v2, s[8:11], s29 offen offset:0 sc1
    s_waitcnt vmcnt(13)
    v_lshl_or_b32 v92, v53, 16, v52
    v_lshl_or_b32 v93, v55, 16, v54
    v_lshl_or_b32 v94, v57, 16, v56
    v_lshl_or_b32 v95, v59, 16, v58
    buffer_store_dwordx4 v[92:95], v2, s[8:11], s29 offen offset:1024 sc1
    s_waitcnt vmcnt(6)
    v_lshl_or_b32 v96, v61, 16, v60
    v_lshl_or_b32 v97, v63, 16, v62
    v_lshl_or_b32 v98, v65, 16, v64
    v_lshl_or_b32 v99, v67, 16, v66
    buffer_store_dwordx4 v[96:99], v2, s[8:11], s29 offen offset:2048 sc1
    s_branch wq_70_e
wq_70_o:
    s_load_dwordx2 s[12:13], s[0:1], 16
    s_mov_b32 s14, 401408
    s_mov_b32 s15, 0x20000
    s_sub_u32 s26, s26, 48
    s_lshl_b32 s27, s26, 6
    s_mul_i32 s28, s21, 100352
    s_add_u32 s27, s27, s28
    s_lshl2_add_u32 s29, s26, s21
    s_lshl_b32 s29, s29, 13
    s_add_u32 s29, s29, 58720256
    v_bfe_u32 v3, v0, 5, 1
    v_mul_u32_u24 v4, 3584, v3
    v_bfe_u32 v3, v0, 0, 4
    v_lshl_add_u32 v4, v3, 2, v4
    v_bfe_u32 v3, v0, 4, 1
    v_lshl_add_u32 v4, v3, 1, v4
    v_and_b32 v3, 32, v0
    v_cmp_eq_u32 vcc, 0, v3
    v_mov_b32 v3, 2147483632
    s_waitcnt lgkmcnt(0)
    v_cndmask_b32 v5, v3, v4, vcc
    s_mov_b32 s34, 2
wq_70_72:
    s_add_u32 s28, s27, 0
    buffer_load_ushort v12, v4, s[12:15], s28 offen offset:0
    buffer_load_ushort v13, v4, s[12:15], s28 offen offset:896
    buffer_load_ushort v14, v4, s[12:15], s28 offen offset:1792
    buffer_load_ushort v15, v4, s[12:15], s28 offen offset:2688
    s_add_u32 s28, s27, 7168
    buffer_load_ushort v16, v4, s[12:15], s28 offen offset:0
    buffer_load_ushort v17, v4, s[12:15], s28 offen offset:896
    buffer_load_ushort v18, v4, s[12:15], s28 offen offset:1792
    buffer_load_ushort v19, v4, s[12:15], s28 offen offset:2688
    s_add_u32 s28, s27, 14336
    buffer_load_ushort v20, v4, s[12:15], s28 offen offset:0
    buffer_load_ushort v21, v4, s[12:15], s28 offen offset:896
    buffer_load_ushort v22, v4, s[12:15], s28 offen offset:1792
    buffer_load_ushort v23, v4, s[12:15], s28 offen offset:2688
    s_add_u32 s28, s27, 21504
    buffer_load_ushort v24, v5, s[12:15], s28 offen offset:0
    buffer_load_ushort v25, v5, s[12:15], s28 offen offset:896
    buffer_load_ushort v26, v5, s[12:15], s28 offen offset:1792
    buffer_load_ushort v27, v5, s[12:15], s28 offen offset:2688
    s_add_u32 s27, s27, 25088
    s_add_u32 s28, s27, 0
    buffer_load_ushort v28, v4, s[12:15], s28 offen offset:0
    buffer_load_ushort v29, v4, s[12:15], s28 offen offset:896
    buffer_load_ushort v30, v4, s[12:15], s28 offen offset:1792
    buffer_load_ushort v31, v4, s[12:15], s28 offen offset:2688
    s_add_u32 s28, s27, 7168
    buffer_load_ushort v32, v4, s[12:15], s28 offen offset:0
    buffer_load_ushort v33, v4, s[12:15], s28 offen offset:896
    buffer_load_ushort v34, v4, s[12:15], s28 offen offset:1792
    buffer_load_ushort v35, v4, s[12:15], s28 offen offset:2688
    s_add_u32 s28, s27, 14336
    buffer_load_ushort v36, v4, s[12:15], s28 offen offset:0
    buffer_load_ushort v37, v4, s[12:15], s28 offen offset:896
    buffer_load_ushort v38, v4, s[12:15], s28 offen offset:1792
    buffer_load_ushort v39, v4, s[12:15], s28 offen offset:2688
    s_add_u32 s28, s27, 21504
    buffer_load_ushort v40, v5, s[12:15], s28 offen offset:0
    buffer_load_ushort v41, v5, s[12:15], s28 offen offset:896
    buffer_load_ushort v42, v5, s[12:15], s28 offen offset:1792
    buffer_load_ushort v43, v5, s[12:15], s28 offen offset:2688
    s_add_u32 s27, s27, 25088
    s_waitcnt vmcnt(24)
    v_lshl_or_b32 v72, v13, 16, v12
    v_lshl_or_b32 v73, v15, 16, v14
    v_lshl_or_b32 v74, v17, 16, v16
    v_lshl_or_b32 v75, v19, 16, v18
    buffer_store_dwordx4 v[72:75], v2, s[8:11], s29 offen offset:0 sc1
    s_waitcnt vmcnt(17)
    v_lshl_or_b32 v76, v21, 16, v20
    v_lshl_or_b32 v77, v23, 16, v22
    v_lshl_or_b32 v78, v25, 16, v24
    v_lshl_or_b32 v79, v27, 16, v26
    buffer_store_dwordx4 v[76:79], v2, s[8:11], s29 offen offset:1024 sc1
    s_waitcnt vmcnt(10)
    v_lshl_or_b32 v80, v29, 16, v28
    v_lshl_or_b32 v81, v31, 16, v30
    v_lshl_or_b32 v82, v33, 16, v32
    v_lshl_or_b32 v83, v35, 16, v34
    buffer_store_dwordx4 v[80:83], v2, s[8:11], s29 offen offset:2048 sc1
    s_waitcnt vmcnt(3)
    v_lshl_or_b32 v84, v37, 16, v36
    v_lshl_or_b32 v85, v39, 16, v38
    v_lshl_or_b32 v86, v41, 16, v40
    v_lshl_or_b32 v87, v43, 16, v42
    buffer_store_dwordx4 v[84:87], v2, s[8:11], s29 offen offset:3072 sc1
    s_add_u32 s29, s29, 4096
    s_sub_u32 s34, s34, 1
    s_cmp_lg_u32 s34, 0
    s_cbranch_scc1 wq_70_72
wq_70_e:
    s_mov_b32 s30, 18620928
    s_waitcnt vmcnt(0)
    s_barrier
    s_cmp_lg_u32 s21, 0
    s_cbranch_scc1 sig_73
    v_mov_b32 v3, 1
    s_mov_b64 exec, 1
    buffer_atomic_add v3, off, s[8:11], s30 sc1
    s_mov_b64 exec, -1
sig_73:
    s_branch main_next
job_9:
    s_mov_b32 s28, 18621056
wc_74:
    buffer_load_dword v3, off, s[8:11], s28 sc1
    s_waitcnt vmcnt(0)
    v_cmp_gt_u32 vcc, s24, v3
    s_cbranch_vccz wc_74k
    s_sleep 12
    s_sub_u32 s23, s23, 1
    s_cbranch_scc0 wc_74
    s_mov_b32 s23, 0
wc_74k:
    s_branch main_next
job_10:
    s_mov_b32 s22, s24
    s_lshr_b32 s20, s25, 1
    s_and_b32 s65, s25, 1
    s_lshl2_add_u32 s19, s65, s20
    s_sub_u32 s3, s19, 7
    s_cselect_b32 s19, s19, s3
    s_lshl_b32 s25, s22, 9
    s_lshl_b32 s28, s21, 13
    s_add_u32 s31, s28, 0x20000
    v_bfe_u32 v3, v0, 5, 1
    v_and_b32 v4, 31, v0
    v_xor_b32 v5, v4, v3
    v_lshlrev_b32 v5, 4, v5
    v_lshl_add_u32 v5, v3, 13, v5
    v_xor_b32 v8, 0, v5
    v_xor_b32 v9, 32, v5
    v_xor_b32 v10, 64, v5
    v_xor_b32 v11, 96, v5
    v_xor_b32 v12, 128, v5
    v_xor_b32 v13, 160, v5
    v_xor_b32 v14, 192, v5
    v_xor_b32 v15, 224, v5
    s_lshl_b32 s26, s20, 2
    s_add_u32 s26, s26, s21
    s_lshl_b32 s26, s26, 17
    s_add_u32 s26, s26, s25
    s_waitcnt lgkmcnt(0)
    s_mov_b32 s36, s42
    s_mov_b32 s37, s43
    s_mov_b32 s38, 3670016
    s_mov_b32 s39, 0x20000
    s_add_u32 m0, s31, 0
    s_add_u32 s27, s26, 0
    buffer_load_dwordx4 v8, s[36:39], s27 offen lds
    s_add_u32 m0, s31, 1024
    s_add_u32 s27, s26, 32768
    buffer_load_dwordx4 v9, s[36:39], s27 offen lds
    s_add_u32 m0, s31, 2048
    s_add_u32 s27, s26, 65536
    buffer_load_dwordx4 v10, s[36:39], s27 offen lds
    s_add_u32 m0, s31, 3072
    s_add_u32 s27, s26, 98304
    buffer_load_dwordx4 v11, s[36:39], s27 offen lds
    s_add_u32 m0, s31, 4096
    s_add_u32 s27, s26, 16384
    buffer_load_dwordx4 v12, s[36:39], s27 offen lds
    s_add_u32 m0, s31, 5120
    s_add_u32 s27, s26, 49152
    buffer_load_dwordx4 v13, s[36:39], s27 offen lds
    s_add_u32 m0, s31, 6144
    s_add_u32 s27, s26, 81920
    buffer_load_dwordx4 v14, s[36:39], s27 offen lds
    s_add_u32 m0, s31, 7168
    s_add_u32 s27, s26, 114688
    buffer_load_dwordx4 v15, s[36:39], s27 offen lds
    s_mov_b32 s12, s40
    s_mov_b32 s13, s41
    s_mov_b32 s14, 3670016
    s_mov_b32 s15, 0x20000
    s_lshl_b32 s33, s21, 17
    s_add_u32 s33, s33, s25
    s_lshl_b32 s32, s19, 19
    s_add_u32 s32, s32, s33
    s_add_u32 m0, s28, 0
    s_add_u32 s27, s32, 0
    buffer_load_dwordx4 v8, s[12:15], s27 offen offset:0 lds
    s_add_u32 s27, s32, 64512
    buffer_load_dwordx4 v9, s[12:15], s27 offen offset:1024 lds
    s_add_u32 s27, s32, 30720
    buffer_load_dwordx4 v10, s[12:15], s27 offen offset:2048 lds
    s_add_u32 s27, s32, 95232
    buffer_load_dwordx4 v11, s[12:15], s27 offen offset:3072 lds
    s_add_u32 m0, s28, 4096
    s_add_u32 s27, s32, 16384
    buffer_load_dwordx4 v12, s[12:15], s27 offen offset:0 lds
    s_add_u32 s27, s32, 80896
    buffer_load_dwordx4 v13, s[12:15], s27 offen offset:1024 lds
    s_add_u32 s27, s32, 47104
    buffer_load_dwordx4 v14, s[12:15], s27 offen offset:2048 lds
    s_add_u32 s27, s32, 111616
    buffer_load_dwordx4 v15, s[12:15], s27 offen offset:3072 lds
    s_add_u32 s32, s32, 524288
    s_cmp_ge_u32 s32, 3670016
    s_cselect_b32 s32, s33, s32
    v_and_b32 v5, 15, v0
    v_xor_b32 v5, v5, v3
    v_lshlrev_b32 v5, 4, v5
    v_lshl_add_u32 v5, v4, 9, v5
    s_lshr_b32 s26, s21, 1
    s_lshl_b32 s29, s26, 14
    s_and_b32 s24, s21, 1
    s_lshl_b32 s30, s24, 14
    s_add_u32 s30, s30, 0x20000
    v_xor_b32 v6, 0, v5
    v_add_u32 v16, s29, v6
    v_add_u32 v32, 0x10000, v16
    v_add_u32 v24, s30, v6
    v_xor_b32 v6, 32, v5
    v_add_u32 v17, s29, v6
    v_add_u32 v33, 0x10000, v17
    v_add_u32 v25, s30, v6
    v_xor_b32 v6, 64, v5
    v_add_u32 v18, s29, v6
    v_add_u32 v34, 0x10000, v18
    v_add_u32 v26, s30, v6
    v_xor_b32 v6, 96, v5
    v_add_u32 v19, s29, v6
    v_add_u32 v35, 0x10000, v19
    v_add_u32 v27, s30, v6
    v_xor_b32 v6, 128, v5
    v_add_u32 v20, s29, v6
    v_add_u32 v36, 0x10000, v20
    v_add_u32 v28, s30, v6
    v_xor_b32 v6, 160, v5
    v_add_u32 v21, s29, v6
    v_add_u32 v37, 0x10000, v21
    v_add_u32 v29, s30, v6
    v_xor_b32 v6, 192, v5
    v_add_u32 v22, s29, v6
    v_add_u32 v38, 0x10000, v22
    v_add_u32 v30, s30, v6
    v_xor_b32 v6, 224, v5
    v_add_u32 v23, s29, v6
    v_add_u32 v39, 0x10000, v23
    v_add_u32 v31, s30, v6
    s_mul_i32 s29, s22, 7
    s_add_u32 s29, s29, s20
    s_lshl1_add_u32 s29, s29, s24
    s_mul_i32 s29, s29, 28672
    s_add_u32 s29, s29, 0
    s_add_u32 s35, s29, 28672
    s_lshl_b32 s26, s26, 11
    s_add_u32 s29, s29, s26
    s_lshl_b32 s34, s19, 12
    s_add_u32 s34, s34, s29
    s_mov_b32 s30, 0x3db8aa3b
    s_waitcnt vmcnt(8)
    s_barrier
    ds_read_b128 a[0:3], v24 offset:0
    ds_read_b128 a[4:7], v25 offset:0
    ds_read_b128 a[8:11], v26 offset:0
    ds_read_b128 a[12:15], v27 offset:0
    ds_read_b128 a[16:19], v28 offset:0
    ds_read_b128 a[20:23], v29 offset:0
    ds_read_b128 a[24:27], v30 offset:0
    ds_read_b128 a[28:31], v31 offset:0
    s_waitcnt lgkmcnt(4)
    ds_read_b128 a[32:35], v24 offset:256
    ds_read_b128 a[36:39], v25 offset:256
    ds_read_b128 a[40:43], v26 offset:256
    ds_read_b128 a[44:47], v27 offset:256
    ds_read_b128 a[48:51], v28 offset:256
    ds_read_b128 a[52:55], v29 offset:256
    ds_read_b128 a[56:59], v30 offset:256
    ds_read_b128 a[60:63], v31 offset:256
    s_add_u32 m0, s28, 32768
    s_add_u32 s27, s32, 0
    buffer_load_dwordx4 v8, s[12:15], s27 offen offset:0 lds
    s_add_u32 s27, s32, 64512
    buffer_load_dwordx4 v9, s[12:15], s27 offen offset:1024 lds
    s_add_u32 s27, s32, 30720
    buffer_load_dwordx4 v10, s[12:15], s27 offen offset:2048 lds
    s_add_u32 s27, s32, 95232
    buffer_load_dwordx4 v11, s[12:15], s27 offen offset:3072 lds
    s_add_u32 m0, s28, 36864
    s_add_u32 s27, s32, 16384
    buffer_load_dwordx4 v12, s[12:15], s27 offen offset:0 lds
    s_add_u32 s27, s32, 80896
    buffer_load_dwordx4 v13, s[12:15], s27 offen offset:1024 lds
    s_add_u32 s27, s32, 47104
    buffer_load_dwordx4 v14, s[12:15], s27 offen offset:2048 lds
    s_add_u32 s27, s32, 111616
    buffer_load_dwordx4 v15, s[12:15], s27 offen offset:3072 lds
    s_add_u32 s32, s32, 524288
    s_cmp_ge_u32 s32, 3670016
    s_cselect_b32 s32, s33, s32
    s_waitcnt vmcnt(8)
    s_waitcnt lgkmcnt(0)
    s_barrier
    ds_read_b128 v[128:131], v16 offset:0
    ds_read_b128 v[132:135], v17 offset:0
    ds_read_b128 v[136:139], v18 offset:0
    ds_read_b128 v[140:143], v19 offset:0
    ds_read_b128 v[144:147], v20 offset:0
    s_waitcnt lgkmcnt(4)
    v_mfma_f32_32x32x16_bf16 v[48:63], v[128:131], a[0:3], 0
    ds_read_b128 v[148:151], v21 offset:0
    s_add_u32 m0, s28, 65536
    s_add_u32 s27, s32, 0
    buffer_load_dwordx4 v8, s[12:15], s27 offen offset:0 lds
    s_waitcnt lgkmcnt(4)
    v_mfma_f32_32x32x16_bf16 v[48:63], v[132:135], a[4:7], v[48:63]
    ds_read_b128 v[152:155], v22 offset:0
    s_add_u32 s27, s32, 64512
    buffer_load_dwordx4 v9, s[12:15], s27 offen offset:1024 lds
    s_waitcnt lgkmcnt(4)
    v_mfma_f32_32x32x16_bf16 v[48:63], v[136:139], a[8:11], v[48:63]
    ds_read_b128 v[156:159], v23 offset:0
    s_add_u32 s27, s32, 30720
    buffer_load_dwordx4 v10, s[12:15], s27 offen offset:2048 lds
    s_waitcnt lgkmcnt(4)
    v_mfma_f32_32x32x16_bf16 v[48:63], v[140:143], a[12:15], v[48:63]
    ds_read_b128 v[128:131], v16 offset:256
    s_add_u32 s27, s32, 95232
    buffer_load_dwordx4 v11, s[12:15], s27 offen offset:3072 lds
    s_waitcnt lgkmcnt(4)
    v_mfma_f32_32x32x16_bf16 v[48:63], v[144:147], a[16:19], v[48:63]
    ds_read_b128 v[132:135], v17 offset:256
    s_add_u32 m0, s28, 69632
    s_add_u32 s27, s32, 16384
    buffer_load_dwordx4 v12, s[12:15], s27 offen offset:0 lds
    s_waitcnt lgkmcnt(4)
    v_mfma_f32_32x32x16_bf16 v[48:63], v[148:151], a[20:23], v[48:63]
    ds_read_b128 v[136:139], v18 offset:256
    s_add_u32 s27, s32, 80896
    buffer_load_dwordx4 v13, s[12:15], s27 offen offset:1024 lds
    s_waitcnt lgkmcnt(4)
    v_mfma_f32_32x32x16_bf16 v[48:63], v[152:155], a[24:27], v[48:63]
    ds_read_b128 v[140:143], v19 offset:256
    s_add_u32 s27, s32, 47104
    buffer_load_dwordx4 v14, s[12:15], s27 offen offset:2048 lds
    s_waitcnt lgkmcnt(4)
    v_mfma_f32_32x32x16_bf16 v[48:63], v[156:159], a[28:31], v[48:63]
    ds_read_b128 v[144:147], v20 offset:256
    s_add_u32 s27, s32, 111616
    buffer_load_dwordx4 v15, s[12:15], s27 offen offset:3072 lds
    s_add_u32 s32, s32, 524288
    s_cmp_ge_u32 s32, 3670016
    s_cselect_b32 s32, s33, s32
    s_waitcnt lgkmcnt(4)
    v_mfma_f32_32x32x16_bf16 v[48:63], v[128:131], a[32:35], v[48:63]
    ds_read_b128 v[148:151], v21 offset:256
    s_add_u32 m0, s28, 98304
    s_add_u32 s27, s32, 0
    buffer_load_dwordx4 v8, s[12:15], s27 offen offset:0 lds
    s_waitcnt lgkmcnt(4)
    v_mfma_f32_32x32x16_bf16 v[48:63], v[132:135], a[36:39], v[48:63]
    ds_read_b128 v[152:155], v22 offset:256
    s_waitcnt vmcnt(9)
    s_barrier
    s_waitcnt lgkmcnt(4)
    v_mfma_f32_32x32x16_bf16 v[48:63], v[136:139], a[40:43], v[48:63]
    ds_read_b128 v[156:159], v23 offset:256
    s_add_u32 s27, s32, 64512
    buffer_load_dwordx4 v9, s[12:15], s27 offen offset:1024 lds
    s_waitcnt lgkmcnt(4)
    v_mfma_f32_32x32x16_bf16 v[48:63], v[140:143], a[44:47], v[48:63]
    ds_read_b128 v[128:131], v16 offset:32768
    s_add_u32 s27, s32, 30720
    buffer_load_dwordx4 v10, s[12:15], s27 offen offset:2048 lds
    s_waitcnt lgkmcnt(4)
    v_mfma_f32_32x32x16_bf16 v[48:63], v[144:147], a[48:51], v[48:63]
    ds_read_b128 v[132:135], v17 offset:32768
    s_add_u32 s27, s32, 95232
    buffer_load_dwordx4 v11, s[12:15], s27 offen offset:3072 lds
    s_waitcnt lgkmcnt(4)
    v_mfma_f32_32x32x16_bf16 v[48:63], v[148:151], a[52:55], v[48:63]
    ds_read_b128 v[136:139], v18 offset:32768
    s_add_u32 m0, s28, 102400
    s_add_u32 s27, s32, 16384
    buffer_load_dwordx4 v12, s[12:15], s27 offen offset:0 lds
    s_waitcnt lgkmcnt(4)
    v_mfma_f32_32x32x16_bf16 v[48:63], v[152:155], a[56:59], v[48:63]
    ds_read_b128 v[140:143], v19 offset:32768
    s_add_u32 s27, s32, 80896
    buffer_load_dwordx4 v13, s[12:15], s27 offen offset:1024 lds
    s_waitcnt lgkmcnt(4)
    v_mfma_f32_32x32x16_bf16 v[48:63], v[156:159], a[60:63], v[48:63]
    ds_read_b128 v[144:147], v20 offset:32768
    s_add_u32 s27, s32, 47104
    buffer_load_dwordx4 v14, s[12:15], s27 offen offset:2048 lds
    s_waitcnt lgkmcnt(4)
    v_mfma_f32_32x32x16_bf16 v[64:79], v[128:131], a[0:3], 0
    ds_read_b128 v[148:151], v21 offset:32768
    s_add_u32 s27, s32, 111616
    buffer_load_dwordx4 v15, s[12:15], s27 offen offset:3072 lds
    s_add_u32 s32, s32, 524288
    s_cmp_ge_u32 s32, 3670016
    s_cselect_b32 s32, s33, s32
    s_waitcnt lgkmcnt(4)
    v_mfma_f32_32x32x16_bf16 v[64:79], v[132:135], a[4:7], v[64:79]
    ds_read_b128 v[152:155], v22 offset:32768
    s_waitcnt lgkmcnt(4)
    v_mfma_f32_32x32x16_bf16 v[64:79], v[136:139], a[8:11], v[64:79]
    ds_read_b128 v[156:159], v23 offset:32768
    s_waitcnt lgkmcnt(4)
    v_mfma_f32_32x32x16_bf16 v[64:79], v[140:143], a[12:15], v[64:79]
    ds_read_b128 v[128:131], v16 offset:33024
    s_waitcnt lgkmcnt(4)
    v_mfma_f32_32x32x16_bf16 v[64:79], v[144:147], a[16:19], v[64:79]
    ds_read_b128 v[132:135], v17 offset:33024
    v_mul_f32 v48, s30, v48
    v_mul_f32 v49, s30, v49
    v_cvt_pk_bf16_f32 v192, v48, v49
    s_waitcnt lgkmcnt(4)
    v_mfma_f32_32x32x16_bf16 v[64:79], v[148:151], a[20:23], v[64:79]
    ds_read_b128 v[136:139], v18 offset:33024
    v_mul_f32 v50, s30, v50
    v_mul_f32 v51, s30, v51
    v_cvt_pk_bf16_f32 v193, v50, v51
    s_waitcnt lgkmcnt(4)
    v_mfma_f32_32x32x16_bf16 v[64:79], v[152:155], a[24:27], v[64:79]
    ds_read_b128 v[140:143], v19 offset:33024
    v_mul_f32 v52, s30, v52
    v_mul_f32 v53, s30, v53
    v_cvt_pk_bf16_f32 v194, v52, v53
    s_waitcnt lgkmcnt(4)
    v_mfma_f32_32x32x16_bf16 v[64:79], v[156:159], a[28:31], v[64:79]
    ds_read_b128 v[144:147], v20 offset:33024
    v_mul_f32 v54, s30, v54
    v_mul_f32 v55, s30, v55
    v_cvt_pk_bf16_f32 v195, v54, v55
    s_waitcnt lgkmcnt(4)
    v_mfma_f32_32x32x16_bf16 v[64:79], v[128:131], a[32:35], v[64:79]
    ds_read_b128 v[148:151], v21 offset:33024
    v_mul_f32 v56, s30, v56
    v_mul_f32 v57, s30, v57
    v_cvt_pk_bf16_f32 v196, v56, v57
    s_waitcnt lgkmcnt(4)
    v_mfma_f32_32x32x16_bf16 v[64:79], v[132:135], a[36:39], v[64:79]
    ds_read_b128 v[152:155], v22 offset:33024
    s_waitcnt vmcnt(8)
    s_barrier
    v_mul_f32 v58, s30, v58
    v_mul_f32 v59, s30, v59
    v_cvt_pk_bf16_f32 v197, v58, v59
    s_waitcnt lgkmcnt(4)
    v_mfma_f32_32x32x16_bf16 v[64:79], v[136:139], a[40:43], v[64:79]
    ds_read_b128 v[156:159], v23 offset:33024
    v_mul_f32 v60, s30, v60
    v_mul_f32 v61, s30, v61
    v_cvt_pk_bf16_f32 v198, v60, v61
    s_waitcnt lgkmcnt(4)
    v_mfma_f32_32x32x16_bf16 v[64:79], v[140:143], a[44:47], v[64:79]
    ds_read_b128 v[128:131], v32 offset:0
    v_mul_f32 v62, s30, v62
    v_mul_f32 v63, s30, v63
    v_cvt_pk_bf16_f32 v199, v62, v63
    s_waitcnt lgkmcnt(4)
    v_mfma_f32_32x32x16_bf16 v[64:79], v[144:147], a[48:51], v[64:79]
    ds_read_b128 v[132:135], v33 offset:0
    buffer_store_dwordx4 v[192:195], v2, s[8:11], s34 offen offset:0 sc1
    s_waitcnt lgkmcnt(4)
    v_mfma_f32_32x32x16_bf16 v[64:79], v[148:151], a[52:55], v[64:79]
    ds_read_b128 v[136:139], v34 offset:0
    s_waitcnt lgkmcnt(4)
    v_mfma_f32_32x32x16_bf16 v[64:79], v[152:155], a[56:59], v[64:79]
    ds_read_b128 v[140:143], v35 offset:0
    buffer_store_dwordx4 v[196:199], v2, s[8:11], s34 offen offset:1024 sc1
    s_add_u32 s34, s34, 4096
    s_cmp_ge_u32 s34, s35
    s_cselect_b32 s34, s29, s34
    s_waitcnt lgkmcnt(4)
    v_mfma_f32_32x32x16_bf16 v[64:79], v[156:159], a[60:63], v[64:79]
    ds_read_b128 v[144:147], v36 offset:0
    s_waitcnt lgkmcnt(4)
    v_mfma_f32_32x32x16_bf16 v[48:63], v[128:131], a[0:3], 0
    ds_read_b128 v[148:151], v37 offset:0
    s_waitcnt lgkmcnt(4)
    v_mfma_f32_32x32x16_bf16 v[48:63], v[132:135], a[4:7], v[48:63]
    ds_read_b128 v[152:155], v38 offset:0
    s_waitcnt lgkmcnt(4)
    v_mfma_f32_32x32x16_bf16 v[48:63], v[136:139], a[8:11], v[48:63]
    ds_read_b128 v[156:159], v39 offset:0
    s_waitcnt lgkmcnt(4)
    v_mfma_f32_32x32x16_bf16 v[48:63], v[140:143], a[12:15], v[48:63]
    ds_read_b128 v[128:131], v32 offset:256
    s_waitcnt lgkmcnt(4)
    v_mfma_f32_32x32x16_bf16 v[48:63], v[144:147], a[16:19], v[48:63]
    ds_read_b128 v[132:135], v33 offset:256
    v_mul_f32 v64, s30, v64
    v_mul_f32 v65, s30, v65
    v_cvt_pk_bf16_f32 v200, v64, v65
    s_waitcnt lgkmcnt(4)
    v_mfma_f32_32x32x16_bf16 v[48:63], v[148:151], a[20:23], v[48:63]
    ds_read_b128 v[136:139], v34 offset:256
    v_mul_f32 v66, s30, v66
    v_mul_f32 v67, s30, v67
    v_cvt_pk_bf16_f32 v201, v66, v67
    s_waitcnt lgkmcnt(4)
    v_mfma_f32_32x32x16_bf16 v[48:63], v[152:155], a[24:27], v[48:63]
    ds_read_b128 v[140:143], v35 offset:256
    v_mul_f32 v68, s30, v68
    v_mul_f32 v69, s30, v69
    v_cvt_pk_bf16_f32 v202, v68, v69
    s_waitcnt lgkmcnt(4)
    v_mfma_f32_32x32x16_bf16 v[48:63], v[156:159], a[28:31], v[48:63]
    ds_read_b128 v[144:147], v36 offset:256
    v_mul_f32 v70, s30, v70
    v_mul_f32 v71, s30, v71
    v_cvt_pk_bf16_f32 v203, v70, v71
    s_waitcnt lgkmcnt(4)
    v_mfma_f32_32x32x16_bf16 v[48:63], v[128:131], a[32:35], v[48:63]
    ds_read_b128 v[148:151], v37 offset:256
    v_mul_f32 v72, s30, v72
    v_mul_f32 v73, s30, v73
    v_cvt_pk_bf16_f32 v204, v72, v73
    s_waitcnt lgkmcnt(4)
    v_mfma_f32_32x32x16_bf16 v[48:63], v[132:135], a[36:39], v[48:63]
    ds_read_b128 v[152:155], v38 offset:256
    s_waitcnt vmcnt(2)
    s_barrier
    v_mul_f32 v74, s30, v74
    v_mul_f32 v75, s30, v75
    v_cvt_pk_bf16_f32 v205, v74, v75
    s_waitcnt lgkmcnt(4)
    v_mfma_f32_32x32x16_bf16 v[48:63], v[136:139], a[40:43], v[48:63]
    ds_read_b128 v[156:159], v39 offset:256
    v_mul_f32 v76, s30, v76
    v_mul_f32 v77, s30, v77
    v_cvt_pk_bf16_f32 v206, v76, v77
    s_waitcnt lgkmcnt(4)
    v_mfma_f32_32x32x16_bf16 v[48:63], v[140:143], a[44:47], v[48:63]
    ds_read_b128 v[128:131], v32 offset:32768
    v_mul_f32 v78, s30, v78
    v_mul_f32 v79, s30, v79
    v_cvt_pk_bf16_f32 v207, v78, v79
    s_waitcnt lgkmcnt(4)
    v_mfma_f32_32x32x16_bf16 v[48:63], v[144:147], a[48:51], v[48:63]
    ds_read_b128 v[132:135], v33 offset:32768
    buffer_store_dwordx4 v[200:203], v2, s[8:11], s34 offen offset:0 sc1
    s_waitcnt lgkmcnt(4)
    v_mfma_f32_32x32x16_bf16 v[48:63], v[148:151], a[52:55], v[48:63]
    ds_read_b128 v[136:139], v34 offset:32768
    s_waitcnt lgkmcnt(4)
    v_mfma_f32_32x32x16_bf16 v[48:63], v[152:155], a[56:59], v[48:63]
    ds_read_b128 v[140:143], v35 offset:32768
    buffer_store_dwordx4 v[204:207], v2, s[8:11], s34 offen offset:1024 sc1
    s_add_u32 s34, s34, 4096
    s_cmp_ge_u32 s34, s35
    s_cselect_b32 s34, s29, s34
    s_waitcnt lgkmcnt(4)
    v_mfma_f32_32x32x16_bf16 v[48:63], v[156:159], a[60:63], v[48:63]
    ds_read_b128 v[144:147], v36 offset:32768
    s_waitcnt lgkmcnt(4)
    v_mfma_f32_32x32x16_bf16 v[64:79], v[128:131], a[0:3], 0
    ds_read_b128 v[148:151], v37 offset:32768
    s_waitcnt lgkmcnt(4)
    v_mfma_f32_32x32x16_bf16 v[64:79], v[132:135], a[4:7], v[64:79]
    ds_read_b128 v[152:155], v38 offset:32768
    s_waitcnt lgkmcnt(4)
    v_mfma_f32_32x32x16_bf16 v[64:79], v[136:139], a[8:11], v[64:79]
    ds_read_b128 v[156:159], v39 offset:32768
    s_waitcnt lgkmcnt(4)
    v_mfma_f32_32x32x16_bf16 v[64:79], v[140:143], a[12:15], v[64:79]
    ds_read_b128 v[128:131], v32 offset:33024
    s_waitcnt lgkmcnt(4)
    v_mfma_f32_32x32x16_bf16 v[64:79], v[144:147], a[16:19], v[64:79]
    ds_read_b128 v[132:135], v33 offset:33024
    v_mul_f32 v48, s30, v48
    v_mul_f32 v49, s30, v49
    v_cvt_pk_bf16_f32 v208, v48, v49
    s_waitcnt lgkmcnt(4)
    v_mfma_f32_32x32x16_bf16 v[64:79], v[148:151], a[20:23], v[64:79]
    ds_read_b128 v[136:139], v34 offset:33024
    v_mul_f32 v50, s30, v50
    v_mul_f32 v51, s30, v51
    v_cvt_pk_bf16_f32 v209, v50, v51
    s_waitcnt lgkmcnt(4)
    v_mfma_f32_32x32x16_bf16 v[64:79], v[152:155], a[24:27], v[64:79]
    ds_read_b128 v[140:143], v35 offset:33024
    v_mul_f32 v52, s30, v52
    v_mul_f32 v53, s30, v53
    v_cvt_pk_bf16_f32 v210, v52, v53
    s_waitcnt lgkmcnt(4)
    v_mfma_f32_32x32x16_bf16 v[64:79], v[156:159], a[28:31], v[64:79]
    ds_read_b128 v[144:147], v36 offset:33024
    v_mul_f32 v54, s30, v54
    v_mul_f32 v55, s30, v55
    v_cvt_pk_bf16_f32 v211, v54, v55
    s_waitcnt lgkmcnt(4)
    v_mfma_f32_32x32x16_bf16 v[64:79], v[128:131], a[32:35], v[64:79]
    ds_read_b128 v[148:151], v37 offset:33024
    v_mul_f32 v56, s30, v56
    v_mul_f32 v57, s30, v57
    v_cvt_pk_bf16_f32 v212, v56, v57
    s_waitcnt lgkmcnt(4)
    v_mfma_f32_32x32x16_bf16 v[64:79], v[132:135], a[36:39], v[64:79]
    ds_read_b128 v[152:155], v38 offset:33024
    v_mul_f32 v58, s30, v58
    v_mul_f32 v59, s30, v59
    v_cvt_pk_bf16_f32 v213, v58, v59
    s_waitcnt lgkmcnt(4)
    v_mfma_f32_32x32x16_bf16 v[64:79], v[136:139], a[40:43], v[64:79]
    ds_read_b128 v[156:159], v39 offset:33024
    v_mul_f32 v60, s30, v60
    v_mul_f32 v61, s30, v61
    v_cvt_pk_bf16_f32 v214, v60, v61
    s_waitcnt lgkmcnt(4)
    v_mfma_f32_32x32x16_bf16 v[64:79], v[140:143], a[44:47], v[64:79]
    v_mul_f32 v62, s30, v62
    v_mul_f32 v63, s30, v63
    v_cvt_pk_bf16_f32 v215, v62, v63
    s_waitcnt lgkmcnt(3)
    v_mfma_f32_32x32x16_bf16 v[64:79], v[144:147], a[48:51], v[64:79]
    buffer_store_dwordx4 v[208:211], v2, s[8:11], s34 offen offset:0 sc1
    s_waitcnt lgkmcnt(2)
    v_mfma_f32_32x32x16_bf16 v[64:79], v[148:151], a[52:55], v[64:79]
    s_waitcnt lgkmcnt(1)
    v_mfma_f32_32x32x16_bf16 v[64:79], v[152:155], a[56:59], v[64:79]
    buffer_store_dwordx4 v[212:215], v2, s[8:11], s34 offen offset:1024 sc1
    s_add_u32 s34, s34, 4096
    s_cmp_ge_u32 s34, s35
    s_cselect_b32 s34, s29, s34
    s_waitcnt lgkmcnt(0)
    v_mfma_f32_32x32x16_bf16 v[64:79], v[156:159], a[60:63], v[64:79]
    s_nop 4
    s_lshl_b32 s19, s20, 1
    s_lshl_b32 s19, 1, s19
    s_lshl_b32 s18, s22, 7
    s_add_u32 s18, s18, 18634752
    s_cmp_eq_u32 s65, 0
    s_cselect_b32 s3, 0, 2147483632
    v_or_b32 v3, s3, v2
    v_or_b32 v5, s3, v4
    v_mul_f32 v64, s30, v64
    v_mul_f32 v65, s30, v65
    v_cvt_pk_bf16_f32 v216, v64, v65
    v_mul_f32 v66, s30, v66
    v_mul_f32 v67, s30, v67
    v_cvt_pk_bf16_f32 v217, v66, v67
    v_mul_f32 v68, s30, v68
    v_mul_f32 v69, s30, v69
    v_cvt_pk_bf16_f32 v218, v68, v69
    v_mul_f32 v70, s30, v70
    v_mul_f32 v71, s30, v71
    v_cvt_pk_bf16_f32 v219, v70, v71
    v_mul_f32 v72, s30, v72
    v_mul_f32 v73, s30, v73
    v_cvt_pk_bf16_f32 v220, v72, v73
    v_mul_f32 v74, s30, v74
    v_mul_f32 v75, s30, v75
    v_cvt_pk_bf16_f32 v221, v74, v75
    v_mul_f32 v76, s30, v76
    v_mul_f32 v77, s30, v77
    v_cvt_pk_bf16_f32 v222, v76, v77
    v_mul_f32 v78, s30, v78
    v_mul_f32 v79, s30, v79
    v_cvt_pk_bf16_f32 v223, v78, v79
    buffer_store_dwordx4 v[216:219], v3, s[8:11], s34 offen offset:0 sc1
    buffer_store_dwordx4 v[220:223], v3, s[8:11], s34 offen offset:1024 sc1
    s_add_u32 s34, s34, 4096
    s_cmp_ge_u32 s34, s35
    s_cselect_b32 s34, s29, s34
    s_waitcnt vmcnt(0)
    s_barrier
    s_cmp_lg_u32 s21, 0
    s_cbranch_scc1 sig_75
    v_mov_b32 v3, s19
    s_mov_b64 exec, 1
    buffer_atomic_add v3, off, s[8:11], s18 sc1
    s_mov_b64 exec, -1
sig_75:
    s_branch main_next
job_12:
    s_mov_b32 s22, s24
    s_lshl2_add_u32 s24, s22, s21
    s_mul_i32 s24, s24, 14336
    s_mul_i32 s28, s21, 14592
    s_mov_b32 s12, s58
    s_mov_b32 s13, s59
    s_mov_b32 s14, 1835008
    s_mov_b32 s15, 0x20000
    s_mov_b32 exec_hi, 0x00ffffff
    s_add_u32 m0, s28, 0
    s_add_u32 s27, s24, 0
    buffer_load_dwordx4 v2, s[12:15], s27 offen lds
    s_add_u32 m0, s28, 912
    s_add_u32 s27, s24, 896
    buffer_load_dwordx4 v2, s[12:15], s27 offen lds
    s_add_u32 m0, s28, 1824
    s_add_u32 s27, s24, 1792
    buffer_load_dwordx4 v2, s[12:15], s27 offen lds
    s_add_u32 m0, s28, 2736
    s_add_u32 s27, s24, 2688
    buffer_load_dwordx4 v2, s[12:15], s27 offen lds
    s_add_u32 m0, s28, 3648
    s_add_u32 s27, s24, 3584
    buffer_load_dwordx4 v2, s[12:15], s27 offen lds
    s_add_u32 m0, s28, 4560
    s_add_u32 s27, s24, 4480
    buffer_load_dwordx4 v2, s[12:15], s27 offen lds
    s_add_u32 m0, s28, 5472
    s_add_u32 s27, s24, 5376
    buffer_load_dwordx4 v2, s[12:15], s27 offen lds
    s_add_u32 m0, s28, 6384
    s_add_u32 s27, s24, 6272
    buffer_load_dwordx4 v2, s[12:15], s27 offen lds
    s_add_u32 m0, s28, 7296
    s_add_u32 s27, s24, 7168
    buffer_load_dwordx4 v2, s[12:15], s27 offen lds
    s_add_u32 m0, s28, 8208
    s_add_u32 s27, s24, 8064
    buffer_load_dwordx4 v2, s[12:15], s27 offen lds
    s_add_u32 m0, s28, 9120
    s_add_u32 s27, s24, 8960
    buffer_load_dwordx4 v2, s[12:15], s27 offen lds
    s_add_u32 m0, s28, 10032
    s_add_u32 s27, s24, 9856
    buffer_load_dwordx4 v2, s[12:15], s27 offen lds
    s_add_u32 m0, s28, 10944
    s_add_u32 s27, s24, 10752
    buffer_load_dwordx4 v2, s[12:15], s27 offen lds
    s_add_u32 m0, s28, 11856
    s_add_u32 s27, s24, 11648
    buffer_load_dwordx4 v2, s[12:15], s27 offen lds
    s_add_u32 m0, s28, 12768
    s_add_u32 s27, s24, 12544
    buffer_load_dwordx4 v2, s[12:15], s27 offen lds
    s_add_u32 m0, s28, 13680
    s_add_u32 s27, s24, 13440
    buffer_load_dwordx4 v2, s[12:15], s27 offen lds
    s_mov_b64 exec, -1
    v_bfe_u32 v3, v0, 3, 1
    v_mul_u32_u24 v5, 14592, v3
    v_bfe_u32 v3, v0, 0, 1
    v_mul_u32_u24 v3, 7296, v3
    v_add_u32 v5, v3, v5
    v_bfe_u32 v3, v0, 1, 1
    v_mul_u32_u24 v3, 3648, v3
    v_add_u32 v5, v3, v5
    v_bfe_u32 v3, v0, 2, 1
    v_mul_u32_u24 v3, 1824, v3
    v_add_u32 v5, v3, v5
    v_bfe_u32 v3, v0, 5, 1
    v_lshl_add_u32 v5, v3, 4, v5
    v_bfe_u32 v3, v0, 7, 1
    v_mul_u32_u24 v3, 448, v3
    v_add_u32 v5, v3, v5
    v_bfe_u32 v3, v0, 6, 1
    v_lshl_add_u32 v5, v3, 8, v5
    v_bfe_u32 v3, v0, 4, 1
    v_lshl_add_u32 v9, v3, 6, v5
    s_and_b32 s26, s21, 1
    s_mul_i32 s26, s26, -256
    s_add_u32 s26, s26, 64
    v_mul_i32_i24 v3, s26, v3
    v_add_u32 v10, v3, v5
    v_add_u32 v10, 128, v10
    s_waitcnt vmcnt(0)
    s_barrier
    ds_read_b128 v[128:131], v9 offset:0
    ds_read_b128 v[132:135], v9 offset:32
    ds_read_b128 v[136:139], v10 offset:0
    ds_read_b128 v[140:143], v10 offset:32
    ds_read_b128 v[144:147], v9 offset:912
    ds_read_b128 v[148:151], v9 offset:944
    ds_read_b128 v[152:155], v10 offset:912
    ds_read_b128 v[156:159], v10 offset:944
    s_lshl_b32 s26, s22, 16
    s_lshl_b32 s27, s21, 13
    s_add_u32 s26, s26, s27
    s_add_u32 s26, s26, 13631488
    s_waitcnt lgkmcnt(7)
    buffer_store_dwordx4 v[128:131], v2, s[8:11], s26 offen offset:0 sc1
    s_waitcnt lgkmcnt(6)
    buffer_store_dwordx4 v[132:135], v2, s[8:11], s26 offen offset:1024 sc1
    s_waitcnt lgkmcnt(5)
    buffer_store_dwordx4 v[136:139], v2, s[8:11], s26 offen offset:2048 sc1
    s_waitcnt lgkmcnt(4)
    buffer_store_dwordx4 v[140:143], v2, s[8:11], s26 offen offset:3072 sc1
    s_add_u32 s26, s26, 4096
    s_waitcnt lgkmcnt(3)
    buffer_store_dwordx4 v[144:147], v2, s[8:11], s26 offen offset:0 sc1
    s_waitcnt lgkmcnt(2)
    buffer_store_dwordx4 v[148:151], v2, s[8:11], s26 offen offset:1024 sc1
    s_waitcnt lgkmcnt(1)
    buffer_store_dwordx4 v[152:155], v2, s[8:11], s26 offen offset:2048 sc1
    s_waitcnt lgkmcnt(0)
    buffer_store_dwordx4 v[156:159], v2, s[8:11], s26 offen offset:3072 sc1
    ds_read_b128 v[160:163], v9 offset:29184
    ds_read_b128 v[164:167], v9 offset:29216
    ds_read_b128 v[168:171], v10 offset:29184
    ds_read_b128 v[172:175], v10 offset:29216
    ds_read_b128 v[176:179], v9 offset:30096
    ds_read_b128 v[180:183], v9 offset:30128
    ds_read_b128 v[184:187], v10 offset:30096
    ds_read_b128 v[188:191], v10 offset:30128
    s_lshl_b32 s26, s22, 16
    s_lshl_b32 s27, s21, 13
    s_add_u32 s26, s26, s27
    s_add_u32 s26, s26, 13664256
    s_waitcnt lgkmcnt(7)
    buffer_store_dwordx4 v[160:163], v2, s[8:11], s26 offen offset:0 sc1
    s_waitcnt lgkmcnt(6)
    buffer_store_dwordx4 v[164:167], v2, s[8:11], s26 offen offset:1024 sc1
    s_waitcnt lgkmcnt(5)
    buffer_store_dwordx4 v[168:171], v2, s[8:11], s26 offen offset:2048 sc1
    s_waitcnt lgkmcnt(4)
    buffer_store_dwordx4 v[172:175], v2, s[8:11], s26 offen offset:3072 sc1
    s_add_u32 s26, s26, 4096
    s_waitcnt lgkmcnt(3)
    buffer_store_dwordx4 v[176:179], v2, s[8:11], s26 offen offset:0 sc1
    s_waitcnt lgkmcnt(2)
    buffer_store_dwordx4 v[180:183], v2, s[8:11], s26 offen offset:1024 sc1
    s_waitcnt lgkmcnt(1)
    buffer_store_dwordx4 v[184:187], v2, s[8:11], s26 offen offset:2048 sc1
    s_waitcnt lgkmcnt(0)
    buffer_store_dwordx4 v[188:191], v2, s[8:11], s26 offen offset:3072 sc1
    s_lshr_b32 s26, s22, 1
    s_lshl_b32 s26, s26, 7
    s_add_u32 s26, s26, 18616320
    s_waitcnt vmcnt(0)
    s_barrier
    s_cmp_lg_u32 s21, 0
    s_cbranch_scc1 sig_76
    v_mov_b32 v3, 1
    s_mov_b64 exec, 1
    buffer_atomic_add v3, off, s[8:11], s26 sc1
    s_mov_b64 exec, -1
sig_76:
    s_branch main_next
main_fin:
main_end:
    s_endpgm
.p2align 6
.type job_table,@object
job_table:
.long 0xa, 0x0, 0x0, 0x0, 0x0, 0x0, 0x0, 0x0, 0x0, 0x0, 0x0, 0x0, 0x0, 0x0, 0x0, 0x0
.long 0x1000a, 0x0, 0x0, 0x0, 0x0, 0x0, 0x0, 0x0, 0x0, 0x0, 0x0, 0x0, 0x0, 0x0, 0x0, 0x0
.long 0x2000a, 0x0, 0x0, 0x0, 0x0, 0x0, 0x0, 0x0, 0x0, 0x0, 0x0, 0x0, 0x0, 0x0, 0x0, 0x0
.long 0x3000a, 0x0, 0x0, 0x0, 0x0, 0x0, 0x0, 0x0, 0x0, 0x0, 0x0, 0x0, 0x0, 0x0, 0x0, 0x0
.long 0x4000a, 0x0, 0x0, 0x0, 0x0, 0x0, 0x0, 0x0, 0x0, 0x0, 0x0, 0x0, 0x0, 0x0, 0x0, 0x0
.long 0x5000a, 0x0, 0x0, 0x0, 0x0, 0x0, 0x0, 0x0, 0x0, 0x0, 0x0, 0x0, 0x0, 0x0, 0x0, 0x0
.long 0x6000a, 0x0, 0x0, 0x0, 0x0, 0x0, 0x0, 0x0, 0x0, 0x0, 0x0, 0x0, 0x0, 0x0, 0x0, 0x0
.long 0x7000a, 0x0, 0x0, 0x0, 0x0, 0x0, 0x0, 0x0, 0x0, 0x0, 0x0, 0x0, 0x0, 0x0, 0x0, 0x0
.long 0x8000a, 0x0, 0x0, 0x0, 0x0, 0x0, 0x0, 0x0, 0x0, 0x0, 0x0, 0x0, 0x0, 0x0, 0x0, 0x0
.long 0x9000a, 0x0, 0x0, 0x0, 0x0, 0x0, 0x0, 0x0, 0x0, 0x0, 0x0, 0x0, 0x0, 0x0, 0x0, 0x0
.long 0xa000a, 0x0, 0x0, 0x0, 0x0, 0x0, 0x0, 0x0, 0x0, 0x0, 0x0, 0x0, 0x0, 0x0, 0x0, 0x0
.long 0xb000a, 0x0, 0x0, 0x0, 0x0, 0x0, 0x0, 0x0, 0x0, 0x0, 0x0, 0x0, 0x0, 0x0, 0x0, 0x0
.long 0xc000a, 0x0, 0x0, 0x0, 0x0, 0x0, 0x0, 0x0, 0x0, 0x0, 0x0, 0x0, 0x0, 0x0, 0x0, 0x0
.long 0xd000a, 0x0, 0x0, 0x0, 0x0, 0x0, 0x0, 0x0, 0x0, 0x0, 0x0, 0x0, 0x0, 0x0, 0x0, 0x0
.long 0x10a, 0x0, 0x0, 0x0, 0x0, 0x0, 0x0, 0x0, 0x0, 0x0, 0x0, 0x0, 0x0, 0x0, 0x0, 0x0
.long 0x1010a, 0x0, 0x0, 0x0, 0x0, 0x0, 0x0, 0x0, 0x0, 0x0, 0x0, 0x0, 0x0, 0x0, 0x0, 0x0
.long 0x2010a, 0x0, 0x0, 0x0, 0x0, 0x0, 0x0, 0x0, 0x0, 0x0, 0x0, 0x0, 0x0, 0x0, 0x0, 0x0
.long 0x3010a, 0x0, 0x0, 0x0, 0x0, 0x0, 0x0, 0x0, 0x0, 0x0, 0x0, 0x0, 0x0, 0x0, 0x0, 0x0
.long 0x4010a, 0x0, 0x0, 0x0, 0x0, 0x0, 0x0, 0x0, 0x0, 0x0, 0x0, 0x0, 0x0, 0x0, 0x0, 0x0
.long 0x5010a, 0x0, 0x0, 0x0, 0x0, 0x0, 0x0, 0x0, 0x0, 0x0, 0x0, 0x0, 0x0, 0x0, 0x0, 0x0
.long 0x6010a, 0x0, 0x0, 0x0, 0x0, 0x0, 0x0, 0x0, 0x0, 0x0, 0x0, 0x0, 0x0, 0x0, 0x0, 0x0
.long 0x7010a, 0x0, 0x0, 0x0, 0x0, 0x0, 0x0, 0x0, 0x0, 0x0, 0x0, 0x0, 0x0, 0x0, 0x0, 0x0
.long 0x8010a, 0x0, 0x0, 0x0, 0x0, 0x0, 0x0, 0x0, 0x0, 0x0, 0x0, 0x0, 0x0, 0x0, 0x0, 0x0
.long 0x9010a, 0x0, 0x0, 0x0, 0x0, 0x0, 0x0, 0x0, 0x0, 0x0, 0x0, 0x0, 0x0, 0x0, 0x0, 0x0
.long 0xa010a, 0x0, 0x0, 0x0, 0x0, 0x0, 0x0, 0x0, 0x0, 0x0, 0x0, 0x0, 0x0, 0x0, 0x0, 0x0
.long 0xb010a, 0x0, 0x0, 0x0, 0x0, 0x0, 0x0, 0x0, 0x0, 0x0, 0x0, 0x0, 0x0, 0x0, 0x0, 0x0
.long 0xc010a, 0x0, 0x0, 0x0, 0x0, 0x0, 0x0, 0x0, 0x0, 0x0, 0x0, 0x0, 0x0, 0x0, 0x0, 0x0
.long 0xd010a, 0x0, 0x0, 0x0, 0x0, 0x0, 0x0, 0x0, 0x0, 0x0, 0x0, 0x0, 0x0, 0x0, 0x0, 0x0
.long 0x20a, 0x0, 0x0, 0x0, 0x0, 0x0, 0x0, 0x0, 0x0, 0x0, 0x0, 0x0, 0x0, 0x0, 0x0, 0x0
.long 0x1020a, 0x0, 0x0, 0x0, 0x0, 0x0, 0x0, 0x0, 0x0, 0x0, 0x0, 0x0, 0x0, 0x0, 0x0, 0x0
.long 0x2020a, 0x0, 0x0, 0x0, 0x0, 0x0, 0x0, 0x0, 0x0, 0x0, 0x0, 0x0, 0x0, 0x0, 0x0, 0x0
.long 0x3020a, 0x0, 0x0, 0x0, 0x0, 0x0, 0x0, 0x0, 0x0, 0x0, 0x0, 0x0, 0x0, 0x0, 0x0, 0x0
.long 0x4020a, 0xb, 0x109, 0x7, 0x0, 0x0, 0x0, 0x0, 0x0, 0x0, 0x0, 0x0, 0x0, 0x0, 0x0, 0x0
.long 0x5020a, 0x100b, 0x109, 0x107, 0x0, 0x0, 0x0, 0x0, 0x0, 0x0, 0x0, 0x0, 0x0, 0x0, 0x0, 0x0
.long 0x6020a, 0x200b, 0x30001, 0x60001, 0x90001, 0xc0001, 0xf0001, 0x11d05, 0x12505, 0x12d05, 0x0, 0x0, 0x0, 0x0, 0x0, 0x0
.long 0x7020a, 0x300b, 0x40001, 0x70001, 0xa0001, 0xd0001, 0x1805, 0x2005, 0x2805, 0x0, 0x0, 0x0, 0x0, 0x0, 0x0, 0x0
.long 0x8020a, 0x10008, 0x50001, 0x80001, 0xb0001, 0xe0001, 0x11805, 0x12005, 0x12805, 0x0, 0x0, 0x0, 0x0, 0x0, 0x0, 0x0
.long 0x9020a, 0x20008, 0x30101, 0x60101, 0x90101, 0xc0101, 0xf0101, 0x21d05, 0x22505, 0x22d05, 0x0, 0x0, 0x0, 0x0, 0x0, 0x0
.long 0xa020a, 0x11008, 0x40101, 0x70101, 0xa0101, 0xd0101, 0x21805, 0x22005, 0x22805, 0x0, 0x0, 0x0, 0x0, 0x0, 0x0, 0x0
.long 0xb020a, 0x21008, 0x50101, 0x80101, 0xb0101, 0xe0101, 0x31805, 0x32005, 0x32805, 0x0, 0x0, 0x0, 0x0, 0x0, 0x0, 0x0
.long 0xc020a, 0xc, 0x309, 0x2, 0x4, 0x40004, 0x80004, 0xc0004, 0x3005, 0x0, 0x0, 0x0, 0x0, 0x0, 0x0, 0x0
.long 0xd020a, 0x6, 0x309, 0x10002, 0x10004, 0x50004, 0x90004, 0xd0004, 0x13005, 0x0, 0x0, 0x0, 0x0, 0x0, 0x0, 0x0
.long 0x30a, 0x10c, 0x106, 0x309, 0x20002, 0x20004, 0x60004, 0xa0004, 0xe0004, 0x23005, 0x0, 0x0, 0x0, 0x0, 0x0, 0x0
.long 0x1030a, 0x206, 0x309, 0x30002, 0x30004, 0x70004, 0xb0004, 0xf0004, 0x33005, 0x0, 0x0, 0x0, 0x0, 0x0, 0x0, 0x0
.long 0x2030a, 0x20c, 0x306, 0x309, 0x40002, 0x104, 0x40104, 0x80104, 0xc0104, 0x3105, 0x0, 0x0, 0x0, 0x0, 0x0, 0x0
.long 0x3030a, 0x406, 0x309, 0x50002, 0x10104, 0x50104, 0x90104, 0xd0104, 0x13105, 0x0, 0x0, 0x0, 0x0, 0x0, 0x0, 0x0
.long 0x4030a, 0x30c, 0x506, 0x309, 0x60002, 0x20104, 0x60104, 0xa0104, 0xe0104, 0x23105, 0x0, 0x0, 0x0, 0x0, 0x0, 0x0
.long 0x5030a, 0x606, 0x309, 0x70002, 0x30104, 0x70104, 0xb0104, 0xf0104, 0x33105, 0x0, 0x0, 0x0, 0x0, 0x0, 0x0, 0x0
.long 0x6030a, 0x40c, 0x706, 0x309, 0x80002, 0x204, 0x40204, 0x80204, 0xc0204, 0x3205, 0x0, 0x0, 0x0, 0x0, 0x0, 0x0
.long 0x7030a, 0x10b, 0x3, 0x30003, 0x60003, 0x90003, 0xc0003, 0x0, 0x0, 0x0, 0x0, 0x0, 0x0, 0x0, 0x0, 0x0
.long 0x8030a, 0x110b, 0x10003, 0x40003, 0x70003, 0xa0003, 0xd0003, 0x0, 0x0, 0x0, 0x0, 0x0, 0x0, 0x0, 0x0, 0x0
.long 0x9030a, 0x210b, 0x20003, 0x50003, 0x80003, 0xb0003, 0xe0003, 0x0, 0x0, 0x0, 0x0, 0x0, 0x0, 0x0, 0x0, 0x0
.long 0xa030a, 0x310b, 0x103, 0x30103, 0x60103, 0x90103, 0xc0103, 0x0, 0x0, 0x0, 0x0, 0x0, 0x0, 0x0, 0x0, 0x0
.long 0xb030a, 0x10108, 0x10103, 0x40103, 0x70103, 0xa0103, 0xd0103, 0x0, 0x0, 0x0, 0x0, 0x0, 0x0, 0x0, 0x0, 0x0
.long 0xc030a, 0x20108, 0x20103, 0x50103, 0x80103, 0xb0103, 0xe0103, 0x0, 0x0, 0x0, 0x0, 0x0, 0x0, 0x0, 0x0, 0x0
.long 0xd030a, 0x11108, 0x203, 0x30203, 0x60203, 0x90203, 0xc0203, 0x0, 0x0, 0x0, 0x0, 0x0, 0x0, 0x0, 0x0, 0x0
.long 0x40a, 0x21108, 0x10203, 0x40203, 0x70203, 0xa0203, 0xd0203, 0x0, 0x0, 0x0, 0x0, 0x0, 0x0, 0x0, 0x0, 0x0
.long 0x1040a, 0x20b, 0x20203, 0x50203, 0x80203, 0xb0203, 0xe0203, 0x0, 0x0, 0x0, 0x0, 0x0, 0x0, 0x0, 0x0, 0x0
.long 0x2040a, 0x120b, 0x5, 0x20405, 0x905, 0x20d05, 0x1205, 0x21605, 0x0, 0x0, 0x0, 0x0, 0x0, 0x0, 0x0, 0x0
.long 0x3040a, 0x220b, 0x10005, 0x30405, 0x10905, 0x30d05, 0x11205, 0x31605, 0x0, 0x0, 0x0, 0x0, 0x0, 0x0, 0x0, 0x0
.long 0x4040a, 0x320b, 0x20005, 0x505, 0x20905, 0xe05, 0x21205, 0x1705, 0x0, 0x0, 0x0, 0x0, 0x0, 0x0, 0x0, 0x0
.long 0x5040a, 0x10208, 0x30005, 0x10505, 0x30905, 0x10e05, 0x31205, 0x11705, 0x0, 0x0, 0x0, 0x0, 0x0, 0x0, 0x0, 0x0
.long 0x6040a, 0x20208, 0x105, 0x20505, 0xa05, 0x20e05, 0x1305, 0x21705, 0x0, 0x0, 0x0, 0x0, 0x0, 0x0, 0x0, 0x0
.long 0x7040a, 0x11208, 0x10105, 0x30505, 0x10a05, 0x30e05, 0x11305, 0x31705, 0x0, 0x0, 0x0, 0x0, 0x0, 0x0, 0x0, 0x0
.long 0x8040a, 0x21208, 0x109, 0x207, 0x0, 0x0, 0x0, 0x0, 0x0, 0x0, 0x0, 0x0, 0x0, 0x0, 0x0, 0x0
.long 0x9040a, 0x30b, 0x109, 0x307, 0x0, 0x0, 0x0, 0x0, 0x0, 0x0, 0x0, 0x0, 0x0, 0x0, 0x0, 0x0
.long 0xa040a, 0x130b, 0x109, 0x407, 0x0, 0x0, 0x0, 0x0, 0x0, 0x0, 0x0, 0x0, 0x0, 0x0, 0x0, 0x0
.long 0xb040a, 0x230b, 0x30201, 0x60201, 0x90201, 0xc0201, 0xf0201, 0x31d05, 0x32505, 0x32d05, 0x0, 0x0, 0x0, 0x0, 0x0, 0x0
.long 0xc040a, 0x330b, 0x40201, 0x70201, 0xa0201, 0xd0201, 0x1905, 0x2105, 0x2905, 0x0, 0x0, 0x0, 0x0, 0x0, 0x0, 0x0
.long 0xd040a, 0x10308, 0x50201, 0x80201, 0xb0201, 0xe0201, 0x11905, 0x12105, 0x12905, 0x0, 0x0, 0x0, 0x0, 0x0, 0x0, 0x0
.long 0x50a, 0x20308, 0x30301, 0x60301, 0x90301, 0xc0301, 0xf0301, 0x1e05, 0x2605, 0x2e05, 0x0, 0x0, 0x0, 0x0, 0x0, 0x0
.long 0x1050a, 0x11308, 0x40301, 0x70301, 0xa0301, 0xd0301, 0x21905, 0x22105, 0x22905, 0x0, 0x0, 0x0, 0x0, 0x0, 0x0, 0x0
.long 0x2050a, 0x21308, 0x50301, 0x80301, 0xb0301, 0xe0301, 0x31905, 0x32105, 0x32905, 0x0, 0x0, 0x0, 0x0, 0x0, 0x0, 0x0
.long 0x3050a, 0x806, 0x309, 0x90002, 0x10204, 0x50204, 0x90204, 0xd0204, 0x13205, 0x0, 0x0, 0x0, 0x0, 0x0, 0x0, 0x0
.long 0x4050a, 0x50c, 0x906, 0x309, 0xa0002, 0x20204, 0x60204, 0xa0204, 0xe0204, 0x23205, 0x0, 0x0, 0x0, 0x0, 0x0, 0x0
.long 0x5050a, 0xa06, 0x309, 0xb0002, 0x30204, 0x70204, 0xb0204, 0xf0204, 0x33205, 0x0, 0x0, 0x0, 0x0, 0x0, 0x0, 0x0
.long 0x6050a, 0x60c, 0xb06, 0x309, 0xc0002, 0x304, 0x40304, 0x80304, 0xc0304, 0x3305, 0x0, 0x0, 0x0, 0x0, 0x0, 0x0
.long 0x7050a, 0xc06, 0x309, 0xd0002, 0x10304, 0x50304, 0x90304, 0xd0304, 0x13305, 0x0, 0x0, 0x0, 0x0, 0x0, 0x0, 0x0
.long 0x8050a, 0x70c, 0xd06, 0x309, 0xe0002, 0x20304, 0x60304, 0xa0304, 0xe0304, 0x23305, 0x0, 0x0, 0x0, 0x0, 0x0, 0x0
.long 0x9050a, 0xe06, 0x309, 0xf0002, 0x30304, 0x70304, 0xb0304, 0xf0304, 0x33305, 0x0, 0x0, 0x0, 0x0, 0x0, 0x0, 0x0
.long 0xa050a, 0x80c, 0xf06, 0x309, 0x102, 0x404, 0x40404, 0x80404, 0xc0404, 0x3405, 0x0, 0x0, 0x0, 0x0, 0x0, 0x0
.long 0xb050a, 0x1006, 0x309, 0x10102, 0x10404, 0x50404, 0x90404, 0xd0404, 0x13405, 0x0, 0x0, 0x0, 0x0, 0x0, 0x0, 0x0
.long 0xc050a, 0x90c, 0x1106, 0x309, 0x20102, 0x20404, 0x60404, 0xa0404, 0xe0404, 0x23405, 0x0, 0x0, 0x0, 0x0, 0x0, 0x0
.long 0xd050a, 0x40b, 0x303, 0x30303, 0x60303, 0x90303, 0xc0303, 0x0, 0x0, 0x0, 0x0, 0x0, 0x0, 0x0, 0x0, 0x0
.long 0x60a, 0x140b, 0x10303, 0x40303, 0x70303, 0xa0303, 0xd0303, 0x0, 0x0, 0x0, 0x0, 0x0, 0x0, 0x0, 0x0, 0x0
.long 0x1060a, 0x240b, 0x20303, 0x50303, 0x80303, 0xb0303, 0xe0303, 0x0, 0x0, 0x0, 0x0, 0x0, 0x0, 0x0, 0x0, 0x0
.long 0x2060a, 0x340b, 0x403, 0x30403, 0x60403, 0x90403, 0xc0403, 0x0, 0x0, 0x0, 0x0, 0x0, 0x0, 0x0, 0x0, 0x0
.long 0x3060a, 0x10408, 0x10403, 0x40403, 0x70403, 0xa0403, 0xd0403, 0x0, 0x0, 0x0, 0x0, 0x0, 0x0, 0x0, 0x0, 0x0
.long 0x4060a, 0x20408, 0x20403, 0x50403, 0x80403, 0xb0403, 0xe0403, 0x0, 0x0, 0x0, 0x0, 0x0, 0x0, 0x0, 0x0, 0x0
.long 0x5060a, 0x11408, 0x503, 0x30503, 0x60503, 0x90503, 0xc0503, 0x0, 0x0, 0x0, 0x0, 0x0, 0x0, 0x0, 0x0, 0x0
.long 0x6060a, 0x21408, 0x10503, 0x40503, 0x70503, 0xa0503, 0xd0503, 0x0, 0x0, 0x0, 0x0, 0x0, 0x0, 0x0, 0x0, 0x0
.long 0x7060a, 0x50b, 0x20503, 0x50503, 0x80503, 0xb0503, 0xe0503, 0x0, 0x0, 0x0, 0x0, 0x0, 0x0, 0x0, 0x0, 0x0
.long 0x8060a, 0x150b, 0x603, 0x30603, 0x60603, 0x90603, 0xc0603, 0x0, 0x0, 0x0, 0x0, 0x0, 0x0, 0x0, 0x0, 0x0
.long 0x9060a, 0x250b, 0x20105, 0x605, 0x20a05, 0xf05, 0x21305, 0x0, 0x0, 0x0, 0x0, 0x0, 0x0, 0x0, 0x0, 0x0
.long 0xa060a, 0x350b, 0x30105, 0x10605, 0x30a05, 0x10f05, 0x31305, 0x0, 0x0, 0x0, 0x0, 0x0, 0x0, 0x0, 0x0, 0x0
.long 0xb060a, 0x10508, 0x205, 0x20605, 0xb05, 0x20f05, 0x1405, 0x0, 0x0, 0x0, 0x0, 0x0, 0x0, 0x0, 0x0, 0x0
.long 0xc060a, 0x20508, 0x109, 0x507, 0x0, 0x0, 0x0, 0x0, 0x0, 0x0, 0x0, 0x0, 0x0, 0x0, 0x0, 0x0
.long 0xd060a, 0x11508, 0x109, 0x607, 0x0, 0x0, 0x0, 0x0, 0x0, 0x0, 0x0, 0x0, 0x0, 0x0, 0x0, 0x0
.long 0x70a, 0x21508, 0x109, 0x707, 0x0, 0x0, 0x0, 0x0, 0x0, 0x0, 0x0, 0x0, 0x0, 0x0, 0x0, 0x0
.long 0x1070a, 0x60b, 0x30401, 0x60401, 0x90401, 0xc0401, 0xf0401, 0x11e05, 0x12605, 0x12e05, 0x0, 0x0, 0x0, 0x0, 0x0, 0x0
.long 0x2070a, 0x160b, 0x40401, 0x70401, 0xa0401, 0xd0401, 0x1a05, 0x2205, 0x2a05, 0x0, 0x0, 0x0, 0x0, 0x0, 0x0, 0x0
.long 0x3070a, 0x260b, 0x50401, 0x80401, 0xb0401, 0xe0401, 0x11a05, 0x12205, 0x12a05, 0x0, 0x0, 0x0, 0x0, 0x0, 0x0, 0x0
.long 0x4070a, 0x360b, 0x30501, 0x60501, 0x90501, 0xc0501, 0xf0501, 0x21e05, 0x22605, 0x22e05, 0x0, 0x0, 0x0, 0x0, 0x0, 0x0
.long 0x5070a, 0x10608, 0x40501, 0x70501, 0xa0501, 0xd0501, 0x21a05, 0x22205, 0x22a05, 0x0, 0x0, 0x0, 0x0, 0x0, 0x0, 0x0
.long 0x6070a, 0x20608, 0x50501, 0x80501, 0xb0501, 0xe0501, 0x31a05, 0x32205, 0x32a05, 0x0, 0x0, 0x0, 0x0, 0x0, 0x0, 0x0
.long 0x7070a, 0x11608, 0x30601, 0x60601, 0x90601, 0xc0601, 0xf0601, 0x31e05, 0x32605, 0x32e05, 0x0, 0x0, 0x0, 0x0, 0x0, 0x0
.long 0x8070a, 0x1206, 0x309, 0x30102, 0x30404, 0x70404, 0xb0404, 0xf0404, 0x33405, 0x0, 0x0, 0x0, 0x0, 0x0, 0x0, 0x0
.long 0x9070a, 0xa0c, 0x1306, 0x309, 0x40102, 0x504, 0x40504, 0x80504, 0xc0504, 0x3505, 0x0, 0x0, 0x0, 0x0, 0x0, 0x0
.long 0xa070a, 0x1406, 0x309, 0x50102, 0x10504, 0x50504, 0x90504, 0xd0504, 0x13505, 0x0, 0x0, 0x0, 0x0, 0x0, 0x0, 0x0
.long 0xb070a, 0xb0c, 0x1506, 0x309, 0x60102, 0x20504, 0x60504, 0xa0504, 0xe0504, 0x23505, 0x0, 0x0, 0x0, 0x0, 0x0, 0x0
.long 0xc070a, 0x1606, 0x309, 0x70102, 0x30504, 0x70504, 0xb0504, 0xf0504, 0x33505, 0x0, 0x0, 0x0, 0x0, 0x0, 0x0, 0x0
.long 0xd070a, 0xc0c, 0x1706, 0x309, 0x80102, 0x604, 0x40604, 0x80604, 0xc0604, 0x3605, 0x0, 0x0, 0x0, 0x0, 0x0, 0x0
.long 0x80a, 0x1806, 0x309, 0x90102, 0x10604, 0x50604, 0x90604, 0xd0604, 0x13605, 0x0, 0x0, 0x0, 0x0, 0x0, 0x0, 0x0
.long 0x1080a, 0xd0c, 0x1906, 0x309, 0xa0102, 0x20604, 0x60604, 0xa0604, 0xe0604, 0x23605, 0x0, 0x0, 0x0, 0x0, 0x0, 0x0
.long 0x2080a, 0x1a06, 0x309, 0xb0102, 0x30604, 0x70604, 0xb0604, 0xf0604, 0x33605, 0x0, 0x0, 0x0, 0x0, 0x0, 0x0, 0x0
.long 0x3080a, 0x21608, 0x10603, 0x40603, 0x70603, 0xa0603, 0xd0603, 0x0, 0x0, 0x0, 0x0, 0x0, 0x0, 0x0, 0x0, 0x0
.long 0x4080a, 0x70b, 0x20603, 0x50603, 0x80603, 0xb0603, 0xe0603, 0x0, 0x0, 0x0, 0x0, 0x0, 0x0, 0x0, 0x0, 0x0
.long 0x5080a, 0x170b, 0x703, 0x30703, 0x60703, 0x90703, 0xc0703, 0x0, 0x0, 0x0, 0x0, 0x0, 0x0, 0x0, 0x0, 0x0
.long 0x6080a, 0x270b, 0x10703, 0x40703, 0x70703, 0xa0703, 0xd0703, 0x0, 0x0, 0x0, 0x0, 0x0, 0x0, 0x0, 0x0, 0x0
.long 0x7080a, 0x370b, 0x20703, 0x50703, 0x80703, 0xb0703, 0xe0703, 0x0, 0x0, 0x0, 0x0, 0x0, 0x0, 0x0, 0x0, 0x0
.long 0x8080a, 0x10708, 0x803, 0x30803, 0x60803, 0x90803, 0xc0803, 0x0, 0x0, 0x0, 0x0, 0x0, 0x0, 0x0, 0x0, 0x0
.long 0x9080a, 0x20708, 0x10803, 0x40803, 0x70803, 0xa0803, 0xd0803, 0x0, 0x0, 0x0, 0x0, 0x0, 0x0, 0x0, 0x0, 0x0
.long 0xa080a, 0x11708, 0x20803, 0x50803, 0x80803, 0xb0803, 0xe0803, 0x0, 0x0, 0x0, 0x0, 0x0, 0x0, 0x0, 0x0, 0x0
.long 0xb080a, 0x21708, 0x903, 0x30903, 0x60903, 0x90903, 0xc0903, 0x0, 0x0, 0x0, 0x0, 0x0, 0x0, 0x0, 0x0, 0x0
.long 0xc080a, 0x80b, 0x10205, 0x30605, 0x10b05, 0x30f05, 0x11405, 0x0, 0x0, 0x0, 0x0, 0x0, 0x0, 0x0, 0x0, 0x0
.long 0xd080a, 0x180b, 0x20205, 0x705, 0x20b05, 0x1005, 0x21405, 0x0, 0x0, 0x0, 0x0, 0x0, 0x0, 0x0, 0x0, 0x0
.long 0x90a, 0x280b, 0x30205, 0x10705, 0x30b05, 0x11005, 0x31405, 0x0, 0x0, 0x0, 0x0, 0x0, 0x0, 0x0, 0x0, 0x0
.long 0x1090a, 0x380b, 0x305, 0x20705, 0xc05, 0x21005, 0x1505, 0x0, 0x0, 0x0, 0x0, 0x0, 0x0, 0x0, 0x0, 0x0
.long 0x2090a, 0x10808, 0x109, 0x807, 0x0, 0x0, 0x0, 0x0, 0x0, 0x0, 0x0, 0x0, 0x0, 0x0, 0x0, 0x0
.long 0x3090a, 0x20808, 0x109, 0x907, 0x0, 0x0, 0x0, 0x0, 0x0, 0x0, 0x0, 0x0, 0x0, 0x0, 0x0, 0x0
.long 0x4090a, 0x11808, 0x109, 0xa07, 0x0, 0x0, 0x0, 0x0, 0x0, 0x0, 0x0, 0x0, 0x0, 0x0, 0x0, 0x0
.long 0x5090a, 0x21808, 0x40601, 0x70601, 0xa0601, 0xd0601, 0x1b05, 0x2305, 0x2b05, 0x0, 0x0, 0x0, 0x0, 0x0, 0x0, 0x0
.long 0x6090a, 0x90b, 0x50601, 0x80601, 0xb0601, 0xe0601, 0x11b05, 0x12305, 0x12b05, 0x0, 0x0, 0x0, 0x0, 0x0, 0x0, 0x0
.long 0x7090a, 0x190b, 0x30701, 0x60701, 0x90701, 0xc0701, 0xf0701, 0x1f05, 0x2705, 0x0, 0x0, 0x0, 0x0, 0x0, 0x0, 0x0
.long 0x8090a, 0x290b, 0x40701, 0x70701, 0xa0701, 0xd0701, 0x21b05, 0x22305, 0x22b05, 0x0, 0x0, 0x0, 0x0, 0x0, 0x0, 0x0
.long 0x9090a, 0x390b, 0x50701, 0x80701, 0xb0701, 0xe0701, 0x31b05, 0x32305, 0x32b05, 0x0, 0x0, 0x0, 0x0, 0x0, 0x0, 0x0
.long 0xa090a, 0x10908, 0x30801, 0x60801, 0x90801, 0xc0801, 0xf0801, 0x11f05, 0x12705, 0x0, 0x0, 0x0, 0x0, 0x0, 0x0, 0x0
.long 0xb090a, 0xe0c, 0x1b06, 0x309, 0xc0102, 0x704, 0x40704, 0x80704, 0xc0704, 0x3705, 0x0, 0x0, 0x0, 0x0, 0x0, 0x0
.long 0xc090a, 0x1c06, 0x309, 0xd0102, 0x10704, 0x50704, 0x90704, 0xd0704, 0x13705, 0x0, 0x0, 0x0, 0x0, 0x0, 0x0, 0x0
.long 0xd090a, 0xf0c, 0x1d06, 0x309, 0xe0102, 0x20704, 0x60704, 0xa0704, 0xe0704, 0x23705, 0x0, 0x0, 0x0, 0x0, 0x0, 0x0
.long 0xa0a, 0x1e06, 0x309, 0xf0102, 0x30704, 0x70704, 0xb0704, 0xf0704, 0x33705, 0x0, 0x0, 0x0, 0x0, 0x0, 0x0, 0x0
.long 0x10a0a, 0x100c, 0x1f06, 0x309, 0x202, 0x804, 0x40804, 0x80804, 0xc0804, 0x3805, 0x0, 0x0, 0x0, 0x0, 0x0, 0x0
.long 0x20a0a, 0x2006, 0x309, 0x10202, 0x10804, 0x50804, 0x90804, 0xd0804, 0x13805, 0x0, 0x0, 0x0, 0x0, 0x0, 0x0, 0x0
.long 0x30a0a, 0x110c, 0x2106, 0x309, 0x20202, 0x20804, 0x60804, 0xa0804, 0xe0804, 0x23805, 0x0, 0x0, 0x0, 0x0, 0x0, 0x0
.long 0x40a0a, 0x2206, 0x309, 0x30202, 0x30804, 0x70804, 0xb0804, 0xf0804, 0x33805, 0x0, 0x0, 0x0, 0x0, 0x0, 0x0, 0x0
.long 0x50a0a, 0x120c, 0x2306, 0x309, 0x40202, 0x904, 0x40904, 0x80904, 0xc0904, 0x3905, 0x0, 0x0, 0x0, 0x0, 0x0, 0x0
.long 0x60a0a, 0x2406, 0x309, 0x50202, 0x10904, 0x50904, 0x90904, 0xd0904, 0x13905, 0x0, 0x0, 0x0, 0x0, 0x0, 0x0, 0x0
.long 0x70a0a, 0x20908, 0x10903, 0x40903, 0x70903, 0xa0903, 0xd0903, 0x0, 0x0, 0x0, 0x0, 0x0, 0x0, 0x0, 0x0, 0x0
.long 0x80a0a, 0x11908, 0x20903, 0x50903, 0x80903, 0xb0903, 0xe0903, 0x0, 0x0, 0x0, 0x0, 0x0, 0x0, 0x0, 0x0, 0x0
.long 0x90a0a, 0x21908, 0xa03, 0x30a03, 0x60a03, 0x90a03, 0xc0a03, 0x0, 0x0, 0x0, 0x0, 0x0, 0x0, 0x0, 0x0, 0x0
.long 0xa0a0a, 0xa0b, 0x10a03, 0x40a03, 0x70a03, 0xa0a03, 0xd0a03, 0x0, 0x0, 0x0, 0x0, 0x0, 0x0, 0x0, 0x0, 0x0
.long 0xb0a0a, 0x1a0b, 0x20a03, 0x50a03, 0x80a03, 0xb0a03, 0xe0a03, 0x0, 0x0, 0x0, 0x0, 0x0, 0x0, 0x0, 0x0, 0x0
.long 0xc0a0a, 0x2a0b, 0xb03, 0x30b03, 0x60b03, 0x90b03, 0xc0b03, 0x0, 0x0, 0x0, 0x0, 0x0, 0x0, 0x0, 0x0, 0x0
.long 0xd0a0a, 0x3a0b, 0x10b03, 0x40b03, 0x70b03, 0xa0b03, 0xd0b03, 0x0, 0x0, 0x0, 0x0, 0x0, 0x0, 0x0, 0x0, 0x0
.long 0xb0a, 0x10a08, 0x20b03, 0x50b03, 0x80b03, 0xb0b03, 0xe0b03, 0x0, 0x0, 0x0, 0x0, 0x0, 0x0, 0x0, 0x0, 0x0
.long 0x10b0a, 0x20a08, 0xc03, 0x30c03, 0x60c03, 0x90c03, 0xc0c03, 0x0, 0x0, 0x0, 0x0, 0x0, 0x0, 0x0, 0x0, 0x0
.long 0x20b0a, 0x11a08, 0x10c03, 0x40c03, 0x70c03, 0xa0c03, 0xd0c03, 0x0, 0x0, 0x0, 0x0, 0x0, 0x0, 0x0, 0x0, 0x0
.long 0x30b0a, 0x21a08, 0x10305, 0x30705, 0x10c05, 0x31005, 0x11505, 0x0, 0x0, 0x0, 0x0, 0x0, 0x0, 0x0, 0x0, 0x0
.long 0x40b0a, 0xb0b, 0x20305, 0x805, 0x20c05, 0x1105, 0x21505, 0x0, 0x0, 0x0, 0x0, 0x0, 0x0, 0x0, 0x0, 0x0
.long 0x50b0a, 0x1b0b, 0x30305, 0x10805, 0x30c05, 0x11105, 0x31505, 0x0, 0x0, 0x0, 0x0, 0x0, 0x0, 0x0, 0x0, 0x0
.long 0x60b0a, 0x2b0b, 0x109, 0xb07, 0x0, 0x0, 0x0, 0x0, 0x0, 0x0, 0x0, 0x0, 0x0, 0x0, 0x0, 0x0
.long 0x70b0a, 0x3b0b, 0x109, 0xc07, 0x0, 0x0, 0x0, 0x0, 0x0, 0x0, 0x0, 0x0, 0x0, 0x0, 0x0, 0x0
.long 0x80b0a, 0x10b08, 0x109, 0xd07, 0x0, 0x0, 0x0, 0x0, 0x0, 0x0, 0x0, 0x0, 0x0, 0x0, 0x0, 0x0
.long 0x90b0a, 0x20b08, 0x40801, 0x70801, 0xa0801, 0xd0801, 0x1c05, 0x2405, 0x2c05, 0x0, 0x0, 0x0, 0x0, 0x0, 0x0, 0x0
.long 0xa0b0a, 0x11b08, 0x50801, 0x80801, 0xb0801, 0xe0801, 0x11c05, 0x12405, 0x12c05, 0x0, 0x0, 0x0, 0x0, 0x0, 0x0, 0x0
.long 0xb0b0a, 0x21b08, 0x30901, 0x60901, 0x90901, 0xc0901, 0xf0901, 0x21f05, 0x22705, 0x0, 0x0, 0x0, 0x0, 0x0, 0x0, 0x0
.long 0xc0b0a, 0xc0b, 0x40901, 0x70901, 0xa0901, 0xd0901, 0x21c05, 0x22405, 0x22c05, 0x0, 0x0, 0x0, 0x0, 0x0, 0x0, 0x0
.long 0xd0b0a, 0x1c0b, 0x50901, 0x80901, 0xb0901, 0xe0901, 0x31c05, 0x32405, 0x32c05, 0x0, 0x0, 0x0, 0x0, 0x0, 0x0, 0x0
.long 0xc0a, 0x2c0b, 0x30a01, 0x60a01, 0x90a01, 0xc0a01, 0xf0a01, 0x31f05, 0x32705, 0x0, 0x0, 0x0, 0x0, 0x0, 0x0, 0x0
.long 0x10c0a, 0x3c0b, 0x40a01, 0x70a01, 0xa0a01, 0xd0a01, 0x1d05, 0x2505, 0x2d05, 0x0, 0x0, 0x0, 0x0, 0x0, 0x0, 0x0
.long 0x20c0a, 0x130c, 0x2506, 0x309, 0x60202, 0x20904, 0x60904, 0xa0904, 0xe0904, 0x23905, 0x0, 0x0, 0x0, 0x0, 0x0, 0x0
.long 0x30c0a, 0x2606, 0x309, 0x70202, 0x30904, 0x70904, 0xb0904, 0xf0904, 0x33905, 0x0, 0x0, 0x0, 0x0, 0x0, 0x0, 0x0
.long 0x40c0a, 0x140c, 0x2706, 0x309, 0x80202, 0xa04, 0x40a04, 0x80a04, 0xc0a04, 0x3a05, 0x0, 0x0, 0x0, 0x0, 0x0, 0x0
.long 0x50c0a, 0x2806, 0x309, 0x90202, 0x10a04, 0x50a04, 0x90a04, 0xd0a04, 0x13a05, 0x0, 0x0, 0x0, 0x0, 0x0, 0x0, 0x0
.long 0x60c0a, 0x150c, 0x2906, 0x309, 0xa0202, 0x20a04, 0x60a04, 0xa0a04, 0xe0a04, 0x23a05, 0x0, 0x0, 0x0, 0x0, 0x0, 0x0
.long 0x70c0a, 0x2a06, 0x309, 0xb0202, 0x30a04, 0x70a04, 0xb0a04, 0xf0a04, 0x33a05, 0x0, 0x0, 0x0, 0x0, 0x0, 0x0, 0x0
.long 0x80c0a, 0x160c, 0x2b06, 0x309, 0xc0202, 0xb04, 0x40b04, 0x80b04, 0xc0b04, 0x3b05, 0x0, 0x0, 0x0, 0x0, 0x0, 0x0
.long 0x90c0a, 0x2c06, 0x309, 0xd0202, 0x10b04, 0x50b04, 0x90b04, 0xd0b04, 0x13b05, 0x0, 0x0, 0x0, 0x0, 0x0, 0x0, 0x0
.long 0xa0c0a, 0x170c, 0x2d06, 0x309, 0xe0202, 0x20b04, 0x60b04, 0xa0b04, 0xe0b04, 0x23b05, 0x0, 0x0, 0x0, 0x0, 0x0, 0x0
.long 0xb0c0a, 0x2e06, 0x309, 0xf0202, 0x30b04, 0x70b04, 0xb0b04, 0xf0b04, 0x33b05, 0x0, 0x0, 0x0, 0x0, 0x0, 0x0, 0x0
.long 0xc0c0a, 0x10c08, 0x20c03, 0x50c03, 0x80c03, 0xb0c03, 0xe0c03, 0x0, 0x0, 0x0, 0x0, 0x0, 0x0, 0x0, 0x0, 0x0
.long 0xd0c0a, 0x20c08, 0xd03, 0x30d03, 0x60d03, 0x90d03, 0xc0d03, 0x0, 0x0, 0x0, 0x0, 0x0, 0x0, 0x0, 0x0, 0x0
.long 0xd0a, 0x11c08, 0x10d03, 0x40d03, 0x70d03, 0xa0d03, 0xd0d03, 0x0, 0x0, 0x0, 0x0, 0x0, 0x0, 0x0, 0x0, 0x0
.long 0x10d0a, 0x21c08, 0x20d03, 0x50d03, 0x80d03, 0xb0d03, 0xe0d03, 0x0, 0x0, 0x0, 0x0, 0x0, 0x0, 0x0, 0x0, 0x0
.long 0x20d0a, 0xd0b, 0xe03, 0x30e03, 0x60e03, 0x90e03, 0xc0e03, 0x0, 0x0, 0x0, 0x0, 0x0, 0x0, 0x0, 0x0, 0x0
.long 0x30d0a, 0x1d0b, 0x10e03, 0x40e03, 0x70e03, 0xa0e03, 0xd0e03, 0x0, 0x0, 0x0, 0x0, 0x0, 0x0, 0x0, 0x0, 0x0
.long 0x40d0a, 0x2d0b, 0x20e03, 0x50e03, 0x80e03, 0xb0e03, 0xe0e03, 0x0, 0x0, 0x0, 0x0, 0x0, 0x0, 0x0, 0x0, 0x0
.long 0x50d0a, 0x3d0b, 0xf03, 0x30f03, 0x60f03, 0x90f03, 0xc0f03, 0x0, 0x0, 0x0, 0x0, 0x0, 0x0, 0x0, 0x0, 0x0
.long 0x60d0a, 0x10d08, 0x10f03, 0x40f03, 0x70f03, 0xa0f03, 0xd0f03, 0x0, 0x0, 0x0, 0x0, 0x0, 0x0, 0x0, 0x0, 0x0
.long 0x70d0a, 0x20d08, 0x20f03, 0x50f03, 0x80f03, 0xb0f03, 0xe0f03, 0x0, 0x0, 0x0, 0x0, 0x0, 0x0, 0x0, 0x0, 0x0
.long 0x80d0a, 0x11d08, 0x405, 0x20805, 0xd05, 0x21105, 0x1605, 0x0, 0x0, 0x0, 0x0, 0x0, 0x0, 0x0, 0x0, 0x0
.long 0x90d0a, 0x21d08, 0x10405, 0x30805, 0x10d05, 0x31105, 0x11605, 0x0, 0x0, 0x0, 0x0, 0x0, 0x0, 0x0, 0x0, 0x0
.long 0xa0d0a, 0xe0b, 0x50a01, 0x80a01, 0xb0a01, 0xe0a01, 0xf1003, 0x0, 0x0, 0x0, 0x0, 0x0, 0x0, 0x0, 0x0, 0x0
.long 0xb0d0a, 0x1e0b, 0x30b01, 0x60b01, 0x90b01, 0xc0b01, 0xf0b01, 0xf1103, 0x0, 0x0, 0x0, 0x0, 0x0, 0x0, 0x0, 0x0
.long 0xc0d0a, 0x2e0b, 0x40b01, 0x70b01, 0xa0b01, 0xd0b01, 0xf1203, 0x0, 0x0, 0x0, 0x0, 0x0, 0x0, 0x0, 0x0, 0x0
.long 0xd0d0a, 0x3e0b, 0x50b01, 0x80b01, 0xb0b01, 0xe0b01, 0xf1303, 0x0, 0x0, 0x0, 0x0, 0x0, 0x0, 0x0, 0x0, 0x0
.long 0xe0a, 0x10e08, 0x30c01, 0x60c01, 0x90c01, 0xc0c01, 0xf0c01, 0xf1403, 0x0, 0x0, 0x0, 0x0, 0x0, 0x0, 0x0, 0x0
.long 0x10e0a, 0x20e08, 0x40c01, 0x70c01, 0xa0c01, 0xd0c01, 0xf1503, 0x0, 0x0, 0x0, 0x0, 0x0, 0x0, 0x0, 0x0, 0x0
.long 0x20e0a, 0x11e08, 0x50c01, 0x80c01, 0xb0c01, 0xe0c01, 0xf1603, 0x0, 0x0, 0x0, 0x0, 0x0, 0x0, 0x0, 0x0, 0x0
.long 0x30e0a, 0x21e08, 0x30d01, 0x60d01, 0x90d01, 0xc0d01, 0xf0d01, 0xf1703, 0x0, 0x0, 0x0, 0x0, 0x0, 0x0, 0x0, 0x0
.long 0x40e0a, 0xf0b, 0x40d01, 0x70d01, 0xa0d01, 0xd0d01, 0xf1803, 0x0, 0x0, 0x0, 0x0, 0x0, 0x0, 0x0, 0x0, 0x0
.long 0x50e0a, 0x1f0b, 0x50d01, 0x80d01, 0xb0d01, 0xe0d01, 0xf1903, 0x0, 0x0, 0x0, 0x0, 0x0, 0x0, 0x0, 0x0, 0x0
.long 0x60e0a, 0x2f0b, 0x30e01, 0x60e01, 0x90e01, 0xc0e01, 0xf0e01, 0xf1a03, 0x0, 0x0, 0x0, 0x0, 0x0, 0x0, 0x0, 0x0
.long 0x70e0a, 0x3f0b, 0x40e01, 0x70e01, 0xa0e01, 0xd0e01, 0xf1b03, 0x0, 0x0, 0x0, 0x0, 0x0, 0x0, 0x0, 0x0, 0x0
.long 0x80e0a, 0x10f08, 0x50e01, 0x80e01, 0xb0e01, 0xe0e01, 0xf1c03, 0x0, 0x0, 0x0, 0x0, 0x0, 0x0, 0x0, 0x0, 0x0
.long 0x90e0a, 0x20f08, 0x30f01, 0x60f01, 0x90f01, 0xc0f01, 0xf0f01, 0xf1d03, 0x0, 0x0, 0x0, 0x0, 0x0, 0x0, 0x0, 0x0
.long 0xa0e0a, 0x11f08, 0x40f01, 0x70f01, 0xa0f01, 0xd0f01, 0xf1e03, 0x0, 0x0, 0x0, 0x0, 0x0, 0x0, 0x0, 0x0, 0x0
.long 0xb0e0a, 0x21f08, 0x50f01, 0x80f01, 0xb0f01, 0xe0f01, 0xf1f03, 0x0, 0x0, 0x0, 0x0, 0x0, 0x0, 0x0, 0x0, 0x0
.long 0xc0e0a, 0x180c, 0x2f06, 0x309, 0x302, 0xc04, 0x40c04, 0x80c04, 0xc0c04, 0x3c05, 0x0, 0x0, 0x0, 0x0, 0x0, 0x0
.long 0xd0e0a, 0x3006, 0x309, 0x10302, 0x10c04, 0x50c04, 0x90c04, 0xd0c04, 0x13c05, 0x0, 0x0, 0x0, 0x0, 0x0, 0x0, 0x0
.long 0xf0a, 0x190c, 0x3106, 0x309, 0x20302, 0x20c04, 0x60c04, 0xa0c04, 0xe0c04, 0x23c05, 0x0, 0x0, 0x0, 0x0, 0x0, 0x0
.long 0x10f0a, 0x3206, 0x309, 0x30302, 0x30c04, 0x70c04, 0xb0c04, 0xf0c04, 0x33c05, 0x0, 0x0, 0x0, 0x0, 0x0, 0x0, 0x0
.long 0x20f0a, 0x1a0c, 0x3306, 0x309, 0x40302, 0xd04, 0x40d04, 0x80d04, 0xc0d04, 0x3d05, 0x0, 0x0, 0x0, 0x0, 0x0, 0x0
.long 0x30f0a, 0x3406, 0x309, 0x50302, 0x10d04, 0x50d04, 0x90d04, 0xd0d04, 0x13d05, 0x0, 0x0, 0x0, 0x0, 0x0, 0x0, 0x0
.long 0x40f0a, 0x1b0c, 0x3506, 0x309, 0x60302, 0x20d04, 0x60d04, 0xa0d04, 0xe0d04, 0x23d05, 0x0, 0x0, 0x0, 0x0, 0x0, 0x0
.long 0x50f0a, 0x3606, 0x309, 0x70302, 0x30d04, 0x70d04, 0xb0d04, 0xf0d04, 0x33d05, 0x0, 0x0, 0x0, 0x0, 0x0, 0x0, 0x0
.long 0x60f0a, 0x1c0c, 0x3706, 0x309, 0x80302, 0xe04, 0x40e04, 0x80e04, 0xc0e04, 0x3e05, 0x0, 0x0, 0x0, 0x0, 0x0, 0x0
.long 0x70f0a, 0x3806, 0x309, 0x90302, 0x10e04, 0x50e04, 0x90e04, 0xd0e04, 0x13e05, 0x0, 0x0, 0x0, 0x0, 0x0, 0x0, 0x0
.long 0x80f0a, 0x1d0c, 0x3906, 0x309, 0xa0302, 0x20e04, 0x60e04, 0xa0e04, 0xe0e04, 0x23e05, 0x0, 0x0, 0x0, 0x0, 0x0, 0x0
.long 0x90f0a, 0x3a06, 0x309, 0xb0302, 0x30e04, 0x70e04, 0xb0e04, 0xf0e04, 0x33e05, 0x0, 0x0, 0x0, 0x0, 0x0, 0x0, 0x0
.long 0xa0f0a, 0x1e0c, 0x3b06, 0x309, 0xc0302, 0xf04, 0x40f04, 0x80f04, 0xc0f04, 0x32f05, 0x3f05, 0x0, 0x0, 0x0, 0x0, 0x0
.long 0xb0f0a, 0x3c06, 0x309, 0xd0302, 0x10f04, 0x50f04, 0x90f04, 0xd0f04, 0x22f05, 0x13f05, 0x0, 0x0, 0x0, 0x0, 0x0, 0x0
.long 0xc0f0a, 0x1f0c, 0x3d06, 0x309, 0xe0302, 0x20f04, 0x60f04, 0xa0f04, 0xe0f04, 0x12f05, 0x23f05, 0x0, 0x0, 0x0, 0x0, 0x0
.long 0xd0f0a, 0x309, 0xf0302, 0x30f04, 0x70f04, 0xb0f04, 0xf0f04, 0x2f05, 0x33f05, 0x0, 0x0, 0x0, 0x0, 0x0, 0x0, 0x0
job_table_end:
.size job_table, .-job_table
.section .rodata,"a"
.p2align 6
.amdhsa_kernel gated_mix__softmax_full_mha__memory_aug_recurrent_mem_tr__prompt_kernel
  .amdhsa_next_free_vgpr 512
  .amdhsa_next_free_sgpr 102
  .amdhsa_accum_offset 256
  .amdhsa_group_segment_fixed_size 0
  .amdhsa_kernarg_size 112
  .amdhsa_user_sgpr_count 2
  .amdhsa_user_sgpr_kernarg_segment_ptr 1
  .amdhsa_system_sgpr_workgroup_id_x 1
.end_amdhsa_kernel
```
